```python
import torch

def _softmax(x, axis=-1):
    return torch.softmax(x, dim=axis)

def _gelu(x):
    return torch.nn.functional.gelu(x, approximate='tanh')

def _silu(x):
    return torch.nn.functional.silu(x)

def _sigmoid(x):
    return torch.sigmoid(x)

def _layernorm(x, axis=-1, eps=1e-05):
    m = x.mean(dim=axis, keepdim=True)
    v = x.var(dim=axis, keepdim=True, unbiased=False)
    return (x - m) / torch.sqrt(v + eps)

def _scatter_add(tgt, idx, src, axis=0):
    return tgt.clone().index_add_(axis, idx, src)

def _segment_sum(src, seg, n):
    out = torch.zeros((n,) + src.shape[1:], dtype=src.dtype)
    return out.index_add_(0, seg, src)

def _pad(x, pw):
    flat = tuple((v for pair in reversed(pw) for v in pair))
    return torch.nn.functional.pad(x, flat)
kernel_name = 'parallel_sum__memory_aug_recurrent_mem_tr__glu_gated_bilinear__prompt'

def setup_inputs():

    _w = lambda a: (lambda t: t.to(torch.bfloat16) if t.is_floating_point() else t)(torch.as_tensor(a))

    def _A_setup():
        B, S, Dm = (1, 2048, 448)
        H, Dh = (16, 256)
        M, seg = (8, 32)
        seg = min(seg, S)
        S = S // seg * seg
        return {'x': _w((lambda *s: torch.randn(*s, dtype=torch.bfloat16) * 0.05)(B, S, Dm)), 'mem0': _w((lambda *s: torch.randn(*s, dtype=torch.bfloat16) * 0.2)(B, M, Dm)), 'Wq': _w((lambda *s: torch.randn(*s, dtype=torch.bfloat16) * 1.6)(Dm, H, Dh) * Dm ** (-0.5)), 'Wk': _w((lambda *s: torch.randn(*s, dtype=torch.bfloat16) * 1.6)(Dm, H, Dh) * Dm ** (-0.5)), 'Wv': _w((lambda *s: torch.randn(*s, dtype=torch.bfloat16) * 0.2)(Dm, H, Dh) * Dm ** (-0.5)), 'Wo': _w((lambda *s: torch.randn(*s, dtype=torch.bfloat16) * 0.2)(H, Dh, Dm) * (H * Dh) ** (-0.5)), 'seg_len': seg}
    _A_in = _A_setup()

    def _B_setup():
        B, S, D, F = (1, 2048, 448, 1792)
        return {'x': _w((lambda *s: torch.randn(*s, dtype=torch.bfloat16) * 0.05)(B, S, D)), 'w_gate': _w((lambda *s: torch.randn(*s, dtype=torch.bfloat16) * 0.2)(D, F) * D ** (-0.5)), 'w_up': _w((lambda *s: torch.randn(*s, dtype=torch.bfloat16) * 0.2)(D, F) * D ** (-0.5)), 'w_down': _w((lambda *s: torch.randn(*s, dtype=torch.bfloat16) * 0.2)(F, D) * F ** (-0.5))}
    _B_in = _B_setup()
    return {'A_x': _A_in['x'], 'A_mem0': _A_in['mem0'], 'A_Wq': _A_in['Wq'], 'A_Wk': _A_in['Wk'], 'A_Wv': _A_in['Wv'], 'A_Wo': _A_in['Wo'], 'A_seg_len': _A_in['seg_len'], 'B_x': _B_in['x'], 'B_w_gate': _B_in['w_gate'], 'B_w_up': _B_in['w_up'], 'B_w_down': _B_in['w_down']}

def reference(A_x, A_mem0, A_Wq, A_Wk, A_Wv, A_Wo, A_seg_len, B_x, B_w_gate, B_w_up, B_w_down):

    def _A_ref(x, mem0, Wq, Wk, Wv, Wo, seg_len):
        B, S, Dm = x.shape
        H, Dh = (Wq.shape[1], Wq.shape[2])
        M = mem0.shape[1]
        scale = Dh ** (-0.5)
        n_seg = S // seg_len
        L = M + seg_len
        idx = torch.arange(L)
        mask = (idx[:, None] < M) | (idx[:, None] >= idx[None, :])
        mem = mem0
        outs = []
        for s in range(n_seg):
            xs = x[:, s * seg_len:(s + 1) * seg_len, :].clone()
            h = torch.concatenate([mem, xs], axis=1)
            q = torch.einsum('btd,dhe->bhte', h, Wq)
            k = torch.einsum('btd,dhe->bhte', h, Wk)
            v = torch.einsum('btd,dhe->bhte', h, Wv)
            scores = torch.einsum('bhqe,bhke->bhqk', q, k) * scale
            scores = torch.where(mask[None, None], scores, -1000000000.0)
            p = _softmax(scores, axis=-1)
            o = torch.einsum('bhqk,bhke->bhqe', p, v)
            o = torch.einsum('bhte,hed->btd', o, Wo)
            mem = o[:, :M, :].clone()
            outs.append(o[:, M:, :])
        return torch.concatenate(outs, axis=1)

    def _B_ref(x, w_gate, w_up, w_down):
        g = torch.einsum('bsd,df->bsf', x, w_gate)
        u = torch.einsum('bsd,df->bsf', x, w_up)
        h = g * u
        return torch.einsum('bsf,fd->bsd', h, w_down)
    x = A_x
    xn = _layernorm(x, axis=-1)
    return x + _A_ref(xn, A_mem0, A_Wq, A_Wk, A_Wv, A_Wo, A_seg_len) + _B_ref(xn, B_w_gate, B_w_up, B_w_down)
```

```asm
; @launch grid=(256,1,1) block=(256,1,1) lds=151552
.amdgcn_target "amdgcn-amd-amdhsa--gfx950"
.text
.globl parallel_sum__memory_aug_recurrent_mem_tr__glu_gated_bilinear__prompt_kernel
.p2align 8
.type parallel_sum__memory_aug_recurrent_mem_tr__glu_gated_bilinear__prompt_kernel,@function
parallel_sum__memory_aug_recurrent_mem_tr__glu_gated_bilinear__prompt_kernel:
    s_cmp_ge_u32 s2, 256
    s_cbranch_scc1 L_bail
    s_load_dwordx4 s[4:7], s[0:1], 96
    s_load_dwordx16 s[80:95], s[0:1], 0
    s_load_dwordx8 s[16:23], s[0:1], 64
    s_memrealtime s[98:99]
    v_lshrrev_b32 v1, 6, v0
    s_nop 0
    v_readfirstlane_b32 s13, v1
    s_mov_b32 s33, 0
    s_getreg_b32 s12, hwreg(HW_REG_XCC_ID)
    s_and_b32 s12, s12, 15
    v_mov_b32 v28, 151296
    v_mov_b32 v31, 0
    v_mov_b32 v29, 32
    s_add_u32 s75, s12, 6
    s_mul_hi_u32 s38, s75, 0x24924925
    s_mul_i32 s38, s38, 7
    s_sub_u32 s77, s75, s38
    s_mov_b32 s78, 7
    v_and_b32 v1, 63, v0
    v_lshlrev_b32 v2, 4, v1
    v_and_b32 v3, 0x33, v1
    v_bfe_u32 v4, v1, 2, 1
    v_lshl_add_u32 v3, v4, 3, v3
    v_bfe_u32 v4, v1, 3, 1
    v_lshl_add_u32 v3, v4, 2, v3
    v_lshlrev_b32 v3, 4, v3
    s_waitcnt lgkmcnt(0)
    s_mov_b32 s8, s6
    s_and_b32 s9, s7, 0xffff
    s_mov_b32 s10, 268435456
    s_mov_b32 s11, 0x20000
    s_mov_b32 s56, s80
    s_and_b32 s57, s81, 0xffff
    s_mov_b32 s58, 1835008
    s_mov_b32 s59, 0x20000
    s_mov_b32 s60, s22
    s_and_b32 s61, s23, 0xffff
    s_mov_b32 s62, 1835008
    s_mov_b32 s63, 0x20000
    s_mov_b64 s[34:35], s[16:17]
    s_mov_b64 s[36:37], s[18:19]
    s_mov_b64 s[64:65], s[20:21]
    s_mov_b64 s[66:67], s[82:83]
    s_cmp_lg_u32 s13, 0
    s_cbranch_scc1 E_1
    s_mov_b64 exec, 1
    s_or_b32 s98, s98, 1
    v_mov_b32 v240, s98
    v_mov_b32 v241, s99
    v_mov_b32 v242, 0
    v_mov_b32 v243, 0
    global_atomic_cmpswap_x2 v[244:245], v31, v[240:243], s[4:5] offset:16 sc0
    v_mov_b32 v246, 64
    s_cmp_eq_u32 s12, 0
    s_cbranch_scc0 E_0
    v_mov_b32 v246, 1
    global_atomic_add v246, v31, v246, s[4:5] sc0
E_0:
    s_mov_b64 exec, -1
E_1:
    v_lshrrev_b32 v21, 5, v1
    v_and_b32 v22, 31, v1
    v_mul_u32_u24 v20, 896, v21
    v_lshl_add_u32 v20, v22, 4, v20
    v_mov_b32 v23, 0x40000000
    v_cmp_gt_u32 vcc, 28, v22
    s_nop 1
    v_cndmask_b32 v20, v23, v20, vcc
    s_lshl_b32 s50, s2, 2
    s_add_u32 s50, s50, s13
    s_mul_i32 s79, s50, 1792
    buffer_load_dwordx4 v[208:211], v20, s[56:59], s79 offen
    buffer_load_dwordx4 v[212:215], v20, s[56:59], s79 offen offset:448
    s_and_b32 s50, s2, 7
    s_lshl_b32 s50, s50, 2
    s_bfe_u32 s51, s2, 0x20003
    s_add_u32 s50, s50, s51
    s_lshr_b32 s51, s2, 5
    s_lshl_b32 s69, s50, 3
    s_add_u32 s3, s69, s51
    s_and_b32 s53, s50, 15
    s_and_b32 s54, s51, 3
    s_lshr_b32 s55, s51, 2
    s_cmp_ge_u32 s50, 16
    s_cbranch_scc1 E_B
    s_mov_b32 s68, s84
    s_and_b32 s69, s85, 0xffff
    s_mov_b32 s70, 3670016
    s_mov_b32 s71, 0x20000
    s_mov_b32 s72, s86
    s_and_b32 s73, s87, 0xffff
    s_mov_b32 s74, 3670016
    s_mov_b32 s75, 0x20000
    v_lshrrev_b32 v8, 3, v1
    v_and_b32 v9, 7, v1
    v_lshrrev_b32 v10, 1, v8
    v_xor_b32 v9, v9, v10
    v_lshlrev_b32 v8, 13, v8
    v_lshl_add_u32 v5, v9, 4, v8
    v_xor_b32 v6, 64, v5
    s_lshl_b32 s44, s54, 2
    s_add_u32 s44, s44, s13
    s_min_u32 s50, s44, 13
    s_lshl_b32 s45, s50, 18
    s_lshl_b32 s51, s53, 9
    s_add_u32 s45, s45, s51
    s_lshl_b32 s46, s13, 12
    v_lshrrev_b32 v8, 4, v3
    v_and_b32 v8, 31, v8
    v_bfe_u32 v9, v8, 1, 3
    v_lshrrev_b32 v10, 5, v1
    v_xor_b32 v9, v9, v10
    v_lshlrev_b32 v9, 4, v9
    v_lshl_add_u32 v9, v8, 7, v9
    v_xor_b32 v12, 0, v9
    v_xor_b32 v13, 32, v9
    v_xor_b32 v14, 64, v9
    v_xor_b32 v15, 96, v9
    v_add_u32 v12, s46, v12
    v_add_u32 v13, s46, v13
    v_add_u32 v14, s46, v14
    v_add_u32 v15, s46, v15
    v_and_b32 v8, 31, v1
    v_bfe_u32 v9, v8, 1, 3
    v_lshrrev_b32 v10, 5, v1
    v_xor_b32 v9, v9, v10
    v_lshlrev_b32 v9, 4, v9
    v_lshl_add_u32 v9, v8, 7, v9
    v_xor_b32 v16, 0, v9
    v_xor_b32 v17, 32, v9
    v_xor_b32 v18, 64, v9
    v_xor_b32 v19, 96, v9
    s_mul_i32 s47, s55, 1835008
    s_add_u32 s47, s47, s51
    s_lshl_b32 s50, s13, 16
    s_add_u32 s47, s47, s50
    s_and_b32 s50, s13, 1
    s_lshl_b32 s50, s50, 6
    v_xor_b32 v7, s50, v5
    v_mov_b32 v24, v2
    s_lshl_b32 s48, s13, 10
    s_add_u32 s50, s46, 0
    s_mov_b32 m0, s50
    s_add_u32 s51, s45, 0
    buffer_load_dwordx4 v5, s[68:71], s51 offen lds
    s_add_u32 s50, s46, 1024
    s_mov_b32 m0, s50
    s_add_u32 s51, s45, 65536
    buffer_load_dwordx4 v6, s[68:71], s51 offen lds
    s_add_u32 s50, s46, 2048
    s_mov_b32 m0, s50
    s_add_u32 s51, s45, 131072
    buffer_load_dwordx4 v5, s[68:71], s51 offen lds
    s_add_u32 s50, s46, 3072
    s_mov_b32 m0, s50
    s_add_u32 s51, s45, 196608
    buffer_load_dwordx4 v6, s[68:71], s51 offen lds
    s_add_u32 s50, s48, 16384
    s_mov_b32 m0, s50
    s_add_u32 s51, s47, 0
    buffer_load_dwordx4 v7, s[72:75], s51 offen lds
    s_add_u32 s50, s48, 20480
    s_mov_b32 m0, s50
    s_add_u32 s51, s47, 262144
    buffer_load_dwordx4 v7, s[72:75], s51 offen lds
    s_add_u32 s50, s48, 24576
    s_mov_b32 m0, s50
    s_add_u32 s51, s47, 524288
    buffer_load_dwordx4 v7, s[72:75], s51 offen lds
    s_add_u32 s50, s48, 28672
    s_mov_b32 m0, s50
    s_add_u32 s51, s47, 786432
    buffer_load_dwordx4 v7, s[72:75], s51 offen lds
    s_add_u32 s50, s48, 32768
    s_mov_b32 m0, s50
    s_add_u32 s51, s47, 1048576
    buffer_load_dwordx4 v7, s[72:75], s51 offen lds
    s_add_u32 s50, s48, 36864
    s_mov_b32 m0, s50
    s_add_u32 s51, s47, 1310720
    buffer_load_dwordx4 v7, s[72:75], s51 offen lds
    s_add_u32 s50, s48, 40960
    s_mov_b32 m0, s50
    s_add_u32 s51, s47, 1572864
    buffer_load_dwordx4 v7, s[72:75], s51 offen lds
    s_add_u32 s50, s46, 45056
    s_mov_b32 m0, s50
    s_add_u32 s51, s45, 128
    buffer_load_dwordx4 v5, s[68:71], s51 offen lds
    s_add_u32 s50, s46, 46080
    s_mov_b32 m0, s50
    s_add_u32 s51, s45, 65664
    buffer_load_dwordx4 v6, s[68:71], s51 offen lds
    s_add_u32 s50, s46, 47104
    s_mov_b32 m0, s50
    s_add_u32 s51, s45, 131200
    buffer_load_dwordx4 v5, s[68:71], s51 offen lds
    s_add_u32 s50, s46, 48128
    s_mov_b32 m0, s50
    s_add_u32 s51, s45, 196736
    buffer_load_dwordx4 v6, s[68:71], s51 offen lds
    s_add_u32 s50, s48, 61440
    s_mov_b32 m0, s50
    s_add_u32 s51, s47, 128
    buffer_load_dwordx4 v7, s[72:75], s51 offen lds
    s_add_u32 s50, s48, 65536
    s_mov_b32 m0, s50
    s_add_u32 s51, s47, 262272
    buffer_load_dwordx4 v7, s[72:75], s51 offen lds
    s_add_u32 s50, s48, 69632
    s_mov_b32 m0, s50
    s_add_u32 s51, s47, 524416
    buffer_load_dwordx4 v7, s[72:75], s51 offen lds
    s_add_u32 s50, s48, 73728
    s_mov_b32 m0, s50
    s_add_u32 s51, s47, 786560
    buffer_load_dwordx4 v7, s[72:75], s51 offen lds
    s_add_u32 s50, s48, 77824
    s_mov_b32 m0, s50
    s_add_u32 s51, s47, 1048704
    buffer_load_dwordx4 v7, s[72:75], s51 offen lds
    s_add_u32 s50, s48, 81920
    s_mov_b32 m0, s50
    s_add_u32 s51, s47, 1310848
    buffer_load_dwordx4 v7, s[72:75], s51 offen lds
    s_add_u32 s50, s48, 86016
    s_mov_b32 m0, s50
    s_add_u32 s51, s47, 1572992
    buffer_load_dwordx4 v7, s[72:75], s51 offen lds
    s_waitcnt vmcnt(22)
    v_lshlrev_b32 v216, 16, v208
    v_and_b32 v217, 0xffff0000, v208
    v_lshlrev_b32 v218, 16, v209
    v_and_b32 v219, 0xffff0000, v209
    v_lshlrev_b32 v220, 16, v210
    v_and_b32 v221, 0xffff0000, v210
    v_lshlrev_b32 v222, 16, v211
    v_and_b32 v223, 0xffff0000, v211
    v_lshlrev_b32 v224, 16, v212
    v_and_b32 v225, 0xffff0000, v212
    v_lshlrev_b32 v226, 16, v213
    v_and_b32 v227, 0xffff0000, v213
    v_lshlrev_b32 v228, 16, v214
    v_and_b32 v229, 0xffff0000, v214
    v_lshlrev_b32 v230, 16, v215
    v_and_b32 v231, 0xffff0000, v215
    v_add_f32 v233, v216, v217
    v_add_f32 v233, v233, v218
    v_add_f32 v233, v233, v219
    v_add_f32 v233, v233, v220
    v_add_f32 v233, v233, v221
    v_add_f32 v233, v233, v222
    v_add_f32 v233, v233, v223
    v_add_f32 v233, v233, v224
    v_add_f32 v233, v233, v225
    v_add_f32 v233, v233, v226
    v_add_f32 v233, v233, v227
    v_add_f32 v233, v233, v228
    v_add_f32 v233, v233, v229
    v_add_f32 v233, v233, v230
    v_add_f32 v233, v233, v231
    s_nop 1
    v_add_f32_dpp v233, v233, v233 quad_perm:[1,0,3,2] row_mask:0xf bank_mask:0xf
    s_nop 1
    v_add_f32_dpp v233, v233, v233 quad_perm:[2,3,0,1] row_mask:0xf bank_mask:0xf
    s_nop 1
    v_add_f32_dpp v233, v233, v233 row_half_mirror row_mask:0xf bank_mask:0xf
    s_nop 1
    v_add_f32_dpp v233, v233, v233 row_mirror row_mask:0xf bank_mask:0xf
    v_mov_b32 v236, v233
    s_nop 1
    v_permlane16_swap_b32 v233, v236
    v_add_f32 v233, v233, v236
    v_mul_f32 v233, 0x3b124925, v233
    v_mov_b32 v234, 0
    v_sub_f32 v232, v216, v233
    v_fmac_f32 v234, v232, v232
    v_sub_f32 v232, v217, v233
    v_fmac_f32 v234, v232, v232
    v_sub_f32 v232, v218, v233
    v_fmac_f32 v234, v232, v232
    v_sub_f32 v232, v219, v233
    v_fmac_f32 v234, v232, v232
    v_sub_f32 v232, v220, v233
    v_fmac_f32 v234, v232, v232
    v_sub_f32 v232, v221, v233
    v_fmac_f32 v234, v232, v232
    v_sub_f32 v232, v222, v233
    v_fmac_f32 v234, v232, v232
    v_sub_f32 v232, v223, v233
    v_fmac_f32 v234, v232, v232
    v_sub_f32 v232, v224, v233
    v_fmac_f32 v234, v232, v232
    v_sub_f32 v232, v225, v233
    v_fmac_f32 v234, v232, v232
    v_sub_f32 v232, v226, v233
    v_fmac_f32 v234, v232, v232
    v_sub_f32 v232, v227, v233
    v_fmac_f32 v234, v232, v232
    v_sub_f32 v232, v228, v233
    v_fmac_f32 v234, v232, v232
    v_sub_f32 v232, v229, v233
    v_fmac_f32 v234, v232, v232
    v_sub_f32 v232, v230, v233
    v_fmac_f32 v234, v232, v232
    v_sub_f32 v232, v231, v233
    v_fmac_f32 v234, v232, v232
    v_and_b32 v232, 31, v1
    v_cmp_gt_u32 vcc, 28, v232
    s_nop 1
    v_cndmask_b32 v234, 0, v234, vcc
    s_nop 1
    v_add_f32_dpp v234, v234, v234 quad_perm:[1,0,3,2] row_mask:0xf bank_mask:0xf
    s_nop 1
    v_add_f32_dpp v234, v234, v234 quad_perm:[2,3,0,1] row_mask:0xf bank_mask:0xf
    s_nop 1
    v_add_f32_dpp v234, v234, v234 row_half_mirror row_mask:0xf bank_mask:0xf
    s_nop 1
    v_add_f32_dpp v234, v234, v234 row_mirror row_mask:0xf bank_mask:0xf
    v_mov_b32 v236, v234
    s_nop 1
    v_permlane16_swap_b32 v234, v236
    v_add_f32 v234, v234, v236
    v_mul_f32 v234, 0x3b124925, v234
    v_cvt_pk_bf16_f32 v233, v233, v233
    v_lshlrev_b32 v233, 16, v233
    v_cvt_pk_bf16_f32 v234, v234, v234
    v_lshlrev_b32 v234, 16, v234
    v_add_f32 v234, 0x3727c5ac, v234
    v_cvt_pk_bf16_f32 v234, v234, v234
    v_lshlrev_b32 v234, 16, v234
    v_sqrt_f32 v234, v234
    s_nop 0
    v_cvt_pk_bf16_f32 v234, v234, v234
    v_lshlrev_b32 v234, 16, v234
    v_rcp_f32 v234, v234
    v_sub_f32 v216, v216, v233
    v_sub_f32 v217, v217, v233
    v_cvt_pk_bf16_f32 v236, v216, v217
    v_lshlrev_b32 v216, 16, v236
    v_and_b32 v217, 0xffff0000, v236
    v_mul_f32 v216, v216, v234
    v_mul_f32 v217, v217, v234
    v_cvt_pk_bf16_f32 v208, v216, v217
    v_sub_f32 v218, v218, v233
    v_sub_f32 v219, v219, v233
    v_cvt_pk_bf16_f32 v236, v218, v219
    v_lshlrev_b32 v218, 16, v236
    v_and_b32 v219, 0xffff0000, v236
    v_mul_f32 v218, v218, v234
    v_mul_f32 v219, v219, v234
    v_cvt_pk_bf16_f32 v209, v218, v219
    v_sub_f32 v220, v220, v233
    v_sub_f32 v221, v221, v233
    v_cvt_pk_bf16_f32 v236, v220, v221
    v_lshlrev_b32 v220, 16, v236
    v_and_b32 v221, 0xffff0000, v236
    v_mul_f32 v220, v220, v234
    v_mul_f32 v221, v221, v234
    v_cvt_pk_bf16_f32 v210, v220, v221
    v_sub_f32 v222, v222, v233
    v_sub_f32 v223, v223, v233
    v_cvt_pk_bf16_f32 v236, v222, v223
    v_lshlrev_b32 v222, 16, v236
    v_and_b32 v223, 0xffff0000, v236
    v_mul_f32 v222, v222, v234
    v_mul_f32 v223, v223, v234
    v_cvt_pk_bf16_f32 v211, v222, v223
    v_sub_f32 v224, v224, v233
    v_sub_f32 v225, v225, v233
    v_cvt_pk_bf16_f32 v236, v224, v225
    v_lshlrev_b32 v224, 16, v236
    v_and_b32 v225, 0xffff0000, v236
    v_mul_f32 v224, v224, v234
    v_mul_f32 v225, v225, v234
    v_cvt_pk_bf16_f32 v212, v224, v225
    v_sub_f32 v226, v226, v233
    v_sub_f32 v227, v227, v233
    v_cvt_pk_bf16_f32 v236, v226, v227
    v_lshlrev_b32 v226, 16, v236
    v_and_b32 v227, 0xffff0000, v236
    v_mul_f32 v226, v226, v234
    v_mul_f32 v227, v227, v234
    v_cvt_pk_bf16_f32 v213, v226, v227
    v_sub_f32 v228, v228, v233
    v_sub_f32 v229, v229, v233
    v_cvt_pk_bf16_f32 v236, v228, v229
    v_lshlrev_b32 v228, 16, v236
    v_and_b32 v229, 0xffff0000, v236
    v_mul_f32 v228, v228, v234
    v_mul_f32 v229, v229, v234
    v_cvt_pk_bf16_f32 v214, v228, v229
    v_sub_f32 v230, v230, v233
    v_sub_f32 v231, v231, v233
    v_cvt_pk_bf16_f32 v236, v230, v231
    v_lshlrev_b32 v230, 16, v236
    v_and_b32 v231, 0xffff0000, v236
    v_mul_f32 v230, v230, v234
    v_mul_f32 v231, v231, v234
    v_cvt_pk_bf16_f32 v215, v230, v231
    v_lshlrev_b32 v235, 9, v232
    v_lshrrev_b32 v236, 5, v1
    v_lshl_add_u32 v235, v236, 4, v235
    v_mov_b32 v236, 0x40000000
    v_cndmask_b32 v235, v236, v235, vcc
    s_lshr_b32 s50, s2, 2
    s_mul_i32 s50, s50, 28672
    s_and_b32 s51, s2, 3
    s_lshl_b32 s51, s51, 2
    s_add_u32 s51, s51, s13
    s_lshl_b32 s51, s51, 5
    s_add_u32 s50, s50, s51
    s_add_u32 s79, s50, 0
    v_mov_b32 v32, 0
    v_mov_b32 v33, 0
    v_mov_b32 v34, 0
    v_mov_b32 v35, 0
    v_mov_b32 v36, 0
    v_mov_b32 v37, 0
    v_mov_b32 v38, 0
    v_mov_b32 v39, 0
    v_mov_b32 v40, 0
    v_mov_b32 v41, 0
    v_mov_b32 v42, 0
    v_mov_b32 v43, 0
    v_mov_b32 v44, 0
    v_mov_b32 v45, 0
    v_mov_b32 v46, 0
    v_mov_b32 v47, 0
    v_mov_b32 v48, 0
    v_mov_b32 v49, 0
    v_mov_b32 v50, 0
    v_mov_b32 v51, 0
    v_mov_b32 v52, 0
    v_mov_b32 v53, 0
    v_mov_b32 v54, 0
    v_mov_b32 v55, 0
    v_mov_b32 v56, 0
    v_mov_b32 v57, 0
    v_mov_b32 v58, 0
    v_mov_b32 v59, 0
    v_mov_b32 v60, 0
    v_mov_b32 v61, 0
    v_mov_b32 v62, 0
    v_mov_b32 v63, 0
    v_mov_b32 v64, 0
    v_mov_b32 v65, 0
    v_mov_b32 v66, 0
    v_mov_b32 v67, 0
    v_mov_b32 v68, 0
    v_mov_b32 v69, 0
    v_mov_b32 v70, 0
    v_mov_b32 v71, 0
    v_mov_b32 v72, 0
    v_mov_b32 v73, 0
    v_mov_b32 v74, 0
    v_mov_b32 v75, 0
    v_mov_b32 v76, 0
    v_mov_b32 v77, 0
    v_mov_b32 v78, 0
    v_mov_b32 v79, 0
    v_mov_b32 v80, 0
    v_mov_b32 v81, 0
    v_mov_b32 v82, 0
    v_mov_b32 v83, 0
    v_mov_b32 v84, 0
    v_mov_b32 v85, 0
    v_mov_b32 v86, 0
    v_mov_b32 v87, 0
    v_mov_b32 v88, 0
    v_mov_b32 v89, 0
    v_mov_b32 v90, 0
    v_mov_b32 v91, 0
    v_mov_b32 v92, 0
    v_mov_b32 v93, 0
    v_mov_b32 v94, 0
    v_mov_b32 v95, 0
    v_mov_b32 v96, 0
    v_mov_b32 v97, 0
    v_mov_b32 v98, 0
    v_mov_b32 v99, 0
    v_mov_b32 v100, 0
    v_mov_b32 v101, 0
    v_mov_b32 v102, 0
    v_mov_b32 v103, 0
    v_mov_b32 v104, 0
    v_mov_b32 v105, 0
    v_mov_b32 v106, 0
    v_mov_b32 v107, 0
    v_mov_b32 v108, 0
    v_mov_b32 v109, 0
    v_mov_b32 v110, 0
    v_mov_b32 v111, 0
    v_mov_b32 v112, 0
    v_mov_b32 v113, 0
    v_mov_b32 v114, 0
    v_mov_b32 v115, 0
    v_mov_b32 v116, 0
    v_mov_b32 v117, 0
    v_mov_b32 v118, 0
    v_mov_b32 v119, 0
    v_mov_b32 v120, 0
    v_mov_b32 v121, 0
    v_mov_b32 v122, 0
    v_mov_b32 v123, 0
    v_mov_b32 v124, 0
    v_mov_b32 v125, 0
    v_mov_b32 v126, 0
    v_mov_b32 v127, 0
    v_mov_b32 v128, 0
    v_mov_b32 v129, 0
    v_mov_b32 v130, 0
    v_mov_b32 v131, 0
    v_mov_b32 v132, 0
    v_mov_b32 v133, 0
    v_mov_b32 v134, 0
    v_mov_b32 v135, 0
    v_mov_b32 v136, 0
    v_mov_b32 v137, 0
    v_mov_b32 v138, 0
    v_mov_b32 v139, 0
    v_mov_b32 v140, 0
    v_mov_b32 v141, 0
    v_mov_b32 v142, 0
    v_mov_b32 v143, 0
    s_waitcnt vmcnt(11)
    s_barrier
    buffer_store_dwordx4 v[208:211], v235, s[8:11], s79 offen sc1
    s_add_u32 s79, s79, 14336
    buffer_store_dwordx4 v[212:215], v235, s[8:11], s79 offen sc1
    ds_read_b128 a[0:3], v12 offset:0
    ds_read_b128 a[8:11], v16 offset:16384
    ds_read_b128 a[12:15], v16 offset:20480
    ds_read_b128 a[16:19], v16 offset:24576
    ds_read_b128 a[20:23], v16 offset:28672
    ds_read_b128 a[24:27], v16 offset:32768
    ds_read_b128 a[28:31], v16 offset:36864
    ds_read_b128 a[32:35], v16 offset:40960
    ds_read_b128 a[4:7], v13 offset:0
    s_waitcnt lgkmcnt(7)
    v_mfma_f32_32x32x16_bf16 v[32:47], a[0:3], a[8:11], v[32:47]
    ds_read_b128 a[36:39], v17 offset:16384
    s_add_u32 s50, s46, 90112
    s_mov_b32 m0, s50
    s_add_u32 s51, s45, 256
    buffer_load_dwordx4 v5, s[68:71], s51 offen lds
    s_waitcnt lgkmcnt(7)
    v_mfma_f32_32x32x16_bf16 v[48:63], a[0:3], a[12:15], v[48:63]
    ds_read_b128 a[40:43], v17 offset:20480
    s_waitcnt lgkmcnt(7)
    v_mfma_f32_32x32x16_bf16 v[64:79], a[0:3], a[16:19], v[64:79]
    ds_read_b128 a[44:47], v17 offset:24576
    s_add_u32 s50, s46, 91136
    s_mov_b32 m0, s50
    s_add_u32 s51, s45, 65792
    buffer_load_dwordx4 v6, s[68:71], s51 offen lds
    s_waitcnt lgkmcnt(7)
    v_mfma_f32_32x32x16_bf16 v[80:95], a[0:3], a[20:23], v[80:95]
    ds_read_b128 a[48:51], v17 offset:28672
    s_waitcnt lgkmcnt(7)
    v_mfma_f32_32x32x16_bf16 v[96:111], a[0:3], a[24:27], v[96:111]
    ds_read_b128 a[52:55], v17 offset:32768
    s_add_u32 s50, s46, 92160
    s_mov_b32 m0, s50
    s_add_u32 s51, s45, 131328
    buffer_load_dwordx4 v5, s[68:71], s51 offen lds
    s_waitcnt lgkmcnt(7)
    v_mfma_f32_32x32x16_bf16 v[112:127], a[0:3], a[28:31], v[112:127]
    ds_read_b128 a[56:59], v17 offset:36864
    s_waitcnt lgkmcnt(7)
    v_mfma_f32_32x32x16_bf16 v[128:143], a[0:3], a[32:35], v[128:143]
    ds_read_b128 a[60:63], v17 offset:40960
    s_add_u32 s50, s46, 93184
    s_mov_b32 m0, s50
    s_add_u32 s51, s45, 196864
    buffer_load_dwordx4 v6, s[68:71], s51 offen lds
    ds_read_b128 a[0:3], v14 offset:0
    s_waitcnt lgkmcnt(7)
    v_mfma_f32_32x32x16_bf16 v[32:47], a[4:7], a[36:39], v[32:47]
    ds_read_b128 a[8:11], v18 offset:16384
    s_add_u32 s50, s48, 106496
    s_mov_b32 m0, s50
    s_add_u32 s51, s47, 256
    buffer_load_dwordx4 v7, s[72:75], s51 offen lds
    s_waitcnt lgkmcnt(7)
    v_mfma_f32_32x32x16_bf16 v[48:63], a[4:7], a[40:43], v[48:63]
    ds_read_b128 a[12:15], v18 offset:20480
    s_waitcnt lgkmcnt(7)
    v_mfma_f32_32x32x16_bf16 v[64:79], a[4:7], a[44:47], v[64:79]
    ds_read_b128 a[16:19], v18 offset:24576
    s_add_u32 s50, s48, 110592
    s_mov_b32 m0, s50
    s_add_u32 s51, s47, 262400
    buffer_load_dwordx4 v7, s[72:75], s51 offen lds
    s_waitcnt lgkmcnt(7)
    v_mfma_f32_32x32x16_bf16 v[80:95], a[4:7], a[48:51], v[80:95]
    ds_read_b128 a[20:23], v18 offset:28672
    s_waitcnt lgkmcnt(7)
    v_mfma_f32_32x32x16_bf16 v[96:111], a[4:7], a[52:55], v[96:111]
    ds_read_b128 a[24:27], v18 offset:32768
    s_add_u32 s50, s48, 114688
    s_mov_b32 m0, s50
    s_add_u32 s51, s47, 524544
    buffer_load_dwordx4 v7, s[72:75], s51 offen lds
    s_waitcnt lgkmcnt(7)
    v_mfma_f32_32x32x16_bf16 v[112:127], a[4:7], a[56:59], v[112:127]
    ds_read_b128 a[28:31], v18 offset:36864
    s_waitcnt lgkmcnt(7)
    v_mfma_f32_32x32x16_bf16 v[128:143], a[4:7], a[60:63], v[128:143]
    ds_read_b128 a[32:35], v18 offset:40960
    s_add_u32 s50, s48, 118784
    s_mov_b32 m0, s50
    s_add_u32 s51, s47, 786688
    buffer_load_dwordx4 v7, s[72:75], s51 offen lds
    ds_read_b128 a[4:7], v15 offset:0
    s_waitcnt lgkmcnt(7)
    v_mfma_f32_32x32x16_bf16 v[32:47], a[0:3], a[8:11], v[32:47]
    ds_read_b128 a[36:39], v19 offset:16384
    s_add_u32 s50, s48, 122880
    s_mov_b32 m0, s50
    s_add_u32 s51, s47, 1048832
    buffer_load_dwordx4 v7, s[72:75], s51 offen lds
    s_waitcnt lgkmcnt(7)
    v_mfma_f32_32x32x16_bf16 v[48:63], a[0:3], a[12:15], v[48:63]
    ds_read_b128 a[40:43], v19 offset:20480
    s_waitcnt lgkmcnt(7)
    v_mfma_f32_32x32x16_bf16 v[64:79], a[0:3], a[16:19], v[64:79]
    ds_read_b128 a[44:47], v19 offset:24576
    s_add_u32 s50, s48, 126976
    s_mov_b32 m0, s50
    s_add_u32 s51, s47, 1310976
    buffer_load_dwordx4 v7, s[72:75], s51 offen lds
    s_waitcnt lgkmcnt(7)
    v_mfma_f32_32x32x16_bf16 v[80:95], a[0:3], a[20:23], v[80:95]
    ds_read_b128 a[48:51], v19 offset:28672
    s_waitcnt lgkmcnt(7)
    v_mfma_f32_32x32x16_bf16 v[96:111], a[0:3], a[24:27], v[96:111]
    ds_read_b128 a[52:55], v19 offset:32768
    s_add_u32 s50, s48, 131072
    s_mov_b32 m0, s50
    s_add_u32 s51, s47, 1573120
    buffer_load_dwordx4 v7, s[72:75], s51 offen lds
    s_waitcnt lgkmcnt(7)
    v_mfma_f32_32x32x16_bf16 v[112:127], a[0:3], a[28:31], v[112:127]
    ds_read_b128 a[56:59], v19 offset:36864
    s_waitcnt lgkmcnt(7)
    v_mfma_f32_32x32x16_bf16 v[128:143], a[0:3], a[32:35], v[128:143]
    ds_read_b128 a[60:63], v19 offset:40960
    s_waitcnt lgkmcnt(6)
    v_mfma_f32_32x32x16_bf16 v[32:47], a[4:7], a[36:39], v[32:47]
    s_waitcnt lgkmcnt(5)
    v_mfma_f32_32x32x16_bf16 v[48:63], a[4:7], a[40:43], v[48:63]
    s_waitcnt lgkmcnt(4)
    v_mfma_f32_32x32x16_bf16 v[64:79], a[4:7], a[44:47], v[64:79]
    s_waitcnt lgkmcnt(3)
    v_mfma_f32_32x32x16_bf16 v[80:95], a[4:7], a[48:51], v[80:95]
    s_waitcnt lgkmcnt(2)
    v_mfma_f32_32x32x16_bf16 v[96:111], a[4:7], a[52:55], v[96:111]
    s_waitcnt lgkmcnt(1)
    v_mfma_f32_32x32x16_bf16 v[112:127], a[4:7], a[56:59], v[112:127]
    s_waitcnt lgkmcnt(0)
    v_mfma_f32_32x32x16_bf16 v[128:143], a[4:7], a[60:63], v[128:143]
    v_add_u32 v12, 0xb000, v12
    v_add_u32 v13, 0xb000, v13
    v_add_u32 v14, 0xb000, v14
    v_add_u32 v15, 0xb000, v15
    v_add_u32 v16, 0xb000, v16
    v_add_u32 v17, 0xb000, v17
    v_add_u32 v18, 0xb000, v18
    v_add_u32 v19, 0xb000, v19
    s_waitcnt vmcnt(13)
    s_barrier
    ds_read_b128 a[0:3], v12 offset:0
    ds_read_b128 a[8:11], v16 offset:16384
    ds_read_b128 a[12:15], v16 offset:20480
    ds_read_b128 a[16:19], v16 offset:24576
    ds_read_b128 a[20:23], v16 offset:28672
    ds_read_b128 a[24:27], v16 offset:32768
    ds_read_b128 a[28:31], v16 offset:36864
    ds_read_b128 a[32:35], v16 offset:40960
    ds_read_b128 a[4:7], v13 offset:0
    s_waitcnt lgkmcnt(7)
    v_mfma_f32_32x32x16_bf16 v[32:47], a[0:3], a[8:11], v[32:47]
    ds_read_b128 a[36:39], v17 offset:16384
    s_add_u32 s50, s46, 0
    s_mov_b32 m0, s50
    s_add_u32 s51, s45, 384
    buffer_load_dwordx4 v5, s[68:71], s51 offen lds
    s_waitcnt lgkmcnt(7)
    v_mfma_f32_32x32x16_bf16 v[48:63], a[0:3], a[12:15], v[48:63]
    ds_read_b128 a[40:43], v17 offset:20480
    s_waitcnt lgkmcnt(7)
    v_mfma_f32_32x32x16_bf16 v[64:79], a[0:3], a[16:19], v[64:79]
    ds_read_b128 a[44:47], v17 offset:24576
    s_add_u32 s50, s46, 1024
    s_mov_b32 m0, s50
    s_add_u32 s51, s45, 65920
    buffer_load_dwordx4 v6, s[68:71], s51 offen lds
    s_waitcnt lgkmcnt(7)
    v_mfma_f32_32x32x16_bf16 v[80:95], a[0:3], a[20:23], v[80:95]
    ds_read_b128 a[48:51], v17 offset:28672
    s_waitcnt lgkmcnt(7)
    v_mfma_f32_32x32x16_bf16 v[96:111], a[0:3], a[24:27], v[96:111]
    ds_read_b128 a[52:55], v17 offset:32768
    s_add_u32 s50, s46, 2048
    s_mov_b32 m0, s50
    s_add_u32 s51, s45, 131456
    buffer_load_dwordx4 v5, s[68:71], s51 offen lds
    s_waitcnt lgkmcnt(7)
    v_mfma_f32_32x32x16_bf16 v[112:127], a[0:3], a[28:31], v[112:127]
    ds_read_b128 a[56:59], v17 offset:36864
    s_waitcnt lgkmcnt(7)
    v_mfma_f32_32x32x16_bf16 v[128:143], a[0:3], a[32:35], v[128:143]
    ds_read_b128 a[60:63], v17 offset:40960
    s_add_u32 s50, s46, 3072
    s_mov_b32 m0, s50
    s_add_u32 s51, s45, 196992
    buffer_load_dwordx4 v6, s[68:71], s51 offen lds
    ds_read_b128 a[0:3], v14 offset:0
    s_waitcnt lgkmcnt(7)
    v_mfma_f32_32x32x16_bf16 v[32:47], a[4:7], a[36:39], v[32:47]
    ds_read_b128 a[8:11], v18 offset:16384
    s_add_u32 s50, s48, 16384
    s_mov_b32 m0, s50
    s_add_u32 s51, s47, 384
    buffer_load_dwordx4 v7, s[72:75], s51 offen lds
    s_waitcnt lgkmcnt(7)
    v_mfma_f32_32x32x16_bf16 v[48:63], a[4:7], a[40:43], v[48:63]
    ds_read_b128 a[12:15], v18 offset:20480
    s_waitcnt lgkmcnt(7)
    v_mfma_f32_32x32x16_bf16 v[64:79], a[4:7], a[44:47], v[64:79]
    ds_read_b128 a[16:19], v18 offset:24576
    s_add_u32 s50, s48, 20480
    s_mov_b32 m0, s50
    s_add_u32 s51, s47, 262528
    buffer_load_dwordx4 v7, s[72:75], s51 offen lds
    s_waitcnt lgkmcnt(7)
    v_mfma_f32_32x32x16_bf16 v[80:95], a[4:7], a[48:51], v[80:95]
    ds_read_b128 a[20:23], v18 offset:28672
    s_waitcnt lgkmcnt(7)
    v_mfma_f32_32x32x16_bf16 v[96:111], a[4:7], a[52:55], v[96:111]
    ds_read_b128 a[24:27], v18 offset:32768
    s_add_u32 s50, s48, 24576
    s_mov_b32 m0, s50
    s_add_u32 s51, s47, 524672
    buffer_load_dwordx4 v7, s[72:75], s51 offen lds
    s_waitcnt lgkmcnt(7)
    v_mfma_f32_32x32x16_bf16 v[112:127], a[4:7], a[56:59], v[112:127]
    ds_read_b128 a[28:31], v18 offset:36864
    s_waitcnt lgkmcnt(7)
    v_mfma_f32_32x32x16_bf16 v[128:143], a[4:7], a[60:63], v[128:143]
    ds_read_b128 a[32:35], v18 offset:40960
    s_add_u32 s50, s48, 28672
    s_mov_b32 m0, s50
    s_add_u32 s51, s47, 786816
    buffer_load_dwordx4 v7, s[72:75], s51 offen lds
    ds_read_b128 a[4:7], v15 offset:0
    s_waitcnt lgkmcnt(7)
    v_mfma_f32_32x32x16_bf16 v[32:47], a[0:3], a[8:11], v[32:47]
    ds_read_b128 a[36:39], v19 offset:16384
    s_add_u32 s50, s48, 32768
    s_mov_b32 m0, s50
    s_add_u32 s51, s47, 1048960
    buffer_load_dwordx4 v7, s[72:75], s51 offen lds
    s_waitcnt lgkmcnt(7)
    v_mfma_f32_32x32x16_bf16 v[48:63], a[0:3], a[12:15], v[48:63]
    ds_read_b128 a[40:43], v19 offset:20480
    s_waitcnt lgkmcnt(7)
    v_mfma_f32_32x32x16_bf16 v[64:79], a[0:3], a[16:19], v[64:79]
    ds_read_b128 a[44:47], v19 offset:24576
    s_add_u32 s50, s48, 36864
    s_mov_b32 m0, s50
    s_add_u32 s51, s47, 1311104
    buffer_load_dwordx4 v7, s[72:75], s51 offen lds
    s_waitcnt lgkmcnt(7)
    v_mfma_f32_32x32x16_bf16 v[80:95], a[0:3], a[20:23], v[80:95]
    ds_read_b128 a[48:51], v19 offset:28672
    s_waitcnt lgkmcnt(7)
    v_mfma_f32_32x32x16_bf16 v[96:111], a[0:3], a[24:27], v[96:111]
    ds_read_b128 a[52:55], v19 offset:32768
    s_add_u32 s50, s48, 40960
    s_mov_b32 m0, s50
    s_add_u32 s51, s47, 1573248
    buffer_load_dwordx4 v7, s[72:75], s51 offen lds
    s_waitcnt lgkmcnt(7)
    v_mfma_f32_32x32x16_bf16 v[112:127], a[0:3], a[28:31], v[112:127]
    ds_read_b128 a[56:59], v19 offset:36864
    s_waitcnt lgkmcnt(7)
    v_mfma_f32_32x32x16_bf16 v[128:143], a[0:3], a[32:35], v[128:143]
    ds_read_b128 a[60:63], v19 offset:40960
    s_waitcnt lgkmcnt(6)
    v_mfma_f32_32x32x16_bf16 v[32:47], a[4:7], a[36:39], v[32:47]
    s_waitcnt lgkmcnt(5)
    v_mfma_f32_32x32x16_bf16 v[48:63], a[4:7], a[40:43], v[48:63]
    s_waitcnt lgkmcnt(4)
    v_mfma_f32_32x32x16_bf16 v[64:79], a[4:7], a[44:47], v[64:79]
    s_waitcnt lgkmcnt(3)
    v_mfma_f32_32x32x16_bf16 v[80:95], a[4:7], a[48:51], v[80:95]
    s_waitcnt lgkmcnt(2)
    v_mfma_f32_32x32x16_bf16 v[96:111], a[4:7], a[52:55], v[96:111]
    s_waitcnt lgkmcnt(1)
    v_mfma_f32_32x32x16_bf16 v[112:127], a[4:7], a[56:59], v[112:127]
    s_waitcnt lgkmcnt(0)
    v_mfma_f32_32x32x16_bf16 v[128:143], a[4:7], a[60:63], v[128:143]
    v_add_u32 v12, 0xb000, v12
    v_add_u32 v13, 0xb000, v13
    v_add_u32 v14, 0xb000, v14
    v_add_u32 v15, 0xb000, v15
    v_add_u32 v16, 0xb000, v16
    v_add_u32 v17, 0xb000, v17
    v_add_u32 v18, 0xb000, v18
    v_add_u32 v19, 0xb000, v19
    s_waitcnt vmcnt(11)
    s_barrier
    ds_read_b128 a[0:3], v12 offset:0
    ds_read_b128 a[8:11], v16 offset:16384
    ds_read_b128 a[12:15], v16 offset:20480
    ds_read_b128 a[16:19], v16 offset:24576
    ds_read_b128 a[20:23], v16 offset:28672
    ds_read_b128 a[24:27], v16 offset:32768
    ds_read_b128 a[28:31], v16 offset:36864
    ds_read_b128 a[32:35], v16 offset:40960
    ds_read_b128 a[4:7], v13 offset:0
    s_waitcnt lgkmcnt(7)
    v_mfma_f32_32x32x16_bf16 v[32:47], a[0:3], a[8:11], v[32:47]
    ds_read_b128 a[36:39], v17 offset:16384
    s_waitcnt lgkmcnt(7)
    v_mfma_f32_32x32x16_bf16 v[48:63], a[0:3], a[12:15], v[48:63]
    ds_read_b128 a[40:43], v17 offset:20480
    s_waitcnt lgkmcnt(7)
    v_mfma_f32_32x32x16_bf16 v[64:79], a[0:3], a[16:19], v[64:79]
    ds_read_b128 a[44:47], v17 offset:24576
    s_waitcnt lgkmcnt(7)
    v_mfma_f32_32x32x16_bf16 v[80:95], a[0:3], a[20:23], v[80:95]
    ds_read_b128 a[48:51], v17 offset:28672
    s_waitcnt lgkmcnt(7)
    v_mfma_f32_32x32x16_bf16 v[96:111], a[0:3], a[24:27], v[96:111]
    ds_read_b128 a[52:55], v17 offset:32768
    s_waitcnt lgkmcnt(7)
    v_mfma_f32_32x32x16_bf16 v[112:127], a[0:3], a[28:31], v[112:127]
    ds_read_b128 a[56:59], v17 offset:36864
    s_waitcnt lgkmcnt(7)
    v_mfma_f32_32x32x16_bf16 v[128:143], a[0:3], a[32:35], v[128:143]
    ds_read_b128 a[60:63], v17 offset:40960
    ds_read_b128 a[0:3], v14 offset:0
    s_waitcnt lgkmcnt(7)
    v_mfma_f32_32x32x16_bf16 v[32:47], a[4:7], a[36:39], v[32:47]
    ds_read_b128 a[8:11], v18 offset:16384
    s_waitcnt lgkmcnt(7)
    v_mfma_f32_32x32x16_bf16 v[48:63], a[4:7], a[40:43], v[48:63]
    ds_read_b128 a[12:15], v18 offset:20480
    s_waitcnt lgkmcnt(7)
    v_mfma_f32_32x32x16_bf16 v[64:79], a[4:7], a[44:47], v[64:79]
    ds_read_b128 a[16:19], v18 offset:24576
    s_waitcnt lgkmcnt(7)
    v_mfma_f32_32x32x16_bf16 v[80:95], a[4:7], a[48:51], v[80:95]
    ds_read_b128 a[20:23], v18 offset:28672
    s_waitcnt lgkmcnt(7)
    v_mfma_f32_32x32x16_bf16 v[96:111], a[4:7], a[52:55], v[96:111]
    ds_read_b128 a[24:27], v18 offset:32768
    s_waitcnt lgkmcnt(7)
    v_mfma_f32_32x32x16_bf16 v[112:127], a[4:7], a[56:59], v[112:127]
    ds_read_b128 a[28:31], v18 offset:36864
    s_waitcnt lgkmcnt(7)
    v_mfma_f32_32x32x16_bf16 v[128:143], a[4:7], a[60:63], v[128:143]
    ds_read_b128 a[32:35], v18 offset:40960
    ds_read_b128 a[4:7], v15 offset:0
    s_waitcnt lgkmcnt(7)
    v_mfma_f32_32x32x16_bf16 v[32:47], a[0:3], a[8:11], v[32:47]
    ds_read_b128 a[36:39], v19 offset:16384
    s_waitcnt lgkmcnt(7)
    v_mfma_f32_32x32x16_bf16 v[48:63], a[0:3], a[12:15], v[48:63]
    ds_read_b128 a[40:43], v19 offset:20480
    s_waitcnt lgkmcnt(7)
    v_mfma_f32_32x32x16_bf16 v[64:79], a[0:3], a[16:19], v[64:79]
    ds_read_b128 a[44:47], v19 offset:24576
    s_waitcnt lgkmcnt(7)
    v_mfma_f32_32x32x16_bf16 v[80:95], a[0:3], a[20:23], v[80:95]
    ds_read_b128 a[48:51], v19 offset:28672
    s_waitcnt lgkmcnt(7)
    v_mfma_f32_32x32x16_bf16 v[96:111], a[0:3], a[24:27], v[96:111]
    ds_read_b128 a[52:55], v19 offset:32768
    s_waitcnt lgkmcnt(7)
    v_mfma_f32_32x32x16_bf16 v[112:127], a[0:3], a[28:31], v[112:127]
    ds_read_b128 a[56:59], v19 offset:36864
    s_waitcnt lgkmcnt(7)
    v_mfma_f32_32x32x16_bf16 v[128:143], a[0:3], a[32:35], v[128:143]
    ds_read_b128 a[60:63], v19 offset:40960
    s_waitcnt lgkmcnt(6)
    v_mfma_f32_32x32x16_bf16 v[32:47], a[4:7], a[36:39], v[32:47]
    s_waitcnt lgkmcnt(5)
    v_mfma_f32_32x32x16_bf16 v[48:63], a[4:7], a[40:43], v[48:63]
    s_waitcnt lgkmcnt(4)
    v_mfma_f32_32x32x16_bf16 v[64:79], a[4:7], a[44:47], v[64:79]
    s_waitcnt lgkmcnt(3)
    v_mfma_f32_32x32x16_bf16 v[80:95], a[4:7], a[48:51], v[80:95]
    s_waitcnt lgkmcnt(2)
    v_mfma_f32_32x32x16_bf16 v[96:111], a[4:7], a[52:55], v[96:111]
    s_waitcnt lgkmcnt(1)
    v_mfma_f32_32x32x16_bf16 v[112:127], a[4:7], a[56:59], v[112:127]
    s_waitcnt lgkmcnt(0)
    v_mfma_f32_32x32x16_bf16 v[128:143], a[4:7], a[60:63], v[128:143]
    v_add_u32 v12, 0xfffea000, v12
    v_add_u32 v13, 0xfffea000, v13
    v_add_u32 v14, 0xfffea000, v14
    v_add_u32 v15, 0xfffea000, v15
    v_add_u32 v16, 0xfffea000, v16
    v_add_u32 v17, 0xfffea000, v17
    v_add_u32 v18, 0xfffea000, v18
    v_add_u32 v19, 0xfffea000, v19
    s_waitcnt vmcnt(0)
    s_barrier
    ds_read_b128 a[0:3], v12 offset:0
    ds_read_b128 a[8:11], v16 offset:16384
    ds_read_b128 a[12:15], v16 offset:20480
    ds_read_b128 a[16:19], v16 offset:24576
    ds_read_b128 a[20:23], v16 offset:28672
    ds_read_b128 a[24:27], v16 offset:32768
    ds_read_b128 a[28:31], v16 offset:36864
    ds_read_b128 a[32:35], v16 offset:40960
    ds_read_b128 a[4:7], v13 offset:0
    s_waitcnt lgkmcnt(7)
    v_mfma_f32_32x32x16_bf16 v[32:47], a[0:3], a[8:11], v[32:47]
    ds_read_b128 a[36:39], v17 offset:16384
    s_waitcnt lgkmcnt(7)
    v_mfma_f32_32x32x16_bf16 v[48:63], a[0:3], a[12:15], v[48:63]
    ds_read_b128 a[40:43], v17 offset:20480
    s_waitcnt lgkmcnt(7)
    v_mfma_f32_32x32x16_bf16 v[64:79], a[0:3], a[16:19], v[64:79]
    ds_read_b128 a[44:47], v17 offset:24576
    s_waitcnt lgkmcnt(7)
    v_mfma_f32_32x32x16_bf16 v[80:95], a[0:3], a[20:23], v[80:95]
    ds_read_b128 a[48:51], v17 offset:28672
    s_waitcnt lgkmcnt(7)
    v_mfma_f32_32x32x16_bf16 v[96:111], a[0:3], a[24:27], v[96:111]
    ds_read_b128 a[52:55], v17 offset:32768
    s_waitcnt lgkmcnt(7)
    v_mfma_f32_32x32x16_bf16 v[112:127], a[0:3], a[28:31], v[112:127]
    ds_read_b128 a[56:59], v17 offset:36864
    s_waitcnt lgkmcnt(7)
    v_mfma_f32_32x32x16_bf16 v[128:143], a[0:3], a[32:35], v[128:143]
    ds_read_b128 a[60:63], v17 offset:40960
    ds_read_b128 a[0:3], v14 offset:0
    s_waitcnt lgkmcnt(7)
    v_mfma_f32_32x32x16_bf16 v[32:47], a[4:7], a[36:39], v[32:47]
    ds_read_b128 a[8:11], v18 offset:16384
    s_waitcnt lgkmcnt(7)
    v_mfma_f32_32x32x16_bf16 v[48:63], a[4:7], a[40:43], v[48:63]
    ds_read_b128 a[12:15], v18 offset:20480
    s_waitcnt lgkmcnt(7)
    v_mfma_f32_32x32x16_bf16 v[64:79], a[4:7], a[44:47], v[64:79]
    ds_read_b128 a[16:19], v18 offset:24576
    s_waitcnt lgkmcnt(7)
    v_mfma_f32_32x32x16_bf16 v[80:95], a[4:7], a[48:51], v[80:95]
    ds_read_b128 a[20:23], v18 offset:28672
    s_waitcnt lgkmcnt(7)
    v_mfma_f32_32x32x16_bf16 v[96:111], a[4:7], a[52:55], v[96:111]
    ds_read_b128 a[24:27], v18 offset:32768
    s_waitcnt lgkmcnt(7)
    v_mfma_f32_32x32x16_bf16 v[112:127], a[4:7], a[56:59], v[112:127]
    ds_read_b128 a[28:31], v18 offset:36864
    s_waitcnt lgkmcnt(7)
    v_mfma_f32_32x32x16_bf16 v[128:143], a[4:7], a[60:63], v[128:143]
    ds_read_b128 a[32:35], v18 offset:40960
    ds_read_b128 a[4:7], v15 offset:0
    s_waitcnt lgkmcnt(7)
    v_mfma_f32_32x32x16_bf16 v[32:47], a[0:3], a[8:11], v[32:47]
    ds_read_b128 a[36:39], v19 offset:16384
    s_waitcnt lgkmcnt(7)
    v_mfma_f32_32x32x16_bf16 v[48:63], a[0:3], a[12:15], v[48:63]
    ds_read_b128 a[40:43], v19 offset:20480
    s_waitcnt lgkmcnt(7)
    v_mfma_f32_32x32x16_bf16 v[64:79], a[0:3], a[16:19], v[64:79]
    ds_read_b128 a[44:47], v19 offset:24576
    s_waitcnt lgkmcnt(7)
    v_mfma_f32_32x32x16_bf16 v[80:95], a[0:3], a[20:23], v[80:95]
    ds_read_b128 a[48:51], v19 offset:28672
    s_waitcnt lgkmcnt(7)
    v_mfma_f32_32x32x16_bf16 v[96:111], a[0:3], a[24:27], v[96:111]
    ds_read_b128 a[52:55], v19 offset:32768
    s_waitcnt lgkmcnt(7)
    v_mfma_f32_32x32x16_bf16 v[112:127], a[0:3], a[28:31], v[112:127]
    ds_read_b128 a[56:59], v19 offset:36864
    s_waitcnt lgkmcnt(7)
    v_mfma_f32_32x32x16_bf16 v[128:143], a[0:3], a[32:35], v[128:143]
    ds_read_b128 a[60:63], v19 offset:40960
    s_waitcnt lgkmcnt(6)
    v_mfma_f32_32x32x16_bf16 v[32:47], a[4:7], a[36:39], v[32:47]
    s_waitcnt lgkmcnt(5)
    v_mfma_f32_32x32x16_bf16 v[48:63], a[4:7], a[40:43], v[48:63]
    s_waitcnt lgkmcnt(4)
    v_mfma_f32_32x32x16_bf16 v[64:79], a[4:7], a[44:47], v[64:79]
    s_waitcnt lgkmcnt(3)
    v_mfma_f32_32x32x16_bf16 v[80:95], a[4:7], a[48:51], v[80:95]
    s_waitcnt lgkmcnt(2)
    v_mfma_f32_32x32x16_bf16 v[96:111], a[4:7], a[52:55], v[96:111]
    s_waitcnt lgkmcnt(1)
    v_mfma_f32_32x32x16_bf16 v[112:127], a[4:7], a[56:59], v[112:127]
    s_waitcnt lgkmcnt(0)
    v_mfma_f32_32x32x16_bf16 v[128:143], a[4:7], a[60:63], v[128:143]
    s_mul_i32 s42, s53, 14
    s_mul_i32 s50, s55, 7
    s_add_u32 s42, s42, s50
    s_mul_i32 s42, s42, 28672
    s_add_u32 s42, s42, 2097152
    s_mov_b32 s52, 1035512379
    s_lshl_b32 s51, s44, 11
    s_add_u32 s51, s51, s42
    s_cmp_gt_u32 s44, 13
    s_cselect_b32 s51, 0x40000000, s51
    v_mul_f32 v32, s52, v32
    v_mul_f32 v33, s52, v33
    v_cvt_pk_bf16_f32 v160, v32, v33
    v_mul_f32 v34, s52, v34
    v_mul_f32 v35, s52, v35
    v_cvt_pk_bf16_f32 v161, v34, v35
    v_mul_f32 v36, s52, v36
    v_mul_f32 v37, s52, v37
    v_cvt_pk_bf16_f32 v162, v36, v37
    v_mul_f32 v38, s52, v38
    v_mul_f32 v39, s52, v39
    v_cvt_pk_bf16_f32 v163, v38, v39
    buffer_store_dwordx4 v[160:163], v24, s[8:11], s51 offen offset:0 sc1
    v_mul_f32 v40, s52, v40
    v_mul_f32 v41, s52, v41
    v_cvt_pk_bf16_f32 v164, v40, v41
    v_mul_f32 v42, s52, v42
    v_mul_f32 v43, s52, v43
    v_cvt_pk_bf16_f32 v165, v42, v43
    v_mul_f32 v44, s52, v44
    v_mul_f32 v45, s52, v45
    v_cvt_pk_bf16_f32 v166, v44, v45
    v_mul_f32 v46, s52, v46
    v_mul_f32 v47, s52, v47
    v_cvt_pk_bf16_f32 v167, v46, v47
    buffer_store_dwordx4 v[164:167], v24, s[8:11], s51 offen offset:1024 sc1
    s_add_u32 s51, s51, 28672
    v_mul_f32 v48, s52, v48
    v_mul_f32 v49, s52, v49
    v_cvt_pk_bf16_f32 v168, v48, v49
    v_mul_f32 v50, s52, v50
    v_mul_f32 v51, s52, v51
    v_cvt_pk_bf16_f32 v169, v50, v51
    v_mul_f32 v52, s52, v52
    v_mul_f32 v53, s52, v53
    v_cvt_pk_bf16_f32 v170, v52, v53
    v_mul_f32 v54, s52, v54
    v_mul_f32 v55, s52, v55
    v_cvt_pk_bf16_f32 v171, v54, v55
    buffer_store_dwordx4 v[168:171], v24, s[8:11], s51 offen offset:0 sc1
    v_mul_f32 v56, s52, v56
    v_mul_f32 v57, s52, v57
    v_cvt_pk_bf16_f32 v172, v56, v57
    v_mul_f32 v58, s52, v58
    v_mul_f32 v59, s52, v59
    v_cvt_pk_bf16_f32 v173, v58, v59
    v_mul_f32 v60, s52, v60
    v_mul_f32 v61, s52, v61
    v_cvt_pk_bf16_f32 v174, v60, v61
    v_mul_f32 v62, s52, v62
    v_mul_f32 v63, s52, v63
    v_cvt_pk_bf16_f32 v175, v62, v63
    buffer_store_dwordx4 v[172:175], v24, s[8:11], s51 offen offset:1024 sc1
    s_add_u32 s51, s51, 28672
    v_mul_f32 v64, s52, v64
    v_mul_f32 v65, s52, v65
    v_cvt_pk_bf16_f32 v176, v64, v65
    v_mul_f32 v66, s52, v66
    v_mul_f32 v67, s52, v67
    v_cvt_pk_bf16_f32 v177, v66, v67
    v_mul_f32 v68, s52, v68
    v_mul_f32 v69, s52, v69
    v_cvt_pk_bf16_f32 v178, v68, v69
    v_mul_f32 v70, s52, v70
    v_mul_f32 v71, s52, v71
    v_cvt_pk_bf16_f32 v179, v70, v71
    buffer_store_dwordx4 v[176:179], v24, s[8:11], s51 offen offset:0 sc1
    v_mul_f32 v72, s52, v72
    v_mul_f32 v73, s52, v73
    v_cvt_pk_bf16_f32 v180, v72, v73
    v_mul_f32 v74, s52, v74
    v_mul_f32 v75, s52, v75
    v_cvt_pk_bf16_f32 v181, v74, v75
    v_mul_f32 v76, s52, v76
    v_mul_f32 v77, s52, v77
    v_cvt_pk_bf16_f32 v182, v76, v77
    v_mul_f32 v78, s52, v78
    v_mul_f32 v79, s52, v79
    v_cvt_pk_bf16_f32 v183, v78, v79
    buffer_store_dwordx4 v[180:183], v24, s[8:11], s51 offen offset:1024 sc1
    s_add_u32 s51, s51, 28672
    v_mul_f32 v80, s52, v80
    v_mul_f32 v81, s52, v81
    v_cvt_pk_bf16_f32 v184, v80, v81
    v_mul_f32 v82, s52, v82
    v_mul_f32 v83, s52, v83
    v_cvt_pk_bf16_f32 v185, v82, v83
    v_mul_f32 v84, s52, v84
    v_mul_f32 v85, s52, v85
    v_cvt_pk_bf16_f32 v186, v84, v85
    v_mul_f32 v86, s52, v86
    v_mul_f32 v87, s52, v87
    v_cvt_pk_bf16_f32 v187, v86, v87
    buffer_store_dwordx4 v[184:187], v24, s[8:11], s51 offen offset:0 sc1
    v_mul_f32 v88, s52, v88
    v_mul_f32 v89, s52, v89
    v_cvt_pk_bf16_f32 v188, v88, v89
    v_mul_f32 v90, s52, v90
    v_mul_f32 v91, s52, v91
    v_cvt_pk_bf16_f32 v189, v90, v91
    v_mul_f32 v92, s52, v92
    v_mul_f32 v93, s52, v93
    v_cvt_pk_bf16_f32 v190, v92, v93
    v_mul_f32 v94, s52, v94
    v_mul_f32 v95, s52, v95
    v_cvt_pk_bf16_f32 v191, v94, v95
    buffer_store_dwordx4 v[188:191], v24, s[8:11], s51 offen offset:1024 sc1
    s_add_u32 s51, s51, 28672
    v_mul_f32 v96, s52, v96
    v_mul_f32 v97, s52, v97
    v_cvt_pk_bf16_f32 v160, v96, v97
    v_mul_f32 v98, s52, v98
    v_mul_f32 v99, s52, v99
    v_cvt_pk_bf16_f32 v161, v98, v99
    v_mul_f32 v100, s52, v100
    v_mul_f32 v101, s52, v101
    v_cvt_pk_bf16_f32 v162, v100, v101
    v_mul_f32 v102, s52, v102
    v_mul_f32 v103, s52, v103
    v_cvt_pk_bf16_f32 v163, v102, v103
    buffer_store_dwordx4 v[160:163], v24, s[8:11], s51 offen offset:0 sc1
    v_mul_f32 v104, s52, v104
    v_mul_f32 v105, s52, v105
    v_cvt_pk_bf16_f32 v164, v104, v105
    v_mul_f32 v106, s52, v106
    v_mul_f32 v107, s52, v107
    v_cvt_pk_bf16_f32 v165, v106, v107
    v_mul_f32 v108, s52, v108
    v_mul_f32 v109, s52, v109
    v_cvt_pk_bf16_f32 v166, v108, v109
    v_mul_f32 v110, s52, v110
    v_mul_f32 v111, s52, v111
    v_cvt_pk_bf16_f32 v167, v110, v111
    buffer_store_dwordx4 v[164:167], v24, s[8:11], s51 offen offset:1024 sc1
    s_add_u32 s51, s51, 28672
    v_mul_f32 v112, s52, v112
    v_mul_f32 v113, s52, v113
    v_cvt_pk_bf16_f32 v168, v112, v113
    v_mul_f32 v114, s52, v114
    v_mul_f32 v115, s52, v115
    v_cvt_pk_bf16_f32 v169, v114, v115
    v_mul_f32 v116, s52, v116
    v_mul_f32 v117, s52, v117
    v_cvt_pk_bf16_f32 v170, v116, v117
    v_mul_f32 v118, s52, v118
    v_mul_f32 v119, s52, v119
    v_cvt_pk_bf16_f32 v171, v118, v119
    buffer_store_dwordx4 v[168:171], v24, s[8:11], s51 offen offset:0 sc1
    v_mul_f32 v120, s52, v120
    v_mul_f32 v121, s52, v121
    v_cvt_pk_bf16_f32 v172, v120, v121
    v_mul_f32 v122, s52, v122
    v_mul_f32 v123, s52, v123
    v_cvt_pk_bf16_f32 v173, v122, v123
    v_mul_f32 v124, s52, v124
    v_mul_f32 v125, s52, v125
    v_cvt_pk_bf16_f32 v174, v124, v125
    v_mul_f32 v126, s52, v126
    v_mul_f32 v127, s52, v127
    v_cvt_pk_bf16_f32 v175, v126, v127
    buffer_store_dwordx4 v[172:175], v24, s[8:11], s51 offen offset:1024 sc1
    s_add_u32 s51, s51, 28672
    v_mul_f32 v128, s52, v128
    v_mul_f32 v129, s52, v129
    v_cvt_pk_bf16_f32 v176, v128, v129
    v_mul_f32 v130, s52, v130
    v_mul_f32 v131, s52, v131
    v_cvt_pk_bf16_f32 v177, v130, v131
    v_mul_f32 v132, s52, v132
    v_mul_f32 v133, s52, v133
    v_cvt_pk_bf16_f32 v178, v132, v133
    v_mul_f32 v134, s52, v134
    v_mul_f32 v135, s52, v135
    v_cvt_pk_bf16_f32 v179, v134, v135
    buffer_store_dwordx4 v[176:179], v24, s[8:11], s51 offen offset:0 sc1
    v_mul_f32 v136, s52, v136
    v_mul_f32 v137, s52, v137
    v_cvt_pk_bf16_f32 v180, v136, v137
    v_mul_f32 v138, s52, v138
    v_mul_f32 v139, s52, v139
    v_cvt_pk_bf16_f32 v181, v138, v139
    v_mul_f32 v140, s52, v140
    v_mul_f32 v141, s52, v141
    v_cvt_pk_bf16_f32 v182, v140, v141
    v_mul_f32 v142, s52, v142
    v_mul_f32 v143, s52, v143
    v_cvt_pk_bf16_f32 v183, v142, v143
    buffer_store_dwordx4 v[180:183], v24, s[8:11], s51 offen offset:1024 sc1
    s_add_u32 s51, s51, 28672
    s_branch E_2
E_B:
    s_mov_b32 s68, s88
    s_and_b32 s69, s89, 0xffff
    s_mov_b32 s70, 3670016
    s_mov_b32 s71, 0x20000
    s_mov_b32 s72, s90
    s_and_b32 s73, s91, 0xffff
    s_mov_b32 s74, 3670016
    s_mov_b32 s75, 0x20000
    v_lshrrev_b32 v8, 3, v1
    v_and_b32 v9, 7, v1
    v_lshrrev_b32 v10, 1, v8
    v_xor_b32 v9, v9, v10
    v_lshlrev_b32 v8, 13, v8
    v_lshl_add_u32 v5, v9, 4, v8
    v_xor_b32 v6, 64, v5
    s_lshl_b32 s44, s54, 2
    s_add_u32 s44, s44, s13
    s_min_u32 s50, s44, 13
    s_lshl_b32 s45, s50, 18
    s_lshl_b32 s51, s53, 9
    s_add_u32 s45, s45, s51
    s_lshl_b32 s46, s13, 12
    v_lshrrev_b32 v8, 4, v3
    v_and_b32 v8, 31, v8
    v_bfe_u32 v9, v8, 1, 3
    v_lshrrev_b32 v10, 5, v1
    v_xor_b32 v9, v9, v10
    v_lshlrev_b32 v9, 4, v9
    v_lshl_add_u32 v9, v8, 7, v9
    v_xor_b32 v12, 0, v9
    v_xor_b32 v13, 32, v9
    v_xor_b32 v14, 64, v9
    v_xor_b32 v15, 96, v9
    v_add_u32 v12, s46, v12
    v_add_u32 v13, s46, v13
    v_add_u32 v14, s46, v14
    v_add_u32 v15, s46, v15
    v_add_u32 v8, 0, v1
    v_mul_u32_u24 v9, 2341, v8
    v_lshrrev_b32 v9, 16, v9
    v_mul_u32_u24 v10, 448, v9
    v_lshl_add_u32 v196, v8, 4, v10
    v_add_u32 v8, 64, v1
    v_mul_u32_u24 v9, 2341, v8
    v_lshrrev_b32 v9, 16, v9
    v_mul_u32_u24 v10, 448, v9
    v_lshl_add_u32 v197, v8, 4, v10
    v_add_u32 v8, 128, v1
    v_mul_u32_u24 v9, 2341, v8
    v_lshrrev_b32 v9, 16, v9
    v_mul_u32_u24 v10, 448, v9
    v_lshl_add_u32 v198, v8, 4, v10
    v_add_u32 v8, 192, v1
    v_mul_u32_u24 v9, 2341, v8
    v_lshrrev_b32 v9, 16, v9
    v_mul_u32_u24 v10, 448, v9
    v_lshl_add_u32 v199, v8, 4, v10
    v_add_u32 v8, 256, v1
    v_mul_u32_u24 v9, 2341, v8
    v_lshrrev_b32 v9, 16, v9
    v_mul_u32_u24 v10, 448, v9
    v_lshl_add_u32 v200, v8, 4, v10
    v_add_u32 v8, 320, v1
    v_mul_u32_u24 v9, 2341, v8
    v_lshrrev_b32 v9, 16, v9
    v_mul_u32_u24 v10, 448, v9
    v_lshl_add_u32 v201, v8, 4, v10
    v_add_u32 v8, 384, v1
    v_mul_u32_u24 v9, 2341, v8
    v_lshrrev_b32 v9, 16, v9
    v_mul_u32_u24 v10, 448, v9
    v_lshl_add_u32 v202, v8, 4, v10
    s_mul_i32 s47, s53, 229376
    s_mul_i32 s50, s55, 448
    s_add_u32 s47, s47, s50
    s_mul_i32 s50, s13, 14336
    s_add_u32 s47, s47, s50
    v_lshrrev_b32 v8, 5, v1
    v_lshlrev_b32 v8, 3, v8
    v_bfe_u32 v9, v1, 2, 2
    v_add_u32 v8, v8, v9
    v_mul_u32_u24 v16, 448, v8
    v_bfe_u32 v8, v1, 4, 1
    v_lshl_add_u32 v16, v8, 5, v16
    v_and_b32 v8, 3, v1
    v_lshl_add_u32 v16, v8, 3, v16
    v_and_b32 v8, 1, v1
    v_lshlrev_b32 v24, 4, v8
    v_bfe_u32 v8, v1, 1, 4
    v_add_u32 v24, v24, v8
    v_lshrrev_b32 v9, 5, v1
    v_lshl_add_u32 v24, v9, 5, v24
    v_lshlrev_b32 v24, 4, v24
    s_mul_i32 s48, s13, 7168
    s_add_u32 s50, s46, 0
    s_mov_b32 m0, s50
    s_add_u32 s51, s45, 0
    buffer_load_dwordx4 v5, s[68:71], s51 offen lds
    s_add_u32 s50, s46, 1024
    s_mov_b32 m0, s50
    s_add_u32 s51, s45, 65536
    buffer_load_dwordx4 v6, s[68:71], s51 offen lds
    s_add_u32 s50, s46, 2048
    s_mov_b32 m0, s50
    s_add_u32 s51, s45, 131072
    buffer_load_dwordx4 v5, s[68:71], s51 offen lds
    s_add_u32 s50, s46, 3072
    s_mov_b32 m0, s50
    s_add_u32 s51, s45, 196608
    buffer_load_dwordx4 v6, s[68:71], s51 offen lds
    s_add_u32 s50, s48, 16384
    s_mov_b32 m0, s50
    s_add_u32 s51, s47, 0
    buffer_load_dwordx4 v196, s[72:75], s51 offen lds
    s_add_u32 s50, s48, 17408
    s_mov_b32 m0, s50
    s_add_u32 s51, s47, 0
    buffer_load_dwordx4 v197, s[72:75], s51 offen lds
    s_add_u32 s50, s48, 18432
    s_mov_b32 m0, s50
    s_add_u32 s51, s47, 0
    buffer_load_dwordx4 v198, s[72:75], s51 offen lds
    s_add_u32 s50, s48, 19456
    s_mov_b32 m0, s50
    s_add_u32 s51, s47, 0
    buffer_load_dwordx4 v199, s[72:75], s51 offen lds
    s_add_u32 s50, s48, 20480
    s_mov_b32 m0, s50
    s_add_u32 s51, s47, 0
    buffer_load_dwordx4 v200, s[72:75], s51 offen lds
    s_add_u32 s50, s48, 21504
    s_mov_b32 m0, s50
    s_add_u32 s51, s47, 0
    buffer_load_dwordx4 v201, s[72:75], s51 offen lds
    s_add_u32 s50, s48, 22528
    s_mov_b32 m0, s50
    s_add_u32 s51, s47, 0
    buffer_load_dwordx4 v202, s[72:75], s51 offen lds
    s_add_u32 s50, s46, 45056
    s_mov_b32 m0, s50
    s_add_u32 s51, s45, 128
    buffer_load_dwordx4 v5, s[68:71], s51 offen lds
    s_add_u32 s50, s46, 46080
    s_mov_b32 m0, s50
    s_add_u32 s51, s45, 65664
    buffer_load_dwordx4 v6, s[68:71], s51 offen lds
    s_add_u32 s50, s46, 47104
    s_mov_b32 m0, s50
    s_add_u32 s51, s45, 131200
    buffer_load_dwordx4 v5, s[68:71], s51 offen lds
    s_add_u32 s50, s46, 48128
    s_mov_b32 m0, s50
    s_add_u32 s51, s45, 196736
    buffer_load_dwordx4 v6, s[68:71], s51 offen lds
    s_add_u32 s50, s48, 61440
    s_mov_b32 m0, s50
    s_add_u32 s51, s47, 57344
    buffer_load_dwordx4 v196, s[72:75], s51 offen lds
    s_add_u32 s50, s48, 62464
    s_mov_b32 m0, s50
    s_add_u32 s51, s47, 57344
    buffer_load_dwordx4 v197, s[72:75], s51 offen lds
    s_add_u32 s50, s48, 63488
    s_mov_b32 m0, s50
    s_add_u32 s51, s47, 57344
    buffer_load_dwordx4 v198, s[72:75], s51 offen lds
    s_add_u32 s50, s48, 64512
    s_mov_b32 m0, s50
    s_add_u32 s51, s47, 57344
    buffer_load_dwordx4 v199, s[72:75], s51 offen lds
    s_add_u32 s50, s48, 65536
    s_mov_b32 m0, s50
    s_add_u32 s51, s47, 57344
    buffer_load_dwordx4 v200, s[72:75], s51 offen lds
    s_add_u32 s50, s48, 66560
    s_mov_b32 m0, s50
    s_add_u32 s51, s47, 57344
    buffer_load_dwordx4 v201, s[72:75], s51 offen lds
    s_add_u32 s50, s48, 67584
    s_mov_b32 m0, s50
    s_add_u32 s51, s47, 57344
    buffer_load_dwordx4 v202, s[72:75], s51 offen lds
    s_waitcnt vmcnt(22)
    v_lshlrev_b32 v216, 16, v208
    v_and_b32 v217, 0xffff0000, v208
    v_lshlrev_b32 v218, 16, v209
    v_and_b32 v219, 0xffff0000, v209
    v_lshlrev_b32 v220, 16, v210
    v_and_b32 v221, 0xffff0000, v210
    v_lshlrev_b32 v222, 16, v211
    v_and_b32 v223, 0xffff0000, v211
    v_lshlrev_b32 v224, 16, v212
    v_and_b32 v225, 0xffff0000, v212
    v_lshlrev_b32 v226, 16, v213
    v_and_b32 v227, 0xffff0000, v213
    v_lshlrev_b32 v228, 16, v214
    v_and_b32 v229, 0xffff0000, v214
    v_lshlrev_b32 v230, 16, v215
    v_and_b32 v231, 0xffff0000, v215
    v_add_f32 v233, v216, v217
    v_add_f32 v233, v233, v218
    v_add_f32 v233, v233, v219
    v_add_f32 v233, v233, v220
    v_add_f32 v233, v233, v221
    v_add_f32 v233, v233, v222
    v_add_f32 v233, v233, v223
    v_add_f32 v233, v233, v224
    v_add_f32 v233, v233, v225
    v_add_f32 v233, v233, v226
    v_add_f32 v233, v233, v227
    v_add_f32 v233, v233, v228
    v_add_f32 v233, v233, v229
    v_add_f32 v233, v233, v230
    v_add_f32 v233, v233, v231
    s_nop 1
    v_add_f32_dpp v233, v233, v233 quad_perm:[1,0,3,2] row_mask:0xf bank_mask:0xf
    s_nop 1
    v_add_f32_dpp v233, v233, v233 quad_perm:[2,3,0,1] row_mask:0xf bank_mask:0xf
    s_nop 1
    v_add_f32_dpp v233, v233, v233 row_half_mirror row_mask:0xf bank_mask:0xf
    s_nop 1
    v_add_f32_dpp v233, v233, v233 row_mirror row_mask:0xf bank_mask:0xf
    v_mov_b32 v236, v233
    s_nop 1
    v_permlane16_swap_b32 v233, v236
    v_add_f32 v233, v233, v236
    v_mul_f32 v233, 0x3b124925, v233
    v_mov_b32 v234, 0
    v_sub_f32 v232, v216, v233
    v_fmac_f32 v234, v232, v232
    v_sub_f32 v232, v217, v233
    v_fmac_f32 v234, v232, v232
    v_sub_f32 v232, v218, v233
    v_fmac_f32 v234, v232, v232
    v_sub_f32 v232, v219, v233
    v_fmac_f32 v234, v232, v232
    v_sub_f32 v232, v220, v233
    v_fmac_f32 v234, v232, v232
    v_sub_f32 v232, v221, v233
    v_fmac_f32 v234, v232, v232
    v_sub_f32 v232, v222, v233
    v_fmac_f32 v234, v232, v232
    v_sub_f32 v232, v223, v233
    v_fmac_f32 v234, v232, v232
    v_sub_f32 v232, v224, v233
    v_fmac_f32 v234, v232, v232
    v_sub_f32 v232, v225, v233
    v_fmac_f32 v234, v232, v232
    v_sub_f32 v232, v226, v233
    v_fmac_f32 v234, v232, v232
    v_sub_f32 v232, v227, v233
    v_fmac_f32 v234, v232, v232
    v_sub_f32 v232, v228, v233
    v_fmac_f32 v234, v232, v232
    v_sub_f32 v232, v229, v233
    v_fmac_f32 v234, v232, v232
    v_sub_f32 v232, v230, v233
    v_fmac_f32 v234, v232, v232
    v_sub_f32 v232, v231, v233
    v_fmac_f32 v234, v232, v232
    v_and_b32 v232, 31, v1
    v_cmp_gt_u32 vcc, 28, v232
    s_nop 1
    v_cndmask_b32 v234, 0, v234, vcc
    s_nop 1
    v_add_f32_dpp v234, v234, v234 quad_perm:[1,0,3,2] row_mask:0xf bank_mask:0xf
    s_nop 1
    v_add_f32_dpp v234, v234, v234 quad_perm:[2,3,0,1] row_mask:0xf bank_mask:0xf
    s_nop 1
    v_add_f32_dpp v234, v234, v234 row_half_mirror row_mask:0xf bank_mask:0xf
    s_nop 1
    v_add_f32_dpp v234, v234, v234 row_mirror row_mask:0xf bank_mask:0xf
    v_mov_b32 v236, v234
    s_nop 1
    v_permlane16_swap_b32 v234, v236
    v_add_f32 v234, v234, v236
    v_mul_f32 v234, 0x3b124925, v234
    v_cvt_pk_bf16_f32 v233, v233, v233
    v_lshlrev_b32 v233, 16, v233
    v_cvt_pk_bf16_f32 v234, v234, v234
    v_lshlrev_b32 v234, 16, v234
    v_add_f32 v234, 0x3727c5ac, v234
    v_cvt_pk_bf16_f32 v234, v234, v234
    v_lshlrev_b32 v234, 16, v234
    v_sqrt_f32 v234, v234
    s_nop 0
    v_cvt_pk_bf16_f32 v234, v234, v234
    v_lshlrev_b32 v234, 16, v234
    v_rcp_f32 v234, v234
    v_sub_f32 v216, v216, v233
    v_sub_f32 v217, v217, v233
    v_cvt_pk_bf16_f32 v236, v216, v217
    v_lshlrev_b32 v216, 16, v236
    v_and_b32 v217, 0xffff0000, v236
    v_mul_f32 v216, v216, v234
    v_mul_f32 v217, v217, v234
    v_cvt_pk_bf16_f32 v208, v216, v217
    v_sub_f32 v218, v218, v233
    v_sub_f32 v219, v219, v233
    v_cvt_pk_bf16_f32 v236, v218, v219
    v_lshlrev_b32 v218, 16, v236
    v_and_b32 v219, 0xffff0000, v236
    v_mul_f32 v218, v218, v234
    v_mul_f32 v219, v219, v234
    v_cvt_pk_bf16_f32 v209, v218, v219
    v_sub_f32 v220, v220, v233
    v_sub_f32 v221, v221, v233
    v_cvt_pk_bf16_f32 v236, v220, v221
    v_lshlrev_b32 v220, 16, v236
    v_and_b32 v221, 0xffff0000, v236
    v_mul_f32 v220, v220, v234
    v_mul_f32 v221, v221, v234
    v_cvt_pk_bf16_f32 v210, v220, v221
    v_sub_f32 v222, v222, v233
    v_sub_f32 v223, v223, v233
    v_cvt_pk_bf16_f32 v236, v222, v223
    v_lshlrev_b32 v222, 16, v236
    v_and_b32 v223, 0xffff0000, v236
    v_mul_f32 v222, v222, v234
    v_mul_f32 v223, v223, v234
    v_cvt_pk_bf16_f32 v211, v222, v223
    v_sub_f32 v224, v224, v233
    v_sub_f32 v225, v225, v233
    v_cvt_pk_bf16_f32 v236, v224, v225
    v_lshlrev_b32 v224, 16, v236
    v_and_b32 v225, 0xffff0000, v236
    v_mul_f32 v224, v224, v234
    v_mul_f32 v225, v225, v234
    v_cvt_pk_bf16_f32 v212, v224, v225
    v_sub_f32 v226, v226, v233
    v_sub_f32 v227, v227, v233
    v_cvt_pk_bf16_f32 v236, v226, v227
    v_lshlrev_b32 v226, 16, v236
    v_and_b32 v227, 0xffff0000, v236
    v_mul_f32 v226, v226, v234
    v_mul_f32 v227, v227, v234
    v_cvt_pk_bf16_f32 v213, v226, v227
    v_sub_f32 v228, v228, v233
    v_sub_f32 v229, v229, v233
    v_cvt_pk_bf16_f32 v236, v228, v229
    v_lshlrev_b32 v228, 16, v236
    v_and_b32 v229, 0xffff0000, v236
    v_mul_f32 v228, v228, v234
    v_mul_f32 v229, v229, v234
    v_cvt_pk_bf16_f32 v214, v228, v229
    v_sub_f32 v230, v230, v233
    v_sub_f32 v231, v231, v233
    v_cvt_pk_bf16_f32 v236, v230, v231
    v_lshlrev_b32 v230, 16, v236
    v_and_b32 v231, 0xffff0000, v236
    v_mul_f32 v230, v230, v234
    v_mul_f32 v231, v231, v234
    v_cvt_pk_bf16_f32 v215, v230, v231
    v_lshlrev_b32 v235, 9, v232
    v_lshrrev_b32 v236, 5, v1
    v_lshl_add_u32 v235, v236, 4, v235
    v_mov_b32 v236, 0x40000000
    v_cndmask_b32 v235, v236, v235, vcc
    s_lshr_b32 s50, s2, 2
    s_mul_i32 s50, s50, 28672
    s_and_b32 s51, s2, 3
    s_lshl_b32 s51, s51, 2
    s_add_u32 s51, s51, s13
    s_lshl_b32 s51, s51, 5
    s_add_u32 s50, s50, s51
    s_add_u32 s79, s50, 0
    v_mov_b32 v32, 0
    v_mov_b32 v33, 0
    v_mov_b32 v34, 0
    v_mov_b32 v35, 0
    v_mov_b32 v36, 0
    v_mov_b32 v37, 0
    v_mov_b32 v38, 0
    v_mov_b32 v39, 0
    v_mov_b32 v40, 0
    v_mov_b32 v41, 0
    v_mov_b32 v42, 0
    v_mov_b32 v43, 0
    v_mov_b32 v44, 0
    v_mov_b32 v45, 0
    v_mov_b32 v46, 0
    v_mov_b32 v47, 0
    v_mov_b32 v48, 0
    v_mov_b32 v49, 0
    v_mov_b32 v50, 0
    v_mov_b32 v51, 0
    v_mov_b32 v52, 0
    v_mov_b32 v53, 0
    v_mov_b32 v54, 0
    v_mov_b32 v55, 0
    v_mov_b32 v56, 0
    v_mov_b32 v57, 0
    v_mov_b32 v58, 0
    v_mov_b32 v59, 0
    v_mov_b32 v60, 0
    v_mov_b32 v61, 0
    v_mov_b32 v62, 0
    v_mov_b32 v63, 0
    v_mov_b32 v64, 0
    v_mov_b32 v65, 0
    v_mov_b32 v66, 0
    v_mov_b32 v67, 0
    v_mov_b32 v68, 0
    v_mov_b32 v69, 0
    v_mov_b32 v70, 0
    v_mov_b32 v71, 0
    v_mov_b32 v72, 0
    v_mov_b32 v73, 0
    v_mov_b32 v74, 0
    v_mov_b32 v75, 0
    v_mov_b32 v76, 0
    v_mov_b32 v77, 0
    v_mov_b32 v78, 0
    v_mov_b32 v79, 0
    v_mov_b32 v80, 0
    v_mov_b32 v81, 0
    v_mov_b32 v82, 0
    v_mov_b32 v83, 0
    v_mov_b32 v84, 0
    v_mov_b32 v85, 0
    v_mov_b32 v86, 0
    v_mov_b32 v87, 0
    v_mov_b32 v88, 0
    v_mov_b32 v89, 0
    v_mov_b32 v90, 0
    v_mov_b32 v91, 0
    v_mov_b32 v92, 0
    v_mov_b32 v93, 0
    v_mov_b32 v94, 0
    v_mov_b32 v95, 0
    v_mov_b32 v96, 0
    v_mov_b32 v97, 0
    v_mov_b32 v98, 0
    v_mov_b32 v99, 0
    v_mov_b32 v100, 0
    v_mov_b32 v101, 0
    v_mov_b32 v102, 0
    v_mov_b32 v103, 0
    v_mov_b32 v104, 0
    v_mov_b32 v105, 0
    v_mov_b32 v106, 0
    v_mov_b32 v107, 0
    v_mov_b32 v108, 0
    v_mov_b32 v109, 0
    v_mov_b32 v110, 0
    v_mov_b32 v111, 0
    v_mov_b32 v112, 0
    v_mov_b32 v113, 0
    v_mov_b32 v114, 0
    v_mov_b32 v115, 0
    v_mov_b32 v116, 0
    v_mov_b32 v117, 0
    v_mov_b32 v118, 0
    v_mov_b32 v119, 0
    v_mov_b32 v120, 0
    v_mov_b32 v121, 0
    v_mov_b32 v122, 0
    v_mov_b32 v123, 0
    v_mov_b32 v124, 0
    v_mov_b32 v125, 0
    v_mov_b32 v126, 0
    v_mov_b32 v127, 0
    v_mov_b32 v128, 0
    v_mov_b32 v129, 0
    v_mov_b32 v130, 0
    v_mov_b32 v131, 0
    v_mov_b32 v132, 0
    v_mov_b32 v133, 0
    v_mov_b32 v134, 0
    v_mov_b32 v135, 0
    v_mov_b32 v136, 0
    v_mov_b32 v137, 0
    v_mov_b32 v138, 0
    v_mov_b32 v139, 0
    v_mov_b32 v140, 0
    v_mov_b32 v141, 0
    v_mov_b32 v142, 0
    v_mov_b32 v143, 0
    s_waitcnt vmcnt(11)
    s_barrier
    buffer_store_dwordx4 v[208:211], v235, s[8:11], s79 offen sc1
    s_add_u32 s79, s79, 14336
    buffer_store_dwordx4 v[212:215], v235, s[8:11], s79 offen sc1
    ds_read_b128 a[0:3], v12 offset:0
    ds_read_b64_tr_b16 a[8:9], v16 offset:16384
    ds_read_b64_tr_b16 a[10:11], v16 offset:18176
    ds_read_b64_tr_b16 a[12:13], v16 offset:16448
    ds_read_b64_tr_b16 a[14:15], v16 offset:18240
    ds_read_b64_tr_b16 a[16:17], v16 offset:16512
    ds_read_b64_tr_b16 a[18:19], v16 offset:18304
    ds_read_b64_tr_b16 a[20:21], v16 offset:16576
    ds_read_b64_tr_b16 a[22:23], v16 offset:18368
    ds_read_b64_tr_b16 a[24:25], v16 offset:16640
    ds_read_b64_tr_b16 a[26:27], v16 offset:18432
    ds_read_b64_tr_b16 a[28:29], v16 offset:16704
    ds_read_b64_tr_b16 a[30:31], v16 offset:18496
    ds_read_b64_tr_b16 a[32:33], v16 offset:16768
    ds_read_b64_tr_b16 a[34:35], v16 offset:18560
    ds_read_b128 a[4:7], v13 offset:0
    s_waitcnt lgkmcnt(13)
    v_mfma_f32_32x32x16_bf16 v[32:47], a[0:3], a[8:11], v[32:47]
    ds_read_b64_tr_b16 a[36:37], v16 offset:23552
    ds_read_b64_tr_b16 a[38:39], v16 offset:25344
    s_add_u32 s50, s46, 90112
    s_mov_b32 m0, s50
    s_add_u32 s51, s45, 256
    buffer_load_dwordx4 v5, s[68:71], s51 offen lds
    s_waitcnt lgkmcnt(13)
    v_mfma_f32_32x32x16_bf16 v[48:63], a[0:3], a[12:15], v[48:63]
    ds_read_b64_tr_b16 a[40:41], v16 offset:23616
    ds_read_b64_tr_b16 a[42:43], v16 offset:25408
    s_waitcnt lgkmcnt(13)
    v_mfma_f32_32x32x16_bf16 v[64:79], a[0:3], a[16:19], v[64:79]
    ds_read_b64_tr_b16 a[44:45], v16 offset:23680
    ds_read_b64_tr_b16 a[46:47], v16 offset:25472
    s_add_u32 s50, s46, 91136
    s_mov_b32 m0, s50
    s_add_u32 s51, s45, 65792
    buffer_load_dwordx4 v6, s[68:71], s51 offen lds
    s_waitcnt lgkmcnt(13)
    v_mfma_f32_32x32x16_bf16 v[80:95], a[0:3], a[20:23], v[80:95]
    ds_read_b64_tr_b16 a[48:49], v16 offset:23744
    ds_read_b64_tr_b16 a[50:51], v16 offset:25536
    s_waitcnt lgkmcnt(13)
    v_mfma_f32_32x32x16_bf16 v[96:111], a[0:3], a[24:27], v[96:111]
    ds_read_b64_tr_b16 a[52:53], v16 offset:23808
    ds_read_b64_tr_b16 a[54:55], v16 offset:25600
    s_add_u32 s50, s46, 92160
    s_mov_b32 m0, s50
    s_add_u32 s51, s45, 131328
    buffer_load_dwordx4 v5, s[68:71], s51 offen lds
    s_waitcnt lgkmcnt(13)
    v_mfma_f32_32x32x16_bf16 v[112:127], a[0:3], a[28:31], v[112:127]
    ds_read_b64_tr_b16 a[56:57], v16 offset:23872
    ds_read_b64_tr_b16 a[58:59], v16 offset:25664
    s_waitcnt lgkmcnt(13)
    v_mfma_f32_32x32x16_bf16 v[128:143], a[0:3], a[32:35], v[128:143]
    ds_read_b64_tr_b16 a[60:61], v16 offset:23936
    ds_read_b64_tr_b16 a[62:63], v16 offset:25728
    s_add_u32 s50, s46, 93184
    s_mov_b32 m0, s50
    s_add_u32 s51, s45, 196864
    buffer_load_dwordx4 v6, s[68:71], s51 offen lds
    ds_read_b128 a[0:3], v14 offset:0
    s_waitcnt lgkmcnt(13)
    v_mfma_f32_32x32x16_bf16 v[32:47], a[4:7], a[36:39], v[32:47]
    ds_read_b64_tr_b16 a[8:9], v16 offset:30720
    ds_read_b64_tr_b16 a[10:11], v16 offset:32512
    s_add_u32 s50, s48, 106496
    s_mov_b32 m0, s50
    s_add_u32 s51, s47, 114688
    buffer_load_dwordx4 v196, s[72:75], s51 offen lds
    s_waitcnt lgkmcnt(13)
    v_mfma_f32_32x32x16_bf16 v[48:63], a[4:7], a[40:43], v[48:63]
    ds_read_b64_tr_b16 a[12:13], v16 offset:30784
    ds_read_b64_tr_b16 a[14:15], v16 offset:32576
    s_waitcnt lgkmcnt(13)
    v_mfma_f32_32x32x16_bf16 v[64:79], a[4:7], a[44:47], v[64:79]
    ds_read_b64_tr_b16 a[16:17], v16 offset:30848
    ds_read_b64_tr_b16 a[18:19], v16 offset:32640
    s_add_u32 s50, s48, 107520
    s_mov_b32 m0, s50
    s_add_u32 s51, s47, 114688
    buffer_load_dwordx4 v197, s[72:75], s51 offen lds
    s_waitcnt lgkmcnt(13)
    v_mfma_f32_32x32x16_bf16 v[80:95], a[4:7], a[48:51], v[80:95]
    ds_read_b64_tr_b16 a[20:21], v16 offset:30912
    ds_read_b64_tr_b16 a[22:23], v16 offset:32704
    s_waitcnt lgkmcnt(13)
    v_mfma_f32_32x32x16_bf16 v[96:111], a[4:7], a[52:55], v[96:111]
    ds_read_b64_tr_b16 a[24:25], v16 offset:30976
    ds_read_b64_tr_b16 a[26:27], v16 offset:32768
    s_add_u32 s50, s48, 108544
    s_mov_b32 m0, s50
    s_add_u32 s51, s47, 114688
    buffer_load_dwordx4 v198, s[72:75], s51 offen lds
    s_waitcnt lgkmcnt(13)
    v_mfma_f32_32x32x16_bf16 v[112:127], a[4:7], a[56:59], v[112:127]
    ds_read_b64_tr_b16 a[28:29], v16 offset:31040
    ds_read_b64_tr_b16 a[30:31], v16 offset:32832
    s_waitcnt lgkmcnt(13)
    v_mfma_f32_32x32x16_bf16 v[128:143], a[4:7], a[60:63], v[128:143]
    ds_read_b64_tr_b16 a[32:33], v16 offset:31104
    ds_read_b64_tr_b16 a[34:35], v16 offset:32896
    s_add_u32 s50, s48, 109568
    s_mov_b32 m0, s50
    s_add_u32 s51, s47, 114688
    buffer_load_dwordx4 v199, s[72:75], s51 offen lds
    ds_read_b128 a[4:7], v15 offset:0
    s_waitcnt lgkmcnt(13)
    v_mfma_f32_32x32x16_bf16 v[32:47], a[0:3], a[8:11], v[32:47]
    ds_read_b64_tr_b16 a[36:37], v16 offset:37888
    ds_read_b64_tr_b16 a[38:39], v16 offset:39680
    s_add_u32 s50, s48, 110592
    s_mov_b32 m0, s50
    s_add_u32 s51, s47, 114688
    buffer_load_dwordx4 v200, s[72:75], s51 offen lds
    s_waitcnt lgkmcnt(13)
    v_mfma_f32_32x32x16_bf16 v[48:63], a[0:3], a[12:15], v[48:63]
    ds_read_b64_tr_b16 a[40:41], v16 offset:37952
    ds_read_b64_tr_b16 a[42:43], v16 offset:39744
    s_waitcnt lgkmcnt(13)
    v_mfma_f32_32x32x16_bf16 v[64:79], a[0:3], a[16:19], v[64:79]
    ds_read_b64_tr_b16 a[44:45], v16 offset:38016
    ds_read_b64_tr_b16 a[46:47], v16 offset:39808
    s_add_u32 s50, s48, 111616
    s_mov_b32 m0, s50
    s_add_u32 s51, s47, 114688
    buffer_load_dwordx4 v201, s[72:75], s51 offen lds
    s_waitcnt lgkmcnt(13)
    v_mfma_f32_32x32x16_bf16 v[80:95], a[0:3], a[20:23], v[80:95]
    ds_read_b64_tr_b16 a[48:49], v16 offset:38080
    ds_read_b64_tr_b16 a[50:51], v16 offset:39872
    s_waitcnt lgkmcnt(13)
    v_mfma_f32_32x32x16_bf16 v[96:111], a[0:3], a[24:27], v[96:111]
    ds_read_b64_tr_b16 a[52:53], v16 offset:38144
    ds_read_b64_tr_b16 a[54:55], v16 offset:39936
    s_add_u32 s50, s48, 112640
    s_mov_b32 m0, s50
    s_add_u32 s51, s47, 114688
    buffer_load_dwordx4 v202, s[72:75], s51 offen lds
    s_waitcnt lgkmcnt(13)
    v_mfma_f32_32x32x16_bf16 v[112:127], a[0:3], a[28:31], v[112:127]
    ds_read_b64_tr_b16 a[56:57], v16 offset:38208
    ds_read_b64_tr_b16 a[58:59], v16 offset:40000
    s_waitcnt lgkmcnt(13)
    v_mfma_f32_32x32x16_bf16 v[128:143], a[0:3], a[32:35], v[128:143]
    ds_read_b64_tr_b16 a[60:61], v16 offset:38272
    ds_read_b64_tr_b16 a[62:63], v16 offset:40064
    s_waitcnt lgkmcnt(12)
    v_mfma_f32_32x32x16_bf16 v[32:47], a[4:7], a[36:39], v[32:47]
    s_waitcnt lgkmcnt(10)
    v_mfma_f32_32x32x16_bf16 v[48:63], a[4:7], a[40:43], v[48:63]
    s_waitcnt lgkmcnt(8)
    v_mfma_f32_32x32x16_bf16 v[64:79], a[4:7], a[44:47], v[64:79]
    s_waitcnt lgkmcnt(6)
    v_mfma_f32_32x32x16_bf16 v[80:95], a[4:7], a[48:51], v[80:95]
    s_waitcnt lgkmcnt(4)
    v_mfma_f32_32x32x16_bf16 v[96:111], a[4:7], a[52:55], v[96:111]
    s_waitcnt lgkmcnt(2)
    v_mfma_f32_32x32x16_bf16 v[112:127], a[4:7], a[56:59], v[112:127]
    s_waitcnt lgkmcnt(0)
    v_mfma_f32_32x32x16_bf16 v[128:143], a[4:7], a[60:63], v[128:143]
    v_add_u32 v12, 0xb000, v12
    v_add_u32 v13, 0xb000, v13
    v_add_u32 v14, 0xb000, v14
    v_add_u32 v15, 0xb000, v15
    v_add_u32 v16, 0xb000, v16
    v_add_u32 v17, 0xb000, v17
    v_add_u32 v18, 0xb000, v18
    v_add_u32 v19, 0xb000, v19
    s_waitcnt vmcnt(13)
    s_barrier
    ds_read_b128 a[0:3], v12 offset:0
    ds_read_b64_tr_b16 a[8:9], v16 offset:16384
    ds_read_b64_tr_b16 a[10:11], v16 offset:18176
    ds_read_b64_tr_b16 a[12:13], v16 offset:16448
    ds_read_b64_tr_b16 a[14:15], v16 offset:18240
    ds_read_b64_tr_b16 a[16:17], v16 offset:16512
    ds_read_b64_tr_b16 a[18:19], v16 offset:18304
    ds_read_b64_tr_b16 a[20:21], v16 offset:16576
    ds_read_b64_tr_b16 a[22:23], v16 offset:18368
    ds_read_b64_tr_b16 a[24:25], v16 offset:16640
    ds_read_b64_tr_b16 a[26:27], v16 offset:18432
    ds_read_b64_tr_b16 a[28:29], v16 offset:16704
    ds_read_b64_tr_b16 a[30:31], v16 offset:18496
    ds_read_b64_tr_b16 a[32:33], v16 offset:16768
    ds_read_b64_tr_b16 a[34:35], v16 offset:18560
    ds_read_b128 a[4:7], v13 offset:0
    s_waitcnt lgkmcnt(13)
    v_mfma_f32_32x32x16_bf16 v[32:47], a[0:3], a[8:11], v[32:47]
    ds_read_b64_tr_b16 a[36:37], v16 offset:23552
    ds_read_b64_tr_b16 a[38:39], v16 offset:25344
    s_add_u32 s50, s46, 0
    s_mov_b32 m0, s50
    s_add_u32 s51, s45, 384
    buffer_load_dwordx4 v5, s[68:71], s51 offen lds
    s_waitcnt lgkmcnt(13)
    v_mfma_f32_32x32x16_bf16 v[48:63], a[0:3], a[12:15], v[48:63]
    ds_read_b64_tr_b16 a[40:41], v16 offset:23616
    ds_read_b64_tr_b16 a[42:43], v16 offset:25408
    s_waitcnt lgkmcnt(13)
    v_mfma_f32_32x32x16_bf16 v[64:79], a[0:3], a[16:19], v[64:79]
    ds_read_b64_tr_b16 a[44:45], v16 offset:23680
    ds_read_b64_tr_b16 a[46:47], v16 offset:25472
    s_add_u32 s50, s46, 1024
    s_mov_b32 m0, s50
    s_add_u32 s51, s45, 65920
    buffer_load_dwordx4 v6, s[68:71], s51 offen lds
    s_waitcnt lgkmcnt(13)
    v_mfma_f32_32x32x16_bf16 v[80:95], a[0:3], a[20:23], v[80:95]
    ds_read_b64_tr_b16 a[48:49], v16 offset:23744
    ds_read_b64_tr_b16 a[50:51], v16 offset:25536
    s_waitcnt lgkmcnt(13)
    v_mfma_f32_32x32x16_bf16 v[96:111], a[0:3], a[24:27], v[96:111]
    ds_read_b64_tr_b16 a[52:53], v16 offset:23808
    ds_read_b64_tr_b16 a[54:55], v16 offset:25600
    s_add_u32 s50, s46, 2048
    s_mov_b32 m0, s50
    s_add_u32 s51, s45, 131456
    buffer_load_dwordx4 v5, s[68:71], s51 offen lds
    s_waitcnt lgkmcnt(13)
    v_mfma_f32_32x32x16_bf16 v[112:127], a[0:3], a[28:31], v[112:127]
    ds_read_b64_tr_b16 a[56:57], v16 offset:23872
    ds_read_b64_tr_b16 a[58:59], v16 offset:25664
    s_waitcnt lgkmcnt(13)
    v_mfma_f32_32x32x16_bf16 v[128:143], a[0:3], a[32:35], v[128:143]
    ds_read_b64_tr_b16 a[60:61], v16 offset:23936
    ds_read_b64_tr_b16 a[62:63], v16 offset:25728
    s_add_u32 s50, s46, 3072
    s_mov_b32 m0, s50
    s_add_u32 s51, s45, 196992
    buffer_load_dwordx4 v6, s[68:71], s51 offen lds
    ds_read_b128 a[0:3], v14 offset:0
    s_waitcnt lgkmcnt(13)
    v_mfma_f32_32x32x16_bf16 v[32:47], a[4:7], a[36:39], v[32:47]
    ds_read_b64_tr_b16 a[8:9], v16 offset:30720
    ds_read_b64_tr_b16 a[10:11], v16 offset:32512
    s_add_u32 s50, s48, 16384
    s_mov_b32 m0, s50
    s_add_u32 s51, s47, 172032
    buffer_load_dwordx4 v196, s[72:75], s51 offen lds
    s_waitcnt lgkmcnt(13)
    v_mfma_f32_32x32x16_bf16 v[48:63], a[4:7], a[40:43], v[48:63]
    ds_read_b64_tr_b16 a[12:13], v16 offset:30784
    ds_read_b64_tr_b16 a[14:15], v16 offset:32576
    s_waitcnt lgkmcnt(13)
    v_mfma_f32_32x32x16_bf16 v[64:79], a[4:7], a[44:47], v[64:79]
    ds_read_b64_tr_b16 a[16:17], v16 offset:30848
    ds_read_b64_tr_b16 a[18:19], v16 offset:32640
    s_add_u32 s50, s48, 17408
    s_mov_b32 m0, s50
    s_add_u32 s51, s47, 172032
    buffer_load_dwordx4 v197, s[72:75], s51 offen lds
    s_waitcnt lgkmcnt(13)
    v_mfma_f32_32x32x16_bf16 v[80:95], a[4:7], a[48:51], v[80:95]
    ds_read_b64_tr_b16 a[20:21], v16 offset:30912
    ds_read_b64_tr_b16 a[22:23], v16 offset:32704
    s_waitcnt lgkmcnt(13)
    v_mfma_f32_32x32x16_bf16 v[96:111], a[4:7], a[52:55], v[96:111]
    ds_read_b64_tr_b16 a[24:25], v16 offset:30976
    ds_read_b64_tr_b16 a[26:27], v16 offset:32768
    s_add_u32 s50, s48, 18432
    s_mov_b32 m0, s50
    s_add_u32 s51, s47, 172032
    buffer_load_dwordx4 v198, s[72:75], s51 offen lds
    s_waitcnt lgkmcnt(13)
    v_mfma_f32_32x32x16_bf16 v[112:127], a[4:7], a[56:59], v[112:127]
    ds_read_b64_tr_b16 a[28:29], v16 offset:31040
    ds_read_b64_tr_b16 a[30:31], v16 offset:32832
    s_waitcnt lgkmcnt(13)
    v_mfma_f32_32x32x16_bf16 v[128:143], a[4:7], a[60:63], v[128:143]
    ds_read_b64_tr_b16 a[32:33], v16 offset:31104
    ds_read_b64_tr_b16 a[34:35], v16 offset:32896
    s_add_u32 s50, s48, 19456
    s_mov_b32 m0, s50
    s_add_u32 s51, s47, 172032
    buffer_load_dwordx4 v199, s[72:75], s51 offen lds
    ds_read_b128 a[4:7], v15 offset:0
    s_waitcnt lgkmcnt(13)
    v_mfma_f32_32x32x16_bf16 v[32:47], a[0:3], a[8:11], v[32:47]
    ds_read_b64_tr_b16 a[36:37], v16 offset:37888
    ds_read_b64_tr_b16 a[38:39], v16 offset:39680
    s_add_u32 s50, s48, 20480
    s_mov_b32 m0, s50
    s_add_u32 s51, s47, 172032
    buffer_load_dwordx4 v200, s[72:75], s51 offen lds
    s_waitcnt lgkmcnt(13)
    v_mfma_f32_32x32x16_bf16 v[48:63], a[0:3], a[12:15], v[48:63]
    ds_read_b64_tr_b16 a[40:41], v16 offset:37952
    ds_read_b64_tr_b16 a[42:43], v16 offset:39744
    s_waitcnt lgkmcnt(13)
    v_mfma_f32_32x32x16_bf16 v[64:79], a[0:3], a[16:19], v[64:79]
    ds_read_b64_tr_b16 a[44:45], v16 offset:38016
    ds_read_b64_tr_b16 a[46:47], v16 offset:39808
    s_add_u32 s50, s48, 21504
    s_mov_b32 m0, s50
    s_add_u32 s51, s47, 172032
    buffer_load_dwordx4 v201, s[72:75], s51 offen lds
    s_waitcnt lgkmcnt(13)
    v_mfma_f32_32x32x16_bf16 v[80:95], a[0:3], a[20:23], v[80:95]
    ds_read_b64_tr_b16 a[48:49], v16 offset:38080
    ds_read_b64_tr_b16 a[50:51], v16 offset:39872
    s_waitcnt lgkmcnt(13)
    v_mfma_f32_32x32x16_bf16 v[96:111], a[0:3], a[24:27], v[96:111]
    ds_read_b64_tr_b16 a[52:53], v16 offset:38144
    ds_read_b64_tr_b16 a[54:55], v16 offset:39936
    s_add_u32 s50, s48, 22528
    s_mov_b32 m0, s50
    s_add_u32 s51, s47, 172032
    buffer_load_dwordx4 v202, s[72:75], s51 offen lds
    s_waitcnt lgkmcnt(13)
    v_mfma_f32_32x32x16_bf16 v[112:127], a[0:3], a[28:31], v[112:127]
    ds_read_b64_tr_b16 a[56:57], v16 offset:38208
    ds_read_b64_tr_b16 a[58:59], v16 offset:40000
    s_waitcnt lgkmcnt(13)
    v_mfma_f32_32x32x16_bf16 v[128:143], a[0:3], a[32:35], v[128:143]
    ds_read_b64_tr_b16 a[60:61], v16 offset:38272
    ds_read_b64_tr_b16 a[62:63], v16 offset:40064
    s_waitcnt lgkmcnt(12)
    v_mfma_f32_32x32x16_bf16 v[32:47], a[4:7], a[36:39], v[32:47]
    s_waitcnt lgkmcnt(10)
    v_mfma_f32_32x32x16_bf16 v[48:63], a[4:7], a[40:43], v[48:63]
    s_waitcnt lgkmcnt(8)
    v_mfma_f32_32x32x16_bf16 v[64:79], a[4:7], a[44:47], v[64:79]
    s_waitcnt lgkmcnt(6)
    v_mfma_f32_32x32x16_bf16 v[80:95], a[4:7], a[48:51], v[80:95]
    s_waitcnt lgkmcnt(4)
    v_mfma_f32_32x32x16_bf16 v[96:111], a[4:7], a[52:55], v[96:111]
    s_waitcnt lgkmcnt(2)
    v_mfma_f32_32x32x16_bf16 v[112:127], a[4:7], a[56:59], v[112:127]
    s_waitcnt lgkmcnt(0)
    v_mfma_f32_32x32x16_bf16 v[128:143], a[4:7], a[60:63], v[128:143]
    v_add_u32 v12, 0xb000, v12
    v_add_u32 v13, 0xb000, v13
    v_add_u32 v14, 0xb000, v14
    v_add_u32 v15, 0xb000, v15
    v_add_u32 v16, 0xb000, v16
    v_add_u32 v17, 0xb000, v17
    v_add_u32 v18, 0xb000, v18
    v_add_u32 v19, 0xb000, v19
    s_waitcnt vmcnt(11)
    s_barrier
    ds_read_b128 a[0:3], v12 offset:0
    ds_read_b64_tr_b16 a[8:9], v16 offset:16384
    ds_read_b64_tr_b16 a[10:11], v16 offset:18176
    ds_read_b64_tr_b16 a[12:13], v16 offset:16448
    ds_read_b64_tr_b16 a[14:15], v16 offset:18240
    ds_read_b64_tr_b16 a[16:17], v16 offset:16512
    ds_read_b64_tr_b16 a[18:19], v16 offset:18304
    ds_read_b64_tr_b16 a[20:21], v16 offset:16576
    ds_read_b64_tr_b16 a[22:23], v16 offset:18368
    ds_read_b64_tr_b16 a[24:25], v16 offset:16640
    ds_read_b64_tr_b16 a[26:27], v16 offset:18432
    ds_read_b64_tr_b16 a[28:29], v16 offset:16704
    ds_read_b64_tr_b16 a[30:31], v16 offset:18496
    ds_read_b64_tr_b16 a[32:33], v16 offset:16768
    ds_read_b64_tr_b16 a[34:35], v16 offset:18560
    ds_read_b128 a[4:7], v13 offset:0
    s_waitcnt lgkmcnt(13)
    v_mfma_f32_32x32x16_bf16 v[32:47], a[0:3], a[8:11], v[32:47]
    ds_read_b64_tr_b16 a[36:37], v16 offset:23552
    ds_read_b64_tr_b16 a[38:39], v16 offset:25344
    s_waitcnt lgkmcnt(13)
    v_mfma_f32_32x32x16_bf16 v[48:63], a[0:3], a[12:15], v[48:63]
    ds_read_b64_tr_b16 a[40:41], v16 offset:23616
    ds_read_b64_tr_b16 a[42:43], v16 offset:25408
    s_waitcnt lgkmcnt(13)
    v_mfma_f32_32x32x16_bf16 v[64:79], a[0:3], a[16:19], v[64:79]
    ds_read_b64_tr_b16 a[44:45], v16 offset:23680
    ds_read_b64_tr_b16 a[46:47], v16 offset:25472
    s_waitcnt lgkmcnt(13)
    v_mfma_f32_32x32x16_bf16 v[80:95], a[0:3], a[20:23], v[80:95]
    ds_read_b64_tr_b16 a[48:49], v16 offset:23744
    ds_read_b64_tr_b16 a[50:51], v16 offset:25536
    s_waitcnt lgkmcnt(13)
    v_mfma_f32_32x32x16_bf16 v[96:111], a[0:3], a[24:27], v[96:111]
    ds_read_b64_tr_b16 a[52:53], v16 offset:23808
    ds_read_b64_tr_b16 a[54:55], v16 offset:25600
    s_waitcnt lgkmcnt(13)
    v_mfma_f32_32x32x16_bf16 v[112:127], a[0:3], a[28:31], v[112:127]
    ds_read_b64_tr_b16 a[56:57], v16 offset:23872
    ds_read_b64_tr_b16 a[58:59], v16 offset:25664
    s_waitcnt lgkmcnt(13)
    v_mfma_f32_32x32x16_bf16 v[128:143], a[0:3], a[32:35], v[128:143]
    ds_read_b64_tr_b16 a[60:61], v16 offset:23936
    ds_read_b64_tr_b16 a[62:63], v16 offset:25728
    ds_read_b128 a[0:3], v14 offset:0
    s_waitcnt lgkmcnt(13)
    v_mfma_f32_32x32x16_bf16 v[32:47], a[4:7], a[36:39], v[32:47]
    ds_read_b64_tr_b16 a[8:9], v16 offset:30720
    ds_read_b64_tr_b16 a[10:11], v16 offset:32512
    s_waitcnt lgkmcnt(13)
    v_mfma_f32_32x32x16_bf16 v[48:63], a[4:7], a[40:43], v[48:63]
    ds_read_b64_tr_b16 a[12:13], v16 offset:30784
    ds_read_b64_tr_b16 a[14:15], v16 offset:32576
    s_waitcnt lgkmcnt(13)
    v_mfma_f32_32x32x16_bf16 v[64:79], a[4:7], a[44:47], v[64:79]
    ds_read_b64_tr_b16 a[16:17], v16 offset:30848
    ds_read_b64_tr_b16 a[18:19], v16 offset:32640
    s_waitcnt lgkmcnt(13)
    v_mfma_f32_32x32x16_bf16 v[80:95], a[4:7], a[48:51], v[80:95]
    ds_read_b64_tr_b16 a[20:21], v16 offset:30912
    ds_read_b64_tr_b16 a[22:23], v16 offset:32704
    s_waitcnt lgkmcnt(13)
    v_mfma_f32_32x32x16_bf16 v[96:111], a[4:7], a[52:55], v[96:111]
    ds_read_b64_tr_b16 a[24:25], v16 offset:30976
    ds_read_b64_tr_b16 a[26:27], v16 offset:32768
    s_waitcnt lgkmcnt(13)
    v_mfma_f32_32x32x16_bf16 v[112:127], a[4:7], a[56:59], v[112:127]
    ds_read_b64_tr_b16 a[28:29], v16 offset:31040
    ds_read_b64_tr_b16 a[30:31], v16 offset:32832
    s_waitcnt lgkmcnt(13)
    v_mfma_f32_32x32x16_bf16 v[128:143], a[4:7], a[60:63], v[128:143]
    ds_read_b64_tr_b16 a[32:33], v16 offset:31104
    ds_read_b64_tr_b16 a[34:35], v16 offset:32896
    ds_read_b128 a[4:7], v15 offset:0
    s_waitcnt lgkmcnt(13)
    v_mfma_f32_32x32x16_bf16 v[32:47], a[0:3], a[8:11], v[32:47]
    ds_read_b64_tr_b16 a[36:37], v16 offset:37888
    ds_read_b64_tr_b16 a[38:39], v16 offset:39680
    s_waitcnt lgkmcnt(13)
    v_mfma_f32_32x32x16_bf16 v[48:63], a[0:3], a[12:15], v[48:63]
    ds_read_b64_tr_b16 a[40:41], v16 offset:37952
    ds_read_b64_tr_b16 a[42:43], v16 offset:39744
    s_waitcnt lgkmcnt(13)
    v_mfma_f32_32x32x16_bf16 v[64:79], a[0:3], a[16:19], v[64:79]
    ds_read_b64_tr_b16 a[44:45], v16 offset:38016
    ds_read_b64_tr_b16 a[46:47], v16 offset:39808
    s_waitcnt lgkmcnt(13)
    v_mfma_f32_32x32x16_bf16 v[80:95], a[0:3], a[20:23], v[80:95]
    ds_read_b64_tr_b16 a[48:49], v16 offset:38080
    ds_read_b64_tr_b16 a[50:51], v16 offset:39872
    s_waitcnt lgkmcnt(13)
    v_mfma_f32_32x32x16_bf16 v[96:111], a[0:3], a[24:27], v[96:111]
    ds_read_b64_tr_b16 a[52:53], v16 offset:38144
    ds_read_b64_tr_b16 a[54:55], v16 offset:39936
    s_waitcnt lgkmcnt(13)
    v_mfma_f32_32x32x16_bf16 v[112:127], a[0:3], a[28:31], v[112:127]
    ds_read_b64_tr_b16 a[56:57], v16 offset:38208
    ds_read_b64_tr_b16 a[58:59], v16 offset:40000
    s_waitcnt lgkmcnt(13)
    v_mfma_f32_32x32x16_bf16 v[128:143], a[0:3], a[32:35], v[128:143]
    ds_read_b64_tr_b16 a[60:61], v16 offset:38272
    ds_read_b64_tr_b16 a[62:63], v16 offset:40064
    s_waitcnt lgkmcnt(12)
    v_mfma_f32_32x32x16_bf16 v[32:47], a[4:7], a[36:39], v[32:47]
    s_waitcnt lgkmcnt(10)
    v_mfma_f32_32x32x16_bf16 v[48:63], a[4:7], a[40:43], v[48:63]
    s_waitcnt lgkmcnt(8)
    v_mfma_f32_32x32x16_bf16 v[64:79], a[4:7], a[44:47], v[64:79]
    s_waitcnt lgkmcnt(6)
    v_mfma_f32_32x32x16_bf16 v[80:95], a[4:7], a[48:51], v[80:95]
    s_waitcnt lgkmcnt(4)
    v_mfma_f32_32x32x16_bf16 v[96:111], a[4:7], a[52:55], v[96:111]
    s_waitcnt lgkmcnt(2)
    v_mfma_f32_32x32x16_bf16 v[112:127], a[4:7], a[56:59], v[112:127]
    s_waitcnt lgkmcnt(0)
    v_mfma_f32_32x32x16_bf16 v[128:143], a[4:7], a[60:63], v[128:143]
    v_add_u32 v12, 0xfffea000, v12
    v_add_u32 v13, 0xfffea000, v13
    v_add_u32 v14, 0xfffea000, v14
    v_add_u32 v15, 0xfffea000, v15
    v_add_u32 v16, 0xfffea000, v16
    v_add_u32 v17, 0xfffea000, v17
    v_add_u32 v18, 0xfffea000, v18
    v_add_u32 v19, 0xfffea000, v19
    s_waitcnt vmcnt(0)
    s_barrier
    ds_read_b128 a[0:3], v12 offset:0
    ds_read_b64_tr_b16 a[8:9], v16 offset:16384
    ds_read_b64_tr_b16 a[10:11], v16 offset:18176
    ds_read_b64_tr_b16 a[12:13], v16 offset:16448
    ds_read_b64_tr_b16 a[14:15], v16 offset:18240
    ds_read_b64_tr_b16 a[16:17], v16 offset:16512
    ds_read_b64_tr_b16 a[18:19], v16 offset:18304
    ds_read_b64_tr_b16 a[20:21], v16 offset:16576
    ds_read_b64_tr_b16 a[22:23], v16 offset:18368
    ds_read_b64_tr_b16 a[24:25], v16 offset:16640
    ds_read_b64_tr_b16 a[26:27], v16 offset:18432
    ds_read_b64_tr_b16 a[28:29], v16 offset:16704
    ds_read_b64_tr_b16 a[30:31], v16 offset:18496
    ds_read_b64_tr_b16 a[32:33], v16 offset:16768
    ds_read_b64_tr_b16 a[34:35], v16 offset:18560
    ds_read_b128 a[4:7], v13 offset:0
    s_waitcnt lgkmcnt(13)
    v_mfma_f32_32x32x16_bf16 v[32:47], a[0:3], a[8:11], v[32:47]
    ds_read_b64_tr_b16 a[36:37], v16 offset:23552
    ds_read_b64_tr_b16 a[38:39], v16 offset:25344
    s_waitcnt lgkmcnt(13)
    v_mfma_f32_32x32x16_bf16 v[48:63], a[0:3], a[12:15], v[48:63]
    ds_read_b64_tr_b16 a[40:41], v16 offset:23616
    ds_read_b64_tr_b16 a[42:43], v16 offset:25408
    s_waitcnt lgkmcnt(13)
    v_mfma_f32_32x32x16_bf16 v[64:79], a[0:3], a[16:19], v[64:79]
    ds_read_b64_tr_b16 a[44:45], v16 offset:23680
    ds_read_b64_tr_b16 a[46:47], v16 offset:25472
    s_waitcnt lgkmcnt(13)
    v_mfma_f32_32x32x16_bf16 v[80:95], a[0:3], a[20:23], v[80:95]
    ds_read_b64_tr_b16 a[48:49], v16 offset:23744
    ds_read_b64_tr_b16 a[50:51], v16 offset:25536
    s_waitcnt lgkmcnt(13)
    v_mfma_f32_32x32x16_bf16 v[96:111], a[0:3], a[24:27], v[96:111]
    ds_read_b64_tr_b16 a[52:53], v16 offset:23808
    ds_read_b64_tr_b16 a[54:55], v16 offset:25600
    s_waitcnt lgkmcnt(13)
    v_mfma_f32_32x32x16_bf16 v[112:127], a[0:3], a[28:31], v[112:127]
    ds_read_b64_tr_b16 a[56:57], v16 offset:23872
    ds_read_b64_tr_b16 a[58:59], v16 offset:25664
    s_waitcnt lgkmcnt(13)
    v_mfma_f32_32x32x16_bf16 v[128:143], a[0:3], a[32:35], v[128:143]
    ds_read_b64_tr_b16 a[60:61], v16 offset:23936
    ds_read_b64_tr_b16 a[62:63], v16 offset:25728
    ds_read_b128 a[0:3], v14 offset:0
    s_waitcnt lgkmcnt(13)
    v_mfma_f32_32x32x16_bf16 v[32:47], a[4:7], a[36:39], v[32:47]
    ds_read_b64_tr_b16 a[8:9], v16 offset:30720
    ds_read_b64_tr_b16 a[10:11], v16 offset:32512
    s_waitcnt lgkmcnt(13)
    v_mfma_f32_32x32x16_bf16 v[48:63], a[4:7], a[40:43], v[48:63]
    ds_read_b64_tr_b16 a[12:13], v16 offset:30784
    ds_read_b64_tr_b16 a[14:15], v16 offset:32576
    s_waitcnt lgkmcnt(13)
    v_mfma_f32_32x32x16_bf16 v[64:79], a[4:7], a[44:47], v[64:79]
    ds_read_b64_tr_b16 a[16:17], v16 offset:30848
    ds_read_b64_tr_b16 a[18:19], v16 offset:32640
    s_waitcnt lgkmcnt(13)
    v_mfma_f32_32x32x16_bf16 v[80:95], a[4:7], a[48:51], v[80:95]
    ds_read_b64_tr_b16 a[20:21], v16 offset:30912
    ds_read_b64_tr_b16 a[22:23], v16 offset:32704
    s_waitcnt lgkmcnt(13)
    v_mfma_f32_32x32x16_bf16 v[96:111], a[4:7], a[52:55], v[96:111]
    ds_read_b64_tr_b16 a[24:25], v16 offset:30976
    ds_read_b64_tr_b16 a[26:27], v16 offset:32768
    s_waitcnt lgkmcnt(13)
    v_mfma_f32_32x32x16_bf16 v[112:127], a[4:7], a[56:59], v[112:127]
    ds_read_b64_tr_b16 a[28:29], v16 offset:31040
    ds_read_b64_tr_b16 a[30:31], v16 offset:32832
    s_waitcnt lgkmcnt(13)
    v_mfma_f32_32x32x16_bf16 v[128:143], a[4:7], a[60:63], v[128:143]
    ds_read_b64_tr_b16 a[32:33], v16 offset:31104
    ds_read_b64_tr_b16 a[34:35], v16 offset:32896
    ds_read_b128 a[4:7], v15 offset:0
    s_waitcnt lgkmcnt(13)
    v_mfma_f32_32x32x16_bf16 v[32:47], a[0:3], a[8:11], v[32:47]
    ds_read_b64_tr_b16 a[36:37], v16 offset:37888
    ds_read_b64_tr_b16 a[38:39], v16 offset:39680
    s_waitcnt lgkmcnt(13)
    v_mfma_f32_32x32x16_bf16 v[48:63], a[0:3], a[12:15], v[48:63]
    ds_read_b64_tr_b16 a[40:41], v16 offset:37952
    ds_read_b64_tr_b16 a[42:43], v16 offset:39744
    s_waitcnt lgkmcnt(13)
    v_mfma_f32_32x32x16_bf16 v[64:79], a[0:3], a[16:19], v[64:79]
    ds_read_b64_tr_b16 a[44:45], v16 offset:38016
    ds_read_b64_tr_b16 a[46:47], v16 offset:39808
    s_waitcnt lgkmcnt(13)
    v_mfma_f32_32x32x16_bf16 v[80:95], a[0:3], a[20:23], v[80:95]
    ds_read_b64_tr_b16 a[48:49], v16 offset:38080
    ds_read_b64_tr_b16 a[50:51], v16 offset:39872
    s_waitcnt lgkmcnt(13)
    v_mfma_f32_32x32x16_bf16 v[96:111], a[0:3], a[24:27], v[96:111]
    ds_read_b64_tr_b16 a[52:53], v16 offset:38144
    ds_read_b64_tr_b16 a[54:55], v16 offset:39936
    s_waitcnt lgkmcnt(13)
    v_mfma_f32_32x32x16_bf16 v[112:127], a[0:3], a[28:31], v[112:127]
    ds_read_b64_tr_b16 a[56:57], v16 offset:38208
    ds_read_b64_tr_b16 a[58:59], v16 offset:40000
    s_waitcnt lgkmcnt(13)
    v_mfma_f32_32x32x16_bf16 v[128:143], a[0:3], a[32:35], v[128:143]
    ds_read_b64_tr_b16 a[60:61], v16 offset:38272
    ds_read_b64_tr_b16 a[62:63], v16 offset:40064
    s_waitcnt lgkmcnt(12)
    v_mfma_f32_32x32x16_bf16 v[32:47], a[4:7], a[36:39], v[32:47]
    s_waitcnt lgkmcnt(10)
    v_mfma_f32_32x32x16_bf16 v[48:63], a[4:7], a[40:43], v[48:63]
    s_waitcnt lgkmcnt(8)
    v_mfma_f32_32x32x16_bf16 v[64:79], a[4:7], a[44:47], v[64:79]
    s_waitcnt lgkmcnt(6)
    v_mfma_f32_32x32x16_bf16 v[80:95], a[4:7], a[48:51], v[80:95]
    s_waitcnt lgkmcnt(4)
    v_mfma_f32_32x32x16_bf16 v[96:111], a[4:7], a[52:55], v[96:111]
    s_waitcnt lgkmcnt(2)
    v_mfma_f32_32x32x16_bf16 v[112:127], a[4:7], a[56:59], v[112:127]
    s_waitcnt lgkmcnt(0)
    v_mfma_f32_32x32x16_bf16 v[128:143], a[4:7], a[60:63], v[128:143]
    s_mul_i32 s42, s53, 14
    s_mul_i32 s50, s55, 7
    s_add_u32 s42, s42, s50
    s_mul_i32 s42, s42, 28672
    s_add_u32 s42, s42, 8519680
    s_mov_b32 s52, 1035512379
    s_lshl_b32 s51, s44, 11
    s_add_u32 s51, s51, s42
    s_cmp_gt_u32 s44, 13
    s_cselect_b32 s51, 0x40000000, s51
    v_cvt_pk_bf16_f32 v160, v32, v33
    v_cvt_pk_bf16_f32 v161, v34, v35
    v_cvt_pk_bf16_f32 v162, v36, v37
    v_cvt_pk_bf16_f32 v163, v38, v39
    buffer_store_dwordx4 v[160:163], v24, s[8:11], s51 offen offset:0 sc1
    v_cvt_pk_bf16_f32 v164, v40, v41
    v_cvt_pk_bf16_f32 v165, v42, v43
    v_cvt_pk_bf16_f32 v166, v44, v45
    v_cvt_pk_bf16_f32 v167, v46, v47
    buffer_store_dwordx4 v[164:167], v24, s[8:11], s51 offen offset:1024 sc1
    s_add_u32 s51, s51, 28672
    v_cvt_pk_bf16_f32 v168, v48, v49
    v_cvt_pk_bf16_f32 v169, v50, v51
    v_cvt_pk_bf16_f32 v170, v52, v53
    v_cvt_pk_bf16_f32 v171, v54, v55
    buffer_store_dwordx4 v[168:171], v24, s[8:11], s51 offen offset:0 sc1
    v_cvt_pk_bf16_f32 v172, v56, v57
    v_cvt_pk_bf16_f32 v173, v58, v59
    v_cvt_pk_bf16_f32 v174, v60, v61
    v_cvt_pk_bf16_f32 v175, v62, v63
    buffer_store_dwordx4 v[172:175], v24, s[8:11], s51 offen offset:1024 sc1
    s_add_u32 s51, s51, 28672
    v_cvt_pk_bf16_f32 v176, v64, v65
    v_cvt_pk_bf16_f32 v177, v66, v67
    v_cvt_pk_bf16_f32 v178, v68, v69
    v_cvt_pk_bf16_f32 v179, v70, v71
    buffer_store_dwordx4 v[176:179], v24, s[8:11], s51 offen offset:0 sc1
    v_cvt_pk_bf16_f32 v180, v72, v73
    v_cvt_pk_bf16_f32 v181, v74, v75
    v_cvt_pk_bf16_f32 v182, v76, v77
    v_cvt_pk_bf16_f32 v183, v78, v79
    buffer_store_dwordx4 v[180:183], v24, s[8:11], s51 offen offset:1024 sc1
    s_add_u32 s51, s51, 28672
    v_cvt_pk_bf16_f32 v184, v80, v81
    v_cvt_pk_bf16_f32 v185, v82, v83
    v_cvt_pk_bf16_f32 v186, v84, v85
    v_cvt_pk_bf16_f32 v187, v86, v87
    buffer_store_dwordx4 v[184:187], v24, s[8:11], s51 offen offset:0 sc1
    v_cvt_pk_bf16_f32 v188, v88, v89
    v_cvt_pk_bf16_f32 v189, v90, v91
    v_cvt_pk_bf16_f32 v190, v92, v93
    v_cvt_pk_bf16_f32 v191, v94, v95
    buffer_store_dwordx4 v[188:191], v24, s[8:11], s51 offen offset:1024 sc1
    s_add_u32 s51, s51, 28672
    v_cvt_pk_bf16_f32 v160, v96, v97
    v_cvt_pk_bf16_f32 v161, v98, v99
    v_cvt_pk_bf16_f32 v162, v100, v101
    v_cvt_pk_bf16_f32 v163, v102, v103
    buffer_store_dwordx4 v[160:163], v24, s[8:11], s51 offen offset:0 sc1
    v_cvt_pk_bf16_f32 v164, v104, v105
    v_cvt_pk_bf16_f32 v165, v106, v107
    v_cvt_pk_bf16_f32 v166, v108, v109
    v_cvt_pk_bf16_f32 v167, v110, v111
    buffer_store_dwordx4 v[164:167], v24, s[8:11], s51 offen offset:1024 sc1
    s_add_u32 s51, s51, 28672
    v_cvt_pk_bf16_f32 v168, v112, v113
    v_cvt_pk_bf16_f32 v169, v114, v115
    v_cvt_pk_bf16_f32 v170, v116, v117
    v_cvt_pk_bf16_f32 v171, v118, v119
    buffer_store_dwordx4 v[168:171], v24, s[8:11], s51 offen offset:0 sc1
    v_cvt_pk_bf16_f32 v172, v120, v121
    v_cvt_pk_bf16_f32 v173, v122, v123
    v_cvt_pk_bf16_f32 v174, v124, v125
    v_cvt_pk_bf16_f32 v175, v126, v127
    buffer_store_dwordx4 v[172:175], v24, s[8:11], s51 offen offset:1024 sc1
    s_add_u32 s51, s51, 28672
    v_cvt_pk_bf16_f32 v176, v128, v129
    v_cvt_pk_bf16_f32 v177, v130, v131
    v_cvt_pk_bf16_f32 v178, v132, v133
    v_cvt_pk_bf16_f32 v179, v134, v135
    buffer_store_dwordx4 v[176:179], v24, s[8:11], s51 offen offset:0 sc1
    v_cvt_pk_bf16_f32 v180, v136, v137
    v_cvt_pk_bf16_f32 v181, v138, v139
    v_cvt_pk_bf16_f32 v182, v140, v141
    v_cvt_pk_bf16_f32 v183, v142, v143
    buffer_store_dwordx4 v[180:183], v24, s[8:11], s51 offen offset:1024 sc1
    s_add_u32 s51, s51, 28672
E_2:
    v_mov_b32 v12, -1
    v_mov_b32 v13, -1
    v_mov_b32 v14, -1
    v_mov_b32 v15, -1
    s_lshl_b32 s50, s2, 2
    s_add_u32 s50, s50, s13
    s_mul_i32 s52, s50, 3072
    s_add_u32 s52, s52, 93847552
    s_and_b32 s51, s50, 0x2fc
    s_lshl_b32 s50, s50, 11
    s_add_u32 s50, s50, 91750400
    s_cmp_eq_u32 s51, 0
    s_cselect_b32 s50, 0x40000000, s50
    buffer_store_dwordx4 v[12:15], v2, s[8:11], s50 offen sc1
    buffer_store_dwordx4 v[12:15], v2, s[8:11], s50 offen offset:1024 sc1
    buffer_store_dwordx4 v[12:15], v2, s[8:11], s52 offen offset:0 sc1
    buffer_store_dwordx4 v[12:15], v2, s[8:11], s52 offen offset:1024 sc1
    buffer_store_dwordx4 v[12:15], v2, s[8:11], s52 offen offset:2048 sc1
    s_cmp_ge_u32 s2, 2
    s_cbranch_scc1 E_2b
    s_lshl_b32 s39, s2, 2
    s_add_u32 s39, s39, s13
    s_min_u32 s39, s39, 6
    s_mov_b32 s68, s66
    s_and_b32 s69, s67, 0xffff
    s_mov_b32 s70, 7168
    s_mov_b32 s71, 0x20000
    s_nop 1
    v_and_b32 v7, 7, v1
    v_mul_u32_u24 v5, 896, v7
    v_lshrrev_b32 v7, 4, v1
    v_lshl_add_u32 v6, v7, 5, v5
    v_bfe_u32 v7, v1, 3, 1
    v_lshl_add_u32 v5, v7, 4, v6
    v_lshl_add_u32 v6, v7, 2, v6
    s_lshl_b32 s50, s39, 7
    buffer_load_dwordx4 v[32:35], v5, s[68:71], s50 offen
    buffer_load_dword v36, v6, s[68:71], s50 offen offset:0
    buffer_load_dword v37, v6, s[68:71], s50 offen offset:8
    buffer_load_dword v38, v6, s[68:71], s50 offen offset:16
    buffer_load_dword v39, v6, s[68:71], s50 offen offset:24
    v_mov_b32 v7, -2
    s_waitcnt vmcnt(0)
    v_min_u32 v32, v32, v7
    v_min_u32 v33, v33, v7
    v_min_u32 v34, v34, v7
    v_min_u32 v35, v35, v7
    v_min_u32 v36, v36, v7
    v_min_u32 v37, v37, v7
    v_min_u32 v38, v38, v7
    v_min_u32 v39, v39, v7
    s_lshl_b32 s50, s39, 10
    s_add_u32 s51, s50, 92274688
    s_add_u32 s50, s50, 91750400
    buffer_store_dwordx4 v[32:35], v2, s[8:11], s51 offen sc1
    buffer_store_dwordx4 v[36:39], v2, s[8:11], s50 offen sc1
E_2b:
    s_mov_b32 s75, s77
    s_mov_b32 s76, s78
    s_waitcnt vmcnt(0)
    s_cmp_lg_u32 s13, 0
    s_cbranch_scc1 E_3
    s_mov_b64 exec, 1
    v_cmp_eq_u64 vcc, 0, v[244:245]
    s_nop 1
    v_cndmask_b32 v244, v244, v240, vcc
    v_cndmask_b32 v245, v245, v241, vcc
    ds_write_b64 v28, v[244:245] offset:8
    ds_write_b32 v28, v246
    s_waitcnt lgkmcnt(0)
    s_mov_b64 exec, -1
E_3:
    s_barrier
    ds_read_b64 v[26:27], v28 offset:8
    ds_read_b32 v30, v28
    s_waitcnt lgkmcnt(0)
    v_readfirstlane_b32 s96, v26
    v_readfirstlane_b32 s97, v27
    v_readfirstlane_b32 s14, v30
    s_cmp_lg_u32 s13, 0
    s_cbranch_scc1 E_4
    s_mov_b64 exec, 1
    s_add_u32 s69, s3, 1536
    s_lshl_b32 s38, s69, 3
    s_add_u32 s38, s38, 117440512
    v_mov_b32 v24, s96
    v_mov_b32 v25, s97
    buffer_store_dwordx2 v[24:25], v31, s[8:11], s38 offen sc1
    s_add_u32 s69, s2, 1792
    s_lshl_b32 s38, s69, 3
    s_add_u32 s38, s38, 117440512
    v_mov_b32 v24, s96
    v_mov_b32 v25, s97
    buffer_store_dwordx2 v[24:25], v31, s[8:11], s38 offen sc1
    s_mov_b64 exec, -1
E_4:
    s_branch CL_got
CLAIM:
    s_cmp_lg_u32 s13, 0
    s_cbranch_scc1 CL_w
    s_mov_b64 exec, 1
    v_mov_b32 v30, 1
    global_atomic_add v30, v31, v30, s[4:5] sc0
    s_waitcnt vmcnt(0)
    ds_write_b32 v28, v30
    s_waitcnt lgkmcnt(0)
    s_mov_b64 exec, -1
CL_w:
    s_barrier
    ds_read_b32 v30, v28
    s_waitcnt lgkmcnt(0)
    v_readfirstlane_b32 s14, v30
CL_got:
    s_barrier
    v_mov_b32 v29, 32
    s_cmp_ge_u32 s14, 32
    s_cbranch_scc1 W_deq
    s_cmp_lg_u32 s13, 0
    s_cbranch_scc1 CL_r
    s_mov_b64 exec, 1
    s_mul_i32 s38, s12, s12
    s_lshl_b32 s38, s38, 9
    s_add_u32 s38, s38, s12
    s_lshl_b32 s38, s38, 6
    s_add_u32 s38, s38, 1
    v_mov_b32 v30, s38
    global_atomic_add v31, v30, s[4:5] offset:8
    s_mov_b64 exec, -1
CL_r:
    s_cmp_ge_u32 s14, 30
    s_cbranch_scc1 L_roleC
    s_cmp_ge_u32 s14, 16
    s_cbranch_scc1 L_roleB
CHAIN_BEGIN:
    v_and_b32 v1, 63, v0
    s_lshl_b32 s23, s13, 1
    s_add_u32 s16, s23, 0
    s_cmp_ge_u32 s16, 7
    s_cselect_b32 s24, 7, 0
    s_sub_u32 s16, s16, s24
    s_lshl_b32 s16, s16, 10
    s_add_u32 s17, s23, 1
    s_cmp_ge_u32 s17, 7
    s_cselect_b32 s24, 7, 0
    s_sub_u32 s17, s17, s24
    s_lshl_b32 s17, s17, 10
    s_add_u32 s18, s23, 2
    s_cmp_ge_u32 s18, 7
    s_cselect_b32 s24, 7, 0
    s_sub_u32 s18, s18, s24
    s_lshl_b32 s18, s18, 10
    s_add_u32 s19, s23, 3
    s_cmp_ge_u32 s19, 7
    s_cselect_b32 s24, 7, 0
    s_sub_u32 s19, s19, s24
    s_lshl_b32 s19, s19, 10
    s_add_u32 s20, s23, 4
    s_cmp_ge_u32 s20, 7
    s_cselect_b32 s24, 7, 0
    s_sub_u32 s20, s20, s24
    s_lshl_b32 s20, s20, 10
    s_add_u32 s21, s23, 5
    s_cmp_ge_u32 s21, 7
    s_cselect_b32 s24, 7, 0
    s_sub_u32 s21, s21, s24
    s_lshl_b32 s21, s21, 10
    s_add_u32 s22, s23, 6
    s_cmp_ge_u32 s22, 7
    s_cselect_b32 s24, 7, 0
    s_sub_u32 s22, s22, s24
    s_lshl_b32 s22, s22, 10
    v_and_b32 v26, 15, v1
    v_lshrrev_b32 v27, 4, v1
    v_and_b32 v28, 8, v1
    v_cmp_ne_u32 vcc, 0, v28
    v_mov_b32 v28, 0x4444
    v_mov_b32 v29, 0xeeee
    v_cndmask_b32 v2, v28, v29, vcc
    v_lshlrev_b32 v28, 9, v27
    v_lshl_add_u32 v17, v26, 4, v28
    s_lshl_b32 s23, s14, 3
    s_lshr_b32 s24, s13, 1
    s_lshl_b32 s24, s24, 2
    s_add_u32 s23, s23, s24
    s_add_u32 s23, s23, 1536
    v_and_b32 v32, 63, v0
    v_min_u32 v32, 3, v32
    v_lshlrev_b32 v32, 3, v32
    s_lshl_b32 s38, s23, 3
    s_add_u32 s38, s38, 117440512
FW_1:
    s_add_u32 s33, s33, 1
    s_cmp_gt_u32 s33, 0x200000
    s_cbranch_scc1 L_bail
    buffer_load_dwordx2 v[34:35], v32, s[8:11], s38 offen sc1
    s_waitcnt vmcnt(0)
    v_cmp_ne_u64 vcc, s[96:97], v[34:35]
    s_cbranch_vccz FWok_2
    s_sleep 2
    s_branch FW_1
FWok_2:
    s_mul_i32 s25, s14, 401408
    s_add_u32 s25, s25, 2097152
    s_mul_i32 s26, s13, 7
    s_mul_i32 s28, s13, 14336
    s_add_u32 s23, s26, 0
    s_lshr_b32 s24, s23, 1
    s_mul_i32 s24, s24, 28672
    s_and_b32 s23, s23, 1
    s_lshl_b32 s23, s23, 8
    s_add_u32 s27, s25, s24
    s_add_u32 s27, s27, s23
    s_lshl_b32 s23, s16, 2
    s_add_u32 s23, s23, s27
    buffer_load_dwordx4 a[0:3], v17, s[8:11], s23 offen offset:0 sc1
    buffer_load_dwordx4 a[4:7], v17, s[8:11], s23 offen offset:2048 sc1
    s_lshl_b32 s23, s17, 2
    s_add_u32 s23, s23, s27
    buffer_load_dwordx4 a[8:11], v17, s[8:11], s23 offen offset:0 sc1
    buffer_load_dwordx4 a[12:15], v17, s[8:11], s23 offen offset:2048 sc1
    s_lshl_b32 s23, s18, 2
    s_add_u32 s23, s23, s27
    buffer_load_dwordx4 a[16:19], v17, s[8:11], s23 offen offset:0 sc1
    buffer_load_dwordx4 a[20:23], v17, s[8:11], s23 offen offset:2048 sc1
    s_lshl_b32 s23, s19, 2
    s_add_u32 s23, s23, s27
    buffer_load_dwordx4 a[24:27], v17, s[8:11], s23 offen offset:0 sc1
    buffer_load_dwordx4 a[28:31], v17, s[8:11], s23 offen offset:2048 sc1
    s_lshl_b32 s23, s20, 2
    s_add_u32 s23, s23, s27
    buffer_load_dwordx4 a[32:35], v17, s[8:11], s23 offen offset:0 sc1
    buffer_load_dwordx4 a[36:39], v17, s[8:11], s23 offen offset:2048 sc1
    s_lshl_b32 s23, s21, 2
    s_add_u32 s23, s23, s27
    buffer_load_dwordx4 a[40:43], v17, s[8:11], s23 offen offset:0 sc1
    buffer_load_dwordx4 a[44:47], v17, s[8:11], s23 offen offset:2048 sc1
    s_lshl_b32 s23, s22, 2
    s_add_u32 s23, s23, s27
    buffer_load_dwordx4 a[48:51], v17, s[8:11], s23 offen offset:0 sc1
    buffer_load_dwordx4 a[52:55], v17, s[8:11], s23 offen offset:2048 sc1
    s_add_u32 s23, s26, 1
    s_lshr_b32 s24, s23, 1
    s_mul_i32 s24, s24, 28672
    s_and_b32 s23, s23, 1
    s_lshl_b32 s23, s23, 8
    s_add_u32 s27, s25, s24
    s_add_u32 s27, s27, s23
    s_lshl_b32 s23, s16, 2
    s_add_u32 s23, s23, s27
    s_add_u32 s24, s28, 0
    s_mov_b32 m0, s24
    s_nop 0
    buffer_load_dwordx4 v17, s[8:11], s23 offen sc1 lds
    s_add_u32 s24, s28, 1024
    s_mov_b32 m0, s24
    s_add_u32 s23, s23, 2048
    buffer_load_dwordx4 v17, s[8:11], s23 offen sc1 lds
    s_waitcnt vmcnt(40)
    s_lshl_b32 s23, s17, 2
    s_add_u32 s23, s23, s27
    s_add_u32 s24, s28, 2048
    s_mov_b32 m0, s24
    s_nop 0
    buffer_load_dwordx4 v17, s[8:11], s23 offen sc1 lds
    s_add_u32 s24, s28, 3072
    s_mov_b32 m0, s24
    s_add_u32 s23, s23, 2048
    buffer_load_dwordx4 v17, s[8:11], s23 offen sc1 lds
    s_lshl_b32 s23, s18, 2
    s_add_u32 s23, s23, s27
    s_add_u32 s24, s28, 4096
    s_mov_b32 m0, s24
    s_nop 0
    buffer_load_dwordx4 v17, s[8:11], s23 offen sc1 lds
    s_add_u32 s24, s28, 5120
    s_mov_b32 m0, s24
    s_add_u32 s23, s23, 2048
    buffer_load_dwordx4 v17, s[8:11], s23 offen sc1 lds
    s_lshl_b32 s23, s19, 2
    s_add_u32 s23, s23, s27
    s_add_u32 s24, s28, 6144
    s_mov_b32 m0, s24
    s_nop 0
    buffer_load_dwordx4 v17, s[8:11], s23 offen sc1 lds
    s_add_u32 s24, s28, 7168
    s_mov_b32 m0, s24
    s_add_u32 s23, s23, 2048
    buffer_load_dwordx4 v17, s[8:11], s23 offen sc1 lds
    s_lshl_b32 s23, s20, 2
    s_add_u32 s23, s23, s27
    s_add_u32 s24, s28, 8192
    s_mov_b32 m0, s24
    s_nop 0
    buffer_load_dwordx4 v17, s[8:11], s23 offen sc1 lds
    s_add_u32 s24, s28, 9216
    s_mov_b32 m0, s24
    s_add_u32 s23, s23, 2048
    buffer_load_dwordx4 v17, s[8:11], s23 offen sc1 lds
    s_lshl_b32 s23, s21, 2
    s_add_u32 s23, s23, s27
    s_add_u32 s24, s28, 10240
    s_mov_b32 m0, s24
    s_nop 0
    buffer_load_dwordx4 v17, s[8:11], s23 offen sc1 lds
    s_add_u32 s24, s28, 11264
    s_mov_b32 m0, s24
    s_add_u32 s23, s23, 2048
    buffer_load_dwordx4 v17, s[8:11], s23 offen sc1 lds
    s_lshl_b32 s23, s22, 2
    s_add_u32 s23, s23, s27
    s_add_u32 s24, s28, 12288
    s_mov_b32 m0, s24
    s_nop 0
    buffer_load_dwordx4 v17, s[8:11], s23 offen sc1 lds
    s_add_u32 s24, s28, 13312
    s_mov_b32 m0, s24
    s_add_u32 s23, s23, 2048
    buffer_load_dwordx4 v17, s[8:11], s23 offen sc1 lds
    s_add_u32 s23, s26, 2
    s_lshr_b32 s24, s23, 1
    s_mul_i32 s24, s24, 28672
    s_and_b32 s23, s23, 1
    s_lshl_b32 s23, s23, 8
    s_add_u32 s27, s25, s24
    s_add_u32 s27, s27, s23
    s_lshl_b32 s23, s16, 2
    s_add_u32 s23, s23, s27
    buffer_load_dwordx4 a[56:59], v17, s[8:11], s23 offen offset:0 sc1
    buffer_load_dwordx4 a[60:63], v17, s[8:11], s23 offen offset:2048 sc1
    s_lshl_b32 s23, s17, 2
    s_add_u32 s23, s23, s27
    buffer_load_dwordx4 a[64:67], v17, s[8:11], s23 offen offset:0 sc1
    buffer_load_dwordx4 a[68:71], v17, s[8:11], s23 offen offset:2048 sc1
    s_waitcnt vmcnt(40)
    s_lshl_b32 s23, s18, 2
    s_add_u32 s23, s23, s27
    buffer_load_dwordx4 a[72:75], v17, s[8:11], s23 offen offset:0 sc1
    buffer_load_dwordx4 a[76:79], v17, s[8:11], s23 offen offset:2048 sc1
    s_lshl_b32 s23, s19, 2
    s_add_u32 s23, s23, s27
    buffer_load_dwordx4 a[80:83], v17, s[8:11], s23 offen offset:0 sc1
    buffer_load_dwordx4 a[84:87], v17, s[8:11], s23 offen offset:2048 sc1
    s_lshl_b32 s23, s20, 2
    s_add_u32 s23, s23, s27
    buffer_load_dwordx4 a[88:91], v17, s[8:11], s23 offen offset:0 sc1
    buffer_load_dwordx4 a[92:95], v17, s[8:11], s23 offen offset:2048 sc1
    s_lshl_b32 s23, s21, 2
    s_add_u32 s23, s23, s27
    buffer_load_dwordx4 a[96:99], v17, s[8:11], s23 offen offset:0 sc1
    buffer_load_dwordx4 a[100:103], v17, s[8:11], s23 offen offset:2048 sc1
    s_lshl_b32 s23, s22, 2
    s_add_u32 s23, s23, s27
    buffer_load_dwordx4 a[104:107], v17, s[8:11], s23 offen offset:0 sc1
    buffer_load_dwordx4 a[108:111], v17, s[8:11], s23 offen offset:2048 sc1
    s_add_u32 s23, s26, 3
    s_lshr_b32 s24, s23, 1
    s_mul_i32 s24, s24, 28672
    s_and_b32 s23, s23, 1
    s_lshl_b32 s23, s23, 8
    s_add_u32 s27, s25, s24
    s_add_u32 s27, s27, s23
    s_lshl_b32 s23, s16, 2
    s_add_u32 s23, s23, s27
    buffer_load_dwordx4 a[112:115], v17, s[8:11], s23 offen offset:0 sc1
    buffer_load_dwordx4 a[116:119], v17, s[8:11], s23 offen offset:2048 sc1
    s_lshl_b32 s23, s17, 2
    s_add_u32 s23, s23, s27
    buffer_load_dwordx4 a[120:123], v17, s[8:11], s23 offen offset:0 sc1
    buffer_load_dwordx4 a[124:127], v17, s[8:11], s23 offen offset:2048 sc1
    s_lshl_b32 s23, s18, 2
    s_add_u32 s23, s23, s27
    buffer_load_dwordx4 a[128:131], v17, s[8:11], s23 offen offset:0 sc1
    buffer_load_dwordx4 a[132:135], v17, s[8:11], s23 offen offset:2048 sc1
    s_waitcnt vmcnt(40)
    s_lshl_b32 s23, s19, 2
    s_add_u32 s23, s23, s27
    buffer_load_dwordx4 a[136:139], v17, s[8:11], s23 offen offset:0 sc1
    buffer_load_dwordx4 a[140:143], v17, s[8:11], s23 offen offset:2048 sc1
    s_lshl_b32 s23, s20, 2
    s_add_u32 s23, s23, s27
    buffer_load_dwordx4 a[144:147], v17, s[8:11], s23 offen offset:0 sc1
    buffer_load_dwordx4 a[148:151], v17, s[8:11], s23 offen offset:2048 sc1
    s_lshl_b32 s23, s21, 2
    s_add_u32 s23, s23, s27
    buffer_load_dwordx4 a[152:155], v17, s[8:11], s23 offen offset:0 sc1
    buffer_load_dwordx4 a[156:159], v17, s[8:11], s23 offen offset:2048 sc1
    s_lshl_b32 s23, s22, 2
    s_add_u32 s23, s23, s27
    buffer_load_dwordx4 a[160:163], v17, s[8:11], s23 offen offset:0 sc1
    buffer_load_dwordx4 a[164:167], v17, s[8:11], s23 offen offset:2048 sc1
    s_add_u32 s23, s26, 4
    s_lshr_b32 s24, s23, 1
    s_mul_i32 s24, s24, 28672
    s_and_b32 s23, s23, 1
    s_lshl_b32 s23, s23, 8
    s_add_u32 s27, s25, s24
    s_add_u32 s27, s27, s23
    s_lshl_b32 s23, s16, 2
    s_add_u32 s23, s23, s27
    buffer_load_dwordx4 a[168:171], v17, s[8:11], s23 offen offset:0 sc1
    buffer_load_dwordx4 a[172:175], v17, s[8:11], s23 offen offset:2048 sc1
    s_lshl_b32 s23, s17, 2
    s_add_u32 s23, s23, s27
    buffer_load_dwordx4 a[176:179], v17, s[8:11], s23 offen offset:0 sc1
    buffer_load_dwordx4 a[180:183], v17, s[8:11], s23 offen offset:2048 sc1
    s_lshl_b32 s23, s18, 2
    s_add_u32 s23, s23, s27
    buffer_load_dwordx4 a[184:187], v17, s[8:11], s23 offen offset:0 sc1
    buffer_load_dwordx4 a[188:191], v17, s[8:11], s23 offen offset:2048 sc1
    s_lshl_b32 s23, s19, 2
    s_add_u32 s23, s23, s27
    buffer_load_dwordx4 a[192:195], v17, s[8:11], s23 offen offset:0 sc1
    buffer_load_dwordx4 a[196:199], v17, s[8:11], s23 offen offset:2048 sc1
    s_waitcnt vmcnt(40)
    s_lshl_b32 s23, s20, 2
    s_add_u32 s23, s23, s27
    buffer_load_dwordx4 a[200:203], v17, s[8:11], s23 offen offset:0 sc1
    buffer_load_dwordx4 a[204:207], v17, s[8:11], s23 offen offset:2048 sc1
    s_lshl_b32 s23, s21, 2
    s_add_u32 s23, s23, s27
    buffer_load_dwordx4 a[208:211], v17, s[8:11], s23 offen offset:0 sc1
    buffer_load_dwordx4 a[212:215], v17, s[8:11], s23 offen offset:2048 sc1
    s_lshl_b32 s23, s22, 2
    s_add_u32 s23, s23, s27
    buffer_load_dwordx4 a[216:219], v17, s[8:11], s23 offen offset:0 sc1
    buffer_load_dwordx4 a[220:223], v17, s[8:11], s23 offen offset:2048 sc1
    s_add_u32 s23, s26, 5
    s_lshr_b32 s24, s23, 1
    s_mul_i32 s24, s24, 28672
    s_and_b32 s23, s23, 1
    s_lshl_b32 s23, s23, 8
    s_add_u32 s27, s25, s24
    s_add_u32 s27, s27, s23
    s_lshl_b32 s23, s16, 2
    s_add_u32 s23, s23, s27
    buffer_load_dwordx4 a[224:227], v17, s[8:11], s23 offen offset:0 sc1
    buffer_load_dwordx4 a[228:231], v17, s[8:11], s23 offen offset:2048 sc1
    s_lshl_b32 s23, s17, 2
    s_add_u32 s23, s23, s27
    buffer_load_dwordx4 a[232:235], v17, s[8:11], s23 offen offset:0 sc1
    buffer_load_dwordx4 a[236:239], v17, s[8:11], s23 offen offset:2048 sc1
    s_lshl_b32 s23, s18, 2
    s_add_u32 s23, s23, s27
    buffer_load_dwordx4 a[240:243], v17, s[8:11], s23 offen offset:0 sc1
    buffer_load_dwordx4 a[244:247], v17, s[8:11], s23 offen offset:2048 sc1
    s_lshl_b32 s23, s19, 2
    s_add_u32 s23, s23, s27
    buffer_load_dwordx4 a[248:251], v17, s[8:11], s23 offen offset:0 sc1
    buffer_load_dwordx4 a[252:255], v17, s[8:11], s23 offen offset:2048 sc1
    s_lshl_b32 s23, s20, 2
    s_add_u32 s23, s23, s27
    buffer_load_dwordx4 v[176:179], v17, s[8:11], s23 offen offset:0 sc1
    buffer_load_dwordx4 v[180:183], v17, s[8:11], s23 offen offset:2048 sc1
    s_waitcnt vmcnt(40)
    s_lshl_b32 s23, s21, 2
    s_add_u32 s23, s23, s27
    buffer_load_dwordx4 v[184:187], v17, s[8:11], s23 offen offset:0 sc1
    buffer_load_dwordx4 v[188:191], v17, s[8:11], s23 offen offset:2048 sc1
    s_lshl_b32 s23, s22, 2
    s_add_u32 s23, s23, s27
    buffer_load_dwordx4 v[192:195], v17, s[8:11], s23 offen offset:0 sc1
    buffer_load_dwordx4 v[196:199], v17, s[8:11], s23 offen offset:2048 sc1
    s_add_u32 s23, s26, 6
    s_lshr_b32 s24, s23, 1
    s_mul_i32 s24, s24, 28672
    s_and_b32 s23, s23, 1
    s_lshl_b32 s23, s23, 8
    s_add_u32 s27, s25, s24
    s_add_u32 s27, s27, s23
    s_lshl_b32 s23, s16, 2
    s_add_u32 s23, s23, s27
    buffer_load_dwordx4 v[200:203], v17, s[8:11], s23 offen offset:0 sc1
    buffer_load_dwordx4 v[204:207], v17, s[8:11], s23 offen offset:2048 sc1
    s_lshl_b32 s23, s17, 2
    s_add_u32 s23, s23, s27
    buffer_load_dwordx4 v[208:211], v17, s[8:11], s23 offen offset:0 sc1
    buffer_load_dwordx4 v[212:215], v17, s[8:11], s23 offen offset:2048 sc1
    s_lshl_b32 s23, s18, 2
    s_add_u32 s23, s23, s27
    buffer_load_dwordx4 v[216:219], v17, s[8:11], s23 offen offset:0 sc1
    buffer_load_dwordx4 v[220:223], v17, s[8:11], s23 offen offset:2048 sc1
    s_lshl_b32 s23, s19, 2
    s_add_u32 s23, s23, s27
    buffer_load_dwordx4 v[224:227], v17, s[8:11], s23 offen offset:0 sc1
    buffer_load_dwordx4 v[228:231], v17, s[8:11], s23 offen offset:2048 sc1
    s_lshl_b32 s23, s20, 2
    s_add_u32 s23, s23, s27
    buffer_load_dwordx4 v[232:235], v17, s[8:11], s23 offen offset:0 sc1
    buffer_load_dwordx4 v[236:239], v17, s[8:11], s23 offen offset:2048 sc1
    s_lshl_b32 s23, s21, 2
    s_add_u32 s23, s23, s27
    buffer_load_dwordx4 v[240:243], v17, s[8:11], s23 offen offset:0 sc1
    buffer_load_dwordx4 v[244:247], v17, s[8:11], s23 offen offset:2048 sc1
    s_waitcnt vmcnt(40)
    s_lshl_b32 s23, s22, 2
    s_add_u32 s23, s23, s27
    buffer_load_dwordx4 v[248:251], v17, s[8:11], s23 offen offset:0 sc1
    buffer_load_dwordx4 v[252:255], v17, s[8:11], s23 offen offset:2048 sc1
    v_lshlrev_b32 v3, 4, v1
    v_add_u32 v7, s28, v3
    s_add_u32 s23, s16, 57344
    v_add_u32 v18, s23, v3
    s_add_u32 s23, s17, 57344
    v_add_u32 v19, s23, v3
    s_add_u32 s23, s18, 57344
    v_add_u32 v20, s23, v3
    s_add_u32 s23, s19, 57344
    v_add_u32 v21, s23, v3
    s_add_u32 s23, s20, 57344
    v_add_u32 v22, s23, v3
    s_add_u32 s23, s21, 57344
    v_add_u32 v23, s23, v3
    s_add_u32 s23, s22, 57344
    v_add_u32 v24, s23, v3
    v_add_u32 v3, 91750400, v3
    v_and_b32 v28, 7, v1
    v_lshlrev_b32 v28, 4, v28
    s_mul_i32 s23, s13, 1792
    s_add_u32 s23, s23, 57344
    v_lshrrev_b32 v29, 1, v27
    v_lshl_add_u32 v4, v29, 8, v28
    v_and_b32 v29, 1, v27
    v_lshl_add_u32 v4, v29, 3, v4
    v_add_u32 v4, s23, v4
    v_add_u32 v5, 1024, v4
    v_lshl_add_u32 v6, v27, 2, v28
    s_add_u32 s23, s23, 1536
    v_add_u32 v6, s23, v6
    v_and_b32 v28, 6, v26
    v_lshlrev_b32 v28, 1, v28
    v_lshrrev_b32 v29, 3, v26
    v_lshl_add_u32 v28, v29, 1, v28
    v_and_b32 v29, 1, v26
    v_add_u32 v28, v29, v28
    v_lshlrev_b32 v28, 4, v28
    v_lshl_add_u32 v8, v27, 9, v28
    v_lshrrev_b32 v29, 1, v27
    v_lshl_add_u32 v9, v29, 9, v28
    v_and_b32 v29, 1, v27
    v_lshl_add_u32 v9, v29, 3, v9
    v_add_u32 v9, 6144, v9
    s_lshl_b32 s30, s13, 11
    s_mul_i32 s23, s13, 4352
    s_add_u32 s23, s23, 65536
    v_lshlrev_b32 v28, 10, v27
    v_and_b32 v29, 1, v27
    v_lshl_add_u32 v28, v29, 5, v28
    v_lshrrev_b32 v29, 1, v27
    v_lshl_add_u32 v28, v29, 7, v28
    v_lshl_add_u32 v10, v26, 3, v28
    v_add_u32 v10, s23, v10
    v_and_b32 v12, 3, v1
    v_lshlrev_b32 v28, 10, v12
    v_and_b32 v29, 1, v12
    v_lshl_add_u32 v28, v29, 5, v28
    v_lshrrev_b32 v29, 1, v12
    v_lshl_add_u32 v28, v29, 7, v28
    v_bfe_u32 v29, v1, 2, 2
    v_lshl_add_u32 v28, v29, 3, v28
    v_lshl_add_u32 v12, v27, 6, v28
    v_add_u32 v12, s23, v12
    v_lshl_add_u32 v13, v27, 5, v28
    v_add_u32 v13, 768, v13
    v_add_u32 v13, s23, v13
    s_add_u32 s23, s30, 83968
    v_lshrrev_b32 v29, 3, v26
    v_lshl_add_u32 v28, v29, 2, v27
    v_mul_u32_u24 v28, 160, v28
    v_and_b32 v25, 7, v26
    v_lshl_add_u32 v14, v25, 4, v28
    v_add_u32 v14, s23, v14
    v_lshlrev_b32 v25, 4, v25
    v_lshl_add_u32 v25, v29, 3, v25
    v_add_u32 v28, 8, v27
    v_mul_u32_u24 v28, 160, v28
    v_add3_u32 v25, v25, v28, s23
    s_mov_b32 s36, 0xff00ff00
    s_mov_b32 s37, 0xff00ff00
    v_mov_b32 v29, 12
    v_cmp_gt_u32 vcc, 10, v26
    s_nop 1
    v_cndmask_b32 v28, v29, v26, vcc
    v_mul_u32_u24 v28, 160, v28
    s_lshl_b32 s23, s13, 2
    v_add_u32 v29, s23, v27
    v_and_b32 v29, 7, v29
    v_lshl_add_u32 v15, v29, 4, v28
    v_add_u32 v15, 83968, v15
    v_lshrrev_b32 v28, 1, v26
    v_lshlrev_b32 v28, 7, v28
    v_lshl_add_u32 v28, v29, 4, v28
    v_and_b32 v29, 1, v26
    v_lshl_add_u32 v28, v29, 3, v28
    v_mov_b32 v29, 0x40000000
    v_cndmask_b32 v16, v29, v28, vcc
    v_mov_b32 v28, 0xf149f2ca
    v_and_b32 v29, 31, v1
    v_lshlrev_b32 v29, 2, v29
    s_add_u32 s23, s30, 85888
    v_add_u32 v29, s23, v29
    ds_write_b32 v29, v28
    s_waitcnt vmcnt(0)
    v_lshlrev_b32 v17, 7, v1
    s_mul_i32 s24, s14, 640
    s_add_u32 s24, s24, 92798976
    s_mul_i32 s25, s13, 7168
    s_add_u32 s25, s25, 0
    s_mul_i32 s26, s14, 4
    s_add_u32 s26, s26, s13
    s_min_u32 s26, s26, 55
    s_lshl_b32 s26, s26, 13
    s_add_u32 s26, s26, 21889024
    s_cmp_ge_u32 s13, 4
    s_cselect_b32 s23, 0x40000000, 0
    v_add_u32 v17, s23, v17
    s_mov_b32 s15, 0
    s_lshl_b32 s31, s14, 2
    s_add_u32 s31, s31, s13
    v_and_b32 v172, 31, v1
    v_lshlrev_b32 v172, 3, v172
    s_waitcnt vmcnt(0) lgkmcnt(0)
    s_cmp_lg_u32 s13, 3
    s_cbranch_scc1 LF_3
    s_add_u32 s38, s14, 2240
    s_lshl_b32 s38, s38, 3
    s_add_u32 s38, s38, 117440512
    v_mov_b32 v48, s96
    v_mov_b32 v49, s97
    v_mov_b32 v50, 0
    s_mov_b64 exec, 1
    buffer_store_dwordx2 v[48:49], v50, s[8:11], s38 offen sc1
    s_mov_b64 exec, -1
LF_3:
    v_and_b32 v32, 63, v0
    v_lshlrev_b32 v32, 3, v32
    v_mov_b32 v33, 0
SG_4:
    s_add_u32 s33, s33, 1
    s_cmp_gt_u32 s33, 0x200000
    s_cbranch_scc1 L_bail
    s_mov_b32 s38, 117451776
    buffer_load_dwordx2 v[34:35], v32, s[8:11], s38 offen sc1
    s_mov_b32 s38, 117454848
    buffer_load_dwordx2 v[36:37], v32, s[8:11], s38 offen sc1
    s_mov_b32 s38, 117455360
    buffer_load_dwordx2 v[38:39], v32, s[8:11], s38 offen sc1
    s_mov_b32 s38, 117455872
    buffer_load_dwordx2 v[40:41], v32, s[8:11], s38 offen sc1
    s_mov_b32 s38, 117456384
    buffer_load_dwordx2 v[42:43], v32, s[8:11], s38 offen sc1
    global_load_dword v46, v33, s[4:5] offset:8 sc1
    s_waitcnt vmcnt(0)
    v_readfirstlane_b32 s12, v46
    s_mov_b64 s[40:41], 0
    v_cmp_ne_u64 vcc, s[96:97], v[34:35]
    s_nop 0
    s_or_b64 s[40:41], s[40:41], vcc
    v_cmp_ne_u64 vcc, s[96:97], v[36:37]
    s_nop 0
    s_or_b64 s[40:41], s[40:41], vcc
    v_cmp_ne_u64 vcc, s[96:97], v[38:39]
    s_nop 0
    s_or_b64 s[40:41], s[40:41], vcc
    v_cmp_ne_u64 vcc, s[96:97], v[40:41]
    s_nop 0
    s_or_b64 s[40:41], s[40:41], vcc
    v_cmp_ne_u64 vcc, s[96:97], v[42:43]
    s_nop 0
    s_or_b64 s[40:41], s[40:41], vcc
    s_cbranch_scc1 SGa_6
    s_and_b32 s38, s12, 63
    s_cmp_ge_u32 s38, 32
    s_cbranch_scc1 SGok_5
SGa_6:
    s_sleep 3
    s_branch SG_4
SGok_5:
    s_bfe_u32 s38, s12, 0x90006
    s_mul_i32 s38, s38, s38
    s_lshr_b32 s12, s12, 15
    s_lshl_b32 s12, s12, 5
    s_cmp_lg_u32 s12, s38
    s_cselect_b32 s12, 1, 0
    buffer_load_dwordx4 v[112:115], v8, s[8:11], s25 offen offset:0 sc1
    buffer_load_dwordx4 v[116:119], v8, s[8:11], s25 offen offset:256 sc1
    buffer_load_dwordx4 v[120:123], v8, s[8:11], s25 offen offset:2048 sc1
    buffer_load_dwordx4 v[124:127], v8, s[8:11], s25 offen offset:2304 sc1
    s_add_u32 s23, s25, 4096
    buffer_load_dwordx4 v[128:131], v8, s[8:11], s23 offen offset:0 sc1
    buffer_load_dwordx4 v[132:135], v8, s[8:11], s23 offen offset:256 sc1
    buffer_load_dwordx2 v[136:137], v9, s[8:11], s25 offen offset:0 sc1
    buffer_load_dwordx2 v[138:139], v9, s[8:11], s25 offen offset:256 sc1
    s_add_u32 s25, s25, 28672
    s_barrier
    ds_read_b128 v[88:91], v7 offset:0
    ds_read_b128 v[92:95], v7 offset:1024
    ds_read_b128 v[96:99], v7 offset:2048
    ds_read_b128 v[100:103], v7 offset:3072
    ds_read_b128 v[104:107], v7 offset:4096
    ds_read_b128 v[108:111], v7 offset:5120
    v_mov_b32 v156, 0
    v_mov_b32 v157, 0
    v_mov_b32 v158, 0
    v_mov_b32 v159, 0
    v_mov_b32 v160, 0
    v_mov_b32 v161, 0
    v_mov_b32 v162, 0
    v_mov_b32 v163, 0
    v_mov_b32 v164, 0
    v_mov_b32 v165, 0
    v_mov_b32 v166, 0
    v_mov_b32 v167, 0
    v_mov_b32 v60, 0
    v_mov_b32 v61, 0
    v_mov_b32 v62, 0
    v_mov_b32 v63, 0
    v_mov_b32 v64, 0
    v_mov_b32 v65, 0
    v_mov_b32 v66, 0
    v_mov_b32 v67, 0
    v_mov_b32 v68, 0
    v_mov_b32 v69, 0
    v_mov_b32 v70, 0
    v_mov_b32 v71, 0
    v_mov_b32 v72, 0
    v_mov_b32 v73, 0
    v_mov_b32 v74, 0
    v_mov_b32 v75, 0
    v_mov_b32 v76, 0
    v_mov_b32 v77, 0
    v_mov_b32 v78, 0
    v_mov_b32 v79, 0
    v_mov_b32 v80, 0
    v_mov_b32 v81, 0
    v_mov_b32 v82, 0
    v_mov_b32 v83, 0
    v_mov_b32 v84, 0
    v_mov_b32 v85, 0
    v_mov_b32 v86, 0
    v_mov_b32 v87, 0
A_top_7:
    s_cmp_eq_u32 s12, 0
    s_cselect_b32 s34, s24, 0x40000000
    s_cselect_b32 s35, 0x40000000, s24
    s_lshr_b32 s39, s15, 3
    s_add_u32 s39, s39, 1
    s_min_u32 s39, s39, 7
    s_lshl_b32 s39, s39, 8
    s_add_u32 s39, s39, 117440512
    s_and_b32 s38, s15, 7
    s_lshl_b32 s38, s38, 8
    s_add_u32 s38, s38, s31
    s_cmp_eq_u32 s38, 1027
    s_cselect_b32 s39, s39, 0x40000000
    s_cmp_lt_u32 s39, 0x40000000
    s_cselect_b32 s30, 1, 0
    s_cmp_eq_u32 s15, 0
    s_cselect_b32 s30, 1, s30
    s_waitcnt lgkmcnt(0)
    s_sleep 5
    buffer_load_dwordx4 v[140:143], v3, s[8:11], s16 offen sc1
    buffer_load_dwordx4 v[144:147], v3, s[8:11], s17 offen sc1
    v_mov_b32 v169, v169
    v_mov_b32 v169, v169
    v_mov_b32 v169, v169
    v_mov_b32 v169, v169
    v_mov_b32 v169, v169
    v_mov_b32 v169, v169
    v_mov_b32 v169, v169
    v_mov_b32 v169, v169
    v_mov_b32 v169, v169
    v_mov_b32 v169, v169
    v_mov_b32 v169, v169
    v_mov_b32 v169, v169
    v_mov_b32 v169, v169
    v_mov_b32 v169, v169
    v_mov_b32 v169, v169
    v_mov_b32 v169, v169
    v_mov_b32 v169, v169
    v_mov_b32 v169, v169
    v_mov_b32 v169, v169
    v_mov_b32 v169, v169
    .p2align 6
A_poll_8:
    s_add_u32 s33, s33, 1
    s_cmp_gt_u32 s33, 0x200000
    s_cbranch_scc1 L_bail
    buffer_load_dwordx4 v[148:151], v3, s[8:11], s16 offen sc1
    buffer_load_dwordx4 v[152:155], v3, s[8:11], s17 offen sc1
    v_mov_b32 v169, v169
    v_mov_b32 v169, v169
    v_mov_b32 v169, v169
    v_mov_b32 v169, v169
    v_mov_b32 v169, v169
    v_mov_b32 v169, v169
    v_mov_b32 v169, v169
    v_mov_b32 v169, v169
    v_mov_b32 v169, v169
    v_mov_b32 v169, v169
    v_mov_b32 v169, v169
    v_mov_b32 v169, v169
    s_waitcnt vmcnt(3)
    v_max3_u32 v26, v140, v141, v142
    s_waitcnt vmcnt(2)
    v_max3_u32 v26, v26, v143, v144
    v_max3_u32 v26, v26, v145, v146
    v_max_u32 v26, v26, v147
    v_cmp_eq_u32 vcc, -1, v26
    s_cbranch_vccz A_var0_12
    buffer_load_dwordx4 v[140:143], v3, s[8:11], s16 offen sc1
    buffer_load_dwordx4 v[144:147], v3, s[8:11], s17 offen sc1
    v_mov_b32 v169, v169
    v_mov_b32 v169, v169
    v_mov_b32 v169, v169
    v_mov_b32 v169, v169
    v_mov_b32 v169, v169
    v_mov_b32 v169, v169
    v_mov_b32 v169, v169
    v_mov_b32 v169, v169
    v_mov_b32 v169, v169
    v_mov_b32 v169, v169
    v_mov_b32 v169, v169
    v_mov_b32 v169, v169
    s_waitcnt vmcnt(3)
    v_max3_u32 v26, v148, v149, v150
    s_waitcnt vmcnt(2)
    v_max3_u32 v26, v26, v151, v152
    v_max3_u32 v26, v26, v153, v154
    v_max_u32 v26, v26, v155
    v_cmp_eq_u32 vcc, -1, v26
    s_cbranch_vccnz A_poll_8
A_var1_9:
    v_smfmac_f32_16x16x64_bf16 v[64:67], v[148:151], v[88:95], v2
    ds_write_b128 v18, v[148:151]
    v_smfmac_f32_16x16x64_bf16 v[60:63], v[148:151], a[0:7], v2
    ds_write_b128 v19, v[152:155]
    v_smfmac_f32_16x16x64_bf16 v[68:71], v[148:151], a[56:63], v2
    v_smfmac_f32_16x16x64_bf16 v[72:75], v[148:151], a[112:119], v2
    v_smfmac_f32_16x16x64_bf16 v[76:79], v[148:151], a[168:175], v2
    s_waitcnt lgkmcnt(0)
    s_barrier
    ds_read_b128 v[40:43], v20
    v_smfmac_f32_16x16x64_bf16 v[80:83], v[148:151], a[224:231], v2
    ds_read_b128 v[44:47], v21
    v_smfmac_f32_16x16x64_bf16 v[84:87], v[148:151], v[200:207], v2
    ds_read_b128 v[48:51], v22
    v_smfmac_f32_16x16x64_bf16 v[64:67], v[152:155], v[96:103], v2
    ds_read_b128 v[52:55], v23
    v_smfmac_f32_16x16x64_bf16 v[60:63], v[152:155], a[8:15], v2
    ds_read_b128 v[56:59], v24
    v_smfmac_f32_16x16x64_bf16 v[68:71], v[152:155], a[64:71], v2
    ds_read_b128 v[88:91], v7 offset:6144
    v_smfmac_f32_16x16x64_bf16 v[72:75], v[152:155], a[120:127], v2
    ds_read_b128 v[92:95], v7 offset:7168
    v_smfmac_f32_16x16x64_bf16 v[76:79], v[152:155], a[176:183], v2
    ds_read_b128 v[96:99], v7 offset:8192
    v_smfmac_f32_16x16x64_bf16 v[80:83], v[152:155], a[232:239], v2
    ds_read_b128 v[100:103], v7 offset:9216
    v_smfmac_f32_16x16x64_bf16 v[84:87], v[152:155], v[208:215], v2
    s_branch A_common_10
    .p2align 6
A_var0_12:
    v_smfmac_f32_16x16x64_bf16 v[64:67], v[140:143], v[88:95], v2
    ds_write_b128 v18, v[140:143]
    v_smfmac_f32_16x16x64_bf16 v[60:63], v[140:143], a[0:7], v2
    ds_write_b128 v19, v[144:147]
    v_smfmac_f32_16x16x64_bf16 v[68:71], v[140:143], a[56:63], v2
    v_smfmac_f32_16x16x64_bf16 v[72:75], v[140:143], a[112:119], v2
    v_smfmac_f32_16x16x64_bf16 v[76:79], v[140:143], a[168:175], v2
    s_waitcnt lgkmcnt(0)
    s_barrier
    ds_read_b128 v[40:43], v20
    v_smfmac_f32_16x16x64_bf16 v[80:83], v[140:143], a[224:231], v2
    ds_read_b128 v[44:47], v21
    v_smfmac_f32_16x16x64_bf16 v[84:87], v[140:143], v[200:207], v2
    ds_read_b128 v[48:51], v22
    v_smfmac_f32_16x16x64_bf16 v[64:67], v[144:147], v[96:103], v2
    ds_read_b128 v[52:55], v23
    v_smfmac_f32_16x16x64_bf16 v[60:63], v[144:147], a[8:15], v2
    ds_read_b128 v[56:59], v24
    v_smfmac_f32_16x16x64_bf16 v[68:71], v[144:147], a[64:71], v2
    ds_read_b128 v[88:91], v7 offset:6144
    v_smfmac_f32_16x16x64_bf16 v[72:75], v[144:147], a[120:127], v2
    ds_read_b128 v[92:95], v7 offset:7168
    v_smfmac_f32_16x16x64_bf16 v[76:79], v[144:147], a[176:183], v2
    ds_read_b128 v[96:99], v7 offset:8192
    v_smfmac_f32_16x16x64_bf16 v[80:83], v[144:147], a[232:239], v2
    ds_read_b128 v[100:103], v7 offset:9216
    v_smfmac_f32_16x16x64_bf16 v[84:87], v[144:147], v[208:215], v2
A_common_10:
    s_waitcnt lgkmcnt(8)
    v_smfmac_f32_16x16x64_bf16 v[64:67], v[40:43], v[104:111], v2
    buffer_load_dword v168, v17, s[8:11], s26 offen
    v_smfmac_f32_16x16x64_bf16 v[68:71], v[40:43], a[72:79], v2
    ds_read_b128 v[104:107], v7 offset:10240
    s_waitcnt lgkmcnt(8)
    v_smfmac_f32_16x16x64_bf16 v[68:71], v[44:47], a[80:87], v2
    ds_read_b128 v[108:111], v7 offset:11264
    s_waitcnt lgkmcnt(8)
    v_smfmac_f32_16x16x64_bf16 v[68:71], v[48:51], a[88:95], v2
    s_waitcnt vmcnt(1)
    ds_read2_b32 v[140:141], v4 offset0:0 offset1:32
    s_waitcnt lgkmcnt(8)
    v_smfmac_f32_16x16x64_bf16 v[68:71], v[52:55], a[96:103], v2
    ds_read2_b32 v[142:143], v4 offset0:1 offset1:33
    s_waitcnt lgkmcnt(6)
    v_smfmac_f32_16x16x64_bf16 v[64:67], v[44:47], v[88:95], v2
    ds_read2_b32 v[144:145], v4 offset0:128 offset1:160
    v_smfmac_f32_16x16x64_bf16 v[68:71], v[56:59], a[104:111], v2
    ds_read2_b32 v[146:147], v4 offset0:129 offset1:161
    v_smfmac_f32_16x16x64_bf16 v[72:75], v[40:43], a[128:135], v2
    ds_read2_b32 v[148:149], v5 offset0:0 offset1:32
    v_smfmac_f32_16x16x64_bf16 v[72:75], v[44:47], a[136:143], v2
    ds_read2_b32 v[150:151], v5 offset0:1 offset1:33
    v_cvt_pk_bf16_f32 v68, v68, v69
    v_smfmac_f32_16x16x64_bf16 v[72:75], v[48:51], a[144:151], v2
    ds_read2_b32 v[152:153], v6 offset0:0 offset1:32
    v_cvt_pk_bf16_f32 v69, v70, v71
    v_smfmac_f32_16x16x64_bf16 v[72:75], v[52:55], a[152:159], v2
    ds_write_b64 v10, v[68:69] offset:256
    v_smfmac_f32_16x16x64_bf16 v[72:75], v[56:59], a[160:167], v2
    ds_read_b128 v[88:91], v7 offset:12288
    v_smfmac_f32_16x16x64_bf16 v[76:79], v[40:43], a[184:191], v2
    ds_read_b128 v[92:95], v7 offset:13312
    v_smfmac_f32_16x16x64_bf16 v[76:79], v[44:47], a[192:199], v2
    v_cvt_pk_bf16_f32 v72, v72, v73
    v_smfmac_f32_16x16x64_bf16 v[76:79], v[48:51], a[200:207], v2
    v_cvt_pk_bf16_f32 v73, v74, v75
    v_smfmac_f32_16x16x64_bf16 v[76:79], v[52:55], a[208:215], v2
    ds_write_b64 v10, v[72:73] offset:384
    v_smfmac_f32_16x16x64_bf16 v[76:79], v[56:59], a[216:223], v2
    ds_read_b64_tr_b16 v[68:69], v12 offset:256
    v_smfmac_f32_16x16x64_bf16 v[80:83], v[40:43], a[240:247], v2
    ds_read_b64_tr_b16 v[70:71], v12 offset:288
    v_smfmac_f32_16x16x64_bf16 v[80:83], v[44:47], a[248:255], v2
    s_cmp_lg_u32 s30, 0
    s_cbranch_scc1 A_rare_17
A_rb_18:
    v_cvt_pk_bf16_f32 v76, v76, v77
    v_smfmac_f32_16x16x64_bf16 v[80:83], v[48:51], v[176:183], v2
    v_cvt_pk_bf16_f32 v77, v78, v79
    v_smfmac_f32_16x16x64_bf16 v[80:83], v[52:55], v[184:191], v2
    ds_write_b64 v10, v[76:77] offset:512
    v_smfmac_f32_16x16x64_bf16 v[80:83], v[56:59], v[192:199], v2
    v_smfmac_f32_16x16x64_bf16 v[60:63], v[40:43], a[16:23], v2
    v_smfmac_f32_16x16x64_bf16 v[60:63], v[44:47], a[24:31], v2
    v_cvt_pk_bf16_f32 v80, v80, v81
    v_smfmac_f32_16x16x64_bf16 v[60:63], v[48:51], a[32:39], v2
    v_cvt_pk_bf16_f32 v81, v82, v83
    v_smfmac_f32_16x16x64_bf16 v[60:63], v[52:55], a[40:47], v2
    ds_write_b64 v10, v[80:81] offset:640
    v_smfmac_f32_16x16x64_bf16 v[60:63], v[56:59], a[48:55], v2
    ds_read_b64_tr_b16 v[76:77], v12 offset:512
    s_waitcnt lgkmcnt(15)
    v_smfmac_f32_16x16x64_bf16 v[64:67], v[48:51], v[96:103], v2
    ds_read_b64_tr_b16 v[78:79], v12 offset:544
    v_smfmac_f32_16x16x64_bf16 v[64:67], v[52:55], v[104:111], v2
    v_cvt_pk_bf16_f32 v60, v60, v61
    s_waitcnt lgkmcnt(7)
    v_smfmac_f32_16x16x64_bf16 v[64:67], v[56:59], v[88:95], v2
    v_cvt_pk_bf16_f32 v61, v62, v63
    v_smfmac_f32_16x16x64_bf16 v[84:87], v[40:43], v[216:223], v2
    ds_write_b64 v10, v[60:61] offset:0
    v_smfmac_f32_16x16x64_bf16 v[84:87], v[44:47], v[224:231], v2
    v_cvt_pk_bf16_f32 v64, v64, v65
    s_waitcnt lgkmcnt(5)
    v_mfma_f32_16x16x32_bf16 v[156:159], v[120:123], v[68:71], v[156:159]
    v_mfma_f32_16x16x32_bf16 v[160:163], v[124:127], v[68:71], v[160:163]
    v_smfmac_f32_16x16x64_bf16 v[84:87], v[48:51], v[232:239], v2
    v_cvt_pk_bf16_f32 v65, v66, v67
    v_smfmac_f32_16x16x64_bf16 v[84:87], v[52:55], v[240:247], v2
    ds_write_b64 v10, v[64:65] offset:128
    v_smfmac_f32_16x16x64_bf16 v[84:87], v[56:59], v[248:255], v2
    ds_read_b64_tr_b16 v[60:61], v12 offset:0
    ds_read_b64_tr_b16 v[62:63], v12 offset:32
    v_mfma_f32_16x16x32_bf16 v[164:167], v[144:147], v[68:71], v[164:167]
    s_waitcnt lgkmcnt(4)
    v_mfma_f32_16x16x32_bf16 v[156:159], v[128:131], v[76:79], v[156:159]
    v_cvt_pk_bf16_f32 v84, v84, v85
    v_cvt_pk_bf16_f32 v85, v86, v87
    ds_write_b64 v10, v[84:85] offset:768
    ds_read_b64_tr_b16 v[86:87], v13
    v_mfma_f32_16x16x32_bf16 v[160:163], v[132:135], v[76:79], v[160:163]
    v_mfma_f32_16x16x32_bf16 v[164:167], v[148:151], v[76:79], v[164:167]
    s_waitcnt lgkmcnt(2)
    v_mfma_f32_16x16x32_bf16 v[156:159], v[112:115], v[60:63], v[156:159]
    v_mfma_f32_16x16x32_bf16 v[160:163], v[116:119], v[60:63], v[160:163]
    v_mfma_f32_16x16x32_bf16 v[164:167], v[140:143], v[60:63], v[164:167]
    s_waitcnt lgkmcnt(0)
    v_mfma_f32_16x16x16_bf16 v[156:159], v[136:137], v[86:87], v[156:159]
    v_mfma_f32_16x16x16_bf16 v[160:163], v[138:139], v[86:87], v[160:163]
    v_mfma_f32_16x16x16_bf16 v[164:167], v[152:153], v[86:87], v[164:167]
    s_nop 3
    v_add_f32_dpp v156, v156, v156 row_ror:8 row_mask:0xf bank_mask:0x3
    v_add_f32_dpp v157, v157, v157 row_ror:8 row_mask:0xf bank_mask:0x3
    v_add_f32_dpp v158, v158, v158 row_ror:8 row_mask:0xf bank_mask:0x3
    v_add_f32_dpp v159, v159, v159 row_ror:8 row_mask:0xf bank_mask:0x3
    v_add_f32_dpp v156, v160, v160 row_ror:8 row_mask:0xf bank_mask:0xc
    v_add_f32_dpp v157, v161, v161 row_ror:8 row_mask:0xf bank_mask:0xc
    v_add_f32_dpp v158, v162, v162 row_ror:8 row_mask:0xf bank_mask:0xc
    v_add_f32_dpp v159, v163, v163 row_ror:8 row_mask:0xf bank_mask:0xc
    ds_write_b128 v14, v[156:159]
    v_add_f32_dpp v164, v164, v164 row_ror:8 row_mask:0xf bank_mask:0x3
    v_add_f32_dpp v165, v165, v165 row_ror:8 row_mask:0xf bank_mask:0x3
    s_nop 0
    v_add_f32_dpp v164, v166, v166 row_ror:8 row_mask:0xf bank_mask:0xc
    v_add_f32_dpp v165, v167, v167 row_ror:8 row_mask:0xf bank_mask:0xc
    ds_write_b64 v25, v[164:165]
    s_cmp_ge_u32 s13, 2
    v_mov_b32 v169, v169
    v_mov_b32 v169, v169
    v_mov_b32 v169, v169
    v_mov_b32 v169, v169
    v_mov_b32 v169, v169
    v_mov_b32 v169, v169
    v_mov_b32 v169, v169
    v_mov_b32 v169, v169
    v_mfma_f32_32x32x16_bf16 v[32:47], v[48:51], v[48:51], v[32:47]
    s_waitcnt lgkmcnt(0)
    s_barrier
    s_cbranch_scc1 A_next_11
    ds_read_b128 v[60:63], v15 offset:0
    v_mov_b32 v169, v169
    ds_read_b128 v[64:67], v15 offset:2048
    v_mov_b32 v169, v169
    ds_read_b128 v[68:71], v15 offset:4096
    v_mov_b32 v169, v169
    ds_read_b128 v[72:75], v15 offset:6144
    v_mov_b32 v169, v169
    v_mov_b32 v169, v169
    v_mov_b32 v169, v169
    v_mov_b32 v169, v169
    v_mov_b32 v169, v169
    v_mov_b32 v169, v169
    v_mov_b32 v169, v169
    v_mov_b32 v169, v169
    v_mov_b32 v169, v169
    v_mov_b32 v84, -2
    s_waitcnt lgkmcnt(2)
    v_pk_add_f32 v[60:61], v[60:61], v[64:65]
    v_pk_add_f32 v[62:63], v[62:63], v[66:67]
    s_waitcnt lgkmcnt(0)
    v_pk_add_f32 v[68:69], v[68:69], v[72:73]
    v_pk_add_f32 v[70:71], v[70:71], v[74:75]
    v_pk_add_f32 v[60:61], v[60:61], v[68:69]
    v_pk_add_f32 v[62:63], v[62:63], v[70:71]
    v_max3_f32 v76, v60, v61, v62
    v_max_f32 v76, v76, v63
    v_sub_f32 v68, v60, v76
    v_sub_f32 v69, v61, v76
    v_max_f32_dpp v78, v76, v76 row_ror:8 row_mask:0xf bank_mask:0xf
    v_sub_f32 v70, v62, v76
    v_sub_f32 v71, v63, v76
    v_max_f32_dpp v78, v78, v78 row_ror:4 row_mask:0xf bank_mask:0xf
    v_exp_f32 v68, v68
    v_exp_f32 v69, v69
    v_max_f32_dpp v78, v78, v78 row_ror:2 row_mask:0xf bank_mask:0xf
    v_exp_f32 v70, v70
    v_exp_f32 v71, v71
    v_max_f32_dpp v78, v78, v78 row_ror:1 row_mask:0xf bank_mask:0xf
    v_sub_f32 v82, v76, v78
    v_pk_add_f32 v[80:81], v[68:69], v[70:71]
    v_exp_f32 v82, v82
    v_add_f32 v80, v80, v81
    v_mul_f32 v80, v80, v82
    v_mul_f32 v68, v68, v82
    v_mul_f32 v69, v69, v82
    v_add_f32_dpp v80, v80, v80 row_ror:8 row_mask:0xf bank_mask:0xf
    v_mul_f32 v70, v70, v82
    v_mul_f32 v71, v71, v82
    v_add_f32_dpp v80, v80, v80 row_ror:4 row_mask:0xf bank_mask:0xf
    s_nop 1
    v_add_f32_dpp v80, v80, v80 row_ror:2 row_mask:0xf bank_mask:0xf
    s_nop 1
    v_add_f32_dpp v80, v80, v80 row_ror:1 row_mask:0xf bank_mask:0xf
    v_rcp_f32 v80, v80
    s_nop 0
    v_pk_mul_f32 v[68:69], v[68:69], v[80:81] op_sel_hi:[1,0]
    v_pk_mul_f32 v[70:71], v[70:71], v[80:81] op_sel_hi:[1,0]
    v_cvt_pk_bf16_f32 v60, v68, v69
    v_cvt_pk_bf16_f32 v61, v70, v71
    v_min_u32 v60, v60, v84
    v_min_u32 v61, v61, v84
    buffer_store_dwordx2 v[60:61], v16, s[8:11], s34 offen
    buffer_store_dwordx2 v[60:61], v16, s[8:11], s35 offen sc1
A_next_11:
    s_barrier
    s_nop 1
    ds_read_b128 v[88:91], v7 offset:0
    ds_read_b128 v[92:95], v7 offset:1024
    ds_read_b128 v[96:99], v7 offset:2048
    ds_read_b128 v[100:103], v7 offset:3072
    ds_read_b128 v[104:107], v7 offset:4096
    ds_read_b128 v[108:111], v7 offset:5120
    v_mov_b32 v156, 0
    v_mov_b32 v157, 0
    v_mov_b32 v158, 0
    v_mov_b32 v159, 0
    v_mov_b32 v160, 0
    v_mov_b32 v161, 0
    v_mov_b32 v162, 0
    v_mov_b32 v163, 0
    v_mov_b32 v164, 0
    v_mov_b32 v165, 0
    v_mov_b32 v166, 0
    v_mov_b32 v167, 0
    v_mov_b32 v60, 0
    v_mov_b32 v61, 0
    v_mov_b32 v62, 0
    v_mov_b32 v63, 0
    v_mov_b32 v64, 0
    v_mov_b32 v65, 0
    v_mov_b32 v66, 0
    v_mov_b32 v67, 0
    v_mov_b32 v68, 0
    v_mov_b32 v69, 0
    v_mov_b32 v70, 0
    v_mov_b32 v71, 0
    v_mov_b32 v72, 0
    v_mov_b32 v73, 0
    v_mov_b32 v74, 0
    v_mov_b32 v75, 0
    v_mov_b32 v76, 0
    v_mov_b32 v77, 0
    v_mov_b32 v78, 0
    v_mov_b32 v79, 0
    v_mov_b32 v80, 0
    v_mov_b32 v81, 0
    v_mov_b32 v82, 0
    v_mov_b32 v83, 0
    v_mov_b32 v84, 0
    v_mov_b32 v85, 0
    v_mov_b32 v86, 0
    v_mov_b32 v87, 0
    buffer_load_dwordx4 v[112:115], v8, s[8:11], s25 offen offset:0 sc1
    buffer_load_dwordx4 v[116:119], v8, s[8:11], s25 offen offset:256 sc1
    buffer_load_dwordx4 v[120:123], v8, s[8:11], s25 offen offset:2048 sc1
    buffer_load_dwordx4 v[124:127], v8, s[8:11], s25 offen offset:2304 sc1
    s_add_u32 s23, s25, 4096
    buffer_load_dwordx4 v[128:131], v8, s[8:11], s23 offen offset:0 sc1
    buffer_load_dwordx4 v[132:135], v8, s[8:11], s23 offen offset:256 sc1
    buffer_load_dwordx2 v[136:137], v9, s[8:11], s25 offen offset:0 sc1
    buffer_load_dwordx2 v[138:139], v9, s[8:11], s25 offen offset:256 sc1
    s_add_u32 s25, s25, 28672
    s_cmp_ge_u32 s39, 0x40000000
    s_cbranch_scc1 MG_19
    s_waitcnt vmcnt(0)
    v_cmp_ne_u64 vcc, s[96:97], v[170:171]
    s_cbranch_vccz MG_19
    s_sub_u32 s39, s39, 117440512
    s_lshr_b32 s39, s39, 3
    v_and_b32 v26, 63, v0
    v_min_u32 v26, 31, v26
    v_lshlrev_b32 v26, 3, v26
    s_lshl_b32 s38, s39, 3
    s_add_u32 s38, s38, 117440512
FW_20:
    s_add_u32 s33, s33, 1
    s_cmp_gt_u32 s33, 0x200000
    s_cbranch_scc1 L_bail
    buffer_load_dwordx2 v[28:29], v26, s[8:11], s38 offen sc1
    s_waitcnt vmcnt(0)
    v_cmp_ne_u64 vcc, s[96:97], v[28:29]
    s_cbranch_vccz FWok_21
    s_sleep 2
    s_branch FW_20
FWok_21:
MG_19:
    v_add_u32 v3, 8192, v3
    s_add_u32 s24, s24, 16384
    s_add_u32 s26, s26, 458752
    s_add_u32 s15, s15, 1
    s_cmp_lt_u32 s15, 63
    s_cbranch_scc1 A_top_7
    s_endpgm
A_rare_17:
    buffer_load_dwordx2 v[170:171], v172, s[8:11], s39 offen sc1
    s_sub_u32 s38, s26, 458752
    s_cmp_eq_u32 s15, 0
    s_cselect_b32 s38, s38, 0x40000000
    buffer_load_dword v168, v17, s[8:11], s38 offen
    s_branch A_rb_18
L_roleB:
    s_sub_u32 s14, s14, 16
    v_and_b32 v1, 63, v0
    s_lshl_b32 s23, s13, 1
    s_add_u32 s16, s23, 0
    s_cmp_ge_u32 s16, 7
    s_cselect_b32 s24, 7, 0
    s_sub_u32 s16, s16, s24
    s_lshl_b32 s16, s16, 10
    s_add_u32 s17, s23, 1
    s_cmp_ge_u32 s17, 7
    s_cselect_b32 s24, 7, 0
    s_sub_u32 s17, s17, s24
    s_lshl_b32 s17, s17, 10
    s_add_u32 s18, s23, 2
    s_cmp_ge_u32 s18, 7
    s_cselect_b32 s24, 7, 0
    s_sub_u32 s18, s18, s24
    s_lshl_b32 s18, s18, 10
    s_add_u32 s19, s23, 3
    s_cmp_ge_u32 s19, 7
    s_cselect_b32 s24, 7, 0
    s_sub_u32 s19, s19, s24
    s_lshl_b32 s19, s19, 10
    s_add_u32 s20, s23, 4
    s_cmp_ge_u32 s20, 7
    s_cselect_b32 s24, 7, 0
    s_sub_u32 s20, s20, s24
    s_lshl_b32 s20, s20, 10
    s_add_u32 s21, s23, 5
    s_cmp_ge_u32 s21, 7
    s_cselect_b32 s24, 7, 0
    s_sub_u32 s21, s21, s24
    s_lshl_b32 s21, s21, 10
    s_add_u32 s22, s23, 6
    s_cmp_ge_u32 s22, 7
    s_cselect_b32 s24, 7, 0
    s_sub_u32 s22, s22, s24
    s_lshl_b32 s22, s22, 10
    v_and_b32 v14, 15, v1
    v_lshrrev_b32 v15, 4, v1
    v_and_b32 v16, 8, v1
    v_cmp_ne_u32 vcc, 0, v16
    v_mov_b32 v16, 0x4444
    v_mov_b32 v17, 0xeeee
    v_cndmask_b32 v2, v16, v17, vcc
    v_lshlrev_b32 v16, 9, v15
    v_lshl_add_u32 v5, v14, 4, v16
    s_lshl_b32 s23, s13, 5
    s_add_u32 s23, s23, 1664
    v_and_b32 v20, 63, v0
    v_min_u32 v20, 31, v20
    v_lshlrev_b32 v20, 3, v20
    s_lshl_b32 s38, s23, 3
    s_add_u32 s38, s38, 117440512
FW_22:
    s_add_u32 s33, s33, 1
    s_cmp_gt_u32 s33, 0x200000
    s_cbranch_scc1 L_bail
    buffer_load_dwordx2 v[22:23], v20, s[8:11], s38 offen sc1
    s_waitcnt vmcnt(0)
    v_cmp_ne_u64 vcc, s[96:97], v[22:23]
    s_cbranch_vccz FWok_23
    s_sleep 2
    s_branch FW_22
FWok_23:
    s_mul_i32 s25, s13, 56
    s_add_u32 s25, s25, s14
    s_mul_i32 s25, s25, 28672
    s_add_u32 s25, s25, 8519680
    s_lshl_b32 s28, s13, 15
    s_lshl_b32 s23, s16, 2
    s_add_u32 s23, s23, s25
    s_add_u32 s23, s23, 0
    buffer_load_dwordx4 a[0:3], v5, s[8:11], s23 offen offset:0 sc1
    buffer_load_dwordx4 a[40:43], v5, s[8:11], s23 offen offset:256 sc1
    buffer_load_dwordx4 a[4:7], v5, s[8:11], s23 offen offset:2048 sc1
    buffer_load_dwordx4 a[44:47], v5, s[8:11], s23 offen offset:2304 sc1
    s_lshl_b32 s23, s17, 2
    s_add_u32 s23, s23, s25
    s_add_u32 s23, s23, 0
    buffer_load_dwordx4 a[8:11], v5, s[8:11], s23 offen offset:0 sc1
    buffer_load_dwordx4 a[48:51], v5, s[8:11], s23 offen offset:256 sc1
    buffer_load_dwordx4 a[12:15], v5, s[8:11], s23 offen offset:2048 sc1
    buffer_load_dwordx4 a[52:55], v5, s[8:11], s23 offen offset:2304 sc1
    s_lshl_b32 s23, s18, 2
    s_add_u32 s23, s23, s25
    s_add_u32 s23, s23, 0
    buffer_load_dwordx4 a[16:19], v5, s[8:11], s23 offen offset:0 sc1
    buffer_load_dwordx4 a[56:59], v5, s[8:11], s23 offen offset:256 sc1
    buffer_load_dwordx4 a[20:23], v5, s[8:11], s23 offen offset:2048 sc1
    buffer_load_dwordx4 a[60:63], v5, s[8:11], s23 offen offset:2304 sc1
    s_lshl_b32 s23, s19, 2
    s_add_u32 s23, s23, s25
    s_add_u32 s23, s23, 0
    buffer_load_dwordx4 a[24:27], v5, s[8:11], s23 offen offset:0 sc1
    buffer_load_dwordx4 a[64:67], v5, s[8:11], s23 offen offset:256 sc1
    buffer_load_dwordx4 a[28:31], v5, s[8:11], s23 offen offset:2048 sc1
    buffer_load_dwordx4 a[68:71], v5, s[8:11], s23 offen offset:2304 sc1
    s_waitcnt vmcnt(40)
    s_lshl_b32 s23, s20, 2
    s_add_u32 s23, s23, s25
    s_add_u32 s23, s23, 0
    buffer_load_dwordx4 a[32:35], v5, s[8:11], s23 offen offset:0 sc1
    buffer_load_dwordx4 a[72:75], v5, s[8:11], s23 offen offset:256 sc1
    buffer_load_dwordx4 a[36:39], v5, s[8:11], s23 offen offset:2048 sc1
    buffer_load_dwordx4 a[76:79], v5, s[8:11], s23 offen offset:2304 sc1
    s_lshl_b32 s23, s21, 2
    s_add_u32 s23, s23, s25
    s_add_u32 s23, s23, 0
    s_add_u32 s24, s28, 0
    s_mov_b32 m0, s24
    s_add_u32 s24, s23, 0
    buffer_load_dwordx4 v5, s[8:11], s24 offen sc1 lds
    s_add_u32 s24, s28, 4096
    s_mov_b32 m0, s24
    s_add_u32 s24, s23, 256
    buffer_load_dwordx4 v5, s[8:11], s24 offen sc1 lds
    s_add_u32 s24, s28, 1024
    s_mov_b32 m0, s24
    s_add_u32 s24, s23, 2048
    buffer_load_dwordx4 v5, s[8:11], s24 offen sc1 lds
    s_add_u32 s24, s28, 5120
    s_mov_b32 m0, s24
    s_add_u32 s24, s23, 2304
    buffer_load_dwordx4 v5, s[8:11], s24 offen sc1 lds
    s_lshl_b32 s23, s22, 2
    s_add_u32 s23, s23, s25
    s_add_u32 s23, s23, 0
    s_add_u32 s24, s28, 2048
    s_mov_b32 m0, s24
    s_add_u32 s24, s23, 0
    buffer_load_dwordx4 v5, s[8:11], s24 offen sc1 lds
    s_add_u32 s24, s28, 6144
    s_mov_b32 m0, s24
    s_add_u32 s24, s23, 256
    buffer_load_dwordx4 v5, s[8:11], s24 offen sc1 lds
    s_add_u32 s24, s28, 3072
    s_mov_b32 m0, s24
    s_add_u32 s24, s23, 2048
    buffer_load_dwordx4 v5, s[8:11], s24 offen sc1 lds
    s_add_u32 s24, s28, 7168
    s_mov_b32 m0, s24
    s_add_u32 s24, s23, 2304
    buffer_load_dwordx4 v5, s[8:11], s24 offen sc1 lds
    s_lshl_b32 s23, s16, 2
    s_add_u32 s23, s23, s25
    s_add_u32 s23, s23, 401408
    buffer_load_dwordx4 a[80:83], v5, s[8:11], s23 offen offset:0 sc1
    buffer_load_dwordx4 a[120:123], v5, s[8:11], s23 offen offset:256 sc1
    buffer_load_dwordx4 a[84:87], v5, s[8:11], s23 offen offset:2048 sc1
    buffer_load_dwordx4 a[124:127], v5, s[8:11], s23 offen offset:2304 sc1
    s_waitcnt vmcnt(40)
    s_lshl_b32 s23, s17, 2
    s_add_u32 s23, s23, s25
    s_add_u32 s23, s23, 401408
    buffer_load_dwordx4 a[88:91], v5, s[8:11], s23 offen offset:0 sc1
    buffer_load_dwordx4 a[128:131], v5, s[8:11], s23 offen offset:256 sc1
    buffer_load_dwordx4 a[92:95], v5, s[8:11], s23 offen offset:2048 sc1
    buffer_load_dwordx4 a[132:135], v5, s[8:11], s23 offen offset:2304 sc1
    s_lshl_b32 s23, s18, 2
    s_add_u32 s23, s23, s25
    s_add_u32 s23, s23, 401408
    buffer_load_dwordx4 a[96:99], v5, s[8:11], s23 offen offset:0 sc1
    buffer_load_dwordx4 a[136:139], v5, s[8:11], s23 offen offset:256 sc1
    buffer_load_dwordx4 a[100:103], v5, s[8:11], s23 offen offset:2048 sc1
    buffer_load_dwordx4 a[140:143], v5, s[8:11], s23 offen offset:2304 sc1
    s_lshl_b32 s23, s19, 2
    s_add_u32 s23, s23, s25
    s_add_u32 s23, s23, 401408
    buffer_load_dwordx4 a[104:107], v5, s[8:11], s23 offen offset:0 sc1
    buffer_load_dwordx4 a[144:147], v5, s[8:11], s23 offen offset:256 sc1
    buffer_load_dwordx4 a[108:111], v5, s[8:11], s23 offen offset:2048 sc1
    buffer_load_dwordx4 a[148:151], v5, s[8:11], s23 offen offset:2304 sc1
    s_lshl_b32 s23, s20, 2
    s_add_u32 s23, s23, s25
    s_add_u32 s23, s23, 401408
    buffer_load_dwordx4 a[112:115], v5, s[8:11], s23 offen offset:0 sc1
    buffer_load_dwordx4 a[152:155], v5, s[8:11], s23 offen offset:256 sc1
    buffer_load_dwordx4 a[116:119], v5, s[8:11], s23 offen offset:2048 sc1
    buffer_load_dwordx4 a[156:159], v5, s[8:11], s23 offen offset:2304 sc1
    s_waitcnt vmcnt(40)
    s_lshl_b32 s23, s21, 2
    s_add_u32 s23, s23, s25
    s_add_u32 s23, s23, 401408
    s_add_u32 s24, s28, 8192
    s_mov_b32 m0, s24
    s_add_u32 s24, s23, 0
    buffer_load_dwordx4 v5, s[8:11], s24 offen sc1 lds
    s_add_u32 s24, s28, 12288
    s_mov_b32 m0, s24
    s_add_u32 s24, s23, 256
    buffer_load_dwordx4 v5, s[8:11], s24 offen sc1 lds
    s_add_u32 s24, s28, 9216
    s_mov_b32 m0, s24
    s_add_u32 s24, s23, 2048
    buffer_load_dwordx4 v5, s[8:11], s24 offen sc1 lds
    s_add_u32 s24, s28, 13312
    s_mov_b32 m0, s24
    s_add_u32 s24, s23, 2304
    buffer_load_dwordx4 v5, s[8:11], s24 offen sc1 lds
    s_lshl_b32 s23, s22, 2
    s_add_u32 s23, s23, s25
    s_add_u32 s23, s23, 401408
    s_add_u32 s24, s28, 10240
    s_mov_b32 m0, s24
    s_add_u32 s24, s23, 0
    buffer_load_dwordx4 v5, s[8:11], s24 offen sc1 lds
    s_add_u32 s24, s28, 14336
    s_mov_b32 m0, s24
    s_add_u32 s24, s23, 256
    buffer_load_dwordx4 v5, s[8:11], s24 offen sc1 lds
    s_add_u32 s24, s28, 11264
    s_mov_b32 m0, s24
    s_add_u32 s24, s23, 2048
    buffer_load_dwordx4 v5, s[8:11], s24 offen sc1 lds
    s_add_u32 s24, s28, 15360
    s_mov_b32 m0, s24
    s_add_u32 s24, s23, 2304
    buffer_load_dwordx4 v5, s[8:11], s24 offen sc1 lds
    s_lshl_b32 s23, s16, 2
    s_add_u32 s23, s23, s25
    s_add_u32 s23, s23, 802816
    buffer_load_dwordx4 a[160:163], v5, s[8:11], s23 offen offset:0 sc1
    buffer_load_dwordx4 a[200:203], v5, s[8:11], s23 offen offset:256 sc1
    buffer_load_dwordx4 a[164:167], v5, s[8:11], s23 offen offset:2048 sc1
    buffer_load_dwordx4 a[204:207], v5, s[8:11], s23 offen offset:2304 sc1
    s_lshl_b32 s23, s17, 2
    s_add_u32 s23, s23, s25
    s_add_u32 s23, s23, 802816
    buffer_load_dwordx4 a[168:171], v5, s[8:11], s23 offen offset:0 sc1
    buffer_load_dwordx4 a[208:211], v5, s[8:11], s23 offen offset:256 sc1
    buffer_load_dwordx4 a[172:175], v5, s[8:11], s23 offen offset:2048 sc1
    buffer_load_dwordx4 a[212:215], v5, s[8:11], s23 offen offset:2304 sc1
    s_waitcnt vmcnt(40)
    s_lshl_b32 s23, s18, 2
    s_add_u32 s23, s23, s25
    s_add_u32 s23, s23, 802816
    buffer_load_dwordx4 a[176:179], v5, s[8:11], s23 offen offset:0 sc1
    buffer_load_dwordx4 a[216:219], v5, s[8:11], s23 offen offset:256 sc1
    buffer_load_dwordx4 a[180:183], v5, s[8:11], s23 offen offset:2048 sc1
    buffer_load_dwordx4 a[220:223], v5, s[8:11], s23 offen offset:2304 sc1
    s_lshl_b32 s23, s19, 2
    s_add_u32 s23, s23, s25
    s_add_u32 s23, s23, 802816
    buffer_load_dwordx4 a[184:187], v5, s[8:11], s23 offen offset:0 sc1
    buffer_load_dwordx4 a[224:227], v5, s[8:11], s23 offen offset:256 sc1
    buffer_load_dwordx4 a[188:191], v5, s[8:11], s23 offen offset:2048 sc1
    buffer_load_dwordx4 a[228:231], v5, s[8:11], s23 offen offset:2304 sc1
    s_lshl_b32 s23, s20, 2
    s_add_u32 s23, s23, s25
    s_add_u32 s23, s23, 802816
    buffer_load_dwordx4 a[192:195], v5, s[8:11], s23 offen offset:0 sc1
    buffer_load_dwordx4 a[232:235], v5, s[8:11], s23 offen offset:256 sc1
    buffer_load_dwordx4 a[196:199], v5, s[8:11], s23 offen offset:2048 sc1
    buffer_load_dwordx4 a[236:239], v5, s[8:11], s23 offen offset:2304 sc1
    s_lshl_b32 s23, s21, 2
    s_add_u32 s23, s23, s25
    s_add_u32 s23, s23, 802816
    s_add_u32 s24, s28, 16384
    s_mov_b32 m0, s24
    s_add_u32 s24, s23, 0
    buffer_load_dwordx4 v5, s[8:11], s24 offen sc1 lds
    s_add_u32 s24, s28, 20480
    s_mov_b32 m0, s24
    s_add_u32 s24, s23, 256
    buffer_load_dwordx4 v5, s[8:11], s24 offen sc1 lds
    s_add_u32 s24, s28, 17408
    s_mov_b32 m0, s24
    s_add_u32 s24, s23, 2048
    buffer_load_dwordx4 v5, s[8:11], s24 offen sc1 lds
    s_add_u32 s24, s28, 21504
    s_mov_b32 m0, s24
    s_add_u32 s24, s23, 2304
    buffer_load_dwordx4 v5, s[8:11], s24 offen sc1 lds
    s_waitcnt vmcnt(40)
    s_lshl_b32 s23, s22, 2
    s_add_u32 s23, s23, s25
    s_add_u32 s23, s23, 802816
    s_add_u32 s24, s28, 18432
    s_mov_b32 m0, s24
    s_add_u32 s24, s23, 0
    buffer_load_dwordx4 v5, s[8:11], s24 offen sc1 lds
    s_add_u32 s24, s28, 22528
    s_mov_b32 m0, s24
    s_add_u32 s24, s23, 256
    buffer_load_dwordx4 v5, s[8:11], s24 offen sc1 lds
    s_add_u32 s24, s28, 19456
    s_mov_b32 m0, s24
    s_add_u32 s24, s23, 2048
    buffer_load_dwordx4 v5, s[8:11], s24 offen sc1 lds
    s_add_u32 s24, s28, 23552
    s_mov_b32 m0, s24
    s_add_u32 s24, s23, 2304
    buffer_load_dwordx4 v5, s[8:11], s24 offen sc1 lds
    s_lshl_b32 s23, s16, 2
    s_add_u32 s23, s23, s25
    s_add_u32 s23, s23, 1204224
    buffer_load_dwordx4 a[240:243], v5, s[8:11], s23 offen offset:0 sc1
    buffer_load_dwordx4 v[216:219], v5, s[8:11], s23 offen offset:256 sc1
    buffer_load_dwordx4 a[244:247], v5, s[8:11], s23 offen offset:2048 sc1
    buffer_load_dwordx4 v[220:223], v5, s[8:11], s23 offen offset:2304 sc1
    s_lshl_b32 s23, s17, 2
    s_add_u32 s23, s23, s25
    s_add_u32 s23, s23, 1204224
    buffer_load_dwordx4 a[248:251], v5, s[8:11], s23 offen offset:0 sc1
    buffer_load_dwordx4 v[224:227], v5, s[8:11], s23 offen offset:256 sc1
    buffer_load_dwordx4 a[252:255], v5, s[8:11], s23 offen offset:2048 sc1
    buffer_load_dwordx4 v[228:231], v5, s[8:11], s23 offen offset:2304 sc1
    s_lshl_b32 s23, s18, 2
    s_add_u32 s23, s23, s25
    s_add_u32 s23, s23, 1204224
    buffer_load_dwordx4 v[192:195], v5, s[8:11], s23 offen offset:0 sc1
    buffer_load_dwordx4 v[232:235], v5, s[8:11], s23 offen offset:256 sc1
    buffer_load_dwordx4 v[196:199], v5, s[8:11], s23 offen offset:2048 sc1
    buffer_load_dwordx4 v[236:239], v5, s[8:11], s23 offen offset:2304 sc1
    s_waitcnt vmcnt(40)
    s_lshl_b32 s23, s19, 2
    s_add_u32 s23, s23, s25
    s_add_u32 s23, s23, 1204224
    buffer_load_dwordx4 v[200:203], v5, s[8:11], s23 offen offset:0 sc1
    buffer_load_dwordx4 v[240:243], v5, s[8:11], s23 offen offset:256 sc1
    buffer_load_dwordx4 v[204:207], v5, s[8:11], s23 offen offset:2048 sc1
    buffer_load_dwordx4 v[244:247], v5, s[8:11], s23 offen offset:2304 sc1
    s_lshl_b32 s23, s20, 2
    s_add_u32 s23, s23, s25
    s_add_u32 s23, s23, 1204224
    buffer_load_dwordx4 v[208:211], v5, s[8:11], s23 offen offset:0 sc1
    buffer_load_dwordx4 v[248:251], v5, s[8:11], s23 offen offset:256 sc1
    buffer_load_dwordx4 v[212:215], v5, s[8:11], s23 offen offset:2048 sc1
    buffer_load_dwordx4 v[252:255], v5, s[8:11], s23 offen offset:2304 sc1
    s_lshl_b32 s23, s21, 2
    s_add_u32 s23, s23, s25
    s_add_u32 s23, s23, 1204224
    s_add_u32 s24, s28, 24576
    s_mov_b32 m0, s24
    s_add_u32 s24, s23, 0
    buffer_load_dwordx4 v5, s[8:11], s24 offen sc1 lds
    s_add_u32 s24, s28, 28672
    s_mov_b32 m0, s24
    s_add_u32 s24, s23, 256
    buffer_load_dwordx4 v5, s[8:11], s24 offen sc1 lds
    s_add_u32 s24, s28, 25600
    s_mov_b32 m0, s24
    s_add_u32 s24, s23, 2048
    buffer_load_dwordx4 v5, s[8:11], s24 offen sc1 lds
    s_add_u32 s24, s28, 29696
    s_mov_b32 m0, s24
    s_add_u32 s24, s23, 2304
    buffer_load_dwordx4 v5, s[8:11], s24 offen sc1 lds
    s_lshl_b32 s23, s22, 2
    s_add_u32 s23, s23, s25
    s_add_u32 s23, s23, 1204224
    s_add_u32 s24, s28, 26624
    s_mov_b32 m0, s24
    s_add_u32 s24, s23, 0
    buffer_load_dwordx4 v5, s[8:11], s24 offen sc1 lds
    s_add_u32 s24, s28, 30720
    s_mov_b32 m0, s24
    s_add_u32 s24, s23, 256
    buffer_load_dwordx4 v5, s[8:11], s24 offen sc1 lds
    s_add_u32 s24, s28, 27648
    s_mov_b32 m0, s24
    s_add_u32 s24, s23, 2048
    buffer_load_dwordx4 v5, s[8:11], s24 offen sc1 lds
    s_add_u32 s24, s28, 31744
    s_mov_b32 m0, s24
    s_add_u32 s24, s23, 2304
    buffer_load_dwordx4 v5, s[8:11], s24 offen sc1 lds
    s_waitcnt vmcnt(40)
    v_lshlrev_b32 v3, 4, v1
    v_add_u32 v4, s28, v3
    v_add_u32 v12, 0, v3
    s_add_u32 s23, s16, 143360
    v_add_u32 v168, s23, v3
    s_add_u32 s23, s17, 143360
    v_add_u32 v169, s23, v3
    s_add_u32 s23, s18, 143360
    v_add_u32 v170, s23, v3
    s_add_u32 s23, s19, 143360
    v_add_u32 v171, s23, v3
    s_add_u32 s23, s20, 143360
    v_add_u32 v172, s23, v3
    s_add_u32 s23, s21, 143360
    v_add_u32 v173, s23, v3
    s_add_u32 s23, s22, 143360
    v_add_u32 v174, s23, v3
    v_add_u32 v3, 91750400, v3
    v_lshrrev_b32 v16, 1, v15
    v_mul_u32_u24 v16, 640, v16
    v_and_b32 v17, 1, v15
    v_lshl_add_u32 v16, v17, 8, v16
    v_lshl_add_u32 v6, v14, 4, v16
    v_lshrrev_b32 v16, 1, v15
    v_bfe_u32 v17, v1, 3, 1
    v_lshl_add_u32 v16, v17, 1, v16
    v_mul_u32_u24 v16, 640, v16
    v_and_b32 v17, 7, v1
    v_lshl_add_u32 v16, v17, 4, v16
    v_and_b32 v17, 1, v15
    v_lshl_add_u32 v16, v17, 3, v16
    v_add_u32 v7, 512, v16
    s_mul_i32 s23, s13, 3072
    s_add_u32 s23, s23, 131072
    v_mul_u32_u24 v16, 768, v15
    v_lshl_add_u32 v8, v14, 3, v16
    v_add_u32 v8, s23, v8
    v_lshrrev_b32 v17, 3, v1
    v_and_b32 v16, 3, v1
    v_lshlrev_b32 v10, 2, v16
    v_lshlrev_b32 v16, 1, v16
    v_bfe_u32 v14, v1, 2, 1
    v_lshl_add_u32 v10, v14, 7, v10
    v_lshl_add_u32 v10, v17, 4, v10
    v_add_u32 v16, v16, v14
    s_and_b32 s23, s13, 1
    s_lshl_b32 s23, s23, 3
    v_add_u32 v14, s23, v16
    v_mul_u32_u24 v16, 192, v17
    v_lshl_add_u32 v9, v14, 3, v16
    v_add_u32 v9, 131072, v9
    s_lshl_b32 s23, s14, 9
    s_and_b32 s24, s13, 1
    s_lshl_b32 s24, s24, 8
    s_add_u32 s24, s24, s23
    v_add_u32 v10, s24, v10
    v_lshlrev_b32 v11, 4, v17
    v_lshrrev_b32 v16, 2, v14
    v_lshl_add_u32 v11, v16, 7, v11
    v_and_b32 v16, 3, v14
    v_lshl_add_u32 v11, v16, 2, v11
    v_add_u32 v11, s23, v11
    s_cmp_ge_u32 s13, 2
    s_cselect_b32 s23, 0x40000000, 0
    v_add_u32 v11, s23, v11
    s_mul_i32 s24, s13, 2560
    s_add_u32 s24, s24, 92798976
    s_mul_i32 s25, s13, 56
    s_add_u32 s25, s25, s14
    s_lshl_b32 s25, s25, 11
    s_add_u32 s25, s25, 20971520
    s_mov_b32 s26, 91758592
    s_mov_b32 s29, 92274688
    s_lshl_b32 s31, s14, 2
    s_add_u32 s31, s31, s13
    s_lshl_b32 s31, s31, 11
    s_add_u32 s31, s31, 98566144
    s_mul_i32 s34, s14, 0
    s_add_u32 s34, s34, 64
    s_add_u32 s34, s34, s13
    s_min_u32 s34, s34, 55
    s_lshl_b32 s34, s34, 13
    s_add_u32 s34, s34, 21889024
    v_lshlrev_b32 v13, 7, v1
    s_cmp_ge_u32 s13, 0
    s_cselect_b32 s23, 0x40000000, 0
    v_add_u32 v13, s23, v13
    s_mov_b32 s15, 0
    s_mov_b32 s35, 0x40000000
    v_mov_b32 v178, s96
    v_mov_b32 v179, s97
    v_mov_b32 v16, 0x40000000
    v_cmp_eq_u32 vcc, 0, v1
    s_nop 1
    v_cndmask_b32 v180, v16, v1, vcc
    s_lshl_b32 s27, s14, 2
    s_add_u32 s27, s27, s13
    s_lshl_b32 s27, s27, 3
    s_add_u32 s27, s27, 117458048
    v_mov_b32 v19, 0
    v_mov_b32 v112, 0
    v_mov_b32 v113, 0
    v_mov_b32 v114, 0
    v_mov_b32 v115, 0
    v_mov_b32 v116, 0
    v_mov_b32 v117, 0
    v_mov_b32 v118, 0
    v_mov_b32 v119, 0
    s_waitcnt vmcnt(0)
    s_cmp_lg_u32 s13, 3
    s_cbranch_scc1 LF_24
    s_add_u32 s38, s14, 2256
    s_lshl_b32 s38, s38, 3
    s_add_u32 s38, s38, 117440512
    v_mov_b32 v36, s96
    v_mov_b32 v37, s97
    v_mov_b32 v38, 0
    s_mov_b64 exec, 1
    buffer_store_dwordx2 v[36:37], v38, s[8:11], s38 offen sc1
    s_mov_b64 exec, -1
LF_24:
    v_and_b32 v20, 63, v0
    v_lshlrev_b32 v20, 3, v20
    v_mov_b32 v21, 0
SG_25:
    s_add_u32 s33, s33, 1
    s_cmp_gt_u32 s33, 0x200000
    s_cbranch_scc1 L_bail
    s_mov_b32 s38, 117451776
    buffer_load_dwordx2 v[22:23], v20, s[8:11], s38 offen sc1
    s_mov_b32 s38, 117454848
    buffer_load_dwordx2 v[24:25], v20, s[8:11], s38 offen sc1
    s_mov_b32 s38, 117455360
    buffer_load_dwordx2 v[26:27], v20, s[8:11], s38 offen sc1
    s_mov_b32 s38, 117455872
    buffer_load_dwordx2 v[28:29], v20, s[8:11], s38 offen sc1
    s_mov_b32 s38, 117456384
    buffer_load_dwordx2 v[30:31], v20, s[8:11], s38 offen sc1
    global_load_dword v34, v21, s[4:5] offset:8 sc1
    s_waitcnt vmcnt(0)
    v_readfirstlane_b32 s12, v34
    s_mov_b64 s[40:41], 0
    v_cmp_ne_u64 vcc, s[96:97], v[22:23]
    s_nop 0
    s_or_b64 s[40:41], s[40:41], vcc
    v_cmp_ne_u64 vcc, s[96:97], v[24:25]
    s_nop 0
    s_or_b64 s[40:41], s[40:41], vcc
    v_cmp_ne_u64 vcc, s[96:97], v[26:27]
    s_nop 0
    s_or_b64 s[40:41], s[40:41], vcc
    v_cmp_ne_u64 vcc, s[96:97], v[28:29]
    s_nop 0
    s_or_b64 s[40:41], s[40:41], vcc
    v_cmp_ne_u64 vcc, s[96:97], v[30:31]
    s_nop 0
    s_or_b64 s[40:41], s[40:41], vcc
    s_cbranch_scc1 SGa_27
    s_and_b32 s38, s12, 63
    s_cmp_ge_u32 s38, 32
    s_cbranch_scc1 SGok_26
SGa_27:
    s_sleep 3
    s_branch SG_25
SGok_26:
    s_bfe_u32 s38, s12, 0x90006
    s_mul_i32 s38, s38, s38
    s_lshr_b32 s12, s12, 15
    s_lshl_b32 s12, s12, 5
    s_cmp_lg_u32 s12, s38
    s_cselect_b32 s12, 1, 0
B_top_28:
    v_mov_b32 v48, 0
    v_mov_b32 v49, 0
    v_mov_b32 v50, 0
    v_mov_b32 v51, 0
    v_mov_b32 v52, 0
    v_mov_b32 v53, 0
    v_mov_b32 v54, 0
    v_mov_b32 v55, 0
    v_mov_b32 v56, 0
    v_mov_b32 v57, 0
    v_mov_b32 v58, 0
    v_mov_b32 v59, 0
    ds_read_b128 v[136:139], v4 offset:0
    ds_read_b128 v[140:143], v4 offset:1024
    ds_read_b128 v[144:147], v4 offset:8192
    ds_read_b128 v[148:151], v4 offset:9216
    ds_read_b128 v[152:155], v4 offset:2048
    ds_read_b128 v[156:159], v4 offset:3072
    ds_read_b128 v[160:163], v4 offset:10240
    ds_read_b128 v[164:167], v4 offset:11264
    s_add_u32 s36, s31, s35
    buffer_load_dwordx4 v[20:23], v3, s[8:11], s16 offen sc1
    buffer_load_dwordx4 v[24:27], v3, s[8:11], s17 offen sc1
    v_mov_b32 v60, 0
    v_mov_b32 v61, 0
    v_mov_b32 v62, 0
    v_mov_b32 v63, 0
    v_mov_b32 v64, 0
    v_mov_b32 v65, 0
    v_mov_b32 v66, 0
    v_mov_b32 v67, 0
    v_mov_b32 v68, 0
    v_mov_b32 v69, 0
    v_mov_b32 v70, 0
    v_mov_b32 v71, 0
    v_mov_b32 v72, 0
    v_mov_b32 v73, 0
    v_mov_b32 v74, 0
    v_mov_b32 v75, 0
    v_mov_b32 v76, 0
    v_mov_b32 v77, 0
    v_mov_b32 v78, 0
    v_mov_b32 v79, 0
    v_mov_b32 v128, 0
    v_mov_b32 v129, 0
    v_mov_b32 v130, 0
    v_mov_b32 v131, 0
    v_mov_b32 v132, 0
    v_mov_b32 v133, 0
    v_mov_b32 v134, 0
    v_mov_b32 v135, 0
B_mpoll_29:
    s_add_u32 s33, s33, 1
    s_cmp_gt_u32 s33, 0x200000
    s_cbranch_scc1 L_bail
    buffer_load_dwordx4 v[120:123], v3, s[8:11], s16 offen sc1
    buffer_load_dwordx4 v[124:127], v3, s[8:11], s17 offen sc1
    s_waitcnt vmcnt(3)
    v_max3_u32 v14, v20, v21, v22
    s_waitcnt vmcnt(2)
    v_max3_u32 v14, v14, v23, v24
    v_max3_u32 v14, v14, v25, v26
    v_max_u32 v14, v14, v27
    v_cmp_eq_u32 vcc, -1, v14
    s_cbranch_vccz B_mv0_33
    buffer_load_dwordx4 v[20:23], v3, s[8:11], s16 offen sc1
    buffer_load_dwordx4 v[24:27], v3, s[8:11], s17 offen sc1
    s_waitcnt vmcnt(3)
    v_max3_u32 v14, v120, v121, v122
    s_waitcnt vmcnt(2)
    v_max3_u32 v14, v14, v123, v124
    v_max3_u32 v14, v14, v125, v126
    v_max_u32 v14, v14, v127
    v_cmp_eq_u32 vcc, -1, v14
    s_cbranch_vccnz B_mpoll_29
B_mv1_34:
    v_smfmac_f32_16x16x64_bf16 v[48:51], v[120:123], a[0:7], v2
    ds_write_b128 v168, v[120:123]
    v_smfmac_f32_16x16x64_bf16 v[52:55], v[120:123], a[40:47], v2
    ds_write_b128 v169, v[124:127]
    v_smfmac_f32_16x16x64_bf16 v[56:59], v[120:123], a[80:87], v2
    v_smfmac_f32_16x16x64_bf16 v[60:63], v[120:123], a[120:127], v2
    v_smfmac_f32_16x16x64_bf16 v[64:67], v[120:123], a[160:167], v2
    s_waitcnt lgkmcnt(0)
    s_barrier
    ds_read_b128 v[28:31], v170
    v_smfmac_f32_16x16x64_bf16 v[68:71], v[120:123], a[200:207], v2
    ds_read_b128 v[32:35], v171
    s_add_u32 s23, s25, 0
    buffer_load_dwordx4 v[80:83], v5, s[8:11], s23 offen offset:0 sc1
    v_smfmac_f32_16x16x64_bf16 v[72:75], v[120:123], a[240:247], v2
    ds_read_b128 v[36:39], v172
    v_smfmac_f32_16x16x64_bf16 v[76:79], v[120:123], v[216:223], v2
    ds_read_b128 v[40:43], v173
    s_add_u32 s23, s25, 0
    buffer_load_dwordx4 v[88:91], v5, s[8:11], s23 offen offset:256 sc1
    v_smfmac_f32_16x16x64_bf16 v[48:51], v[124:127], a[8:15], v2
    ds_read_b128 v[44:47], v174
    v_smfmac_f32_16x16x64_bf16 v[52:55], v[124:127], a[48:55], v2
    s_add_u32 s23, s25, 28672
    buffer_load_dwordx4 v[84:87], v5, s[8:11], s23 offen offset:0 sc1
    v_smfmac_f32_16x16x64_bf16 v[56:59], v[124:127], a[88:95], v2
    v_smfmac_f32_16x16x64_bf16 v[60:63], v[124:127], a[128:135], v2
    s_add_u32 s23, s25, 28672
    buffer_load_dwordx4 v[92:95], v5, s[8:11], s23 offen offset:256 sc1
    v_smfmac_f32_16x16x64_bf16 v[64:67], v[124:127], a[168:175], v2
    v_smfmac_f32_16x16x64_bf16 v[68:71], v[124:127], a[208:215], v2
    s_add_u32 s23, s25, 57344
    buffer_load_dwordx4 v[96:99], v5, s[8:11], s23 offen offset:0 sc1
    v_smfmac_f32_16x16x64_bf16 v[72:75], v[124:127], a[248:255], v2
    v_smfmac_f32_16x16x64_bf16 v[76:79], v[124:127], v[224:231], v2
    s_add_u32 s23, s25, 57344
    buffer_load_dwordx4 v[104:107], v5, s[8:11], s23 offen offset:256 sc1
    s_branch B_mc_35
    .p2align 6
B_mv0_33:
    v_smfmac_f32_16x16x64_bf16 v[48:51], v[20:23], a[0:7], v2
    ds_write_b128 v168, v[20:23]
    v_smfmac_f32_16x16x64_bf16 v[52:55], v[20:23], a[40:47], v2
    ds_write_b128 v169, v[24:27]
    v_smfmac_f32_16x16x64_bf16 v[56:59], v[20:23], a[80:87], v2
    v_smfmac_f32_16x16x64_bf16 v[60:63], v[20:23], a[120:127], v2
    v_smfmac_f32_16x16x64_bf16 v[64:67], v[20:23], a[160:167], v2
    s_waitcnt lgkmcnt(0)
    s_barrier
    ds_read_b128 v[28:31], v170
    v_smfmac_f32_16x16x64_bf16 v[68:71], v[20:23], a[200:207], v2
    ds_read_b128 v[32:35], v171
    s_add_u32 s23, s25, 0
    buffer_load_dwordx4 v[80:83], v5, s[8:11], s23 offen offset:0 sc1
    v_smfmac_f32_16x16x64_bf16 v[72:75], v[20:23], a[240:247], v2
    ds_read_b128 v[36:39], v172
    v_smfmac_f32_16x16x64_bf16 v[76:79], v[20:23], v[216:223], v2
    ds_read_b128 v[40:43], v173
    s_add_u32 s23, s25, 0
    buffer_load_dwordx4 v[88:91], v5, s[8:11], s23 offen offset:256 sc1
    v_smfmac_f32_16x16x64_bf16 v[48:51], v[24:27], a[8:15], v2
    ds_read_b128 v[44:47], v174
    v_smfmac_f32_16x16x64_bf16 v[52:55], v[24:27], a[48:55], v2
    s_add_u32 s23, s25, 28672
    buffer_load_dwordx4 v[84:87], v5, s[8:11], s23 offen offset:0 sc1
    v_smfmac_f32_16x16x64_bf16 v[56:59], v[24:27], a[88:95], v2
    v_smfmac_f32_16x16x64_bf16 v[60:63], v[24:27], a[128:135], v2
    s_add_u32 s23, s25, 28672
    buffer_load_dwordx4 v[92:95], v5, s[8:11], s23 offen offset:256 sc1
    v_smfmac_f32_16x16x64_bf16 v[64:67], v[24:27], a[168:175], v2
    v_smfmac_f32_16x16x64_bf16 v[68:71], v[24:27], a[208:215], v2
    s_add_u32 s23, s25, 57344
    buffer_load_dwordx4 v[96:99], v5, s[8:11], s23 offen offset:0 sc1
    v_smfmac_f32_16x16x64_bf16 v[72:75], v[24:27], a[248:255], v2
    v_smfmac_f32_16x16x64_bf16 v[76:79], v[24:27], v[224:231], v2
    s_add_u32 s23, s25, 57344
    buffer_load_dwordx4 v[104:107], v5, s[8:11], s23 offen offset:256 sc1
B_mc_35:
    s_waitcnt lgkmcnt(1)
    v_smfmac_f32_16x16x64_bf16 v[48:51], v[40:43], v[136:143], v2
    ds_read_b128 v[136:139], v4 offset:16384
    s_add_u32 s23, s25, 86016
    buffer_load_dwordx4 v[100:103], v5, s[8:11], s23 offen offset:0 sc1
    v_smfmac_f32_16x16x64_bf16 v[48:51], v[28:31], a[16:23], v2
    ds_read_b128 v[140:143], v4 offset:17408
    v_smfmac_f32_16x16x64_bf16 v[56:59], v[28:31], a[96:103], v2
    s_add_u32 s23, s25, 86016
    buffer_load_dwordx4 v[108:111], v5, s[8:11], s23 offen offset:256 sc1
    v_smfmac_f32_16x16x64_bf16 v[56:59], v[40:43], v[144:151], v2
    ds_read_b128 v[144:147], v4 offset:24576
    v_smfmac_f32_16x16x64_bf16 v[48:51], v[32:35], a[24:31], v2
    ds_read_b128 v[148:151], v4 offset:25600
    buffer_store_dwordx4 v[112:115], v12, s[8:11], s36 offen offset:0 sc1
    s_waitcnt lgkmcnt(4)
    v_smfmac_f32_16x16x64_bf16 v[48:51], v[44:47], v[152:159], v2
    ds_read_b128 v[152:155], v4 offset:18432
    v_smfmac_f32_16x16x64_bf16 v[56:59], v[32:35], a[104:111], v2
    ds_read_b128 v[156:159], v4 offset:19456
    buffer_store_dwordx4 v[116:119], v12, s[8:11], s36 offen offset:1024 sc1
    v_smfmac_f32_16x16x64_bf16 v[48:51], v[36:39], a[32:39], v2
    v_smfmac_f32_16x16x64_bf16 v[56:59], v[44:47], v[160:167], v2
    ds_read_b128 v[160:163], v4 offset:26624
    v_smfmac_f32_16x16x64_bf16 v[56:59], v[36:39], a[112:119], v2
    ds_read_b128 v[164:167], v4 offset:27648
    s_waitcnt lgkmcnt(6)
    v_smfmac_f32_16x16x64_bf16 v[64:67], v[40:43], v[136:143], v2
    ds_read_b128 v[136:139], v4 offset:4096
    v_smfmac_f32_16x16x64_bf16 v[64:67], v[28:31], a[176:183], v2
    ds_read_b128 v[140:143], v4 offset:5120
    v_permlane32_swap_b32 v48, v56
    v_smfmac_f32_16x16x64_bf16 v[72:75], v[28:31], v[192:199], v2
    v_permlane32_swap_b32 v49, v57
    s_waitcnt lgkmcnt(6)
    v_smfmac_f32_16x16x64_bf16 v[72:75], v[40:43], v[144:151], v2
    ds_read_b128 v[144:147], v4 offset:12288
    v_permlane32_swap_b32 v50, v58
    v_smfmac_f32_16x16x64_bf16 v[64:67], v[32:35], a[184:191], v2
    ds_read_b128 v[148:151], v4 offset:13312
    v_permlane32_swap_b32 v51, v59
    s_waitcnt lgkmcnt(6)
    v_smfmac_f32_16x16x64_bf16 v[64:67], v[44:47], v[152:159], v2
    ds_read_b128 v[152:155], v4 offset:6144
    v_add_f32 v48, v48, v56
    v_smfmac_f32_16x16x64_bf16 v[72:75], v[32:35], v[200:207], v2
    ds_read_b128 v[156:159], v4 offset:7168
    v_add_f32 v49, v49, v57
    v_smfmac_f32_16x16x64_bf16 v[64:67], v[36:39], a[192:199], v2
    v_add_f32 v50, v50, v58
    s_waitcnt lgkmcnt(6)
    v_smfmac_f32_16x16x64_bf16 v[72:75], v[44:47], v[160:167], v2
    ds_read_b128 v[160:163], v4 offset:14336
    v_add_f32 v51, v51, v59
    v_smfmac_f32_16x16x64_bf16 v[72:75], v[36:39], v[208:215], v2
    ds_read_b128 v[164:167], v4 offset:15360
    v_cvt_pk_bf16_f32 v112, v48, v49
    s_waitcnt lgkmcnt(6)
    v_smfmac_f32_16x16x64_bf16 v[52:55], v[40:43], v[136:143], v2
    ds_read_b128 v[136:139], v4 offset:20480
    v_cvt_pk_bf16_f32 v114, v50, v51
    v_smfmac_f32_16x16x64_bf16 v[52:55], v[28:31], a[56:63], v2
    ds_read_b128 v[140:143], v4 offset:21504
    v_permlane32_swap_b32 v64, v72
    v_smfmac_f32_16x16x64_bf16 v[60:63], v[28:31], a[136:143], v2
    v_permlane32_swap_b32 v65, v73
    s_waitcnt lgkmcnt(6)
    v_smfmac_f32_16x16x64_bf16 v[60:63], v[40:43], v[144:151], v2
    ds_read_b128 v[144:147], v4 offset:28672
    v_permlane32_swap_b32 v66, v74
    v_smfmac_f32_16x16x64_bf16 v[52:55], v[32:35], a[64:71], v2
    ds_read_b128 v[148:151], v4 offset:29696
    v_permlane32_swap_b32 v67, v75
    s_waitcnt lgkmcnt(6)
    v_smfmac_f32_16x16x64_bf16 v[52:55], v[44:47], v[152:159], v2
    ds_read_b128 v[152:155], v4 offset:22528
    v_add_f32 v64, v64, v72
    v_smfmac_f32_16x16x64_bf16 v[60:63], v[32:35], a[144:151], v2
    ds_read_b128 v[156:159], v4 offset:23552
    v_add_f32 v65, v65, v73
    v_smfmac_f32_16x16x64_bf16 v[52:55], v[36:39], a[72:79], v2
    v_add_f32 v66, v66, v74
    s_waitcnt lgkmcnt(6)
    v_smfmac_f32_16x16x64_bf16 v[60:63], v[44:47], v[160:167], v2
    ds_read_b128 v[160:163], v4 offset:30720
    v_add_f32 v67, v67, v75
    v_smfmac_f32_16x16x64_bf16 v[60:63], v[36:39], a[152:159], v2
    ds_read_b128 v[164:167], v4 offset:31744
    v_cvt_pk_bf16_f32 v113, v64, v65
    s_waitcnt lgkmcnt(6)
    v_smfmac_f32_16x16x64_bf16 v[68:71], v[40:43], v[136:143], v2
    v_cvt_pk_bf16_f32 v115, v66, v67
    v_smfmac_f32_16x16x64_bf16 v[68:71], v[28:31], a[216:223], v2
    v_permlane32_swap_b32 v52, v60
    v_smfmac_f32_16x16x64_bf16 v[76:79], v[28:31], v[232:239], v2
    v_permlane32_swap_b32 v53, v61
    s_waitcnt lgkmcnt(4)
    v_smfmac_f32_16x16x64_bf16 v[76:79], v[40:43], v[144:151], v2
    v_permlane32_swap_b32 v54, v62
    v_smfmac_f32_16x16x64_bf16 v[68:71], v[32:35], a[224:231], v2
    v_permlane32_swap_b32 v55, v63
    s_waitcnt lgkmcnt(2)
    v_smfmac_f32_16x16x64_bf16 v[68:71], v[44:47], v[152:159], v2
    v_add_f32 v52, v52, v60
    v_smfmac_f32_16x16x64_bf16 v[76:79], v[32:35], v[240:247], v2
    v_add_f32 v53, v53, v61
    v_smfmac_f32_16x16x64_bf16 v[68:71], v[36:39], a[232:239], v2
    v_add_f32 v54, v54, v62
    s_waitcnt lgkmcnt(0)
    v_smfmac_f32_16x16x64_bf16 v[76:79], v[44:47], v[160:167], v2
    v_add_f32 v55, v55, v63
    v_smfmac_f32_16x16x64_bf16 v[76:79], v[36:39], v[248:255], v2
    v_cvt_pk_bf16_f32 v116, v52, v53
    v_cvt_pk_bf16_f32 v118, v54, v55
    s_nop 5
    v_permlane32_swap_b32 v68, v76
    v_permlane32_swap_b32 v69, v77
    v_permlane32_swap_b32 v70, v78
    v_permlane32_swap_b32 v71, v79
    v_add_f32 v68, v68, v76
    v_add_f32 v69, v69, v77
    v_add_f32 v70, v70, v78
    v_add_f32 v71, v71, v79
    v_cvt_pk_bf16_f32 v117, v68, v69
    v_cvt_pk_bf16_f32 v119, v70, v71
    s_cmp_eq_u32 s15, 0
    s_cselect_b32 s23, 0, 114688
    s_add_u32 s31, s31, s23
    s_mov_b32 s35, 0
    s_add_u32 s27, s27, 448
    s_add_u32 s25, s25, 458752
    s_add_u32 s34, s34, 458752
    s_cmp_ge_u32 s15, 62
    s_cbranch_scc1 B_lq_36
B_lqb_37:
    s_cmp_ge_u32 s13, 2
    s_cselect_b32 s23, 0x40000000, s26
    s_cmp_eq_u32 s12, 0
    s_cselect_b32 s29, s23, 0x40000000
    s_cselect_b32 s37, 0x40000000, s23
    v_mov_b32 v177, v177
    v_mov_b32 v177, v177
    v_mov_b32 v177, v177
    v_mov_b32 v177, v177
    v_mov_b32 v177, v177
    v_mov_b32 v177, v177
    v_mov_b32 v177, v177
    v_mov_b32 v177, v177
    v_mov_b32 v177, v177
    v_mov_b32 v177, v177
    v_mov_b32 v177, v177
    v_mov_b32 v177, v177
    v_mov_b32 v177, v177
    v_mov_b32 v177, v177
    v_mov_b32 v177, v177
    v_mov_b32 v177, v177
    v_mov_b32 v177, v177
    v_mov_b32 v177, v177
    v_mov_b32 v177, v177
    v_mov_b32 v177, v177
    v_mov_b32 v177, v177
    v_mov_b32 v177, v177
    v_mov_b32 v177, v177
    v_mov_b32 v177, v177
    v_mov_b32 v177, v177
    v_mov_b32 v177, v177
    v_mov_b32 v177, v177
    v_mov_b32 v177, v177
    v_mov_b32 v177, v177
    v_mov_b32 v177, v177
    v_mov_b32 v177, v177
    v_mov_b32 v177, v177
    buffer_load_dwordx4 v[20:23], v6, s[8:11], s24 offen sc1
    buffer_load_dwordx4 v[24:27], v6, s[8:11], s24 offen offset:1280 sc1
    buffer_load_dwordx2 v[182:183], v7, s[8:11], s24 offen sc1
    v_mov_b32 v177, v177
    v_mov_b32 v177, v177
    v_mov_b32 v177, v177
    v_mov_b32 v177, v177
    v_mov_b32 v177, v177
    v_mov_b32 v177, v177
    v_mov_b32 v177, v177
    v_mov_b32 v177, v177
B_ppoll_30:
    s_add_u32 s33, s33, 1
    s_cmp_gt_u32 s33, 0x200000
    s_cbranch_scc1 L_bail
    buffer_load_dwordx4 v[120:123], v6, s[8:11], s24 offen sc1
    buffer_load_dwordx4 v[124:127], v6, s[8:11], s24 offen offset:1280 sc1
    buffer_load_dwordx2 v[184:185], v7, s[8:11], s24 offen sc1
B_chk0_42:
    s_waitcnt vmcnt(3)
    v_max3_u32 v14, v23, v27, v183
    v_cmp_eq_u32 vcc, -1, v14
    s_cbranch_vccz B_var0_38
    buffer_load_dwordx4 v[20:23], v6, s[8:11], s24 offen sc1
    buffer_load_dwordx4 v[24:27], v6, s[8:11], s24 offen offset:1280 sc1
    buffer_load_dwordx2 v[182:183], v7, s[8:11], s24 offen sc1
    s_waitcnt vmcnt(3)
    v_max3_u32 v14, v123, v127, v185
    v_cmp_eq_u32 vcc, -1, v14
    s_cbranch_vccnz B_ppoll_30
B_var1_39:
    v_smfmac_f32_16x16x64_bf16 v[128:131], v[120:123], v[80:87], v2
    v_smfmac_f32_16x16x64_bf16 v[132:135], v[120:123], v[88:95], v2
    v_smfmac_f32_16x16x64_bf16 v[128:131], v[124:127], v[96:103], v2
    v_smfmac_f32_16x16x64_bf16 v[132:135], v[124:127], v[104:111], v2
    v_smfmac_f32_16x16x32_bf16 v[128:131], v[184:185], v[112:115], v2
    v_smfmac_f32_16x16x32_bf16 v[132:135], v[184:185], v[116:119], v2
    v_max3_u32 v14, v120, v121, v122
    v_max3_u32 v14, v14, v124, v125
    s_nop 5
    ds_write2_b32 v8, v128, v132 offset0:0 offset1:1
    ds_write2_b32 v8, v129, v133 offset0:48 offset1:49
    ds_write2_b32 v8, v130, v134 offset0:96 offset1:97
    ds_write2_b32 v8, v131, v135 offset0:144 offset1:145
    v_max3_u32 v14, v14, v126, v184
    v_cmp_eq_u32 vcc, -1, v14
    s_cbranch_vccnz B_bad_43
    s_branch B_common_40
B_bad_43:
    s_waitcnt vmcnt(0) lgkmcnt(0)
    s_nop 7
    v_mov_b32 v128, 0
    v_mov_b32 v129, 0
    v_mov_b32 v130, 0
    v_mov_b32 v131, 0
    v_mov_b32 v132, 0
    v_mov_b32 v133, 0
    v_mov_b32 v134, 0
    v_mov_b32 v135, 0
    buffer_load_dwordx4 v[20:23], v6, s[8:11], s24 offen sc1
    buffer_load_dwordx4 v[24:27], v6, s[8:11], s24 offen offset:1280 sc1
    buffer_load_dwordx2 v[182:183], v7, s[8:11], s24 offen sc1
    s_branch B_ppoll_30
    .p2align 6
B_var0_38:
    v_smfmac_f32_16x16x64_bf16 v[128:131], v[20:23], v[80:87], v2
    v_smfmac_f32_16x16x64_bf16 v[132:135], v[20:23], v[88:95], v2
    v_smfmac_f32_16x16x64_bf16 v[128:131], v[24:27], v[96:103], v2
    v_smfmac_f32_16x16x64_bf16 v[132:135], v[24:27], v[104:111], v2
    v_smfmac_f32_16x16x32_bf16 v[128:131], v[182:183], v[112:115], v2
    v_smfmac_f32_16x16x32_bf16 v[132:135], v[182:183], v[116:119], v2
    v_max3_u32 v14, v20, v21, v22
    v_max3_u32 v14, v14, v24, v25
    s_nop 5
    ds_write2_b32 v8, v128, v132 offset0:0 offset1:1
    ds_write2_b32 v8, v129, v133 offset0:48 offset1:49
    ds_write2_b32 v8, v130, v134 offset0:96 offset1:97
    ds_write2_b32 v8, v131, v135 offset0:144 offset1:145
    v_max3_u32 v14, v14, v26, v182
    v_cmp_eq_u32 vcc, -1, v14
    s_cbranch_vccnz B_bad_43
B_common_40:
    s_cmp_ge_u32 s13, 2
    v_mfma_f32_32x32x16_bf16 v[136:151], v[152:155], v[152:155], v[136:151]
    s_waitcnt lgkmcnt(0)
    s_barrier
    s_cbranch_scc1 B_next_31
    ds_read2st64_b64 v[48:51], v9 offset0:0 offset1:3
    ds_read2st64_b64 v[52:55], v9 offset0:6 offset1:9
    ds_read2st64_b64 v[56:59], v9 offset0:12 offset1:15
    ds_read2st64_b64 v[60:63], v9 offset0:18 offset1:21
    v_mov_b32 v177, v177
    v_mov_b32 v177, v177
    v_mov_b32 v177, v177
    v_mov_b32 v15, -2
    s_waitcnt lgkmcnt(3)
    v_pk_add_f32 v[48:49], v[48:49], v[50:51]
    s_waitcnt lgkmcnt(2)
    v_pk_add_f32 v[52:53], v[52:53], v[54:55]
    v_pk_add_f32 v[48:49], v[48:49], v[52:53]
    s_waitcnt lgkmcnt(1)
    v_pk_add_f32 v[56:57], v[56:57], v[58:59]
    v_pk_add_f32 v[48:49], v[48:49], v[56:57]
    s_waitcnt lgkmcnt(0)
    v_pk_add_f32 v[60:61], v[60:61], v[62:63]
    v_pk_add_f32 v[48:49], v[48:49], v[60:61]
    v_cvt_pk_bf16_f32 v19, v48, v49
    v_min_u32 v19, v19, v15
B_next_31:
    buffer_store_dword v19, v10, s[8:11], s29 offen
    buffer_store_dword v19, v10, s[8:11], s37 offen sc1
    s_barrier
    s_cmp_lg_u32 s15, 62
    s_cbranch_scc1 B_nl_44
    s_mov_b32 s23, 92790784
    s_waitcnt vmcnt(2)
    buffer_store_dword v19, v11, s[8:11], s23 offen sc1
    s_branch B_nl_44x
B_nl_44:
    s_waitcnt vmcnt(2)
B_nl_44x:
    v_add_u32 v3, 8192, v3
    s_add_u32 s24, s24, 16384
    s_add_u32 s26, s26, 8192
    s_add_u32 s15, s15, 1
    s_branch B_top_28
B_lq_36:
    v_min_u32 v112, -2, v112
    v_min_u32 v113, -2, v113
    v_min_u32 v114, -2, v114
    v_min_u32 v115, -2, v115
    v_min_u32 v116, -2, v116
    v_min_u32 v117, -2, v117
    v_min_u32 v118, -2, v118
    v_min_u32 v119, -2, v119
    s_cmp_eq_u32 s15, 63
    s_cbranch_scc1 B_fin_32
    s_add_u32 s31, s31, 0xff738000
    s_nop 1
    s_branch B_lqb_37
B_fin_32:
    buffer_store_dwordx4 v[112:115], v12, s[8:11], s31 offen offset:0 sc1
    buffer_store_dwordx4 v[116:119], v12, s[8:11], s31 offen offset:1024 sc1
    s_endpgm
L_roleC:
    s_sub_u32 s14, s14, 30
    v_and_b32 v1, 63, v0
    v_lshlrev_b32 v2, 7, v1
    s_lshl_b32 s16, s14, 2
    s_add_u32 s16, s16, s13
    s_cmp_eq_u32 s16, 7
    s_cselect_b32 s19, 0, s16
    s_lshl_b32 s19, s19, 10
    v_lshlrev_b32 v7, 4, v1
    s_lshl_b32 s23, s13, 10
    v_add_u32 v5, s23, v7
    v_lshrrev_b32 v8, 4, v1
    v_lshlrev_b32 v6, 8, v8
    v_and_b32 v8, 7, v1
    v_lshl_add_u32 v6, v8, 4, v6
    v_bfe_u32 v8, v1, 3, 1
    v_lshl_add_u32 v6, v8, 3, v6
    v_add_u32 v6, s23, v6
    v_add_u32 v7, s19, v7
    v_add_u32 v3, 91758592, v7
    s_cmp_eq_u32 s16, 7
    s_cselect_b32 s19, 0x40000000, 0
    s_add_u32 s19, s19, 92282880
    s_lshl_b32 s17, s16, 13
    s_add_u32 s17, s17, 0
    s_mov_b32 s18, 28672
    s_cmp_ge_u32 s16, 4
    s_cselect_b32 s17, 91758592, s17
    s_cselect_b32 s18, 8192, s18
    s_cmp_eq_u32 s16, 6
    s_cselect_b32 s17, 92798976, s17
    s_cmp_eq_u32 s16, 7
    s_cselect_b32 s17, 92807168, s17
    s_cmp_ge_u32 s16, 6
    s_cselect_b32 s18, 16384, s18
    v_and_b32 v12, 63, v0
    v_lshlrev_b32 v12, 3, v12
FM_45:
    s_add_u32 s33, s33, 1
    s_cmp_gt_u32 s33, 0x200000
    s_cbranch_scc1 L_bail
    s_mov_b32 s38, 117454848
    buffer_load_dwordx2 v[14:15], v12, s[8:11], s38 offen sc1
    s_mov_b32 s38, 117455360
    buffer_load_dwordx2 v[16:17], v12, s[8:11], s38 offen sc1
    s_mov_b32 s38, 117455872
    buffer_load_dwordx2 v[18:19], v12, s[8:11], s38 offen sc1
    s_mov_b32 s38, 117456384
    buffer_load_dwordx2 v[20:21], v12, s[8:11], s38 offen sc1
    s_waitcnt vmcnt(0)
    s_mov_b64 s[40:41], 0
    v_cmp_ne_u64 vcc, s[96:97], v[14:15]
    s_nop 0
    s_or_b64 s[40:41], s[40:41], vcc
    v_cmp_ne_u64 vcc, s[96:97], v[16:17]
    s_nop 0
    s_or_b64 s[40:41], s[40:41], vcc
    v_cmp_ne_u64 vcc, s[96:97], v[18:19]
    s_nop 0
    s_or_b64 s[40:41], s[40:41], vcc
    v_cmp_ne_u64 vcc, s[96:97], v[20:21]
    s_nop 0
    s_or_b64 s[40:41], s[40:41], vcc
    s_cbranch_scc0 FMok_46
    s_sleep 4
    s_branch FM_45
FMok_46:
    s_mov_b32 s23, 91750400
    buffer_load_dword v4, v2, s[8:11], s23 offen
    buffer_load_dword v4, v2, s[8:11], s17 offen
    s_add_u32 s17, s17, s18
    buffer_load_dword v4, v2, s[8:11], s17 offen
    s_add_u32 s17, s17, s18
    buffer_load_dword v4, v2, s[8:11], s17 offen
    s_add_u32 s17, s17, s18
    v_and_b32 v12, 63, v0
    v_lshlrev_b32 v12, 3, v12
    v_mov_b32 v13, 0
SG_47:
    s_add_u32 s33, s33, 1
    s_cmp_gt_u32 s33, 0x200000
    s_cbranch_scc1 L_bail
    s_mov_b32 s38, 117451776
    buffer_load_dwordx2 v[14:15], v12, s[8:11], s38 offen sc1
    global_load_dword v26, v13, s[4:5] offset:8 sc1
    s_waitcnt vmcnt(0)
    v_readfirstlane_b32 s12, v26
    s_mov_b64 s[40:41], 0
    v_cmp_ne_u64 vcc, s[96:97], v[14:15]
    s_nop 0
    s_or_b64 s[40:41], s[40:41], vcc
    s_cbranch_scc1 SGa_49
    s_and_b32 s38, s12, 63
    s_cmp_ge_u32 s38, 32
    s_cbranch_scc1 SGok_48
SGa_49:
    s_sleep 3
    s_branch SG_47
SGok_48:
    s_bfe_u32 s38, s12, 0x90006
    s_mul_i32 s38, s38, s38
    s_lshr_b32 s12, s12, 15
    s_lshl_b32 s12, s12, 5
    s_cmp_lg_u32 s12, s38
    s_cselect_b32 s12, 1, 0
    s_add_u32 s23, s16, 0
    s_lshl_b32 s23, s23, 13
    s_add_u32 s23, s23, 20971520
    buffer_load_dword v4, v2, s[8:11], s23 offen
    s_add_u32 s23, s16, 8
    s_lshl_b32 s23, s23, 13
    s_add_u32 s23, s23, 20971520
    buffer_load_dword v4, v2, s[8:11], s23 offen
    s_add_u32 s23, s16, 16
    s_lshl_b32 s23, s23, 13
    s_add_u32 s23, s23, 20971520
    buffer_load_dword v4, v2, s[8:11], s23 offen
    s_add_u32 s23, s16, 24
    s_lshl_b32 s23, s23, 13
    s_add_u32 s23, s23, 20971520
    buffer_load_dword v4, v2, s[8:11], s23 offen
    s_add_u32 s23, s16, 32
    s_lshl_b32 s23, s23, 13
    s_add_u32 s23, s23, 20971520
    buffer_load_dword v4, v2, s[8:11], s23 offen
    s_add_u32 s23, s16, 40
    s_lshl_b32 s23, s23, 13
    s_add_u32 s23, s23, 20971520
    buffer_load_dword v4, v2, s[8:11], s23 offen
    s_add_u32 s23, s16, 48
    s_lshl_b32 s23, s23, 13
    s_add_u32 s23, s23, 20971520
    buffer_load_dword v4, v2, s[8:11], s23 offen
    s_mov_b32 s15, 1
C_top_50:
    s_add_u32 s33, s33, 1
    s_cmp_gt_u32 s33, 0x200000
    s_cbranch_scc1 L_bail
    s_sleep 1
    buffer_load_dwordx4 v[12:15], v3, s[8:11], 0 offen sc1
    s_waitcnt vmcnt(0)
    v_max3_u32 v8, v12, v13, v14
    v_max_u32 v8, v8, v15
    v_cmp_eq_u32 vcc, -1, v8
    s_cbranch_vccnz C_top_50
    ds_write_b128 v5, v[12:15]
    ds_read2_b32 v[16:17], v6 offset0:0 offset1:32
    ds_read2_b32 v[18:19], v6 offset0:1 offset1:33
    s_waitcnt lgkmcnt(0)
    buffer_store_dwordx4 v[16:19], v7, s[8:11], s19 offen sc1
    v_add_u32 v3, 8192, v3
    s_add_u32 s19, s19, 8192
    s_cmp_gt_u32 s15, 61
    s_cbranch_scc1 C_skip_51
    buffer_load_dword v4, v2, s[8:11], s17 offen
    s_add_u32 s17, s17, s18
C_skip_51:
    s_add_u32 s15, s15, 1
    s_cmp_lt_u32 s15, 64
    s_cbranch_scc1 C_top_50
    s_endpgm
L_bail:
    s_endpgm
W_deq:
    s_cmp_lg_u32 s13, 0
    s_cbranch_scc1 W_f2
    s_mov_b64 exec, 1
    s_lshl_b32 s38, s75, 2
    v_mov_b32 v26, s38
    v_mov_b32 v30, 1
    global_atomic_add v30, v26, v30, s[4:5] offset:128 sc0
    s_waitcnt vmcnt(0)
    ds_write_b32 v28, v30
    s_waitcnt lgkmcnt(0)
    s_mov_b64 exec, -1
W_f2:
    s_barrier
W_next:
    ds_read_b32 v26, v28
    s_waitcnt lgkmcnt(0)
    v_readfirstlane_b32 s68, v26
    s_nop 0
    s_cmp_eq_u32 s68, -1
    s_cbranch_scc1 W_claim
    s_cmp_eq_u32 s75, 7
    s_cbranch_scc1 W_late
    s_add_u32 s70, s75, 0
    s_cmp_ge_u32 s70, 7
    s_cselect_b32 s38, 7, 0
    s_sub_u32 s70, s70, s38
    s_cmp_lt_u32 s70, 4
    s_cselect_b32 s71, 5, 4
    s_cselect_b32 s72, 13108, 0
    s_cselect_b32 s38, 0, 16384
    s_add_u32 s72, s72, s38
    s_mul_i32 s38, s71, 2
    s_cmp_lt_u32 s68, s38
    s_cbranch_scc1 W_y0
    s_sub_u32 s68, s68, s38
    s_add_u32 s70, s75, 0
    s_cmp_ge_u32 s70, 7
    s_cselect_b32 s38, 7, 0
    s_sub_u32 s70, s70, s38
    s_cmp_lt_u32 s70, 4
    s_cselect_b32 s71, 5, 4
    s_cselect_b32 s72, 13108, 0
    s_cselect_b32 s38, 0, 16384
    s_add_u32 s72, s72, s38
    s_mul_i32 s38, s71, 7
    s_cmp_lt_u32 s68, s38
    s_cbranch_scc1 W_y
    s_sub_u32 s68, s68, s38
    s_add_u32 s70, s75, 3
    s_cmp_ge_u32 s70, 7
    s_cselect_b32 s38, 7, 0
    s_sub_u32 s70, s70, s38
    s_cmp_lt_u32 s70, 2
    s_cselect_b32 s71, 3, 2
    s_cselect_b32 s72, 21846, 0
    s_cselect_b32 s38, 0, 32768
    s_add_u32 s72, s72, s38
    s_mul_i32 s38, s71, 7
    s_cmp_lt_u32 s68, s38
    s_cbranch_scc1 W_pk
    s_sub_u32 s68, s68, s38
    s_add_u32 s70, s75, 3
    s_cmp_ge_u32 s70, 7
    s_cselect_b32 s38, 7, 0
    s_sub_u32 s70, s70, s38
    s_cmp_lt_u32 s70, 0
    s_cselect_b32 s71, 9, 8
    s_cselect_b32 s72, 7282, 0
    s_cselect_b32 s38, 0, 8192
    s_add_u32 s72, s72, s38
    s_mul_i32 s38, s71, 1
    s_cmp_lt_u32 s68, s38
    s_cbranch_scc1 W_pw
    s_sub_u32 s68, s68, s38
    s_add_u32 s70, s75, 3
    s_cmp_ge_u32 s70, 7
    s_cselect_b32 s38, 7, 0
    s_sub_u32 s70, s70, s38
    s_cmp_lt_u32 s70, 2
    s_cselect_b32 s71, 3, 2
    s_cselect_b32 s72, 21846, 0
    s_cselect_b32 s38, 0, 32768
    s_add_u32 s72, s72, s38
    s_mul_i32 s38, s71, 8
    s_cmp_lt_u32 s68, s38
    s_cbranch_scc1 W_gu
    s_sub_u32 s68, s68, s38
    s_add_u32 s70, s75, 1
    s_cmp_ge_u32 s70, 7
    s_cselect_b32 s38, 7, 0
    s_sub_u32 s70, s70, s38
    s_cmp_lt_u32 s70, 2
    s_cselect_b32 s71, 3, 2
    s_cselect_b32 s72, 21846, 0
    s_cselect_b32 s38, 0, 32768
    s_add_u32 s72, s72, s38
    s_mul_i32 s38, s71, 8
    s_cmp_lt_u32 s68, s38
    s_cbranch_scc1 W_t1
    s_sub_u32 s68, s68, s38
    s_add_u32 s70, s75, 6
    s_cmp_ge_u32 s70, 7
    s_cselect_b32 s38, 7, 0
    s_sub_u32 s70, s70, s38
    s_cmp_lt_u32 s70, 1
    s_cselect_b32 s71, 10, 9
    s_cselect_b32 s72, 6554, 0
    s_cselect_b32 s38, 0, 7282
    s_add_u32 s72, s72, s38
    s_mul_i32 s38, s71, 1
    s_cmp_lt_u32 s68, s38
    s_cbranch_scc1 W_g2
    s_sub_u32 s68, s68, s38
    s_add_u32 s70, s75, 5
    s_cmp_ge_u32 s70, 7
    s_cselect_b32 s38, 7, 0
    s_sub_u32 s70, s70, s38
    s_cmp_lt_u32 s70, 2
    s_cselect_b32 s71, 3, 2
    s_cselect_b32 s72, 21846, 0
    s_cselect_b32 s38, 0, 32768
    s_add_u32 s72, s72, s38
    s_mul_i32 s38, s71, 8
    s_cmp_lt_u32 s68, s38
    s_cbranch_scc1 W_t2
    s_sub_u32 s68, s68, s38
    v_and_b32 v8, 7, v0
    v_lshlrev_b32 v8, 2, v8
    global_load_dword v9, v8, s[4:5] offset:128 sc1
    v_mov_b32 v10, 0
    s_mov_b32 s38, 132
    v_writelane_b32 v10, s38, 0
    s_mov_b32 s38, 125
    v_writelane_b32 v10, s38, 1
    s_mov_b32 s38, 132
    v_writelane_b32 v10, s38, 2
    s_mov_b32 s38, 132
    v_writelane_b32 v10, s38, 3
    s_mov_b32 s38, 130
    v_writelane_b32 v10, s38, 4
    s_mov_b32 s38, 130
    v_writelane_b32 v10, s38, 5
    s_mov_b32 s38, 123
    v_writelane_b32 v10, s38, 6
    s_waitcnt vmcnt(0)
    v_cmp_lt_u32 vcc, v9, v10
    s_nop 0
    s_and_b32 s38, vcc_lo, 0x7f
    s_or_b32 s38, s38, 0x80
    s_ff1_i32_b32 s38, s38
    v_mov_b32 v9, s38
    s_barrier
    s_cmp_lg_u32 s13, 0
    s_cbranch_scc1 W_x1
    ds_write_b32 v28, v9 offset:4
    s_waitcnt lgkmcnt(0)
W_x1:
    s_barrier
    ds_read_b32 v9, v28 offset:4
    s_waitcnt lgkmcnt(0)
    v_readfirstlane_b32 s75, v9
    s_branch W_deq
W_y0:
    s_mul_i32 s73, s68, s72
    s_lshr_b32 s73, s73, 16
    s_mul_i32 s74, s73, s71
    s_sub_u32 s74, s68, s74
    s_mul_i32 s74, s74, 7
    s_add_u32 s74, s74, s70
    s_lshl_b32 s39, s73, 5
    s_add_u32 s39, s39, s74
    s_add_u32 s69, s39, 1408
    s_lshl_b32 s70, s73, 4
    s_add_u32 s70, s70, 1792
    v_and_b32 v8, 63, v0
    v_min_u32 v8, 15, v8
    v_lshlrev_b32 v8, 3, v8
    s_lshl_b32 s38, s70, 3
    s_add_u32 s38, s38, 117440512
FW_52:
    s_add_u32 s33, s33, 1
    s_cmp_gt_u32 s33, 0x200000
    s_cbranch_scc1 L_bail
    buffer_load_dwordx2 v[10:11], v8, s[8:11], s38 offen sc1
    s_waitcnt vmcnt(0)
    v_cmp_ne_u64 vcc, s[96:97], v[10:11]
    s_cbranch_vccz FWok_53
    s_sleep 4
    s_branch FW_52
FWok_53:
    s_lshl_b32 s70, s74, 2
    s_add_u32 s70, s70, 1664
    v_and_b32 v8, 63, v0
    v_min_u32 v8, 3, v8
    v_lshlrev_b32 v8, 3, v8
    s_lshl_b32 s38, s70, 3
    s_add_u32 s38, s38, 117440512
FW_54:
    s_add_u32 s33, s33, 1
    s_cmp_gt_u32 s33, 0x200000
    s_cbranch_scc1 L_bail
    buffer_load_dwordx2 v[10:11], v8, s[8:11], s38 offen sc1
    s_waitcnt vmcnt(0)
    v_cmp_ne_u64 vcc, s[96:97], v[10:11]
    s_cbranch_vccz FWok_55
    s_sleep 4
    s_branch FW_54
FWok_55:
    s_lshr_b32 s53, s39, 5
    s_and_b32 s54, s39, 31
    s_lshl_b32 s55, s53, 2
    s_add_u32 s55, s55, s13
    s_mul_i32 s40, s55, 28672
    s_add_u32 s40, s40, 0
    s_mul_i32 s41, s54, 200704
    s_add_u32 s41, s41, 8519680
    s_mul_i32 s42, s55, 458752
    s_mul_i32 s50, s54, 14336
    s_add_u32 s42, s42, s50
    s_add_u32 s42, s42, 20971520
    v_add_u32 v5, 0, v2
    v_add_u32 v6, 28672, v2
    v_add_u32 v7, 57344, v2
    s_lshl_b32 s44, s13, 1
    s_min_u32 s45, s44, 6
    s_add_u32 s44, s44, 1
    s_min_u32 s46, s44, 6
    s_mul_i32 s47, s45, 28672
    s_add_u32 s47, s47, s41
    s_mul_i32 s48, s46, 28672
    s_add_u32 s48, s48, s41
    s_lshl_b32 s45, s45, 12
    s_lshl_b32 s46, s46, 12
    s_mov_b32 s49, s40
    s_add_u32 s50, s45, 0
    s_mov_b32 m0, s50
    s_nop 0
    buffer_load_dwordx4 v2, s[8:11], s47 offen sc1 lds
    buffer_load_dwordx4 v2, s[8:11], s47 offen offset:1024 sc1 lds
    buffer_load_dwordx4 v2, s[8:11], s47 offen offset:2048 sc1 lds
    buffer_load_dwordx4 v2, s[8:11], s47 offen offset:3072 sc1 lds
    s_add_u32 s47, s47, 4096
    s_add_u32 s50, s46, 0
    s_mov_b32 m0, s50
    s_nop 0
    buffer_load_dwordx4 v2, s[8:11], s48 offen sc1 lds
    buffer_load_dwordx4 v2, s[8:11], s48 offen offset:1024 sc1 lds
    buffer_load_dwordx4 v2, s[8:11], s48 offen offset:2048 sc1 lds
    buffer_load_dwordx4 v2, s[8:11], s48 offen offset:3072 sc1 lds
    s_add_u32 s48, s48, 4096
    buffer_load_dwordx4 a[0:3], v3, s[8:11], s49 offen offset:0 sc1
    buffer_load_dwordx4 a[4:7], v3, s[8:11], s49 offen offset:1024 sc1
    buffer_load_dwordx4 a[8:11], v3, s[8:11], s49 offen offset:2048 sc1
    buffer_load_dwordx4 a[12:15], v3, s[8:11], s49 offen offset:3072 sc1
    s_add_u32 s49, s49, 4096
    s_add_u32 s50, s45, 28672
    s_mov_b32 m0, s50
    s_nop 0
    buffer_load_dwordx4 v2, s[8:11], s47 offen sc1 lds
    buffer_load_dwordx4 v2, s[8:11], s47 offen offset:1024 sc1 lds
    buffer_load_dwordx4 v2, s[8:11], s47 offen offset:2048 sc1 lds
    buffer_load_dwordx4 v2, s[8:11], s47 offen offset:3072 sc1 lds
    s_add_u32 s47, s47, 4096
    s_add_u32 s50, s46, 28672
    s_mov_b32 m0, s50
    s_nop 0
    buffer_load_dwordx4 v2, s[8:11], s48 offen sc1 lds
    buffer_load_dwordx4 v2, s[8:11], s48 offen offset:1024 sc1 lds
    buffer_load_dwordx4 v2, s[8:11], s48 offen offset:2048 sc1 lds
    buffer_load_dwordx4 v2, s[8:11], s48 offen offset:3072 sc1 lds
    s_add_u32 s48, s48, 4096
    buffer_load_dwordx4 a[16:19], v3, s[8:11], s49 offen offset:0 sc1
    buffer_load_dwordx4 a[20:23], v3, s[8:11], s49 offen offset:1024 sc1
    buffer_load_dwordx4 a[24:27], v3, s[8:11], s49 offen offset:2048 sc1
    buffer_load_dwordx4 a[28:31], v3, s[8:11], s49 offen offset:3072 sc1
    s_add_u32 s49, s49, 4096
    v_mov_b32 v32, 0
    v_mov_b32 v33, 0
    v_mov_b32 v34, 0
    v_mov_b32 v35, 0
    v_mov_b32 v36, 0
    v_mov_b32 v37, 0
    v_mov_b32 v38, 0
    v_mov_b32 v39, 0
    v_mov_b32 v40, 0
    v_mov_b32 v41, 0
    v_mov_b32 v42, 0
    v_mov_b32 v43, 0
    v_mov_b32 v44, 0
    v_mov_b32 v45, 0
    v_mov_b32 v46, 0
    v_mov_b32 v47, 0
    v_mov_b32 v48, 0
    v_mov_b32 v49, 0
    v_mov_b32 v50, 0
    v_mov_b32 v51, 0
    v_mov_b32 v52, 0
    v_mov_b32 v53, 0
    v_mov_b32 v54, 0
    v_mov_b32 v55, 0
    v_mov_b32 v56, 0
    v_mov_b32 v57, 0
    v_mov_b32 v58, 0
    v_mov_b32 v59, 0
    v_mov_b32 v60, 0
    v_mov_b32 v61, 0
    v_mov_b32 v62, 0
    v_mov_b32 v63, 0
    v_mov_b32 v64, 0
    v_mov_b32 v65, 0
    v_mov_b32 v66, 0
    v_mov_b32 v67, 0
    v_mov_b32 v68, 0
    v_mov_b32 v69, 0
    v_mov_b32 v70, 0
    v_mov_b32 v71, 0
    v_mov_b32 v72, 0
    v_mov_b32 v73, 0
    v_mov_b32 v74, 0
    v_mov_b32 v75, 0
    v_mov_b32 v76, 0
    v_mov_b32 v77, 0
    v_mov_b32 v78, 0
    v_mov_b32 v79, 0
    v_mov_b32 v80, 0
    v_mov_b32 v81, 0
    v_mov_b32 v82, 0
    v_mov_b32 v83, 0
    v_mov_b32 v84, 0
    v_mov_b32 v85, 0
    v_mov_b32 v86, 0
    v_mov_b32 v87, 0
    v_mov_b32 v88, 0
    v_mov_b32 v89, 0
    v_mov_b32 v90, 0
    v_mov_b32 v91, 0
    v_mov_b32 v92, 0
    v_mov_b32 v93, 0
    v_mov_b32 v94, 0
    v_mov_b32 v95, 0
    v_mov_b32 v96, 0
    v_mov_b32 v97, 0
    v_mov_b32 v98, 0
    v_mov_b32 v99, 0
    v_mov_b32 v100, 0
    v_mov_b32 v101, 0
    v_mov_b32 v102, 0
    v_mov_b32 v103, 0
    v_mov_b32 v104, 0
    v_mov_b32 v105, 0
    v_mov_b32 v106, 0
    v_mov_b32 v107, 0
    v_mov_b32 v108, 0
    v_mov_b32 v109, 0
    v_mov_b32 v110, 0
    v_mov_b32 v111, 0
    v_mov_b32 v112, 0
    v_mov_b32 v113, 0
    v_mov_b32 v114, 0
    v_mov_b32 v115, 0
    v_mov_b32 v116, 0
    v_mov_b32 v117, 0
    v_mov_b32 v118, 0
    v_mov_b32 v119, 0
    v_mov_b32 v120, 0
    v_mov_b32 v121, 0
    v_mov_b32 v122, 0
    v_mov_b32 v123, 0
    v_mov_b32 v124, 0
    v_mov_b32 v125, 0
    v_mov_b32 v126, 0
    v_mov_b32 v127, 0
    v_mov_b32 v128, 0
    v_mov_b32 v129, 0
    v_mov_b32 v130, 0
    v_mov_b32 v131, 0
    v_mov_b32 v132, 0
    v_mov_b32 v133, 0
    v_mov_b32 v134, 0
    v_mov_b32 v135, 0
    v_mov_b32 v136, 0
    v_mov_b32 v137, 0
    v_mov_b32 v138, 0
    v_mov_b32 v139, 0
    v_mov_b32 v140, 0
    v_mov_b32 v141, 0
    v_mov_b32 v142, 0
    v_mov_b32 v143, 0
    s_waitcnt vmcnt(12)
    s_barrier
    ds_read_b128 a[48:51], v5 offset:0
    ds_read_b128 a[52:55], v5 offset:4096
    ds_read_b128 a[56:59], v5 offset:8192
    ds_read_b128 a[60:63], v5 offset:12288
    ds_read_b128 a[64:67], v5 offset:16384
    ds_read_b128 a[68:71], v5 offset:20480
    ds_read_b128 a[72:75], v5 offset:24576
    s_waitcnt lgkmcnt(6)
    v_mfma_f32_32x32x16_bf16 v[32:47], a[0:3], a[48:51], v[32:47]
    ds_read_b128 a[76:79], v5 offset:1024
    s_waitcnt lgkmcnt(6)
    v_mfma_f32_32x32x16_bf16 v[48:63], a[0:3], a[52:55], v[48:63]
    ds_read_b128 a[80:83], v5 offset:5120
    s_add_u32 s50, s45, 57344
    s_mov_b32 m0, s50
    s_nop 0
    buffer_load_dwordx4 v2, s[8:11], s47 offen sc1 lds
    s_waitcnt lgkmcnt(6)
    v_mfma_f32_32x32x16_bf16 v[64:79], a[0:3], a[56:59], v[64:79]
    ds_read_b128 a[84:87], v5 offset:9216
    s_waitcnt lgkmcnt(6)
    v_mfma_f32_32x32x16_bf16 v[80:95], a[0:3], a[60:63], v[80:95]
    ds_read_b128 a[88:91], v5 offset:13312
    buffer_load_dwordx4 v2, s[8:11], s47 offen offset:1024 sc1 lds
    s_waitcnt lgkmcnt(6)
    v_mfma_f32_32x32x16_bf16 v[96:111], a[0:3], a[64:67], v[96:111]
    ds_read_b128 a[92:95], v5 offset:17408
    s_waitcnt lgkmcnt(6)
    v_mfma_f32_32x32x16_bf16 v[112:127], a[0:3], a[68:71], v[112:127]
    ds_read_b128 a[96:99], v5 offset:21504
    buffer_load_dwordx4 v2, s[8:11], s47 offen offset:2048 sc1 lds
    s_waitcnt lgkmcnt(6)
    v_mfma_f32_32x32x16_bf16 v[128:143], a[0:3], a[72:75], v[128:143]
    ds_read_b128 a[100:103], v5 offset:25600
    s_waitcnt lgkmcnt(6)
    v_mfma_f32_32x32x16_bf16 v[32:47], a[4:7], a[76:79], v[32:47]
    ds_read_b128 a[48:51], v5 offset:2048
    s_waitcnt lgkmcnt(6)
    v_mfma_f32_32x32x16_bf16 v[48:63], a[4:7], a[80:83], v[48:63]
    ds_read_b128 a[52:55], v5 offset:6144
    buffer_load_dwordx4 v2, s[8:11], s47 offen offset:3072 sc1 lds
    s_add_u32 s47, s47, 4096
    s_waitcnt lgkmcnt(6)
    v_mfma_f32_32x32x16_bf16 v[64:79], a[4:7], a[84:87], v[64:79]
    ds_read_b128 a[56:59], v5 offset:10240
    s_waitcnt lgkmcnt(6)
    v_mfma_f32_32x32x16_bf16 v[80:95], a[4:7], a[88:91], v[80:95]
    ds_read_b128 a[60:63], v5 offset:14336
    s_add_u32 s50, s46, 57344
    s_mov_b32 m0, s50
    s_nop 0
    buffer_load_dwordx4 v2, s[8:11], s48 offen sc1 lds
    s_waitcnt lgkmcnt(6)
    v_mfma_f32_32x32x16_bf16 v[96:111], a[4:7], a[92:95], v[96:111]
    ds_read_b128 a[64:67], v5 offset:18432
    s_waitcnt lgkmcnt(6)
    v_mfma_f32_32x32x16_bf16 v[112:127], a[4:7], a[96:99], v[112:127]
    ds_read_b128 a[68:71], v5 offset:22528
    buffer_load_dwordx4 v2, s[8:11], s48 offen offset:1024 sc1 lds
    s_waitcnt lgkmcnt(6)
    v_mfma_f32_32x32x16_bf16 v[128:143], a[4:7], a[100:103], v[128:143]
    ds_read_b128 a[72:75], v5 offset:26624
    s_waitcnt lgkmcnt(6)
    v_mfma_f32_32x32x16_bf16 v[32:47], a[8:11], a[48:51], v[32:47]
    ds_read_b128 a[76:79], v5 offset:3072
    s_waitcnt lgkmcnt(6)
    v_mfma_f32_32x32x16_bf16 v[48:63], a[8:11], a[52:55], v[48:63]
    ds_read_b128 a[80:83], v5 offset:7168
    buffer_load_dwordx4 v2, s[8:11], s48 offen offset:2048 sc1 lds
    s_waitcnt lgkmcnt(6)
    v_mfma_f32_32x32x16_bf16 v[64:79], a[8:11], a[56:59], v[64:79]
    ds_read_b128 a[84:87], v5 offset:11264
    s_waitcnt lgkmcnt(6)
    v_mfma_f32_32x32x16_bf16 v[80:95], a[8:11], a[60:63], v[80:95]
    ds_read_b128 a[88:91], v5 offset:15360
    buffer_load_dwordx4 v2, s[8:11], s48 offen offset:3072 sc1 lds
    s_add_u32 s48, s48, 4096
    s_waitcnt lgkmcnt(6)
    v_mfma_f32_32x32x16_bf16 v[96:111], a[8:11], a[64:67], v[96:111]
    ds_read_b128 a[92:95], v5 offset:19456
    s_waitcnt lgkmcnt(6)
    v_mfma_f32_32x32x16_bf16 v[112:127], a[8:11], a[68:71], v[112:127]
    ds_read_b128 a[96:99], v5 offset:23552
    buffer_load_dwordx4 a[32:35], v3, s[8:11], s49 offen offset:0 sc1
    s_waitcnt lgkmcnt(6)
    v_mfma_f32_32x32x16_bf16 v[128:143], a[8:11], a[72:75], v[128:143]
    ds_read_b128 a[100:103], v5 offset:27648
    s_waitcnt lgkmcnt(6)
    v_mfma_f32_32x32x16_bf16 v[32:47], a[12:15], a[76:79], v[32:47]
    buffer_load_dwordx4 a[36:39], v3, s[8:11], s49 offen offset:1024 sc1
    s_waitcnt lgkmcnt(5)
    v_mfma_f32_32x32x16_bf16 v[48:63], a[12:15], a[80:83], v[48:63]
    buffer_load_dwordx4 a[40:43], v3, s[8:11], s49 offen offset:2048 sc1
    buffer_load_dwordx4 a[44:47], v3, s[8:11], s49 offen offset:3072 sc1
    s_add_u32 s49, s49, 4096
    s_waitcnt lgkmcnt(4)
    v_mfma_f32_32x32x16_bf16 v[64:79], a[12:15], a[84:87], v[64:79]
    s_waitcnt lgkmcnt(3)
    v_mfma_f32_32x32x16_bf16 v[80:95], a[12:15], a[88:91], v[80:95]
    s_waitcnt lgkmcnt(2)
    v_mfma_f32_32x32x16_bf16 v[96:111], a[12:15], a[92:95], v[96:111]
    s_waitcnt lgkmcnt(1)
    v_mfma_f32_32x32x16_bf16 v[112:127], a[12:15], a[96:99], v[112:127]
    s_waitcnt lgkmcnt(0)
    v_mfma_f32_32x32x16_bf16 v[128:143], a[12:15], a[100:103], v[128:143]
    s_waitcnt vmcnt(12)
    s_barrier
    ds_read_b128 a[48:51], v6 offset:0
    ds_read_b128 a[52:55], v6 offset:4096
    ds_read_b128 a[56:59], v6 offset:8192
    ds_read_b128 a[60:63], v6 offset:12288
    ds_read_b128 a[64:67], v6 offset:16384
    ds_read_b128 a[68:71], v6 offset:20480
    ds_read_b128 a[72:75], v6 offset:24576
    s_waitcnt lgkmcnt(6)
    v_mfma_f32_32x32x16_bf16 v[32:47], a[16:19], a[48:51], v[32:47]
    ds_read_b128 a[76:79], v6 offset:1024
    s_waitcnt lgkmcnt(6)
    v_mfma_f32_32x32x16_bf16 v[48:63], a[16:19], a[52:55], v[48:63]
    ds_read_b128 a[80:83], v6 offset:5120
    s_add_u32 s50, s45, 0
    s_mov_b32 m0, s50
    s_nop 0
    buffer_load_dwordx4 v2, s[8:11], s47 offen sc1 lds
    s_waitcnt lgkmcnt(6)
    v_mfma_f32_32x32x16_bf16 v[64:79], a[16:19], a[56:59], v[64:79]
    ds_read_b128 a[84:87], v6 offset:9216
    s_waitcnt lgkmcnt(6)
    v_mfma_f32_32x32x16_bf16 v[80:95], a[16:19], a[60:63], v[80:95]
    ds_read_b128 a[88:91], v6 offset:13312
    buffer_load_dwordx4 v2, s[8:11], s47 offen offset:1024 sc1 lds
    s_waitcnt lgkmcnt(6)
    v_mfma_f32_32x32x16_bf16 v[96:111], a[16:19], a[64:67], v[96:111]
    ds_read_b128 a[92:95], v6 offset:17408
    s_waitcnt lgkmcnt(6)
    v_mfma_f32_32x32x16_bf16 v[112:127], a[16:19], a[68:71], v[112:127]
    ds_read_b128 a[96:99], v6 offset:21504
    buffer_load_dwordx4 v2, s[8:11], s47 offen offset:2048 sc1 lds
    s_waitcnt lgkmcnt(6)
    v_mfma_f32_32x32x16_bf16 v[128:143], a[16:19], a[72:75], v[128:143]
    ds_read_b128 a[100:103], v6 offset:25600
    s_waitcnt lgkmcnt(6)
    v_mfma_f32_32x32x16_bf16 v[32:47], a[20:23], a[76:79], v[32:47]
    ds_read_b128 a[48:51], v6 offset:2048
    s_waitcnt lgkmcnt(6)
    v_mfma_f32_32x32x16_bf16 v[48:63], a[20:23], a[80:83], v[48:63]
    ds_read_b128 a[52:55], v6 offset:6144
    buffer_load_dwordx4 v2, s[8:11], s47 offen offset:3072 sc1 lds
    s_add_u32 s47, s47, 4096
    s_waitcnt lgkmcnt(6)
    v_mfma_f32_32x32x16_bf16 v[64:79], a[20:23], a[84:87], v[64:79]
    ds_read_b128 a[56:59], v6 offset:10240
    s_waitcnt lgkmcnt(6)
    v_mfma_f32_32x32x16_bf16 v[80:95], a[20:23], a[88:91], v[80:95]
    ds_read_b128 a[60:63], v6 offset:14336
    s_add_u32 s50, s46, 0
    s_mov_b32 m0, s50
    s_nop 0
    buffer_load_dwordx4 v2, s[8:11], s48 offen sc1 lds
    s_waitcnt lgkmcnt(6)
    v_mfma_f32_32x32x16_bf16 v[96:111], a[20:23], a[92:95], v[96:111]
    ds_read_b128 a[64:67], v6 offset:18432
    s_waitcnt lgkmcnt(6)
    v_mfma_f32_32x32x16_bf16 v[112:127], a[20:23], a[96:99], v[112:127]
    ds_read_b128 a[68:71], v6 offset:22528
    buffer_load_dwordx4 v2, s[8:11], s48 offen offset:1024 sc1 lds
    s_waitcnt lgkmcnt(6)
    v_mfma_f32_32x32x16_bf16 v[128:143], a[20:23], a[100:103], v[128:143]
    ds_read_b128 a[72:75], v6 offset:26624
    s_waitcnt lgkmcnt(6)
    v_mfma_f32_32x32x16_bf16 v[32:47], a[24:27], a[48:51], v[32:47]
    ds_read_b128 a[76:79], v6 offset:3072
    s_waitcnt lgkmcnt(6)
    v_mfma_f32_32x32x16_bf16 v[48:63], a[24:27], a[52:55], v[48:63]
    ds_read_b128 a[80:83], v6 offset:7168
    buffer_load_dwordx4 v2, s[8:11], s48 offen offset:2048 sc1 lds
    s_waitcnt lgkmcnt(6)
    v_mfma_f32_32x32x16_bf16 v[64:79], a[24:27], a[56:59], v[64:79]
    ds_read_b128 a[84:87], v6 offset:11264
    s_waitcnt lgkmcnt(6)
    v_mfma_f32_32x32x16_bf16 v[80:95], a[24:27], a[60:63], v[80:95]
    ds_read_b128 a[88:91], v6 offset:15360
    buffer_load_dwordx4 v2, s[8:11], s48 offen offset:3072 sc1 lds
    s_add_u32 s48, s48, 4096
    s_waitcnt lgkmcnt(6)
    v_mfma_f32_32x32x16_bf16 v[96:111], a[24:27], a[64:67], v[96:111]
    ds_read_b128 a[92:95], v6 offset:19456
    s_waitcnt lgkmcnt(6)
    v_mfma_f32_32x32x16_bf16 v[112:127], a[24:27], a[68:71], v[112:127]
    ds_read_b128 a[96:99], v6 offset:23552
    buffer_load_dwordx4 a[0:3], v3, s[8:11], s49 offen offset:0 sc1
    s_waitcnt lgkmcnt(6)
    v_mfma_f32_32x32x16_bf16 v[128:143], a[24:27], a[72:75], v[128:143]
    ds_read_b128 a[100:103], v6 offset:27648
    s_waitcnt lgkmcnt(6)
    v_mfma_f32_32x32x16_bf16 v[32:47], a[28:31], a[76:79], v[32:47]
    buffer_load_dwordx4 a[4:7], v3, s[8:11], s49 offen offset:1024 sc1
    s_waitcnt lgkmcnt(5)
    v_mfma_f32_32x32x16_bf16 v[48:63], a[28:31], a[80:83], v[48:63]
    buffer_load_dwordx4 a[8:11], v3, s[8:11], s49 offen offset:2048 sc1
    buffer_load_dwordx4 a[12:15], v3, s[8:11], s49 offen offset:3072 sc1
    s_add_u32 s49, s49, 4096
    s_waitcnt lgkmcnt(4)
    v_mfma_f32_32x32x16_bf16 v[64:79], a[28:31], a[84:87], v[64:79]
    s_waitcnt lgkmcnt(3)
    v_mfma_f32_32x32x16_bf16 v[80:95], a[28:31], a[88:91], v[80:95]
    s_waitcnt lgkmcnt(2)
    v_mfma_f32_32x32x16_bf16 v[96:111], a[28:31], a[92:95], v[96:111]
    s_waitcnt lgkmcnt(1)
    v_mfma_f32_32x32x16_bf16 v[112:127], a[28:31], a[96:99], v[112:127]
    s_waitcnt lgkmcnt(0)
    v_mfma_f32_32x32x16_bf16 v[128:143], a[28:31], a[100:103], v[128:143]
    s_waitcnt vmcnt(12)
    s_barrier
    ds_read_b128 a[48:51], v7 offset:0
    ds_read_b128 a[52:55], v7 offset:4096
    ds_read_b128 a[56:59], v7 offset:8192
    ds_read_b128 a[60:63], v7 offset:12288
    ds_read_b128 a[64:67], v7 offset:16384
    ds_read_b128 a[68:71], v7 offset:20480
    ds_read_b128 a[72:75], v7 offset:24576
    s_waitcnt lgkmcnt(6)
    v_mfma_f32_32x32x16_bf16 v[32:47], a[32:35], a[48:51], v[32:47]
    ds_read_b128 a[76:79], v7 offset:1024
    s_waitcnt lgkmcnt(6)
    v_mfma_f32_32x32x16_bf16 v[48:63], a[32:35], a[52:55], v[48:63]
    ds_read_b128 a[80:83], v7 offset:5120
    s_add_u32 s50, s45, 28672
    s_mov_b32 m0, s50
    s_nop 0
    buffer_load_dwordx4 v2, s[8:11], s47 offen sc1 lds
    s_waitcnt lgkmcnt(6)
    v_mfma_f32_32x32x16_bf16 v[64:79], a[32:35], a[56:59], v[64:79]
    ds_read_b128 a[84:87], v7 offset:9216
    s_waitcnt lgkmcnt(6)
    v_mfma_f32_32x32x16_bf16 v[80:95], a[32:35], a[60:63], v[80:95]
    ds_read_b128 a[88:91], v7 offset:13312
    buffer_load_dwordx4 v2, s[8:11], s47 offen offset:1024 sc1 lds
    s_waitcnt lgkmcnt(6)
    v_mfma_f32_32x32x16_bf16 v[96:111], a[32:35], a[64:67], v[96:111]
    ds_read_b128 a[92:95], v7 offset:17408
    s_waitcnt lgkmcnt(6)
    v_mfma_f32_32x32x16_bf16 v[112:127], a[32:35], a[68:71], v[112:127]
    ds_read_b128 a[96:99], v7 offset:21504
    buffer_load_dwordx4 v2, s[8:11], s47 offen offset:2048 sc1 lds
    s_waitcnt lgkmcnt(6)
    v_mfma_f32_32x32x16_bf16 v[128:143], a[32:35], a[72:75], v[128:143]
    ds_read_b128 a[100:103], v7 offset:25600
    s_waitcnt lgkmcnt(6)
    v_mfma_f32_32x32x16_bf16 v[32:47], a[36:39], a[76:79], v[32:47]
    ds_read_b128 a[48:51], v7 offset:2048
    s_waitcnt lgkmcnt(6)
    v_mfma_f32_32x32x16_bf16 v[48:63], a[36:39], a[80:83], v[48:63]
    ds_read_b128 a[52:55], v7 offset:6144
    buffer_load_dwordx4 v2, s[8:11], s47 offen offset:3072 sc1 lds
    s_add_u32 s47, s47, 4096
    s_waitcnt lgkmcnt(6)
    v_mfma_f32_32x32x16_bf16 v[64:79], a[36:39], a[84:87], v[64:79]
    ds_read_b128 a[56:59], v7 offset:10240
    s_waitcnt lgkmcnt(6)
    v_mfma_f32_32x32x16_bf16 v[80:95], a[36:39], a[88:91], v[80:95]
    ds_read_b128 a[60:63], v7 offset:14336
    s_add_u32 s50, s46, 28672
    s_mov_b32 m0, s50
    s_nop 0
    buffer_load_dwordx4 v2, s[8:11], s48 offen sc1 lds
    s_waitcnt lgkmcnt(6)
    v_mfma_f32_32x32x16_bf16 v[96:111], a[36:39], a[92:95], v[96:111]
    ds_read_b128 a[64:67], v7 offset:18432
    s_waitcnt lgkmcnt(6)
    v_mfma_f32_32x32x16_bf16 v[112:127], a[36:39], a[96:99], v[112:127]
    ds_read_b128 a[68:71], v7 offset:22528
    buffer_load_dwordx4 v2, s[8:11], s48 offen offset:1024 sc1 lds
    s_waitcnt lgkmcnt(6)
    v_mfma_f32_32x32x16_bf16 v[128:143], a[36:39], a[100:103], v[128:143]
    ds_read_b128 a[72:75], v7 offset:26624
    s_waitcnt lgkmcnt(6)
    v_mfma_f32_32x32x16_bf16 v[32:47], a[40:43], a[48:51], v[32:47]
    ds_read_b128 a[76:79], v7 offset:3072
    s_waitcnt lgkmcnt(6)
    v_mfma_f32_32x32x16_bf16 v[48:63], a[40:43], a[52:55], v[48:63]
    ds_read_b128 a[80:83], v7 offset:7168
    buffer_load_dwordx4 v2, s[8:11], s48 offen offset:2048 sc1 lds
    s_waitcnt lgkmcnt(6)
    v_mfma_f32_32x32x16_bf16 v[64:79], a[40:43], a[56:59], v[64:79]
    ds_read_b128 a[84:87], v7 offset:11264
    s_waitcnt lgkmcnt(6)
    v_mfma_f32_32x32x16_bf16 v[80:95], a[40:43], a[60:63], v[80:95]
    ds_read_b128 a[88:91], v7 offset:15360
    buffer_load_dwordx4 v2, s[8:11], s48 offen offset:3072 sc1 lds
    s_add_u32 s48, s48, 4096
    s_waitcnt lgkmcnt(6)
    v_mfma_f32_32x32x16_bf16 v[96:111], a[40:43], a[64:67], v[96:111]
    ds_read_b128 a[92:95], v7 offset:19456
    s_waitcnt lgkmcnt(6)
    v_mfma_f32_32x32x16_bf16 v[112:127], a[40:43], a[68:71], v[112:127]
    ds_read_b128 a[96:99], v7 offset:23552
    buffer_load_dwordx4 a[16:19], v3, s[8:11], s49 offen offset:0 sc1
    s_waitcnt lgkmcnt(6)
    v_mfma_f32_32x32x16_bf16 v[128:143], a[40:43], a[72:75], v[128:143]
    ds_read_b128 a[100:103], v7 offset:27648
    s_waitcnt lgkmcnt(6)
    v_mfma_f32_32x32x16_bf16 v[32:47], a[44:47], a[76:79], v[32:47]
    buffer_load_dwordx4 a[20:23], v3, s[8:11], s49 offen offset:1024 sc1
    s_waitcnt lgkmcnt(5)
    v_mfma_f32_32x32x16_bf16 v[48:63], a[44:47], a[80:83], v[48:63]
    buffer_load_dwordx4 a[24:27], v3, s[8:11], s49 offen offset:2048 sc1
    buffer_load_dwordx4 a[28:31], v3, s[8:11], s49 offen offset:3072 sc1
    s_add_u32 s49, s49, 4096
    s_waitcnt lgkmcnt(4)
    v_mfma_f32_32x32x16_bf16 v[64:79], a[44:47], a[84:87], v[64:79]
    s_waitcnt lgkmcnt(3)
    v_mfma_f32_32x32x16_bf16 v[80:95], a[44:47], a[88:91], v[80:95]
    s_waitcnt lgkmcnt(2)
    v_mfma_f32_32x32x16_bf16 v[96:111], a[44:47], a[92:95], v[96:111]
    s_waitcnt lgkmcnt(1)
    v_mfma_f32_32x32x16_bf16 v[112:127], a[44:47], a[96:99], v[112:127]
    s_waitcnt lgkmcnt(0)
    v_mfma_f32_32x32x16_bf16 v[128:143], a[44:47], a[100:103], v[128:143]
    s_waitcnt vmcnt(12)
    s_barrier
    ds_read_b128 a[48:51], v5 offset:0
    ds_read_b128 a[52:55], v5 offset:4096
    ds_read_b128 a[56:59], v5 offset:8192
    ds_read_b128 a[60:63], v5 offset:12288
    ds_read_b128 a[64:67], v5 offset:16384
    ds_read_b128 a[68:71], v5 offset:20480
    ds_read_b128 a[72:75], v5 offset:24576
    s_waitcnt lgkmcnt(6)
    v_mfma_f32_32x32x16_bf16 v[32:47], a[0:3], a[48:51], v[32:47]
    ds_read_b128 a[76:79], v5 offset:1024
    s_waitcnt lgkmcnt(6)
    v_mfma_f32_32x32x16_bf16 v[48:63], a[0:3], a[52:55], v[48:63]
    ds_read_b128 a[80:83], v5 offset:5120
    s_add_u32 s50, s45, 57344
    s_mov_b32 m0, s50
    s_nop 0
    buffer_load_dwordx4 v2, s[8:11], s47 offen sc1 lds
    s_waitcnt lgkmcnt(6)
    v_mfma_f32_32x32x16_bf16 v[64:79], a[0:3], a[56:59], v[64:79]
    ds_read_b128 a[84:87], v5 offset:9216
    s_waitcnt lgkmcnt(6)
    v_mfma_f32_32x32x16_bf16 v[80:95], a[0:3], a[60:63], v[80:95]
    ds_read_b128 a[88:91], v5 offset:13312
    buffer_load_dwordx4 v2, s[8:11], s47 offen offset:1024 sc1 lds
    s_waitcnt lgkmcnt(6)
    v_mfma_f32_32x32x16_bf16 v[96:111], a[0:3], a[64:67], v[96:111]
    ds_read_b128 a[92:95], v5 offset:17408
    s_waitcnt lgkmcnt(6)
    v_mfma_f32_32x32x16_bf16 v[112:127], a[0:3], a[68:71], v[112:127]
    ds_read_b128 a[96:99], v5 offset:21504
    buffer_load_dwordx4 v2, s[8:11], s47 offen offset:2048 sc1 lds
    s_waitcnt lgkmcnt(6)
    v_mfma_f32_32x32x16_bf16 v[128:143], a[0:3], a[72:75], v[128:143]
    ds_read_b128 a[100:103], v5 offset:25600
    s_waitcnt lgkmcnt(6)
    v_mfma_f32_32x32x16_bf16 v[32:47], a[4:7], a[76:79], v[32:47]
    ds_read_b128 a[48:51], v5 offset:2048
    s_waitcnt lgkmcnt(6)
    v_mfma_f32_32x32x16_bf16 v[48:63], a[4:7], a[80:83], v[48:63]
    ds_read_b128 a[52:55], v5 offset:6144
    buffer_load_dwordx4 v2, s[8:11], s47 offen offset:3072 sc1 lds
    s_add_u32 s47, s47, 4096
    s_waitcnt lgkmcnt(6)
    v_mfma_f32_32x32x16_bf16 v[64:79], a[4:7], a[84:87], v[64:79]
    ds_read_b128 a[56:59], v5 offset:10240
    s_waitcnt lgkmcnt(6)
    v_mfma_f32_32x32x16_bf16 v[80:95], a[4:7], a[88:91], v[80:95]
    ds_read_b128 a[60:63], v5 offset:14336
    s_add_u32 s50, s46, 57344
    s_mov_b32 m0, s50
    s_nop 0
    buffer_load_dwordx4 v2, s[8:11], s48 offen sc1 lds
    s_waitcnt lgkmcnt(6)
    v_mfma_f32_32x32x16_bf16 v[96:111], a[4:7], a[92:95], v[96:111]
    ds_read_b128 a[64:67], v5 offset:18432
    s_waitcnt lgkmcnt(6)
    v_mfma_f32_32x32x16_bf16 v[112:127], a[4:7], a[96:99], v[112:127]
    ds_read_b128 a[68:71], v5 offset:22528
    buffer_load_dwordx4 v2, s[8:11], s48 offen offset:1024 sc1 lds
    s_waitcnt lgkmcnt(6)
    v_mfma_f32_32x32x16_bf16 v[128:143], a[4:7], a[100:103], v[128:143]
    ds_read_b128 a[72:75], v5 offset:26624
    s_waitcnt lgkmcnt(6)
    v_mfma_f32_32x32x16_bf16 v[32:47], a[8:11], a[48:51], v[32:47]
    ds_read_b128 a[76:79], v5 offset:3072
    s_waitcnt lgkmcnt(6)
    v_mfma_f32_32x32x16_bf16 v[48:63], a[8:11], a[52:55], v[48:63]
    ds_read_b128 a[80:83], v5 offset:7168
    buffer_load_dwordx4 v2, s[8:11], s48 offen offset:2048 sc1 lds
    s_waitcnt lgkmcnt(6)
    v_mfma_f32_32x32x16_bf16 v[64:79], a[8:11], a[56:59], v[64:79]
    ds_read_b128 a[84:87], v5 offset:11264
    s_waitcnt lgkmcnt(6)
    v_mfma_f32_32x32x16_bf16 v[80:95], a[8:11], a[60:63], v[80:95]
    ds_read_b128 a[88:91], v5 offset:15360
    buffer_load_dwordx4 v2, s[8:11], s48 offen offset:3072 sc1 lds
    s_add_u32 s48, s48, 4096
    s_waitcnt lgkmcnt(6)
    v_mfma_f32_32x32x16_bf16 v[96:111], a[8:11], a[64:67], v[96:111]
    ds_read_b128 a[92:95], v5 offset:19456
    s_waitcnt lgkmcnt(6)
    v_mfma_f32_32x32x16_bf16 v[112:127], a[8:11], a[68:71], v[112:127]
    ds_read_b128 a[96:99], v5 offset:23552
    buffer_load_dwordx4 a[32:35], v3, s[8:11], s49 offen offset:0 sc1
    s_waitcnt lgkmcnt(6)
    v_mfma_f32_32x32x16_bf16 v[128:143], a[8:11], a[72:75], v[128:143]
    ds_read_b128 a[100:103], v5 offset:27648
    s_waitcnt lgkmcnt(6)
    v_mfma_f32_32x32x16_bf16 v[32:47], a[12:15], a[76:79], v[32:47]
    buffer_load_dwordx4 a[36:39], v3, s[8:11], s49 offen offset:1024 sc1
    s_waitcnt lgkmcnt(5)
    v_mfma_f32_32x32x16_bf16 v[48:63], a[12:15], a[80:83], v[48:63]
    buffer_load_dwordx4 a[40:43], v3, s[8:11], s49 offen offset:2048 sc1
    buffer_load_dwordx4 a[44:47], v3, s[8:11], s49 offen offset:3072 sc1
    s_add_u32 s49, s49, 4096
    s_waitcnt lgkmcnt(4)
    v_mfma_f32_32x32x16_bf16 v[64:79], a[12:15], a[84:87], v[64:79]
    s_waitcnt lgkmcnt(3)
    v_mfma_f32_32x32x16_bf16 v[80:95], a[12:15], a[88:91], v[80:95]
    s_waitcnt lgkmcnt(2)
    v_mfma_f32_32x32x16_bf16 v[96:111], a[12:15], a[92:95], v[96:111]
    s_waitcnt lgkmcnt(1)
    v_mfma_f32_32x32x16_bf16 v[112:127], a[12:15], a[96:99], v[112:127]
    s_waitcnt lgkmcnt(0)
    v_mfma_f32_32x32x16_bf16 v[128:143], a[12:15], a[100:103], v[128:143]
    s_waitcnt vmcnt(12)
    s_barrier
    ds_read_b128 a[48:51], v6 offset:0
    ds_read_b128 a[52:55], v6 offset:4096
    ds_read_b128 a[56:59], v6 offset:8192
    ds_read_b128 a[60:63], v6 offset:12288
    ds_read_b128 a[64:67], v6 offset:16384
    ds_read_b128 a[68:71], v6 offset:20480
    ds_read_b128 a[72:75], v6 offset:24576
    s_waitcnt lgkmcnt(6)
    v_mfma_f32_32x32x16_bf16 v[32:47], a[16:19], a[48:51], v[32:47]
    ds_read_b128 a[76:79], v6 offset:1024
    s_waitcnt lgkmcnt(6)
    v_mfma_f32_32x32x16_bf16 v[48:63], a[16:19], a[52:55], v[48:63]
    ds_read_b128 a[80:83], v6 offset:5120
    s_add_u32 s50, s45, 0
    s_mov_b32 m0, s50
    s_nop 0
    buffer_load_dwordx4 v2, s[8:11], s47 offen sc1 lds
    s_waitcnt lgkmcnt(6)
    v_mfma_f32_32x32x16_bf16 v[64:79], a[16:19], a[56:59], v[64:79]
    ds_read_b128 a[84:87], v6 offset:9216
    s_waitcnt lgkmcnt(6)
    v_mfma_f32_32x32x16_bf16 v[80:95], a[16:19], a[60:63], v[80:95]
    ds_read_b128 a[88:91], v6 offset:13312
    buffer_load_dwordx4 v2, s[8:11], s47 offen offset:1024 sc1 lds
    s_waitcnt lgkmcnt(6)
    v_mfma_f32_32x32x16_bf16 v[96:111], a[16:19], a[64:67], v[96:111]
    ds_read_b128 a[92:95], v6 offset:17408
    s_waitcnt lgkmcnt(6)
    v_mfma_f32_32x32x16_bf16 v[112:127], a[16:19], a[68:71], v[112:127]
    ds_read_b128 a[96:99], v6 offset:21504
    buffer_load_dwordx4 v2, s[8:11], s47 offen offset:2048 sc1 lds
    s_waitcnt lgkmcnt(6)
    v_mfma_f32_32x32x16_bf16 v[128:143], a[16:19], a[72:75], v[128:143]
    ds_read_b128 a[100:103], v6 offset:25600
    s_waitcnt lgkmcnt(6)
    v_mfma_f32_32x32x16_bf16 v[32:47], a[20:23], a[76:79], v[32:47]
    ds_read_b128 a[48:51], v6 offset:2048
    s_waitcnt lgkmcnt(6)
    v_mfma_f32_32x32x16_bf16 v[48:63], a[20:23], a[80:83], v[48:63]
    ds_read_b128 a[52:55], v6 offset:6144
    buffer_load_dwordx4 v2, s[8:11], s47 offen offset:3072 sc1 lds
    s_add_u32 s47, s47, 4096
    s_waitcnt lgkmcnt(6)
    v_mfma_f32_32x32x16_bf16 v[64:79], a[20:23], a[84:87], v[64:79]
    ds_read_b128 a[56:59], v6 offset:10240
    s_waitcnt lgkmcnt(6)
    v_mfma_f32_32x32x16_bf16 v[80:95], a[20:23], a[88:91], v[80:95]
    ds_read_b128 a[60:63], v6 offset:14336
    s_add_u32 s50, s46, 0
    s_mov_b32 m0, s50
    s_nop 0
    buffer_load_dwordx4 v2, s[8:11], s48 offen sc1 lds
    s_waitcnt lgkmcnt(6)
    v_mfma_f32_32x32x16_bf16 v[96:111], a[20:23], a[92:95], v[96:111]
    ds_read_b128 a[64:67], v6 offset:18432
    s_waitcnt lgkmcnt(6)
    v_mfma_f32_32x32x16_bf16 v[112:127], a[20:23], a[96:99], v[112:127]
    ds_read_b128 a[68:71], v6 offset:22528
    buffer_load_dwordx4 v2, s[8:11], s48 offen offset:1024 sc1 lds
    s_waitcnt lgkmcnt(6)
    v_mfma_f32_32x32x16_bf16 v[128:143], a[20:23], a[100:103], v[128:143]
    ds_read_b128 a[72:75], v6 offset:26624
    s_waitcnt lgkmcnt(6)
    v_mfma_f32_32x32x16_bf16 v[32:47], a[24:27], a[48:51], v[32:47]
    ds_read_b128 a[76:79], v6 offset:3072
    s_waitcnt lgkmcnt(6)
    v_mfma_f32_32x32x16_bf16 v[48:63], a[24:27], a[52:55], v[48:63]
    ds_read_b128 a[80:83], v6 offset:7168
    buffer_load_dwordx4 v2, s[8:11], s48 offen offset:2048 sc1 lds
    s_waitcnt lgkmcnt(6)
    v_mfma_f32_32x32x16_bf16 v[64:79], a[24:27], a[56:59], v[64:79]
    ds_read_b128 a[84:87], v6 offset:11264
    s_waitcnt lgkmcnt(6)
    v_mfma_f32_32x32x16_bf16 v[80:95], a[24:27], a[60:63], v[80:95]
    ds_read_b128 a[88:91], v6 offset:15360
    buffer_load_dwordx4 v2, s[8:11], s48 offen offset:3072 sc1 lds
    s_add_u32 s48, s48, 4096
    s_waitcnt lgkmcnt(6)
    v_mfma_f32_32x32x16_bf16 v[96:111], a[24:27], a[64:67], v[96:111]
    ds_read_b128 a[92:95], v6 offset:19456
    s_waitcnt lgkmcnt(6)
    v_mfma_f32_32x32x16_bf16 v[112:127], a[24:27], a[68:71], v[112:127]
    ds_read_b128 a[96:99], v6 offset:23552
    buffer_load_dwordx4 a[0:3], v3, s[8:11], s49 offen offset:0 sc1
    s_waitcnt lgkmcnt(6)
    v_mfma_f32_32x32x16_bf16 v[128:143], a[24:27], a[72:75], v[128:143]
    ds_read_b128 a[100:103], v6 offset:27648
    s_waitcnt lgkmcnt(6)
    v_mfma_f32_32x32x16_bf16 v[32:47], a[28:31], a[76:79], v[32:47]
    buffer_load_dwordx4 a[4:7], v3, s[8:11], s49 offen offset:1024 sc1
    s_waitcnt lgkmcnt(5)
    v_mfma_f32_32x32x16_bf16 v[48:63], a[28:31], a[80:83], v[48:63]
    buffer_load_dwordx4 a[8:11], v3, s[8:11], s49 offen offset:2048 sc1
    buffer_load_dwordx4 a[12:15], v3, s[8:11], s49 offen offset:3072 sc1
    s_add_u32 s49, s49, 4096
    s_waitcnt lgkmcnt(4)
    v_mfma_f32_32x32x16_bf16 v[64:79], a[28:31], a[84:87], v[64:79]
    s_waitcnt lgkmcnt(3)
    v_mfma_f32_32x32x16_bf16 v[80:95], a[28:31], a[88:91], v[80:95]
    s_waitcnt lgkmcnt(2)
    v_mfma_f32_32x32x16_bf16 v[96:111], a[28:31], a[92:95], v[96:111]
    s_waitcnt lgkmcnt(1)
    v_mfma_f32_32x32x16_bf16 v[112:127], a[28:31], a[96:99], v[112:127]
    s_waitcnt lgkmcnt(0)
    v_mfma_f32_32x32x16_bf16 v[128:143], a[28:31], a[100:103], v[128:143]
    s_waitcnt vmcnt(12)
    s_barrier
    ds_read_b128 a[48:51], v7 offset:0
    ds_read_b128 a[52:55], v7 offset:4096
    ds_read_b128 a[56:59], v7 offset:8192
    ds_read_b128 a[60:63], v7 offset:12288
    ds_read_b128 a[64:67], v7 offset:16384
    ds_read_b128 a[68:71], v7 offset:20480
    ds_read_b128 a[72:75], v7 offset:24576
    s_waitcnt lgkmcnt(6)
    v_mfma_f32_32x32x16_bf16 v[32:47], a[32:35], a[48:51], v[32:47]
    ds_read_b128 a[76:79], v7 offset:1024
    s_waitcnt lgkmcnt(6)
    v_mfma_f32_32x32x16_bf16 v[48:63], a[32:35], a[52:55], v[48:63]
    ds_read_b128 a[80:83], v7 offset:5120
    s_waitcnt lgkmcnt(6)
    v_mfma_f32_32x32x16_bf16 v[64:79], a[32:35], a[56:59], v[64:79]
    ds_read_b128 a[84:87], v7 offset:9216
    s_waitcnt lgkmcnt(6)
    v_mfma_f32_32x32x16_bf16 v[80:95], a[32:35], a[60:63], v[80:95]
    ds_read_b128 a[88:91], v7 offset:13312
    s_waitcnt lgkmcnt(6)
    v_mfma_f32_32x32x16_bf16 v[96:111], a[32:35], a[64:67], v[96:111]
    ds_read_b128 a[92:95], v7 offset:17408
    s_waitcnt lgkmcnt(6)
    v_mfma_f32_32x32x16_bf16 v[112:127], a[32:35], a[68:71], v[112:127]
    ds_read_b128 a[96:99], v7 offset:21504
    s_waitcnt lgkmcnt(6)
    v_mfma_f32_32x32x16_bf16 v[128:143], a[32:35], a[72:75], v[128:143]
    ds_read_b128 a[100:103], v7 offset:25600
    s_waitcnt lgkmcnt(6)
    v_mfma_f32_32x32x16_bf16 v[32:47], a[36:39], a[76:79], v[32:47]
    ds_read_b128 a[48:51], v7 offset:2048
    s_waitcnt lgkmcnt(6)
    v_mfma_f32_32x32x16_bf16 v[48:63], a[36:39], a[80:83], v[48:63]
    ds_read_b128 a[52:55], v7 offset:6144
    s_waitcnt lgkmcnt(6)
    v_mfma_f32_32x32x16_bf16 v[64:79], a[36:39], a[84:87], v[64:79]
    ds_read_b128 a[56:59], v7 offset:10240
    s_waitcnt lgkmcnt(6)
    v_mfma_f32_32x32x16_bf16 v[80:95], a[36:39], a[88:91], v[80:95]
    ds_read_b128 a[60:63], v7 offset:14336
    s_waitcnt lgkmcnt(6)
    v_mfma_f32_32x32x16_bf16 v[96:111], a[36:39], a[92:95], v[96:111]
    ds_read_b128 a[64:67], v7 offset:18432
    s_waitcnt lgkmcnt(6)
    v_mfma_f32_32x32x16_bf16 v[112:127], a[36:39], a[96:99], v[112:127]
    ds_read_b128 a[68:71], v7 offset:22528
    s_waitcnt lgkmcnt(6)
    v_mfma_f32_32x32x16_bf16 v[128:143], a[36:39], a[100:103], v[128:143]
    ds_read_b128 a[72:75], v7 offset:26624
    s_waitcnt lgkmcnt(6)
    v_mfma_f32_32x32x16_bf16 v[32:47], a[40:43], a[48:51], v[32:47]
    ds_read_b128 a[76:79], v7 offset:3072
    s_waitcnt lgkmcnt(6)
    v_mfma_f32_32x32x16_bf16 v[48:63], a[40:43], a[52:55], v[48:63]
    ds_read_b128 a[80:83], v7 offset:7168
    s_waitcnt lgkmcnt(6)
    v_mfma_f32_32x32x16_bf16 v[64:79], a[40:43], a[56:59], v[64:79]
    ds_read_b128 a[84:87], v7 offset:11264
    s_waitcnt lgkmcnt(6)
    v_mfma_f32_32x32x16_bf16 v[80:95], a[40:43], a[60:63], v[80:95]
    ds_read_b128 a[88:91], v7 offset:15360
    s_waitcnt lgkmcnt(6)
    v_mfma_f32_32x32x16_bf16 v[96:111], a[40:43], a[64:67], v[96:111]
    ds_read_b128 a[92:95], v7 offset:19456
    s_waitcnt lgkmcnt(6)
    v_mfma_f32_32x32x16_bf16 v[112:127], a[40:43], a[68:71], v[112:127]
    ds_read_b128 a[96:99], v7 offset:23552
    s_waitcnt lgkmcnt(6)
    v_mfma_f32_32x32x16_bf16 v[128:143], a[40:43], a[72:75], v[128:143]
    ds_read_b128 a[100:103], v7 offset:27648
    s_waitcnt lgkmcnt(6)
    v_mfma_f32_32x32x16_bf16 v[32:47], a[44:47], a[76:79], v[32:47]
    s_waitcnt lgkmcnt(5)
    v_mfma_f32_32x32x16_bf16 v[48:63], a[44:47], a[80:83], v[48:63]
    s_waitcnt lgkmcnt(4)
    v_mfma_f32_32x32x16_bf16 v[64:79], a[44:47], a[84:87], v[64:79]
    s_waitcnt lgkmcnt(3)
    v_mfma_f32_32x32x16_bf16 v[80:95], a[44:47], a[88:91], v[80:95]
    s_waitcnt lgkmcnt(2)
    v_mfma_f32_32x32x16_bf16 v[96:111], a[44:47], a[92:95], v[96:111]
    s_waitcnt lgkmcnt(1)
    v_mfma_f32_32x32x16_bf16 v[112:127], a[44:47], a[96:99], v[112:127]
    s_waitcnt lgkmcnt(0)
    v_mfma_f32_32x32x16_bf16 v[128:143], a[44:47], a[100:103], v[128:143]
    s_waitcnt vmcnt(0)
    s_barrier
    ds_read_b128 a[48:51], v5 offset:0
    ds_read_b128 a[52:55], v5 offset:4096
    ds_read_b128 a[56:59], v5 offset:8192
    ds_read_b128 a[60:63], v5 offset:12288
    ds_read_b128 a[64:67], v5 offset:16384
    ds_read_b128 a[68:71], v5 offset:20480
    ds_read_b128 a[72:75], v5 offset:24576
    s_waitcnt lgkmcnt(6)
    v_mfma_f32_32x32x16_bf16 v[32:47], a[0:3], a[48:51], v[32:47]
    ds_read_b128 a[76:79], v5 offset:1024
    s_waitcnt lgkmcnt(6)
    v_mfma_f32_32x32x16_bf16 v[48:63], a[0:3], a[52:55], v[48:63]
    ds_read_b128 a[80:83], v5 offset:5120
    s_waitcnt lgkmcnt(6)
    v_mfma_f32_32x32x16_bf16 v[64:79], a[0:3], a[56:59], v[64:79]
    ds_read_b128 a[84:87], v5 offset:9216
    s_waitcnt lgkmcnt(6)
    v_mfma_f32_32x32x16_bf16 v[80:95], a[0:3], a[60:63], v[80:95]
    ds_read_b128 a[88:91], v5 offset:13312
    s_waitcnt lgkmcnt(6)
    v_mfma_f32_32x32x16_bf16 v[96:111], a[0:3], a[64:67], v[96:111]
    ds_read_b128 a[92:95], v5 offset:17408
    s_waitcnt lgkmcnt(6)
    v_mfma_f32_32x32x16_bf16 v[112:127], a[0:3], a[68:71], v[112:127]
    ds_read_b128 a[96:99], v5 offset:21504
    s_waitcnt lgkmcnt(6)
    v_mfma_f32_32x32x16_bf16 v[128:143], a[0:3], a[72:75], v[128:143]
    ds_read_b128 a[100:103], v5 offset:25600
    s_waitcnt lgkmcnt(6)
    v_mfma_f32_32x32x16_bf16 v[32:47], a[4:7], a[76:79], v[32:47]
    ds_read_b128 a[48:51], v5 offset:2048
    s_waitcnt lgkmcnt(6)
    v_mfma_f32_32x32x16_bf16 v[48:63], a[4:7], a[80:83], v[48:63]
    ds_read_b128 a[52:55], v5 offset:6144
    s_waitcnt lgkmcnt(6)
    v_mfma_f32_32x32x16_bf16 v[64:79], a[4:7], a[84:87], v[64:79]
    ds_read_b128 a[56:59], v5 offset:10240
    s_waitcnt lgkmcnt(6)
    v_mfma_f32_32x32x16_bf16 v[80:95], a[4:7], a[88:91], v[80:95]
    ds_read_b128 a[60:63], v5 offset:14336
    s_waitcnt lgkmcnt(6)
    v_mfma_f32_32x32x16_bf16 v[96:111], a[4:7], a[92:95], v[96:111]
    ds_read_b128 a[64:67], v5 offset:18432
    s_waitcnt lgkmcnt(6)
    v_mfma_f32_32x32x16_bf16 v[112:127], a[4:7], a[96:99], v[112:127]
    ds_read_b128 a[68:71], v5 offset:22528
    s_waitcnt lgkmcnt(6)
    v_mfma_f32_32x32x16_bf16 v[128:143], a[4:7], a[100:103], v[128:143]
    ds_read_b128 a[72:75], v5 offset:26624
    s_waitcnt lgkmcnt(6)
    v_mfma_f32_32x32x16_bf16 v[32:47], a[8:11], a[48:51], v[32:47]
    ds_read_b128 a[76:79], v5 offset:3072
    s_waitcnt lgkmcnt(6)
    v_mfma_f32_32x32x16_bf16 v[48:63], a[8:11], a[52:55], v[48:63]
    ds_read_b128 a[80:83], v5 offset:7168
    s_waitcnt lgkmcnt(6)
    v_mfma_f32_32x32x16_bf16 v[64:79], a[8:11], a[56:59], v[64:79]
    ds_read_b128 a[84:87], v5 offset:11264
    s_waitcnt lgkmcnt(6)
    v_mfma_f32_32x32x16_bf16 v[80:95], a[8:11], a[60:63], v[80:95]
    ds_read_b128 a[88:91], v5 offset:15360
    s_waitcnt lgkmcnt(6)
    v_mfma_f32_32x32x16_bf16 v[96:111], a[8:11], a[64:67], v[96:111]
    ds_read_b128 a[92:95], v5 offset:19456
    s_waitcnt lgkmcnt(6)
    v_mfma_f32_32x32x16_bf16 v[112:127], a[8:11], a[68:71], v[112:127]
    ds_read_b128 a[96:99], v5 offset:23552
    s_waitcnt lgkmcnt(6)
    v_mfma_f32_32x32x16_bf16 v[128:143], a[8:11], a[72:75], v[128:143]
    ds_read_b128 a[100:103], v5 offset:27648
    s_waitcnt lgkmcnt(6)
    v_mfma_f32_32x32x16_bf16 v[32:47], a[12:15], a[76:79], v[32:47]
    s_waitcnt lgkmcnt(5)
    v_mfma_f32_32x32x16_bf16 v[48:63], a[12:15], a[80:83], v[48:63]
    s_waitcnt lgkmcnt(4)
    v_mfma_f32_32x32x16_bf16 v[64:79], a[12:15], a[84:87], v[64:79]
    s_waitcnt lgkmcnt(3)
    v_mfma_f32_32x32x16_bf16 v[80:95], a[12:15], a[88:91], v[80:95]
    s_waitcnt lgkmcnt(2)
    v_mfma_f32_32x32x16_bf16 v[96:111], a[12:15], a[92:95], v[96:111]
    s_waitcnt lgkmcnt(1)
    v_mfma_f32_32x32x16_bf16 v[112:127], a[12:15], a[96:99], v[112:127]
    s_waitcnt lgkmcnt(0)
    v_mfma_f32_32x32x16_bf16 v[128:143], a[12:15], a[100:103], v[128:143]
    s_add_u32 s50, s42, 0
    v_cvt_pk_bf16_f32 v8, v32, v33
    v_cvt_pk_bf16_f32 v9, v34, v35
    v_cvt_pk_bf16_f32 v10, v36, v37
    v_cvt_pk_bf16_f32 v11, v38, v39
    buffer_store_dwordx4 v[8:11], v2, s[8:11], s50 offen offset:0 sc1
    v_cvt_pk_bf16_f32 v12, v40, v41
    v_cvt_pk_bf16_f32 v13, v42, v43
    v_cvt_pk_bf16_f32 v14, v44, v45
    v_cvt_pk_bf16_f32 v15, v46, v47
    buffer_store_dwordx4 v[12:15], v2, s[8:11], s50 offen offset:1024 sc1
    v_cvt_pk_bf16_f32 v16, v48, v49
    v_cvt_pk_bf16_f32 v17, v50, v51
    v_cvt_pk_bf16_f32 v18, v52, v53
    v_cvt_pk_bf16_f32 v19, v54, v55
    buffer_store_dwordx4 v[16:19], v2, s[8:11], s50 offen offset:2048 sc1
    v_cvt_pk_bf16_f32 v20, v56, v57
    v_cvt_pk_bf16_f32 v21, v58, v59
    v_cvt_pk_bf16_f32 v22, v60, v61
    v_cvt_pk_bf16_f32 v23, v62, v63
    buffer_store_dwordx4 v[20:23], v2, s[8:11], s50 offen offset:3072 sc1
    s_add_u32 s50, s50, 4096
    v_cvt_pk_bf16_f32 v8, v64, v65
    v_cvt_pk_bf16_f32 v9, v66, v67
    v_cvt_pk_bf16_f32 v10, v68, v69
    v_cvt_pk_bf16_f32 v11, v70, v71
    buffer_store_dwordx4 v[8:11], v2, s[8:11], s50 offen offset:0 sc1
    v_cvt_pk_bf16_f32 v12, v72, v73
    v_cvt_pk_bf16_f32 v13, v74, v75
    v_cvt_pk_bf16_f32 v14, v76, v77
    v_cvt_pk_bf16_f32 v15, v78, v79
    buffer_store_dwordx4 v[12:15], v2, s[8:11], s50 offen offset:1024 sc1
    v_cvt_pk_bf16_f32 v16, v80, v81
    v_cvt_pk_bf16_f32 v17, v82, v83
    v_cvt_pk_bf16_f32 v18, v84, v85
    v_cvt_pk_bf16_f32 v19, v86, v87
    buffer_store_dwordx4 v[16:19], v2, s[8:11], s50 offen offset:2048 sc1
    v_cvt_pk_bf16_f32 v20, v88, v89
    v_cvt_pk_bf16_f32 v21, v90, v91
    v_cvt_pk_bf16_f32 v22, v92, v93
    v_cvt_pk_bf16_f32 v23, v94, v95
    buffer_store_dwordx4 v[20:23], v2, s[8:11], s50 offen offset:3072 sc1
    s_add_u32 s50, s50, 4096
    v_cvt_pk_bf16_f32 v8, v96, v97
    v_cvt_pk_bf16_f32 v9, v98, v99
    v_cvt_pk_bf16_f32 v10, v100, v101
    v_cvt_pk_bf16_f32 v11, v102, v103
    buffer_store_dwordx4 v[8:11], v2, s[8:11], s50 offen offset:0 sc1
    v_cvt_pk_bf16_f32 v12, v104, v105
    v_cvt_pk_bf16_f32 v13, v106, v107
    v_cvt_pk_bf16_f32 v14, v108, v109
    v_cvt_pk_bf16_f32 v15, v110, v111
    buffer_store_dwordx4 v[12:15], v2, s[8:11], s50 offen offset:1024 sc1
    v_cvt_pk_bf16_f32 v16, v112, v113
    v_cvt_pk_bf16_f32 v17, v114, v115
    v_cvt_pk_bf16_f32 v18, v116, v117
    v_cvt_pk_bf16_f32 v19, v118, v119
    buffer_store_dwordx4 v[16:19], v2, s[8:11], s50 offen offset:2048 sc1
    v_cvt_pk_bf16_f32 v20, v120, v121
    v_cvt_pk_bf16_f32 v21, v122, v123
    v_cvt_pk_bf16_f32 v22, v124, v125
    v_cvt_pk_bf16_f32 v23, v126, v127
    buffer_store_dwordx4 v[20:23], v2, s[8:11], s50 offen offset:3072 sc1
    s_add_u32 s50, s50, 4096
    v_cvt_pk_bf16_f32 v8, v128, v129
    v_cvt_pk_bf16_f32 v9, v130, v131
    v_cvt_pk_bf16_f32 v10, v132, v133
    v_cvt_pk_bf16_f32 v11, v134, v135
    buffer_store_dwordx4 v[8:11], v2, s[8:11], s50 offen offset:0 sc1
    v_cvt_pk_bf16_f32 v12, v136, v137
    v_cvt_pk_bf16_f32 v13, v138, v139
    v_cvt_pk_bf16_f32 v14, v140, v141
    v_cvt_pk_bf16_f32 v15, v142, v143
    buffer_store_dwordx4 v[12:15], v2, s[8:11], s50 offen offset:1024 sc1
    s_branch W_end
W_t2:
    s_add_u32 s70, s70, 16
W_t1:
    s_mul_i32 s73, s68, s72
    s_lshr_b32 s73, s73, 16
    s_mul_i32 s74, s73, s71
    s_sub_u32 s74, s68, s74
    s_mul_i32 s74, s74, 7
    s_add_u32 s74, s74, s70
    s_lshl_b32 s39, s73, 5
    s_add_u32 s39, s39, s74
    s_add_u32 s69, s39, 384
    s_lshl_b32 s70, s73, 5
    s_add_u32 s70, s70, 1792
    v_and_b32 v8, 63, v0
    v_min_u32 v8, 31, v8
    v_lshlrev_b32 v8, 3, v8
    s_lshl_b32 s38, s70, 3
    s_add_u32 s38, s38, 117440512
FW_56:
    s_add_u32 s33, s33, 1
    s_cmp_gt_u32 s33, 0x200000
    s_cbranch_scc1 L_bail
    buffer_load_dwordx2 v[10:11], v8, s[8:11], s38 offen sc1
    s_waitcnt vmcnt(0)
    v_cmp_ne_u64 vcc, s[96:97], v[10:11]
    s_cbranch_vccz FWok_57
    s_sleep 4
    s_branch FW_56
FWok_57:
    s_lshl_b32 s70, s74, 2
    s_add_u32 s70, s70, 1536
    v_and_b32 v8, 63, v0
    v_min_u32 v8, 3, v8
    v_lshlrev_b32 v8, 3, v8
    s_lshl_b32 s38, s70, 3
    s_add_u32 s38, s38, 117440512
FW_58:
    s_add_u32 s33, s33, 1
    s_cmp_gt_u32 s33, 0x200000
    s_cbranch_scc1 L_bail
    buffer_load_dwordx2 v[10:11], v8, s[8:11], s38 offen sc1
    s_waitcnt vmcnt(0)
    v_cmp_ne_u64 vcc, s[96:97], v[10:11]
    s_cbranch_vccz FWok_59
    s_sleep 4
    s_branch FW_58
FWok_59:
    s_lshr_b32 s53, s39, 5
    s_and_b32 s54, s39, 31
    s_lshl_b32 s55, s53, 3
    s_lshl_b32 s50, s13, 1
    s_add_u32 s55, s55, s50
    s_mul_i32 s40, s55, 28672
    s_add_u32 s40, s40, 0
    s_mul_i32 s41, s54, 200704
    s_add_u32 s41, s41, 2097152
    s_mul_i32 s42, s55, 458752
    s_mul_i32 s50, s54, 14336
    s_add_u32 s42, s42, s50
    s_add_u32 s42, s42, 50331648
    v_add_u32 v5, 0, v3
    v_add_u32 v6, 28672, v3
    v_add_u32 v7, 57344, v3
    s_lshl_b32 s44, s13, 1
    s_min_u32 s45, s44, 6
    s_add_u32 s44, s44, 1
    s_min_u32 s46, s44, 6
    s_mul_i32 s47, s45, 28672
    s_add_u32 s47, s47, s41
    s_mul_i32 s48, s46, 28672
    s_add_u32 s48, s48, s41
    s_lshl_b32 s45, s45, 12
    s_lshl_b32 s46, s46, 12
    s_mov_b32 s49, s40
    s_add_u32 s50, s45, 0
    s_mov_b32 m0, s50
    s_nop 0
    buffer_load_dwordx4 v2, s[8:11], s47 offen sc1 lds
    buffer_load_dwordx4 v2, s[8:11], s47 offen offset:1024 sc1 lds
    buffer_load_dwordx4 v2, s[8:11], s47 offen offset:2048 sc1 lds
    buffer_load_dwordx4 v2, s[8:11], s47 offen offset:3072 sc1 lds
    s_add_u32 s47, s47, 4096
    s_add_u32 s50, s46, 0
    s_mov_b32 m0, s50
    s_nop 0
    buffer_load_dwordx4 v2, s[8:11], s48 offen sc1 lds
    buffer_load_dwordx4 v2, s[8:11], s48 offen offset:1024 sc1 lds
    buffer_load_dwordx4 v2, s[8:11], s48 offen offset:2048 sc1 lds
    buffer_load_dwordx4 v2, s[8:11], s48 offen offset:3072 sc1 lds
    s_add_u32 s48, s48, 4096
    buffer_load_dwordx4 a[0:3], v2, s[8:11], s49 offen offset:0 sc1
    buffer_load_dwordx4 a[8:11], v2, s[8:11], s49 offen offset:1024 sc1
    buffer_load_dwordx4 a[16:19], v2, s[8:11], s49 offen offset:2048 sc1
    buffer_load_dwordx4 a[24:27], v2, s[8:11], s49 offen offset:3072 sc1
    s_add_u32 s51, s49, 28672
    buffer_load_dwordx4 a[4:7], v2, s[8:11], s51 offen offset:0 sc1
    buffer_load_dwordx4 a[12:15], v2, s[8:11], s51 offen offset:1024 sc1
    buffer_load_dwordx4 a[20:23], v2, s[8:11], s51 offen offset:2048 sc1
    buffer_load_dwordx4 a[28:31], v2, s[8:11], s51 offen offset:3072 sc1
    s_add_u32 s49, s49, 4096
    s_add_u32 s50, s45, 28672
    s_mov_b32 m0, s50
    s_nop 0
    buffer_load_dwordx4 v2, s[8:11], s47 offen sc1 lds
    buffer_load_dwordx4 v2, s[8:11], s47 offen offset:1024 sc1 lds
    buffer_load_dwordx4 v2, s[8:11], s47 offen offset:2048 sc1 lds
    buffer_load_dwordx4 v2, s[8:11], s47 offen offset:3072 sc1 lds
    s_add_u32 s47, s47, 4096
    s_add_u32 s50, s46, 28672
    s_mov_b32 m0, s50
    s_nop 0
    buffer_load_dwordx4 v2, s[8:11], s48 offen sc1 lds
    buffer_load_dwordx4 v2, s[8:11], s48 offen offset:1024 sc1 lds
    buffer_load_dwordx4 v2, s[8:11], s48 offen offset:2048 sc1 lds
    buffer_load_dwordx4 v2, s[8:11], s48 offen offset:3072 sc1 lds
    s_add_u32 s48, s48, 4096
    buffer_load_dwordx4 a[32:35], v2, s[8:11], s49 offen offset:0 sc1
    buffer_load_dwordx4 a[40:43], v2, s[8:11], s49 offen offset:1024 sc1
    buffer_load_dwordx4 a[48:51], v2, s[8:11], s49 offen offset:2048 sc1
    buffer_load_dwordx4 a[56:59], v2, s[8:11], s49 offen offset:3072 sc1
    s_add_u32 s51, s49, 28672
    buffer_load_dwordx4 a[36:39], v2, s[8:11], s51 offen offset:0 sc1
    buffer_load_dwordx4 a[44:47], v2, s[8:11], s51 offen offset:1024 sc1
    buffer_load_dwordx4 a[52:55], v2, s[8:11], s51 offen offset:2048 sc1
    buffer_load_dwordx4 a[60:63], v2, s[8:11], s51 offen offset:3072 sc1
    s_add_u32 s49, s49, 4096
    v_mov_b32 v32, 0
    v_mov_b32 v33, 0
    v_mov_b32 v34, 0
    v_mov_b32 v35, 0
    v_mov_b32 v36, 0
    v_mov_b32 v37, 0
    v_mov_b32 v38, 0
    v_mov_b32 v39, 0
    v_mov_b32 v40, 0
    v_mov_b32 v41, 0
    v_mov_b32 v42, 0
    v_mov_b32 v43, 0
    v_mov_b32 v44, 0
    v_mov_b32 v45, 0
    v_mov_b32 v46, 0
    v_mov_b32 v47, 0
    v_mov_b32 v48, 0
    v_mov_b32 v49, 0
    v_mov_b32 v50, 0
    v_mov_b32 v51, 0
    v_mov_b32 v52, 0
    v_mov_b32 v53, 0
    v_mov_b32 v54, 0
    v_mov_b32 v55, 0
    v_mov_b32 v56, 0
    v_mov_b32 v57, 0
    v_mov_b32 v58, 0
    v_mov_b32 v59, 0
    v_mov_b32 v60, 0
    v_mov_b32 v61, 0
    v_mov_b32 v62, 0
    v_mov_b32 v63, 0
    v_mov_b32 v64, 0
    v_mov_b32 v65, 0
    v_mov_b32 v66, 0
    v_mov_b32 v67, 0
    v_mov_b32 v68, 0
    v_mov_b32 v69, 0
    v_mov_b32 v70, 0
    v_mov_b32 v71, 0
    v_mov_b32 v72, 0
    v_mov_b32 v73, 0
    v_mov_b32 v74, 0
    v_mov_b32 v75, 0
    v_mov_b32 v76, 0
    v_mov_b32 v77, 0
    v_mov_b32 v78, 0
    v_mov_b32 v79, 0
    v_mov_b32 v80, 0
    v_mov_b32 v81, 0
    v_mov_b32 v82, 0
    v_mov_b32 v83, 0
    v_mov_b32 v84, 0
    v_mov_b32 v85, 0
    v_mov_b32 v86, 0
    v_mov_b32 v87, 0
    v_mov_b32 v88, 0
    v_mov_b32 v89, 0
    v_mov_b32 v90, 0
    v_mov_b32 v91, 0
    v_mov_b32 v92, 0
    v_mov_b32 v93, 0
    v_mov_b32 v94, 0
    v_mov_b32 v95, 0
    v_mov_b32 v96, 0
    v_mov_b32 v97, 0
    v_mov_b32 v98, 0
    v_mov_b32 v99, 0
    v_mov_b32 v100, 0
    v_mov_b32 v101, 0
    v_mov_b32 v102, 0
    v_mov_b32 v103, 0
    v_mov_b32 v104, 0
    v_mov_b32 v105, 0
    v_mov_b32 v106, 0
    v_mov_b32 v107, 0
    v_mov_b32 v108, 0
    v_mov_b32 v109, 0
    v_mov_b32 v110, 0
    v_mov_b32 v111, 0
    v_mov_b32 v112, 0
    v_mov_b32 v113, 0
    v_mov_b32 v114, 0
    v_mov_b32 v115, 0
    v_mov_b32 v116, 0
    v_mov_b32 v117, 0
    v_mov_b32 v118, 0
    v_mov_b32 v119, 0
    v_mov_b32 v120, 0
    v_mov_b32 v121, 0
    v_mov_b32 v122, 0
    v_mov_b32 v123, 0
    v_mov_b32 v124, 0
    v_mov_b32 v125, 0
    v_mov_b32 v126, 0
    v_mov_b32 v127, 0
    v_mov_b32 v128, 0
    v_mov_b32 v129, 0
    v_mov_b32 v130, 0
    v_mov_b32 v131, 0
    v_mov_b32 v132, 0
    v_mov_b32 v133, 0
    v_mov_b32 v134, 0
    v_mov_b32 v135, 0
    v_mov_b32 v136, 0
    v_mov_b32 v137, 0
    v_mov_b32 v138, 0
    v_mov_b32 v139, 0
    v_mov_b32 v140, 0
    v_mov_b32 v141, 0
    v_mov_b32 v142, 0
    v_mov_b32 v143, 0
    v_mov_b32 v144, 0
    v_mov_b32 v145, 0
    v_mov_b32 v146, 0
    v_mov_b32 v147, 0
    v_mov_b32 v148, 0
    v_mov_b32 v149, 0
    v_mov_b32 v150, 0
    v_mov_b32 v151, 0
    v_mov_b32 v152, 0
    v_mov_b32 v153, 0
    v_mov_b32 v154, 0
    v_mov_b32 v155, 0
    v_mov_b32 v156, 0
    v_mov_b32 v157, 0
    v_mov_b32 v158, 0
    v_mov_b32 v159, 0
    v_mov_b32 v160, 0
    v_mov_b32 v161, 0
    v_mov_b32 v162, 0
    v_mov_b32 v163, 0
    v_mov_b32 v164, 0
    v_mov_b32 v165, 0
    v_mov_b32 v166, 0
    v_mov_b32 v167, 0
    v_mov_b32 v168, 0
    v_mov_b32 v169, 0
    v_mov_b32 v170, 0
    v_mov_b32 v171, 0
    v_mov_b32 v172, 0
    v_mov_b32 v173, 0
    v_mov_b32 v174, 0
    v_mov_b32 v175, 0
    v_mov_b32 v176, 0
    v_mov_b32 v177, 0
    v_mov_b32 v178, 0
    v_mov_b32 v179, 0
    v_mov_b32 v180, 0
    v_mov_b32 v181, 0
    v_mov_b32 v182, 0
    v_mov_b32 v183, 0
    v_mov_b32 v184, 0
    v_mov_b32 v185, 0
    v_mov_b32 v186, 0
    v_mov_b32 v187, 0
    v_mov_b32 v188, 0
    v_mov_b32 v189, 0
    v_mov_b32 v190, 0
    v_mov_b32 v191, 0
    v_mov_b32 v192, 0
    v_mov_b32 v193, 0
    v_mov_b32 v194, 0
    v_mov_b32 v195, 0
    v_mov_b32 v196, 0
    v_mov_b32 v197, 0
    v_mov_b32 v198, 0
    v_mov_b32 v199, 0
    v_mov_b32 v200, 0
    v_mov_b32 v201, 0
    v_mov_b32 v202, 0
    v_mov_b32 v203, 0
    v_mov_b32 v204, 0
    v_mov_b32 v205, 0
    v_mov_b32 v206, 0
    v_mov_b32 v207, 0
    v_mov_b32 v208, 0
    v_mov_b32 v209, 0
    v_mov_b32 v210, 0
    v_mov_b32 v211, 0
    v_mov_b32 v212, 0
    v_mov_b32 v213, 0
    v_mov_b32 v214, 0
    v_mov_b32 v215, 0
    v_mov_b32 v216, 0
    v_mov_b32 v217, 0
    v_mov_b32 v218, 0
    v_mov_b32 v219, 0
    v_mov_b32 v220, 0
    v_mov_b32 v221, 0
    v_mov_b32 v222, 0
    v_mov_b32 v223, 0
    v_mov_b32 v224, 0
    v_mov_b32 v225, 0
    v_mov_b32 v226, 0
    v_mov_b32 v227, 0
    v_mov_b32 v228, 0
    v_mov_b32 v229, 0
    v_mov_b32 v230, 0
    v_mov_b32 v231, 0
    v_mov_b32 v232, 0
    v_mov_b32 v233, 0
    v_mov_b32 v234, 0
    v_mov_b32 v235, 0
    v_mov_b32 v236, 0
    v_mov_b32 v237, 0
    v_mov_b32 v238, 0
    v_mov_b32 v239, 0
    v_mov_b32 v240, 0
    v_mov_b32 v241, 0
    v_mov_b32 v242, 0
    v_mov_b32 v243, 0
    v_mov_b32 v244, 0
    v_mov_b32 v245, 0
    v_mov_b32 v246, 0
    v_mov_b32 v247, 0
    v_mov_b32 v248, 0
    v_mov_b32 v249, 0
    v_mov_b32 v250, 0
    v_mov_b32 v251, 0
    v_mov_b32 v252, 0
    v_mov_b32 v253, 0
    v_mov_b32 v254, 0
    v_mov_b32 v255, 0
    s_waitcnt vmcnt(16)
    s_barrier
    ds_read_b128 a[96:99], v5 offset:0
    ds_read_b128 a[100:103], v5 offset:4096
    ds_read_b128 a[104:107], v5 offset:8192
    ds_read_b128 a[108:111], v5 offset:12288
    ds_read_b128 a[112:115], v5 offset:16384
    ds_read_b128 a[116:119], v5 offset:20480
    ds_read_b128 a[120:123], v5 offset:24576
    s_waitcnt lgkmcnt(6)
    v_mfma_f32_32x32x16_bf16 v[32:47], a[96:99], a[0:3], v[32:47]
    ds_read_b128 a[124:127], v5 offset:1024
    v_mfma_f32_32x32x16_bf16 v[144:159], a[96:99], a[4:7], v[144:159]
    s_add_u32 s50, s45, 57344
    s_mov_b32 m0, s50
    s_nop 0
    buffer_load_dwordx4 v2, s[8:11], s47 offen sc1 lds
    s_waitcnt lgkmcnt(6)
    v_mfma_f32_32x32x16_bf16 v[48:63], a[100:103], a[0:3], v[48:63]
    ds_read_b128 a[128:131], v5 offset:5120
    v_mfma_f32_32x32x16_bf16 v[160:175], a[100:103], a[4:7], v[160:175]
    s_waitcnt lgkmcnt(6)
    v_mfma_f32_32x32x16_bf16 v[64:79], a[104:107], a[0:3], v[64:79]
    ds_read_b128 a[132:135], v5 offset:9216
    v_mfma_f32_32x32x16_bf16 v[176:191], a[104:107], a[4:7], v[176:191]
    buffer_load_dwordx4 v2, s[8:11], s47 offen offset:1024 sc1 lds
    s_waitcnt lgkmcnt(6)
    v_mfma_f32_32x32x16_bf16 v[80:95], a[108:111], a[0:3], v[80:95]
    ds_read_b128 a[136:139], v5 offset:13312
    v_mfma_f32_32x32x16_bf16 v[192:207], a[108:111], a[4:7], v[192:207]
    s_waitcnt lgkmcnt(6)
    v_mfma_f32_32x32x16_bf16 v[96:111], a[112:115], a[0:3], v[96:111]
    ds_read_b128 a[140:143], v5 offset:17408
    v_mfma_f32_32x32x16_bf16 v[208:223], a[112:115], a[4:7], v[208:223]
    buffer_load_dwordx4 v2, s[8:11], s47 offen offset:2048 sc1 lds
    s_waitcnt lgkmcnt(6)
    v_mfma_f32_32x32x16_bf16 v[112:127], a[116:119], a[0:3], v[112:127]
    ds_read_b128 a[144:147], v5 offset:21504
    v_mfma_f32_32x32x16_bf16 v[224:239], a[116:119], a[4:7], v[224:239]
    s_waitcnt lgkmcnt(6)
    v_mfma_f32_32x32x16_bf16 v[128:143], a[120:123], a[0:3], v[128:143]
    ds_read_b128 a[148:151], v5 offset:25600
    v_mfma_f32_32x32x16_bf16 v[240:255], a[120:123], a[4:7], v[240:255]
    buffer_load_dwordx4 v2, s[8:11], s47 offen offset:3072 sc1 lds
    s_add_u32 s47, s47, 4096
    s_waitcnt lgkmcnt(6)
    v_mfma_f32_32x32x16_bf16 v[32:47], a[124:127], a[8:11], v[32:47]
    ds_read_b128 a[96:99], v5 offset:2048
    v_mfma_f32_32x32x16_bf16 v[144:159], a[124:127], a[12:15], v[144:159]
    s_add_u32 s50, s46, 57344
    s_mov_b32 m0, s50
    s_nop 0
    buffer_load_dwordx4 v2, s[8:11], s48 offen sc1 lds
    s_waitcnt lgkmcnt(6)
    v_mfma_f32_32x32x16_bf16 v[48:63], a[128:131], a[8:11], v[48:63]
    ds_read_b128 a[100:103], v5 offset:6144
    v_mfma_f32_32x32x16_bf16 v[160:175], a[128:131], a[12:15], v[160:175]
    s_waitcnt lgkmcnt(6)
    v_mfma_f32_32x32x16_bf16 v[64:79], a[132:135], a[8:11], v[64:79]
    ds_read_b128 a[104:107], v5 offset:10240
    v_mfma_f32_32x32x16_bf16 v[176:191], a[132:135], a[12:15], v[176:191]
    buffer_load_dwordx4 v2, s[8:11], s48 offen offset:1024 sc1 lds
    s_waitcnt lgkmcnt(6)
    v_mfma_f32_32x32x16_bf16 v[80:95], a[136:139], a[8:11], v[80:95]
    ds_read_b128 a[108:111], v5 offset:14336
    v_mfma_f32_32x32x16_bf16 v[192:207], a[136:139], a[12:15], v[192:207]
    s_waitcnt lgkmcnt(6)
    v_mfma_f32_32x32x16_bf16 v[96:111], a[140:143], a[8:11], v[96:111]
    ds_read_b128 a[112:115], v5 offset:18432
    v_mfma_f32_32x32x16_bf16 v[208:223], a[140:143], a[12:15], v[208:223]
    buffer_load_dwordx4 v2, s[8:11], s48 offen offset:2048 sc1 lds
    s_waitcnt lgkmcnt(6)
    v_mfma_f32_32x32x16_bf16 v[112:127], a[144:147], a[8:11], v[112:127]
    ds_read_b128 a[116:119], v5 offset:22528
    v_mfma_f32_32x32x16_bf16 v[224:239], a[144:147], a[12:15], v[224:239]
    s_waitcnt lgkmcnt(6)
    v_mfma_f32_32x32x16_bf16 v[128:143], a[148:151], a[8:11], v[128:143]
    ds_read_b128 a[120:123], v5 offset:26624
    v_mfma_f32_32x32x16_bf16 v[240:255], a[148:151], a[12:15], v[240:255]
    buffer_load_dwordx4 v2, s[8:11], s48 offen offset:3072 sc1 lds
    s_add_u32 s48, s48, 4096
    s_waitcnt lgkmcnt(6)
    v_mfma_f32_32x32x16_bf16 v[32:47], a[96:99], a[16:19], v[32:47]
    ds_read_b128 a[124:127], v5 offset:3072
    v_mfma_f32_32x32x16_bf16 v[144:159], a[96:99], a[20:23], v[144:159]
    buffer_load_dwordx4 a[64:67], v2, s[8:11], s49 offen offset:0 sc1
    s_waitcnt lgkmcnt(6)
    v_mfma_f32_32x32x16_bf16 v[48:63], a[100:103], a[16:19], v[48:63]
    ds_read_b128 a[128:131], v5 offset:7168
    v_mfma_f32_32x32x16_bf16 v[160:175], a[100:103], a[20:23], v[160:175]
    s_waitcnt lgkmcnt(6)
    v_mfma_f32_32x32x16_bf16 v[64:79], a[104:107], a[16:19], v[64:79]
    ds_read_b128 a[132:135], v5 offset:11264
    v_mfma_f32_32x32x16_bf16 v[176:191], a[104:107], a[20:23], v[176:191]
    buffer_load_dwordx4 a[72:75], v2, s[8:11], s49 offen offset:1024 sc1
    s_waitcnt lgkmcnt(6)
    v_mfma_f32_32x32x16_bf16 v[80:95], a[108:111], a[16:19], v[80:95]
    ds_read_b128 a[136:139], v5 offset:15360
    v_mfma_f32_32x32x16_bf16 v[192:207], a[108:111], a[20:23], v[192:207]
    s_waitcnt lgkmcnt(6)
    v_mfma_f32_32x32x16_bf16 v[96:111], a[112:115], a[16:19], v[96:111]
    ds_read_b128 a[140:143], v5 offset:19456
    v_mfma_f32_32x32x16_bf16 v[208:223], a[112:115], a[20:23], v[208:223]
    buffer_load_dwordx4 a[80:83], v2, s[8:11], s49 offen offset:2048 sc1
    s_waitcnt lgkmcnt(6)
    v_mfma_f32_32x32x16_bf16 v[112:127], a[116:119], a[16:19], v[112:127]
    ds_read_b128 a[144:147], v5 offset:23552
    v_mfma_f32_32x32x16_bf16 v[224:239], a[116:119], a[20:23], v[224:239]
    s_waitcnt lgkmcnt(6)
    v_mfma_f32_32x32x16_bf16 v[128:143], a[120:123], a[16:19], v[128:143]
    ds_read_b128 a[148:151], v5 offset:27648
    v_mfma_f32_32x32x16_bf16 v[240:255], a[120:123], a[20:23], v[240:255]
    buffer_load_dwordx4 a[88:91], v2, s[8:11], s49 offen offset:3072 sc1
    s_waitcnt lgkmcnt(6)
    v_mfma_f32_32x32x16_bf16 v[32:47], a[124:127], a[24:27], v[32:47]
    v_mfma_f32_32x32x16_bf16 v[144:159], a[124:127], a[28:31], v[144:159]
    s_add_u32 s51, s49, 28672
    buffer_load_dwordx4 a[68:71], v2, s[8:11], s51 offen offset:0 sc1
    s_waitcnt lgkmcnt(5)
    v_mfma_f32_32x32x16_bf16 v[48:63], a[128:131], a[24:27], v[48:63]
    v_mfma_f32_32x32x16_bf16 v[160:175], a[128:131], a[28:31], v[160:175]
    s_waitcnt lgkmcnt(4)
    v_mfma_f32_32x32x16_bf16 v[64:79], a[132:135], a[24:27], v[64:79]
    v_mfma_f32_32x32x16_bf16 v[176:191], a[132:135], a[28:31], v[176:191]
    buffer_load_dwordx4 a[76:79], v2, s[8:11], s51 offen offset:1024 sc1
    s_waitcnt lgkmcnt(3)
    v_mfma_f32_32x32x16_bf16 v[80:95], a[136:139], a[24:27], v[80:95]
    v_mfma_f32_32x32x16_bf16 v[192:207], a[136:139], a[28:31], v[192:207]
    s_waitcnt lgkmcnt(2)
    v_mfma_f32_32x32x16_bf16 v[96:111], a[140:143], a[24:27], v[96:111]
    v_mfma_f32_32x32x16_bf16 v[208:223], a[140:143], a[28:31], v[208:223]
    buffer_load_dwordx4 a[84:87], v2, s[8:11], s51 offen offset:2048 sc1
    s_waitcnt lgkmcnt(1)
    v_mfma_f32_32x32x16_bf16 v[112:127], a[144:147], a[24:27], v[112:127]
    v_mfma_f32_32x32x16_bf16 v[224:239], a[144:147], a[28:31], v[224:239]
    s_waitcnt lgkmcnt(0)
    v_mfma_f32_32x32x16_bf16 v[128:143], a[148:151], a[24:27], v[128:143]
    v_mfma_f32_32x32x16_bf16 v[240:255], a[148:151], a[28:31], v[240:255]
    buffer_load_dwordx4 a[92:95], v2, s[8:11], s51 offen offset:3072 sc1
    s_add_u32 s49, s49, 4096
    s_waitcnt vmcnt(16)
    s_barrier
    ds_read_b128 a[96:99], v6 offset:0
    ds_read_b128 a[100:103], v6 offset:4096
    ds_read_b128 a[104:107], v6 offset:8192
    ds_read_b128 a[108:111], v6 offset:12288
    ds_read_b128 a[112:115], v6 offset:16384
    ds_read_b128 a[116:119], v6 offset:20480
    ds_read_b128 a[120:123], v6 offset:24576
    s_waitcnt lgkmcnt(6)
    v_mfma_f32_32x32x16_bf16 v[32:47], a[96:99], a[32:35], v[32:47]
    ds_read_b128 a[124:127], v6 offset:1024
    v_mfma_f32_32x32x16_bf16 v[144:159], a[96:99], a[36:39], v[144:159]
    s_add_u32 s50, s45, 0
    s_mov_b32 m0, s50
    s_nop 0
    buffer_load_dwordx4 v2, s[8:11], s47 offen sc1 lds
    s_waitcnt lgkmcnt(6)
    v_mfma_f32_32x32x16_bf16 v[48:63], a[100:103], a[32:35], v[48:63]
    ds_read_b128 a[128:131], v6 offset:5120
    v_mfma_f32_32x32x16_bf16 v[160:175], a[100:103], a[36:39], v[160:175]
    s_waitcnt lgkmcnt(6)
    v_mfma_f32_32x32x16_bf16 v[64:79], a[104:107], a[32:35], v[64:79]
    ds_read_b128 a[132:135], v6 offset:9216
    v_mfma_f32_32x32x16_bf16 v[176:191], a[104:107], a[36:39], v[176:191]
    buffer_load_dwordx4 v2, s[8:11], s47 offen offset:1024 sc1 lds
    s_waitcnt lgkmcnt(6)
    v_mfma_f32_32x32x16_bf16 v[80:95], a[108:111], a[32:35], v[80:95]
    ds_read_b128 a[136:139], v6 offset:13312
    v_mfma_f32_32x32x16_bf16 v[192:207], a[108:111], a[36:39], v[192:207]
    s_waitcnt lgkmcnt(6)
    v_mfma_f32_32x32x16_bf16 v[96:111], a[112:115], a[32:35], v[96:111]
    ds_read_b128 a[140:143], v6 offset:17408
    v_mfma_f32_32x32x16_bf16 v[208:223], a[112:115], a[36:39], v[208:223]
    buffer_load_dwordx4 v2, s[8:11], s47 offen offset:2048 sc1 lds
    s_waitcnt lgkmcnt(6)
    v_mfma_f32_32x32x16_bf16 v[112:127], a[116:119], a[32:35], v[112:127]
    ds_read_b128 a[144:147], v6 offset:21504
    v_mfma_f32_32x32x16_bf16 v[224:239], a[116:119], a[36:39], v[224:239]
    s_waitcnt lgkmcnt(6)
    v_mfma_f32_32x32x16_bf16 v[128:143], a[120:123], a[32:35], v[128:143]
    ds_read_b128 a[148:151], v6 offset:25600
    v_mfma_f32_32x32x16_bf16 v[240:255], a[120:123], a[36:39], v[240:255]
    buffer_load_dwordx4 v2, s[8:11], s47 offen offset:3072 sc1 lds
    s_add_u32 s47, s47, 4096
    s_waitcnt lgkmcnt(6)
    v_mfma_f32_32x32x16_bf16 v[32:47], a[124:127], a[40:43], v[32:47]
    ds_read_b128 a[96:99], v6 offset:2048
    v_mfma_f32_32x32x16_bf16 v[144:159], a[124:127], a[44:47], v[144:159]
    s_add_u32 s50, s46, 0
    s_mov_b32 m0, s50
    s_nop 0
    buffer_load_dwordx4 v2, s[8:11], s48 offen sc1 lds
    s_waitcnt lgkmcnt(6)
    v_mfma_f32_32x32x16_bf16 v[48:63], a[128:131], a[40:43], v[48:63]
    ds_read_b128 a[100:103], v6 offset:6144
    v_mfma_f32_32x32x16_bf16 v[160:175], a[128:131], a[44:47], v[160:175]
    s_waitcnt lgkmcnt(6)
    v_mfma_f32_32x32x16_bf16 v[64:79], a[132:135], a[40:43], v[64:79]
    ds_read_b128 a[104:107], v6 offset:10240
    v_mfma_f32_32x32x16_bf16 v[176:191], a[132:135], a[44:47], v[176:191]
    buffer_load_dwordx4 v2, s[8:11], s48 offen offset:1024 sc1 lds
    s_waitcnt lgkmcnt(6)
    v_mfma_f32_32x32x16_bf16 v[80:95], a[136:139], a[40:43], v[80:95]
    ds_read_b128 a[108:111], v6 offset:14336
    v_mfma_f32_32x32x16_bf16 v[192:207], a[136:139], a[44:47], v[192:207]
    s_waitcnt lgkmcnt(6)
    v_mfma_f32_32x32x16_bf16 v[96:111], a[140:143], a[40:43], v[96:111]
    ds_read_b128 a[112:115], v6 offset:18432
    v_mfma_f32_32x32x16_bf16 v[208:223], a[140:143], a[44:47], v[208:223]
    buffer_load_dwordx4 v2, s[8:11], s48 offen offset:2048 sc1 lds
    s_waitcnt lgkmcnt(6)
    v_mfma_f32_32x32x16_bf16 v[112:127], a[144:147], a[40:43], v[112:127]
    ds_read_b128 a[116:119], v6 offset:22528
    v_mfma_f32_32x32x16_bf16 v[224:239], a[144:147], a[44:47], v[224:239]
    s_waitcnt lgkmcnt(6)
    v_mfma_f32_32x32x16_bf16 v[128:143], a[148:151], a[40:43], v[128:143]
    ds_read_b128 a[120:123], v6 offset:26624
    v_mfma_f32_32x32x16_bf16 v[240:255], a[148:151], a[44:47], v[240:255]
    buffer_load_dwordx4 v2, s[8:11], s48 offen offset:3072 sc1 lds
    s_add_u32 s48, s48, 4096
    s_waitcnt lgkmcnt(6)
    v_mfma_f32_32x32x16_bf16 v[32:47], a[96:99], a[48:51], v[32:47]
    ds_read_b128 a[124:127], v6 offset:3072
    v_mfma_f32_32x32x16_bf16 v[144:159], a[96:99], a[52:55], v[144:159]
    buffer_load_dwordx4 a[0:3], v2, s[8:11], s49 offen offset:0 sc1
    s_waitcnt lgkmcnt(6)
    v_mfma_f32_32x32x16_bf16 v[48:63], a[100:103], a[48:51], v[48:63]
    ds_read_b128 a[128:131], v6 offset:7168
    v_mfma_f32_32x32x16_bf16 v[160:175], a[100:103], a[52:55], v[160:175]
    s_waitcnt lgkmcnt(6)
    v_mfma_f32_32x32x16_bf16 v[64:79], a[104:107], a[48:51], v[64:79]
    ds_read_b128 a[132:135], v6 offset:11264
    v_mfma_f32_32x32x16_bf16 v[176:191], a[104:107], a[52:55], v[176:191]
    buffer_load_dwordx4 a[8:11], v2, s[8:11], s49 offen offset:1024 sc1
    s_waitcnt lgkmcnt(6)
    v_mfma_f32_32x32x16_bf16 v[80:95], a[108:111], a[48:51], v[80:95]
    ds_read_b128 a[136:139], v6 offset:15360
    v_mfma_f32_32x32x16_bf16 v[192:207], a[108:111], a[52:55], v[192:207]
    s_waitcnt lgkmcnt(6)
    v_mfma_f32_32x32x16_bf16 v[96:111], a[112:115], a[48:51], v[96:111]
    ds_read_b128 a[140:143], v6 offset:19456
    v_mfma_f32_32x32x16_bf16 v[208:223], a[112:115], a[52:55], v[208:223]
    buffer_load_dwordx4 a[16:19], v2, s[8:11], s49 offen offset:2048 sc1
    s_waitcnt lgkmcnt(6)
    v_mfma_f32_32x32x16_bf16 v[112:127], a[116:119], a[48:51], v[112:127]
    ds_read_b128 a[144:147], v6 offset:23552
    v_mfma_f32_32x32x16_bf16 v[224:239], a[116:119], a[52:55], v[224:239]
    s_waitcnt lgkmcnt(6)
    v_mfma_f32_32x32x16_bf16 v[128:143], a[120:123], a[48:51], v[128:143]
    ds_read_b128 a[148:151], v6 offset:27648
    v_mfma_f32_32x32x16_bf16 v[240:255], a[120:123], a[52:55], v[240:255]
    buffer_load_dwordx4 a[24:27], v2, s[8:11], s49 offen offset:3072 sc1
    s_waitcnt lgkmcnt(6)
    v_mfma_f32_32x32x16_bf16 v[32:47], a[124:127], a[56:59], v[32:47]
    v_mfma_f32_32x32x16_bf16 v[144:159], a[124:127], a[60:63], v[144:159]
    s_add_u32 s51, s49, 28672
    buffer_load_dwordx4 a[4:7], v2, s[8:11], s51 offen offset:0 sc1
    s_waitcnt lgkmcnt(5)
    v_mfma_f32_32x32x16_bf16 v[48:63], a[128:131], a[56:59], v[48:63]
    v_mfma_f32_32x32x16_bf16 v[160:175], a[128:131], a[60:63], v[160:175]
    s_waitcnt lgkmcnt(4)
    v_mfma_f32_32x32x16_bf16 v[64:79], a[132:135], a[56:59], v[64:79]
    v_mfma_f32_32x32x16_bf16 v[176:191], a[132:135], a[60:63], v[176:191]
    buffer_load_dwordx4 a[12:15], v2, s[8:11], s51 offen offset:1024 sc1
    s_waitcnt lgkmcnt(3)
    v_mfma_f32_32x32x16_bf16 v[80:95], a[136:139], a[56:59], v[80:95]
    v_mfma_f32_32x32x16_bf16 v[192:207], a[136:139], a[60:63], v[192:207]
    s_waitcnt lgkmcnt(2)
    v_mfma_f32_32x32x16_bf16 v[96:111], a[140:143], a[56:59], v[96:111]
    v_mfma_f32_32x32x16_bf16 v[208:223], a[140:143], a[60:63], v[208:223]
    buffer_load_dwordx4 a[20:23], v2, s[8:11], s51 offen offset:2048 sc1
    s_waitcnt lgkmcnt(1)
    v_mfma_f32_32x32x16_bf16 v[112:127], a[144:147], a[56:59], v[112:127]
    v_mfma_f32_32x32x16_bf16 v[224:239], a[144:147], a[60:63], v[224:239]
    s_waitcnt lgkmcnt(0)
    v_mfma_f32_32x32x16_bf16 v[128:143], a[148:151], a[56:59], v[128:143]
    v_mfma_f32_32x32x16_bf16 v[240:255], a[148:151], a[60:63], v[240:255]
    buffer_load_dwordx4 a[28:31], v2, s[8:11], s51 offen offset:3072 sc1
    s_add_u32 s49, s49, 4096
    s_waitcnt vmcnt(16)
    s_barrier
    ds_read_b128 a[96:99], v7 offset:0
    ds_read_b128 a[100:103], v7 offset:4096
    ds_read_b128 a[104:107], v7 offset:8192
    ds_read_b128 a[108:111], v7 offset:12288
    ds_read_b128 a[112:115], v7 offset:16384
    ds_read_b128 a[116:119], v7 offset:20480
    ds_read_b128 a[120:123], v7 offset:24576
    s_waitcnt lgkmcnt(6)
    v_mfma_f32_32x32x16_bf16 v[32:47], a[96:99], a[64:67], v[32:47]
    ds_read_b128 a[124:127], v7 offset:1024
    v_mfma_f32_32x32x16_bf16 v[144:159], a[96:99], a[68:71], v[144:159]
    s_add_u32 s50, s45, 28672
    s_mov_b32 m0, s50
    s_nop 0
    buffer_load_dwordx4 v2, s[8:11], s47 offen sc1 lds
    s_waitcnt lgkmcnt(6)
    v_mfma_f32_32x32x16_bf16 v[48:63], a[100:103], a[64:67], v[48:63]
    ds_read_b128 a[128:131], v7 offset:5120
    v_mfma_f32_32x32x16_bf16 v[160:175], a[100:103], a[68:71], v[160:175]
    s_waitcnt lgkmcnt(6)
    v_mfma_f32_32x32x16_bf16 v[64:79], a[104:107], a[64:67], v[64:79]
    ds_read_b128 a[132:135], v7 offset:9216
    v_mfma_f32_32x32x16_bf16 v[176:191], a[104:107], a[68:71], v[176:191]
    buffer_load_dwordx4 v2, s[8:11], s47 offen offset:1024 sc1 lds
    s_waitcnt lgkmcnt(6)
    v_mfma_f32_32x32x16_bf16 v[80:95], a[108:111], a[64:67], v[80:95]
    ds_read_b128 a[136:139], v7 offset:13312
    v_mfma_f32_32x32x16_bf16 v[192:207], a[108:111], a[68:71], v[192:207]
    s_waitcnt lgkmcnt(6)
    v_mfma_f32_32x32x16_bf16 v[96:111], a[112:115], a[64:67], v[96:111]
    ds_read_b128 a[140:143], v7 offset:17408
    v_mfma_f32_32x32x16_bf16 v[208:223], a[112:115], a[68:71], v[208:223]
    buffer_load_dwordx4 v2, s[8:11], s47 offen offset:2048 sc1 lds
    s_waitcnt lgkmcnt(6)
    v_mfma_f32_32x32x16_bf16 v[112:127], a[116:119], a[64:67], v[112:127]
    ds_read_b128 a[144:147], v7 offset:21504
    v_mfma_f32_32x32x16_bf16 v[224:239], a[116:119], a[68:71], v[224:239]
    s_waitcnt lgkmcnt(6)
    v_mfma_f32_32x32x16_bf16 v[128:143], a[120:123], a[64:67], v[128:143]
    ds_read_b128 a[148:151], v7 offset:25600
    v_mfma_f32_32x32x16_bf16 v[240:255], a[120:123], a[68:71], v[240:255]
    buffer_load_dwordx4 v2, s[8:11], s47 offen offset:3072 sc1 lds
    s_add_u32 s47, s47, 4096
    s_waitcnt lgkmcnt(6)
    v_mfma_f32_32x32x16_bf16 v[32:47], a[124:127], a[72:75], v[32:47]
    ds_read_b128 a[96:99], v7 offset:2048
    v_mfma_f32_32x32x16_bf16 v[144:159], a[124:127], a[76:79], v[144:159]
    s_add_u32 s50, s46, 28672
    s_mov_b32 m0, s50
    s_nop 0
    buffer_load_dwordx4 v2, s[8:11], s48 offen sc1 lds
    s_waitcnt lgkmcnt(6)
    v_mfma_f32_32x32x16_bf16 v[48:63], a[128:131], a[72:75], v[48:63]
    ds_read_b128 a[100:103], v7 offset:6144
    v_mfma_f32_32x32x16_bf16 v[160:175], a[128:131], a[76:79], v[160:175]
    s_waitcnt lgkmcnt(6)
    v_mfma_f32_32x32x16_bf16 v[64:79], a[132:135], a[72:75], v[64:79]
    ds_read_b128 a[104:107], v7 offset:10240
    v_mfma_f32_32x32x16_bf16 v[176:191], a[132:135], a[76:79], v[176:191]
    buffer_load_dwordx4 v2, s[8:11], s48 offen offset:1024 sc1 lds
    s_waitcnt lgkmcnt(6)
    v_mfma_f32_32x32x16_bf16 v[80:95], a[136:139], a[72:75], v[80:95]
    ds_read_b128 a[108:111], v7 offset:14336
    v_mfma_f32_32x32x16_bf16 v[192:207], a[136:139], a[76:79], v[192:207]
    s_waitcnt lgkmcnt(6)
    v_mfma_f32_32x32x16_bf16 v[96:111], a[140:143], a[72:75], v[96:111]
    ds_read_b128 a[112:115], v7 offset:18432
    v_mfma_f32_32x32x16_bf16 v[208:223], a[140:143], a[76:79], v[208:223]
    buffer_load_dwordx4 v2, s[8:11], s48 offen offset:2048 sc1 lds
    s_waitcnt lgkmcnt(6)
    v_mfma_f32_32x32x16_bf16 v[112:127], a[144:147], a[72:75], v[112:127]
    ds_read_b128 a[116:119], v7 offset:22528
    v_mfma_f32_32x32x16_bf16 v[224:239], a[144:147], a[76:79], v[224:239]
    s_waitcnt lgkmcnt(6)
    v_mfma_f32_32x32x16_bf16 v[128:143], a[148:151], a[72:75], v[128:143]
    ds_read_b128 a[120:123], v7 offset:26624
    v_mfma_f32_32x32x16_bf16 v[240:255], a[148:151], a[76:79], v[240:255]
    buffer_load_dwordx4 v2, s[8:11], s48 offen offset:3072 sc1 lds
    s_add_u32 s48, s48, 4096
    s_waitcnt lgkmcnt(6)
    v_mfma_f32_32x32x16_bf16 v[32:47], a[96:99], a[80:83], v[32:47]
    ds_read_b128 a[124:127], v7 offset:3072
    v_mfma_f32_32x32x16_bf16 v[144:159], a[96:99], a[84:87], v[144:159]
    buffer_load_dwordx4 a[32:35], v2, s[8:11], s49 offen offset:0 sc1
    s_waitcnt lgkmcnt(6)
    v_mfma_f32_32x32x16_bf16 v[48:63], a[100:103], a[80:83], v[48:63]
    ds_read_b128 a[128:131], v7 offset:7168
    v_mfma_f32_32x32x16_bf16 v[160:175], a[100:103], a[84:87], v[160:175]
    s_waitcnt lgkmcnt(6)
    v_mfma_f32_32x32x16_bf16 v[64:79], a[104:107], a[80:83], v[64:79]
    ds_read_b128 a[132:135], v7 offset:11264
    v_mfma_f32_32x32x16_bf16 v[176:191], a[104:107], a[84:87], v[176:191]
    buffer_load_dwordx4 a[40:43], v2, s[8:11], s49 offen offset:1024 sc1
    s_waitcnt lgkmcnt(6)
    v_mfma_f32_32x32x16_bf16 v[80:95], a[108:111], a[80:83], v[80:95]
    ds_read_b128 a[136:139], v7 offset:15360
    v_mfma_f32_32x32x16_bf16 v[192:207], a[108:111], a[84:87], v[192:207]
    s_waitcnt lgkmcnt(6)
    v_mfma_f32_32x32x16_bf16 v[96:111], a[112:115], a[80:83], v[96:111]
    ds_read_b128 a[140:143], v7 offset:19456
    v_mfma_f32_32x32x16_bf16 v[208:223], a[112:115], a[84:87], v[208:223]
    buffer_load_dwordx4 a[48:51], v2, s[8:11], s49 offen offset:2048 sc1
    s_waitcnt lgkmcnt(6)
    v_mfma_f32_32x32x16_bf16 v[112:127], a[116:119], a[80:83], v[112:127]
    ds_read_b128 a[144:147], v7 offset:23552
    v_mfma_f32_32x32x16_bf16 v[224:239], a[116:119], a[84:87], v[224:239]
    s_waitcnt lgkmcnt(6)
    v_mfma_f32_32x32x16_bf16 v[128:143], a[120:123], a[80:83], v[128:143]
    ds_read_b128 a[148:151], v7 offset:27648
    v_mfma_f32_32x32x16_bf16 v[240:255], a[120:123], a[84:87], v[240:255]
    buffer_load_dwordx4 a[56:59], v2, s[8:11], s49 offen offset:3072 sc1
    s_waitcnt lgkmcnt(6)
    v_mfma_f32_32x32x16_bf16 v[32:47], a[124:127], a[88:91], v[32:47]
    v_mfma_f32_32x32x16_bf16 v[144:159], a[124:127], a[92:95], v[144:159]
    s_add_u32 s51, s49, 28672
    buffer_load_dwordx4 a[36:39], v2, s[8:11], s51 offen offset:0 sc1
    s_waitcnt lgkmcnt(5)
    v_mfma_f32_32x32x16_bf16 v[48:63], a[128:131], a[88:91], v[48:63]
    v_mfma_f32_32x32x16_bf16 v[160:175], a[128:131], a[92:95], v[160:175]
    s_waitcnt lgkmcnt(4)
    v_mfma_f32_32x32x16_bf16 v[64:79], a[132:135], a[88:91], v[64:79]
    v_mfma_f32_32x32x16_bf16 v[176:191], a[132:135], a[92:95], v[176:191]
    buffer_load_dwordx4 a[44:47], v2, s[8:11], s51 offen offset:1024 sc1
    s_waitcnt lgkmcnt(3)
    v_mfma_f32_32x32x16_bf16 v[80:95], a[136:139], a[88:91], v[80:95]
    v_mfma_f32_32x32x16_bf16 v[192:207], a[136:139], a[92:95], v[192:207]
    s_waitcnt lgkmcnt(2)
    v_mfma_f32_32x32x16_bf16 v[96:111], a[140:143], a[88:91], v[96:111]
    v_mfma_f32_32x32x16_bf16 v[208:223], a[140:143], a[92:95], v[208:223]
    buffer_load_dwordx4 a[52:55], v2, s[8:11], s51 offen offset:2048 sc1
    s_waitcnt lgkmcnt(1)
    v_mfma_f32_32x32x16_bf16 v[112:127], a[144:147], a[88:91], v[112:127]
    v_mfma_f32_32x32x16_bf16 v[224:239], a[144:147], a[92:95], v[224:239]
    s_waitcnt lgkmcnt(0)
    v_mfma_f32_32x32x16_bf16 v[128:143], a[148:151], a[88:91], v[128:143]
    v_mfma_f32_32x32x16_bf16 v[240:255], a[148:151], a[92:95], v[240:255]
    buffer_load_dwordx4 a[60:63], v2, s[8:11], s51 offen offset:3072 sc1
    s_add_u32 s49, s49, 4096
    s_waitcnt vmcnt(16)
    s_barrier
    ds_read_b128 a[96:99], v5 offset:0
    ds_read_b128 a[100:103], v5 offset:4096
    ds_read_b128 a[104:107], v5 offset:8192
    ds_read_b128 a[108:111], v5 offset:12288
    ds_read_b128 a[112:115], v5 offset:16384
    ds_read_b128 a[116:119], v5 offset:20480
    ds_read_b128 a[120:123], v5 offset:24576
    s_waitcnt lgkmcnt(6)
    v_mfma_f32_32x32x16_bf16 v[32:47], a[96:99], a[0:3], v[32:47]
    ds_read_b128 a[124:127], v5 offset:1024
    v_mfma_f32_32x32x16_bf16 v[144:159], a[96:99], a[4:7], v[144:159]
    s_add_u32 s50, s45, 57344
    s_mov_b32 m0, s50
    s_nop 0
    buffer_load_dwordx4 v2, s[8:11], s47 offen sc1 lds
    s_waitcnt lgkmcnt(6)
    v_mfma_f32_32x32x16_bf16 v[48:63], a[100:103], a[0:3], v[48:63]
    ds_read_b128 a[128:131], v5 offset:5120
    v_mfma_f32_32x32x16_bf16 v[160:175], a[100:103], a[4:7], v[160:175]
    s_waitcnt lgkmcnt(6)
    v_mfma_f32_32x32x16_bf16 v[64:79], a[104:107], a[0:3], v[64:79]
    ds_read_b128 a[132:135], v5 offset:9216
    v_mfma_f32_32x32x16_bf16 v[176:191], a[104:107], a[4:7], v[176:191]
    buffer_load_dwordx4 v2, s[8:11], s47 offen offset:1024 sc1 lds
    s_waitcnt lgkmcnt(6)
    v_mfma_f32_32x32x16_bf16 v[80:95], a[108:111], a[0:3], v[80:95]
    ds_read_b128 a[136:139], v5 offset:13312
    v_mfma_f32_32x32x16_bf16 v[192:207], a[108:111], a[4:7], v[192:207]
    s_waitcnt lgkmcnt(6)
    v_mfma_f32_32x32x16_bf16 v[96:111], a[112:115], a[0:3], v[96:111]
    ds_read_b128 a[140:143], v5 offset:17408
    v_mfma_f32_32x32x16_bf16 v[208:223], a[112:115], a[4:7], v[208:223]
    buffer_load_dwordx4 v2, s[8:11], s47 offen offset:2048 sc1 lds
    s_waitcnt lgkmcnt(6)
    v_mfma_f32_32x32x16_bf16 v[112:127], a[116:119], a[0:3], v[112:127]
    ds_read_b128 a[144:147], v5 offset:21504
    v_mfma_f32_32x32x16_bf16 v[224:239], a[116:119], a[4:7], v[224:239]
    s_waitcnt lgkmcnt(6)
    v_mfma_f32_32x32x16_bf16 v[128:143], a[120:123], a[0:3], v[128:143]
    ds_read_b128 a[148:151], v5 offset:25600
    v_mfma_f32_32x32x16_bf16 v[240:255], a[120:123], a[4:7], v[240:255]
    buffer_load_dwordx4 v2, s[8:11], s47 offen offset:3072 sc1 lds
    s_add_u32 s47, s47, 4096
    s_waitcnt lgkmcnt(6)
    v_mfma_f32_32x32x16_bf16 v[32:47], a[124:127], a[8:11], v[32:47]
    ds_read_b128 a[96:99], v5 offset:2048
    v_mfma_f32_32x32x16_bf16 v[144:159], a[124:127], a[12:15], v[144:159]
    s_add_u32 s50, s46, 57344
    s_mov_b32 m0, s50
    s_nop 0
    buffer_load_dwordx4 v2, s[8:11], s48 offen sc1 lds
    s_waitcnt lgkmcnt(6)
    v_mfma_f32_32x32x16_bf16 v[48:63], a[128:131], a[8:11], v[48:63]
    ds_read_b128 a[100:103], v5 offset:6144
    v_mfma_f32_32x32x16_bf16 v[160:175], a[128:131], a[12:15], v[160:175]
    s_waitcnt lgkmcnt(6)
    v_mfma_f32_32x32x16_bf16 v[64:79], a[132:135], a[8:11], v[64:79]
    ds_read_b128 a[104:107], v5 offset:10240
    v_mfma_f32_32x32x16_bf16 v[176:191], a[132:135], a[12:15], v[176:191]
    buffer_load_dwordx4 v2, s[8:11], s48 offen offset:1024 sc1 lds
    s_waitcnt lgkmcnt(6)
    v_mfma_f32_32x32x16_bf16 v[80:95], a[136:139], a[8:11], v[80:95]
    ds_read_b128 a[108:111], v5 offset:14336
    v_mfma_f32_32x32x16_bf16 v[192:207], a[136:139], a[12:15], v[192:207]
    s_waitcnt lgkmcnt(6)
    v_mfma_f32_32x32x16_bf16 v[96:111], a[140:143], a[8:11], v[96:111]
    ds_read_b128 a[112:115], v5 offset:18432
    v_mfma_f32_32x32x16_bf16 v[208:223], a[140:143], a[12:15], v[208:223]
    buffer_load_dwordx4 v2, s[8:11], s48 offen offset:2048 sc1 lds
    s_waitcnt lgkmcnt(6)
    v_mfma_f32_32x32x16_bf16 v[112:127], a[144:147], a[8:11], v[112:127]
    ds_read_b128 a[116:119], v5 offset:22528
    v_mfma_f32_32x32x16_bf16 v[224:239], a[144:147], a[12:15], v[224:239]
    s_waitcnt lgkmcnt(6)
    v_mfma_f32_32x32x16_bf16 v[128:143], a[148:151], a[8:11], v[128:143]
    ds_read_b128 a[120:123], v5 offset:26624
    v_mfma_f32_32x32x16_bf16 v[240:255], a[148:151], a[12:15], v[240:255]
    buffer_load_dwordx4 v2, s[8:11], s48 offen offset:3072 sc1 lds
    s_add_u32 s48, s48, 4096
    s_waitcnt lgkmcnt(6)
    v_mfma_f32_32x32x16_bf16 v[32:47], a[96:99], a[16:19], v[32:47]
    ds_read_b128 a[124:127], v5 offset:3072
    v_mfma_f32_32x32x16_bf16 v[144:159], a[96:99], a[20:23], v[144:159]
    buffer_load_dwordx4 a[64:67], v2, s[8:11], s49 offen offset:0 sc1
    s_waitcnt lgkmcnt(6)
    v_mfma_f32_32x32x16_bf16 v[48:63], a[100:103], a[16:19], v[48:63]
    ds_read_b128 a[128:131], v5 offset:7168
    v_mfma_f32_32x32x16_bf16 v[160:175], a[100:103], a[20:23], v[160:175]
    s_waitcnt lgkmcnt(6)
    v_mfma_f32_32x32x16_bf16 v[64:79], a[104:107], a[16:19], v[64:79]
    ds_read_b128 a[132:135], v5 offset:11264
    v_mfma_f32_32x32x16_bf16 v[176:191], a[104:107], a[20:23], v[176:191]
    buffer_load_dwordx4 a[72:75], v2, s[8:11], s49 offen offset:1024 sc1
    s_waitcnt lgkmcnt(6)
    v_mfma_f32_32x32x16_bf16 v[80:95], a[108:111], a[16:19], v[80:95]
    ds_read_b128 a[136:139], v5 offset:15360
    v_mfma_f32_32x32x16_bf16 v[192:207], a[108:111], a[20:23], v[192:207]
    s_waitcnt lgkmcnt(6)
    v_mfma_f32_32x32x16_bf16 v[96:111], a[112:115], a[16:19], v[96:111]
    ds_read_b128 a[140:143], v5 offset:19456
    v_mfma_f32_32x32x16_bf16 v[208:223], a[112:115], a[20:23], v[208:223]
    buffer_load_dwordx4 a[80:83], v2, s[8:11], s49 offen offset:2048 sc1
    s_waitcnt lgkmcnt(6)
    v_mfma_f32_32x32x16_bf16 v[112:127], a[116:119], a[16:19], v[112:127]
    ds_read_b128 a[144:147], v5 offset:23552
    v_mfma_f32_32x32x16_bf16 v[224:239], a[116:119], a[20:23], v[224:239]
    s_waitcnt lgkmcnt(6)
    v_mfma_f32_32x32x16_bf16 v[128:143], a[120:123], a[16:19], v[128:143]
    ds_read_b128 a[148:151], v5 offset:27648
    v_mfma_f32_32x32x16_bf16 v[240:255], a[120:123], a[20:23], v[240:255]
    buffer_load_dwordx4 a[88:91], v2, s[8:11], s49 offen offset:3072 sc1
    s_waitcnt lgkmcnt(6)
    v_mfma_f32_32x32x16_bf16 v[32:47], a[124:127], a[24:27], v[32:47]
    v_mfma_f32_32x32x16_bf16 v[144:159], a[124:127], a[28:31], v[144:159]
    s_add_u32 s51, s49, 28672
    buffer_load_dwordx4 a[68:71], v2, s[8:11], s51 offen offset:0 sc1
    s_waitcnt lgkmcnt(5)
    v_mfma_f32_32x32x16_bf16 v[48:63], a[128:131], a[24:27], v[48:63]
    v_mfma_f32_32x32x16_bf16 v[160:175], a[128:131], a[28:31], v[160:175]
    s_waitcnt lgkmcnt(4)
    v_mfma_f32_32x32x16_bf16 v[64:79], a[132:135], a[24:27], v[64:79]
    v_mfma_f32_32x32x16_bf16 v[176:191], a[132:135], a[28:31], v[176:191]
    buffer_load_dwordx4 a[76:79], v2, s[8:11], s51 offen offset:1024 sc1
    s_waitcnt lgkmcnt(3)
    v_mfma_f32_32x32x16_bf16 v[80:95], a[136:139], a[24:27], v[80:95]
    v_mfma_f32_32x32x16_bf16 v[192:207], a[136:139], a[28:31], v[192:207]
    s_waitcnt lgkmcnt(2)
    v_mfma_f32_32x32x16_bf16 v[96:111], a[140:143], a[24:27], v[96:111]
    v_mfma_f32_32x32x16_bf16 v[208:223], a[140:143], a[28:31], v[208:223]
    buffer_load_dwordx4 a[84:87], v2, s[8:11], s51 offen offset:2048 sc1
    s_waitcnt lgkmcnt(1)
    v_mfma_f32_32x32x16_bf16 v[112:127], a[144:147], a[24:27], v[112:127]
    v_mfma_f32_32x32x16_bf16 v[224:239], a[144:147], a[28:31], v[224:239]
    s_waitcnt lgkmcnt(0)
    v_mfma_f32_32x32x16_bf16 v[128:143], a[148:151], a[24:27], v[128:143]
    v_mfma_f32_32x32x16_bf16 v[240:255], a[148:151], a[28:31], v[240:255]
    buffer_load_dwordx4 a[92:95], v2, s[8:11], s51 offen offset:3072 sc1
    s_add_u32 s49, s49, 4096
    s_waitcnt vmcnt(16)
    s_barrier
    ds_read_b128 a[96:99], v6 offset:0
    ds_read_b128 a[100:103], v6 offset:4096
    ds_read_b128 a[104:107], v6 offset:8192
    ds_read_b128 a[108:111], v6 offset:12288
    ds_read_b128 a[112:115], v6 offset:16384
    ds_read_b128 a[116:119], v6 offset:20480
    ds_read_b128 a[120:123], v6 offset:24576
    s_waitcnt lgkmcnt(6)
    v_mfma_f32_32x32x16_bf16 v[32:47], a[96:99], a[32:35], v[32:47]
    ds_read_b128 a[124:127], v6 offset:1024
    v_mfma_f32_32x32x16_bf16 v[144:159], a[96:99], a[36:39], v[144:159]
    s_add_u32 s50, s45, 0
    s_mov_b32 m0, s50
    s_nop 0
    buffer_load_dwordx4 v2, s[8:11], s47 offen sc1 lds
    s_waitcnt lgkmcnt(6)
    v_mfma_f32_32x32x16_bf16 v[48:63], a[100:103], a[32:35], v[48:63]
    ds_read_b128 a[128:131], v6 offset:5120
    v_mfma_f32_32x32x16_bf16 v[160:175], a[100:103], a[36:39], v[160:175]
    s_waitcnt lgkmcnt(6)
    v_mfma_f32_32x32x16_bf16 v[64:79], a[104:107], a[32:35], v[64:79]
    ds_read_b128 a[132:135], v6 offset:9216
    v_mfma_f32_32x32x16_bf16 v[176:191], a[104:107], a[36:39], v[176:191]
    buffer_load_dwordx4 v2, s[8:11], s47 offen offset:1024 sc1 lds
    s_waitcnt lgkmcnt(6)
    v_mfma_f32_32x32x16_bf16 v[80:95], a[108:111], a[32:35], v[80:95]
    ds_read_b128 a[136:139], v6 offset:13312
    v_mfma_f32_32x32x16_bf16 v[192:207], a[108:111], a[36:39], v[192:207]
    s_waitcnt lgkmcnt(6)
    v_mfma_f32_32x32x16_bf16 v[96:111], a[112:115], a[32:35], v[96:111]
    ds_read_b128 a[140:143], v6 offset:17408
    v_mfma_f32_32x32x16_bf16 v[208:223], a[112:115], a[36:39], v[208:223]
    buffer_load_dwordx4 v2, s[8:11], s47 offen offset:2048 sc1 lds
    s_waitcnt lgkmcnt(6)
    v_mfma_f32_32x32x16_bf16 v[112:127], a[116:119], a[32:35], v[112:127]
    ds_read_b128 a[144:147], v6 offset:21504
    v_mfma_f32_32x32x16_bf16 v[224:239], a[116:119], a[36:39], v[224:239]
    s_waitcnt lgkmcnt(6)
    v_mfma_f32_32x32x16_bf16 v[128:143], a[120:123], a[32:35], v[128:143]
    ds_read_b128 a[148:151], v6 offset:25600
    v_mfma_f32_32x32x16_bf16 v[240:255], a[120:123], a[36:39], v[240:255]
    buffer_load_dwordx4 v2, s[8:11], s47 offen offset:3072 sc1 lds
    s_add_u32 s47, s47, 4096
    s_waitcnt lgkmcnt(6)
    v_mfma_f32_32x32x16_bf16 v[32:47], a[124:127], a[40:43], v[32:47]
    ds_read_b128 a[96:99], v6 offset:2048
    v_mfma_f32_32x32x16_bf16 v[144:159], a[124:127], a[44:47], v[144:159]
    s_add_u32 s50, s46, 0
    s_mov_b32 m0, s50
    s_nop 0
    buffer_load_dwordx4 v2, s[8:11], s48 offen sc1 lds
    s_waitcnt lgkmcnt(6)
    v_mfma_f32_32x32x16_bf16 v[48:63], a[128:131], a[40:43], v[48:63]
    ds_read_b128 a[100:103], v6 offset:6144
    v_mfma_f32_32x32x16_bf16 v[160:175], a[128:131], a[44:47], v[160:175]
    s_waitcnt lgkmcnt(6)
    v_mfma_f32_32x32x16_bf16 v[64:79], a[132:135], a[40:43], v[64:79]
    ds_read_b128 a[104:107], v6 offset:10240
    v_mfma_f32_32x32x16_bf16 v[176:191], a[132:135], a[44:47], v[176:191]
    buffer_load_dwordx4 v2, s[8:11], s48 offen offset:1024 sc1 lds
    s_waitcnt lgkmcnt(6)
    v_mfma_f32_32x32x16_bf16 v[80:95], a[136:139], a[40:43], v[80:95]
    ds_read_b128 a[108:111], v6 offset:14336
    v_mfma_f32_32x32x16_bf16 v[192:207], a[136:139], a[44:47], v[192:207]
    s_waitcnt lgkmcnt(6)
    v_mfma_f32_32x32x16_bf16 v[96:111], a[140:143], a[40:43], v[96:111]
    ds_read_b128 a[112:115], v6 offset:18432
    v_mfma_f32_32x32x16_bf16 v[208:223], a[140:143], a[44:47], v[208:223]
    buffer_load_dwordx4 v2, s[8:11], s48 offen offset:2048 sc1 lds
    s_waitcnt lgkmcnt(6)
    v_mfma_f32_32x32x16_bf16 v[112:127], a[144:147], a[40:43], v[112:127]
    ds_read_b128 a[116:119], v6 offset:22528
    v_mfma_f32_32x32x16_bf16 v[224:239], a[144:147], a[44:47], v[224:239]
    s_waitcnt lgkmcnt(6)
    v_mfma_f32_32x32x16_bf16 v[128:143], a[148:151], a[40:43], v[128:143]
    ds_read_b128 a[120:123], v6 offset:26624
    v_mfma_f32_32x32x16_bf16 v[240:255], a[148:151], a[44:47], v[240:255]
    buffer_load_dwordx4 v2, s[8:11], s48 offen offset:3072 sc1 lds
    s_add_u32 s48, s48, 4096
    s_waitcnt lgkmcnt(6)
    v_mfma_f32_32x32x16_bf16 v[32:47], a[96:99], a[48:51], v[32:47]
    ds_read_b128 a[124:127], v6 offset:3072
    v_mfma_f32_32x32x16_bf16 v[144:159], a[96:99], a[52:55], v[144:159]
    buffer_load_dwordx4 a[0:3], v2, s[8:11], s49 offen offset:0 sc1
    s_waitcnt lgkmcnt(6)
    v_mfma_f32_32x32x16_bf16 v[48:63], a[100:103], a[48:51], v[48:63]
    ds_read_b128 a[128:131], v6 offset:7168
    v_mfma_f32_32x32x16_bf16 v[160:175], a[100:103], a[52:55], v[160:175]
    s_waitcnt lgkmcnt(6)
    v_mfma_f32_32x32x16_bf16 v[64:79], a[104:107], a[48:51], v[64:79]
    ds_read_b128 a[132:135], v6 offset:11264
    v_mfma_f32_32x32x16_bf16 v[176:191], a[104:107], a[52:55], v[176:191]
    buffer_load_dwordx4 a[8:11], v2, s[8:11], s49 offen offset:1024 sc1
    s_waitcnt lgkmcnt(6)
    v_mfma_f32_32x32x16_bf16 v[80:95], a[108:111], a[48:51], v[80:95]
    ds_read_b128 a[136:139], v6 offset:15360
    v_mfma_f32_32x32x16_bf16 v[192:207], a[108:111], a[52:55], v[192:207]
    s_waitcnt lgkmcnt(6)
    v_mfma_f32_32x32x16_bf16 v[96:111], a[112:115], a[48:51], v[96:111]
    ds_read_b128 a[140:143], v6 offset:19456
    v_mfma_f32_32x32x16_bf16 v[208:223], a[112:115], a[52:55], v[208:223]
    buffer_load_dwordx4 a[16:19], v2, s[8:11], s49 offen offset:2048 sc1
    s_waitcnt lgkmcnt(6)
    v_mfma_f32_32x32x16_bf16 v[112:127], a[116:119], a[48:51], v[112:127]
    ds_read_b128 a[144:147], v6 offset:23552
    v_mfma_f32_32x32x16_bf16 v[224:239], a[116:119], a[52:55], v[224:239]
    s_waitcnt lgkmcnt(6)
    v_mfma_f32_32x32x16_bf16 v[128:143], a[120:123], a[48:51], v[128:143]
    ds_read_b128 a[148:151], v6 offset:27648
    v_mfma_f32_32x32x16_bf16 v[240:255], a[120:123], a[52:55], v[240:255]
    buffer_load_dwordx4 a[24:27], v2, s[8:11], s49 offen offset:3072 sc1
    s_waitcnt lgkmcnt(6)
    v_mfma_f32_32x32x16_bf16 v[32:47], a[124:127], a[56:59], v[32:47]
    v_mfma_f32_32x32x16_bf16 v[144:159], a[124:127], a[60:63], v[144:159]
    s_add_u32 s51, s49, 28672
    buffer_load_dwordx4 a[4:7], v2, s[8:11], s51 offen offset:0 sc1
    s_waitcnt lgkmcnt(5)
    v_mfma_f32_32x32x16_bf16 v[48:63], a[128:131], a[56:59], v[48:63]
    v_mfma_f32_32x32x16_bf16 v[160:175], a[128:131], a[60:63], v[160:175]
    s_waitcnt lgkmcnt(4)
    v_mfma_f32_32x32x16_bf16 v[64:79], a[132:135], a[56:59], v[64:79]
    v_mfma_f32_32x32x16_bf16 v[176:191], a[132:135], a[60:63], v[176:191]
    buffer_load_dwordx4 a[12:15], v2, s[8:11], s51 offen offset:1024 sc1
    s_waitcnt lgkmcnt(3)
    v_mfma_f32_32x32x16_bf16 v[80:95], a[136:139], a[56:59], v[80:95]
    v_mfma_f32_32x32x16_bf16 v[192:207], a[136:139], a[60:63], v[192:207]
    s_waitcnt lgkmcnt(2)
    v_mfma_f32_32x32x16_bf16 v[96:111], a[140:143], a[56:59], v[96:111]
    v_mfma_f32_32x32x16_bf16 v[208:223], a[140:143], a[60:63], v[208:223]
    buffer_load_dwordx4 a[20:23], v2, s[8:11], s51 offen offset:2048 sc1
    s_waitcnt lgkmcnt(1)
    v_mfma_f32_32x32x16_bf16 v[112:127], a[144:147], a[56:59], v[112:127]
    v_mfma_f32_32x32x16_bf16 v[224:239], a[144:147], a[60:63], v[224:239]
    s_waitcnt lgkmcnt(0)
    v_mfma_f32_32x32x16_bf16 v[128:143], a[148:151], a[56:59], v[128:143]
    v_mfma_f32_32x32x16_bf16 v[240:255], a[148:151], a[60:63], v[240:255]
    buffer_load_dwordx4 a[28:31], v2, s[8:11], s51 offen offset:3072 sc1
    s_add_u32 s49, s49, 4096
    s_waitcnt vmcnt(16)
    s_barrier
    ds_read_b128 a[96:99], v7 offset:0
    ds_read_b128 a[100:103], v7 offset:4096
    ds_read_b128 a[104:107], v7 offset:8192
    ds_read_b128 a[108:111], v7 offset:12288
    ds_read_b128 a[112:115], v7 offset:16384
    ds_read_b128 a[116:119], v7 offset:20480
    ds_read_b128 a[120:123], v7 offset:24576
    s_waitcnt lgkmcnt(6)
    v_mfma_f32_32x32x16_bf16 v[32:47], a[96:99], a[64:67], v[32:47]
    ds_read_b128 a[124:127], v7 offset:1024
    v_mfma_f32_32x32x16_bf16 v[144:159], a[96:99], a[68:71], v[144:159]
    s_waitcnt lgkmcnt(6)
    v_mfma_f32_32x32x16_bf16 v[48:63], a[100:103], a[64:67], v[48:63]
    ds_read_b128 a[128:131], v7 offset:5120
    v_mfma_f32_32x32x16_bf16 v[160:175], a[100:103], a[68:71], v[160:175]
    s_waitcnt lgkmcnt(6)
    v_mfma_f32_32x32x16_bf16 v[64:79], a[104:107], a[64:67], v[64:79]
    ds_read_b128 a[132:135], v7 offset:9216
    v_mfma_f32_32x32x16_bf16 v[176:191], a[104:107], a[68:71], v[176:191]
    s_waitcnt lgkmcnt(6)
    v_mfma_f32_32x32x16_bf16 v[80:95], a[108:111], a[64:67], v[80:95]
    ds_read_b128 a[136:139], v7 offset:13312
    v_mfma_f32_32x32x16_bf16 v[192:207], a[108:111], a[68:71], v[192:207]
    s_waitcnt lgkmcnt(6)
    v_mfma_f32_32x32x16_bf16 v[96:111], a[112:115], a[64:67], v[96:111]
    ds_read_b128 a[140:143], v7 offset:17408
    v_mfma_f32_32x32x16_bf16 v[208:223], a[112:115], a[68:71], v[208:223]
    s_waitcnt lgkmcnt(6)
    v_mfma_f32_32x32x16_bf16 v[112:127], a[116:119], a[64:67], v[112:127]
    ds_read_b128 a[144:147], v7 offset:21504
    v_mfma_f32_32x32x16_bf16 v[224:239], a[116:119], a[68:71], v[224:239]
    s_waitcnt lgkmcnt(6)
    v_mfma_f32_32x32x16_bf16 v[128:143], a[120:123], a[64:67], v[128:143]
    ds_read_b128 a[148:151], v7 offset:25600
    v_mfma_f32_32x32x16_bf16 v[240:255], a[120:123], a[68:71], v[240:255]
    s_waitcnt lgkmcnt(6)
    v_mfma_f32_32x32x16_bf16 v[32:47], a[124:127], a[72:75], v[32:47]
    ds_read_b128 a[96:99], v7 offset:2048
    v_mfma_f32_32x32x16_bf16 v[144:159], a[124:127], a[76:79], v[144:159]
    s_waitcnt lgkmcnt(6)
    v_mfma_f32_32x32x16_bf16 v[48:63], a[128:131], a[72:75], v[48:63]
    ds_read_b128 a[100:103], v7 offset:6144
    v_mfma_f32_32x32x16_bf16 v[160:175], a[128:131], a[76:79], v[160:175]
    s_waitcnt lgkmcnt(6)
    v_mfma_f32_32x32x16_bf16 v[64:79], a[132:135], a[72:75], v[64:79]
    ds_read_b128 a[104:107], v7 offset:10240
    v_mfma_f32_32x32x16_bf16 v[176:191], a[132:135], a[76:79], v[176:191]
    s_waitcnt lgkmcnt(6)
    v_mfma_f32_32x32x16_bf16 v[80:95], a[136:139], a[72:75], v[80:95]
    ds_read_b128 a[108:111], v7 offset:14336
    v_mfma_f32_32x32x16_bf16 v[192:207], a[136:139], a[76:79], v[192:207]
    s_waitcnt lgkmcnt(6)
    v_mfma_f32_32x32x16_bf16 v[96:111], a[140:143], a[72:75], v[96:111]
    ds_read_b128 a[112:115], v7 offset:18432
    v_mfma_f32_32x32x16_bf16 v[208:223], a[140:143], a[76:79], v[208:223]
    s_waitcnt lgkmcnt(6)
    v_mfma_f32_32x32x16_bf16 v[112:127], a[144:147], a[72:75], v[112:127]
    ds_read_b128 a[116:119], v7 offset:22528
    v_mfma_f32_32x32x16_bf16 v[224:239], a[144:147], a[76:79], v[224:239]
    s_waitcnt lgkmcnt(6)
    v_mfma_f32_32x32x16_bf16 v[128:143], a[148:151], a[72:75], v[128:143]
    ds_read_b128 a[120:123], v7 offset:26624
    v_mfma_f32_32x32x16_bf16 v[240:255], a[148:151], a[76:79], v[240:255]
    s_waitcnt lgkmcnt(6)
    v_mfma_f32_32x32x16_bf16 v[32:47], a[96:99], a[80:83], v[32:47]
    ds_read_b128 a[124:127], v7 offset:3072
    v_mfma_f32_32x32x16_bf16 v[144:159], a[96:99], a[84:87], v[144:159]
    s_waitcnt lgkmcnt(6)
    v_mfma_f32_32x32x16_bf16 v[48:63], a[100:103], a[80:83], v[48:63]
    ds_read_b128 a[128:131], v7 offset:7168
    v_mfma_f32_32x32x16_bf16 v[160:175], a[100:103], a[84:87], v[160:175]
    s_waitcnt lgkmcnt(6)
    v_mfma_f32_32x32x16_bf16 v[64:79], a[104:107], a[80:83], v[64:79]
    ds_read_b128 a[132:135], v7 offset:11264
    v_mfma_f32_32x32x16_bf16 v[176:191], a[104:107], a[84:87], v[176:191]
    s_waitcnt lgkmcnt(6)
    v_mfma_f32_32x32x16_bf16 v[80:95], a[108:111], a[80:83], v[80:95]
    ds_read_b128 a[136:139], v7 offset:15360
    v_mfma_f32_32x32x16_bf16 v[192:207], a[108:111], a[84:87], v[192:207]
    s_waitcnt lgkmcnt(6)
    v_mfma_f32_32x32x16_bf16 v[96:111], a[112:115], a[80:83], v[96:111]
    ds_read_b128 a[140:143], v7 offset:19456
    v_mfma_f32_32x32x16_bf16 v[208:223], a[112:115], a[84:87], v[208:223]
    s_waitcnt lgkmcnt(6)
    v_mfma_f32_32x32x16_bf16 v[112:127], a[116:119], a[80:83], v[112:127]
    ds_read_b128 a[144:147], v7 offset:23552
    v_mfma_f32_32x32x16_bf16 v[224:239], a[116:119], a[84:87], v[224:239]
    s_waitcnt lgkmcnt(6)
    v_mfma_f32_32x32x16_bf16 v[128:143], a[120:123], a[80:83], v[128:143]
    ds_read_b128 a[148:151], v7 offset:27648
    v_mfma_f32_32x32x16_bf16 v[240:255], a[120:123], a[84:87], v[240:255]
    s_waitcnt lgkmcnt(6)
    v_mfma_f32_32x32x16_bf16 v[32:47], a[124:127], a[88:91], v[32:47]
    v_mfma_f32_32x32x16_bf16 v[144:159], a[124:127], a[92:95], v[144:159]
    s_waitcnt lgkmcnt(5)
    v_mfma_f32_32x32x16_bf16 v[48:63], a[128:131], a[88:91], v[48:63]
    v_mfma_f32_32x32x16_bf16 v[160:175], a[128:131], a[92:95], v[160:175]
    s_waitcnt lgkmcnt(4)
    v_mfma_f32_32x32x16_bf16 v[64:79], a[132:135], a[88:91], v[64:79]
    v_mfma_f32_32x32x16_bf16 v[176:191], a[132:135], a[92:95], v[176:191]
    s_waitcnt lgkmcnt(3)
    v_mfma_f32_32x32x16_bf16 v[80:95], a[136:139], a[88:91], v[80:95]
    v_mfma_f32_32x32x16_bf16 v[192:207], a[136:139], a[92:95], v[192:207]
    s_waitcnt lgkmcnt(2)
    v_mfma_f32_32x32x16_bf16 v[96:111], a[140:143], a[88:91], v[96:111]
    v_mfma_f32_32x32x16_bf16 v[208:223], a[140:143], a[92:95], v[208:223]
    s_waitcnt lgkmcnt(1)
    v_mfma_f32_32x32x16_bf16 v[112:127], a[144:147], a[88:91], v[112:127]
    v_mfma_f32_32x32x16_bf16 v[224:239], a[144:147], a[92:95], v[224:239]
    s_waitcnt lgkmcnt(0)
    v_mfma_f32_32x32x16_bf16 v[128:143], a[148:151], a[88:91], v[128:143]
    v_mfma_f32_32x32x16_bf16 v[240:255], a[148:151], a[92:95], v[240:255]
    s_waitcnt vmcnt(0)
    s_barrier
    ds_read_b128 a[96:99], v5 offset:0
    ds_read_b128 a[100:103], v5 offset:4096
    ds_read_b128 a[104:107], v5 offset:8192
    ds_read_b128 a[108:111], v5 offset:12288
    ds_read_b128 a[112:115], v5 offset:16384
    ds_read_b128 a[116:119], v5 offset:20480
    ds_read_b128 a[120:123], v5 offset:24576
    s_waitcnt lgkmcnt(6)
    v_mfma_f32_32x32x16_bf16 v[32:47], a[96:99], a[0:3], v[32:47]
    ds_read_b128 a[124:127], v5 offset:1024
    v_mfma_f32_32x32x16_bf16 v[144:159], a[96:99], a[4:7], v[144:159]
    s_waitcnt lgkmcnt(6)
    v_mfma_f32_32x32x16_bf16 v[48:63], a[100:103], a[0:3], v[48:63]
    ds_read_b128 a[128:131], v5 offset:5120
    v_mfma_f32_32x32x16_bf16 v[160:175], a[100:103], a[4:7], v[160:175]
    s_waitcnt lgkmcnt(6)
    v_mfma_f32_32x32x16_bf16 v[64:79], a[104:107], a[0:3], v[64:79]
    ds_read_b128 a[132:135], v5 offset:9216
    v_mfma_f32_32x32x16_bf16 v[176:191], a[104:107], a[4:7], v[176:191]
    s_waitcnt lgkmcnt(6)
    v_mfma_f32_32x32x16_bf16 v[80:95], a[108:111], a[0:3], v[80:95]
    ds_read_b128 a[136:139], v5 offset:13312
    v_mfma_f32_32x32x16_bf16 v[192:207], a[108:111], a[4:7], v[192:207]
    s_waitcnt lgkmcnt(6)
    v_mfma_f32_32x32x16_bf16 v[96:111], a[112:115], a[0:3], v[96:111]
    ds_read_b128 a[140:143], v5 offset:17408
    v_mfma_f32_32x32x16_bf16 v[208:223], a[112:115], a[4:7], v[208:223]
    s_waitcnt lgkmcnt(6)
    v_mfma_f32_32x32x16_bf16 v[112:127], a[116:119], a[0:3], v[112:127]
    ds_read_b128 a[144:147], v5 offset:21504
    v_mfma_f32_32x32x16_bf16 v[224:239], a[116:119], a[4:7], v[224:239]
    s_waitcnt lgkmcnt(6)
    v_mfma_f32_32x32x16_bf16 v[128:143], a[120:123], a[0:3], v[128:143]
    ds_read_b128 a[148:151], v5 offset:25600
    v_mfma_f32_32x32x16_bf16 v[240:255], a[120:123], a[4:7], v[240:255]
    s_waitcnt lgkmcnt(6)
    v_mfma_f32_32x32x16_bf16 v[32:47], a[124:127], a[8:11], v[32:47]
    ds_read_b128 a[96:99], v5 offset:2048
    v_mfma_f32_32x32x16_bf16 v[144:159], a[124:127], a[12:15], v[144:159]
    s_waitcnt lgkmcnt(6)
    v_mfma_f32_32x32x16_bf16 v[48:63], a[128:131], a[8:11], v[48:63]
    ds_read_b128 a[100:103], v5 offset:6144
    v_mfma_f32_32x32x16_bf16 v[160:175], a[128:131], a[12:15], v[160:175]
    s_waitcnt lgkmcnt(6)
    v_mfma_f32_32x32x16_bf16 v[64:79], a[132:135], a[8:11], v[64:79]
    ds_read_b128 a[104:107], v5 offset:10240
    v_mfma_f32_32x32x16_bf16 v[176:191], a[132:135], a[12:15], v[176:191]
    s_waitcnt lgkmcnt(6)
    v_mfma_f32_32x32x16_bf16 v[80:95], a[136:139], a[8:11], v[80:95]
    ds_read_b128 a[108:111], v5 offset:14336
    v_mfma_f32_32x32x16_bf16 v[192:207], a[136:139], a[12:15], v[192:207]
    s_waitcnt lgkmcnt(6)
    v_mfma_f32_32x32x16_bf16 v[96:111], a[140:143], a[8:11], v[96:111]
    ds_read_b128 a[112:115], v5 offset:18432
    v_mfma_f32_32x32x16_bf16 v[208:223], a[140:143], a[12:15], v[208:223]
    s_waitcnt lgkmcnt(6)
    v_mfma_f32_32x32x16_bf16 v[112:127], a[144:147], a[8:11], v[112:127]
    ds_read_b128 a[116:119], v5 offset:22528
    v_mfma_f32_32x32x16_bf16 v[224:239], a[144:147], a[12:15], v[224:239]
    s_waitcnt lgkmcnt(6)
    v_mfma_f32_32x32x16_bf16 v[128:143], a[148:151], a[8:11], v[128:143]
    ds_read_b128 a[120:123], v5 offset:26624
    v_mfma_f32_32x32x16_bf16 v[240:255], a[148:151], a[12:15], v[240:255]
    s_waitcnt lgkmcnt(6)
    v_mfma_f32_32x32x16_bf16 v[32:47], a[96:99], a[16:19], v[32:47]
    ds_read_b128 a[124:127], v5 offset:3072
    v_mfma_f32_32x32x16_bf16 v[144:159], a[96:99], a[20:23], v[144:159]
    s_waitcnt lgkmcnt(6)
    v_mfma_f32_32x32x16_bf16 v[48:63], a[100:103], a[16:19], v[48:63]
    ds_read_b128 a[128:131], v5 offset:7168
    v_mfma_f32_32x32x16_bf16 v[160:175], a[100:103], a[20:23], v[160:175]
    s_waitcnt lgkmcnt(6)
    v_mfma_f32_32x32x16_bf16 v[64:79], a[104:107], a[16:19], v[64:79]
    ds_read_b128 a[132:135], v5 offset:11264
    v_mfma_f32_32x32x16_bf16 v[176:191], a[104:107], a[20:23], v[176:191]
    s_waitcnt lgkmcnt(6)
    v_mfma_f32_32x32x16_bf16 v[80:95], a[108:111], a[16:19], v[80:95]
    ds_read_b128 a[136:139], v5 offset:15360
    v_mfma_f32_32x32x16_bf16 v[192:207], a[108:111], a[20:23], v[192:207]
    s_waitcnt lgkmcnt(6)
    v_mfma_f32_32x32x16_bf16 v[96:111], a[112:115], a[16:19], v[96:111]
    ds_read_b128 a[140:143], v5 offset:19456
    v_mfma_f32_32x32x16_bf16 v[208:223], a[112:115], a[20:23], v[208:223]
    s_waitcnt lgkmcnt(6)
    v_mfma_f32_32x32x16_bf16 v[112:127], a[116:119], a[16:19], v[112:127]
    ds_read_b128 a[144:147], v5 offset:23552
    v_mfma_f32_32x32x16_bf16 v[224:239], a[116:119], a[20:23], v[224:239]
    s_waitcnt lgkmcnt(6)
    v_mfma_f32_32x32x16_bf16 v[128:143], a[120:123], a[16:19], v[128:143]
    ds_read_b128 a[148:151], v5 offset:27648
    v_mfma_f32_32x32x16_bf16 v[240:255], a[120:123], a[20:23], v[240:255]
    s_waitcnt lgkmcnt(6)
    v_mfma_f32_32x32x16_bf16 v[32:47], a[124:127], a[24:27], v[32:47]
    v_mfma_f32_32x32x16_bf16 v[144:159], a[124:127], a[28:31], v[144:159]
    s_waitcnt lgkmcnt(5)
    v_mfma_f32_32x32x16_bf16 v[48:63], a[128:131], a[24:27], v[48:63]
    v_mfma_f32_32x32x16_bf16 v[160:175], a[128:131], a[28:31], v[160:175]
    s_waitcnt lgkmcnt(4)
    v_mfma_f32_32x32x16_bf16 v[64:79], a[132:135], a[24:27], v[64:79]
    v_mfma_f32_32x32x16_bf16 v[176:191], a[132:135], a[28:31], v[176:191]
    s_waitcnt lgkmcnt(3)
    v_mfma_f32_32x32x16_bf16 v[80:95], a[136:139], a[24:27], v[80:95]
    v_mfma_f32_32x32x16_bf16 v[192:207], a[136:139], a[28:31], v[192:207]
    s_waitcnt lgkmcnt(2)
    v_mfma_f32_32x32x16_bf16 v[96:111], a[140:143], a[24:27], v[96:111]
    v_mfma_f32_32x32x16_bf16 v[208:223], a[140:143], a[28:31], v[208:223]
    s_waitcnt lgkmcnt(1)
    v_mfma_f32_32x32x16_bf16 v[112:127], a[144:147], a[24:27], v[112:127]
    v_mfma_f32_32x32x16_bf16 v[224:239], a[144:147], a[28:31], v[224:239]
    s_waitcnt lgkmcnt(0)
    v_mfma_f32_32x32x16_bf16 v[128:143], a[148:151], a[24:27], v[128:143]
    v_mfma_f32_32x32x16_bf16 v[240:255], a[148:151], a[28:31], v[240:255]
    s_add_u32 s50, s42, 0
    v_cvt_pk_bf16_f32 v8, v32, v33
    v_cvt_pk_bf16_f32 v9, v34, v35
    v_cvt_pk_bf16_f32 v10, v36, v37
    v_cvt_pk_bf16_f32 v11, v38, v39
    buffer_store_dwordx4 v[8:11], v2, s[8:11], s50 offen offset:0 sc1
    v_cvt_pk_bf16_f32 v12, v40, v41
    v_cvt_pk_bf16_f32 v13, v42, v43
    v_cvt_pk_bf16_f32 v14, v44, v45
    v_cvt_pk_bf16_f32 v15, v46, v47
    buffer_store_dwordx4 v[12:15], v2, s[8:11], s50 offen offset:1024 sc1
    v_cvt_pk_bf16_f32 v16, v48, v49
    v_cvt_pk_bf16_f32 v17, v50, v51
    v_cvt_pk_bf16_f32 v18, v52, v53
    v_cvt_pk_bf16_f32 v19, v54, v55
    buffer_store_dwordx4 v[16:19], v2, s[8:11], s50 offen offset:2048 sc1
    v_cvt_pk_bf16_f32 v20, v56, v57
    v_cvt_pk_bf16_f32 v21, v58, v59
    v_cvt_pk_bf16_f32 v22, v60, v61
    v_cvt_pk_bf16_f32 v23, v62, v63
    buffer_store_dwordx4 v[20:23], v2, s[8:11], s50 offen offset:3072 sc1
    s_add_u32 s50, s50, 4096
    v_cvt_pk_bf16_f32 v8, v64, v65
    v_cvt_pk_bf16_f32 v9, v66, v67
    v_cvt_pk_bf16_f32 v10, v68, v69
    v_cvt_pk_bf16_f32 v11, v70, v71
    buffer_store_dwordx4 v[8:11], v2, s[8:11], s50 offen offset:0 sc1
    v_cvt_pk_bf16_f32 v12, v72, v73
    v_cvt_pk_bf16_f32 v13, v74, v75
    v_cvt_pk_bf16_f32 v14, v76, v77
    v_cvt_pk_bf16_f32 v15, v78, v79
    buffer_store_dwordx4 v[12:15], v2, s[8:11], s50 offen offset:1024 sc1
    v_cvt_pk_bf16_f32 v16, v80, v81
    v_cvt_pk_bf16_f32 v17, v82, v83
    v_cvt_pk_bf16_f32 v18, v84, v85
    v_cvt_pk_bf16_f32 v19, v86, v87
    buffer_store_dwordx4 v[16:19], v2, s[8:11], s50 offen offset:2048 sc1
    v_cvt_pk_bf16_f32 v20, v88, v89
    v_cvt_pk_bf16_f32 v21, v90, v91
    v_cvt_pk_bf16_f32 v22, v92, v93
    v_cvt_pk_bf16_f32 v23, v94, v95
    buffer_store_dwordx4 v[20:23], v2, s[8:11], s50 offen offset:3072 sc1
    s_add_u32 s50, s50, 4096
    v_cvt_pk_bf16_f32 v8, v96, v97
    v_cvt_pk_bf16_f32 v9, v98, v99
    v_cvt_pk_bf16_f32 v10, v100, v101
    v_cvt_pk_bf16_f32 v11, v102, v103
    buffer_store_dwordx4 v[8:11], v2, s[8:11], s50 offen offset:0 sc1
    v_cvt_pk_bf16_f32 v12, v104, v105
    v_cvt_pk_bf16_f32 v13, v106, v107
    v_cvt_pk_bf16_f32 v14, v108, v109
    v_cvt_pk_bf16_f32 v15, v110, v111
    buffer_store_dwordx4 v[12:15], v2, s[8:11], s50 offen offset:1024 sc1
    v_cvt_pk_bf16_f32 v16, v112, v113
    v_cvt_pk_bf16_f32 v17, v114, v115
    v_cvt_pk_bf16_f32 v18, v116, v117
    v_cvt_pk_bf16_f32 v19, v118, v119
    buffer_store_dwordx4 v[16:19], v2, s[8:11], s50 offen offset:2048 sc1
    v_cvt_pk_bf16_f32 v20, v120, v121
    v_cvt_pk_bf16_f32 v21, v122, v123
    v_cvt_pk_bf16_f32 v22, v124, v125
    v_cvt_pk_bf16_f32 v23, v126, v127
    buffer_store_dwordx4 v[20:23], v2, s[8:11], s50 offen offset:3072 sc1
    s_add_u32 s50, s50, 4096
    v_cvt_pk_bf16_f32 v8, v128, v129
    v_cvt_pk_bf16_f32 v9, v130, v131
    v_cvt_pk_bf16_f32 v10, v132, v133
    v_cvt_pk_bf16_f32 v11, v134, v135
    buffer_store_dwordx4 v[8:11], v2, s[8:11], s50 offen offset:0 sc1
    v_cvt_pk_bf16_f32 v12, v136, v137
    v_cvt_pk_bf16_f32 v13, v138, v139
    v_cvt_pk_bf16_f32 v14, v140, v141
    v_cvt_pk_bf16_f32 v15, v142, v143
    buffer_store_dwordx4 v[12:15], v2, s[8:11], s50 offen offset:1024 sc1
    s_add_u32 s50, s42, 458752
    v_cvt_pk_bf16_f32 v16, v144, v145
    v_cvt_pk_bf16_f32 v17, v146, v147
    v_cvt_pk_bf16_f32 v18, v148, v149
    v_cvt_pk_bf16_f32 v19, v150, v151
    buffer_store_dwordx4 v[16:19], v2, s[8:11], s50 offen offset:0 sc1
    v_cvt_pk_bf16_f32 v20, v152, v153
    v_cvt_pk_bf16_f32 v21, v154, v155
    v_cvt_pk_bf16_f32 v22, v156, v157
    v_cvt_pk_bf16_f32 v23, v158, v159
    buffer_store_dwordx4 v[20:23], v2, s[8:11], s50 offen offset:1024 sc1
    v_cvt_pk_bf16_f32 v8, v160, v161
    v_cvt_pk_bf16_f32 v9, v162, v163
    v_cvt_pk_bf16_f32 v10, v164, v165
    v_cvt_pk_bf16_f32 v11, v166, v167
    buffer_store_dwordx4 v[8:11], v2, s[8:11], s50 offen offset:2048 sc1
    v_cvt_pk_bf16_f32 v12, v168, v169
    v_cvt_pk_bf16_f32 v13, v170, v171
    v_cvt_pk_bf16_f32 v14, v172, v173
    v_cvt_pk_bf16_f32 v15, v174, v175
    buffer_store_dwordx4 v[12:15], v2, s[8:11], s50 offen offset:3072 sc1
    s_add_u32 s50, s50, 4096
    v_cvt_pk_bf16_f32 v16, v176, v177
    v_cvt_pk_bf16_f32 v17, v178, v179
    v_cvt_pk_bf16_f32 v18, v180, v181
    v_cvt_pk_bf16_f32 v19, v182, v183
    buffer_store_dwordx4 v[16:19], v2, s[8:11], s50 offen offset:0 sc1
    v_cvt_pk_bf16_f32 v20, v184, v185
    v_cvt_pk_bf16_f32 v21, v186, v187
    v_cvt_pk_bf16_f32 v22, v188, v189
    v_cvt_pk_bf16_f32 v23, v190, v191
    buffer_store_dwordx4 v[20:23], v2, s[8:11], s50 offen offset:1024 sc1
    v_cvt_pk_bf16_f32 v8, v192, v193
    v_cvt_pk_bf16_f32 v9, v194, v195
    v_cvt_pk_bf16_f32 v10, v196, v197
    v_cvt_pk_bf16_f32 v11, v198, v199
    buffer_store_dwordx4 v[8:11], v2, s[8:11], s50 offen offset:2048 sc1
    v_cvt_pk_bf16_f32 v12, v200, v201
    v_cvt_pk_bf16_f32 v13, v202, v203
    v_cvt_pk_bf16_f32 v14, v204, v205
    v_cvt_pk_bf16_f32 v15, v206, v207
    buffer_store_dwordx4 v[12:15], v2, s[8:11], s50 offen offset:3072 sc1
    s_add_u32 s50, s50, 4096
    v_cvt_pk_bf16_f32 v16, v208, v209
    v_cvt_pk_bf16_f32 v17, v210, v211
    v_cvt_pk_bf16_f32 v18, v212, v213
    v_cvt_pk_bf16_f32 v19, v214, v215
    buffer_store_dwordx4 v[16:19], v2, s[8:11], s50 offen offset:0 sc1
    v_cvt_pk_bf16_f32 v20, v216, v217
    v_cvt_pk_bf16_f32 v21, v218, v219
    v_cvt_pk_bf16_f32 v22, v220, v221
    v_cvt_pk_bf16_f32 v23, v222, v223
    buffer_store_dwordx4 v[20:23], v2, s[8:11], s50 offen offset:1024 sc1
    v_cvt_pk_bf16_f32 v8, v224, v225
    v_cvt_pk_bf16_f32 v9, v226, v227
    v_cvt_pk_bf16_f32 v10, v228, v229
    v_cvt_pk_bf16_f32 v11, v230, v231
    buffer_store_dwordx4 v[8:11], v2, s[8:11], s50 offen offset:2048 sc1
    v_cvt_pk_bf16_f32 v12, v232, v233
    v_cvt_pk_bf16_f32 v13, v234, v235
    v_cvt_pk_bf16_f32 v14, v236, v237
    v_cvt_pk_bf16_f32 v15, v238, v239
    buffer_store_dwordx4 v[12:15], v2, s[8:11], s50 offen offset:3072 sc1
    s_add_u32 s50, s50, 4096
    v_cvt_pk_bf16_f32 v16, v240, v241
    v_cvt_pk_bf16_f32 v17, v242, v243
    v_cvt_pk_bf16_f32 v18, v244, v245
    v_cvt_pk_bf16_f32 v19, v246, v247
    buffer_store_dwordx4 v[16:19], v2, s[8:11], s50 offen offset:0 sc1
    v_cvt_pk_bf16_f32 v20, v248, v249
    v_cvt_pk_bf16_f32 v21, v250, v251
    v_cvt_pk_bf16_f32 v22, v252, v253
    v_cvt_pk_bf16_f32 v23, v254, v255
    buffer_store_dwordx4 v[20:23], v2, s[8:11], s50 offen offset:1024 sc1
    s_branch W_end
W_y:
    s_mul_i32 s73, s68, s72
    s_lshr_b32 s73, s73, 16
    s_mul_i32 s74, s73, s71
    s_sub_u32 s74, s68, s74
    s_mul_i32 s74, s74, 7
    s_add_u32 s74, s74, s70
    s_add_u32 s73, s73, 1
    s_lshl_b32 s39, s73, 5
    s_add_u32 s39, s39, s74
    s_add_u32 s69, s39, 0
    s_cmp_lt_u32 s73, 2
    s_cbranch_scc1 W_ny
    s_cmp_lg_u32 s13, 0
    s_cbranch_scc1 W_ny2
    v_and_b32 v8, 63, v0
    v_min_u32 v8, 29, v8
    v_lshlrev_b32 v8, 3, v8
    s_mov_b32 s38, 117458432
    s_mov_b32 s40, 7
SW_60:
    buffer_load_dwordx2 v[10:11], v8, s[8:11], s38 offen sc1
    s_waitcnt vmcnt(0)
    v_cmp_ne_u64 vcc, s[96:97], v[10:11]
    s_cbranch_vccz SWok_61
    s_sleep 24
    s_sub_u32 s40, s40, 1
    s_cmp_lg_u32 s40, 0
    s_cbranch_scc1 SW_60
SWok_61:
W_ny2:
    s_barrier
W_ny:
    s_lshl_b32 s70, s73, 5
    s_add_u32 s70, s70, 1792
    v_and_b32 v8, 63, v0
    v_min_u32 v8, 31, v8
    v_lshlrev_b32 v8, 3, v8
    s_lshl_b32 s38, s70, 3
    s_add_u32 s38, s38, 117440512
FW_62:
    s_add_u32 s33, s33, 1
    s_cmp_gt_u32 s33, 0x200000
    s_cbranch_scc1 L_bail
    buffer_load_dwordx2 v[10:11], v8, s[8:11], s38 offen sc1
    s_waitcnt vmcnt(0)
    v_cmp_ne_u64 vcc, s[96:97], v[10:11]
    s_cbranch_vccz FWok_63
    s_sleep 4
    s_branch FW_62
FWok_63:
    s_lshl_b32 s70, s74, 2
    s_add_u32 s70, s70, 1664
    v_and_b32 v8, 63, v0
    v_min_u32 v8, 3, v8
    v_lshlrev_b32 v8, 3, v8
    s_lshl_b32 s38, s70, 3
    s_add_u32 s38, s38, 117440512
FW_64:
    s_add_u32 s33, s33, 1
    s_cmp_gt_u32 s33, 0x200000
    s_cbranch_scc1 L_bail
    buffer_load_dwordx2 v[10:11], v8, s[8:11], s38 offen sc1
    s_waitcnt vmcnt(0)
    v_cmp_ne_u64 vcc, s[96:97], v[10:11]
    s_cbranch_vccz FWok_65
    s_sleep 4
    s_branch FW_64
FWok_65:
    s_lshr_b32 s53, s39, 5
    s_and_b32 s54, s39, 31
    s_lshl_b32 s55, s53, 3
    s_lshl_b32 s50, s13, 1
    s_add_u32 s55, s55, s50
    s_mul_i32 s40, s55, 28672
    s_add_u32 s40, s40, 0
    s_mul_i32 s41, s54, 200704
    s_add_u32 s41, s41, 8519680
    s_mul_i32 s42, s55, 458752
    s_mul_i32 s50, s54, 14336
    s_add_u32 s42, s42, s50
    s_add_u32 s42, s42, 20971520
    v_add_u32 v5, 0, v2
    v_add_u32 v6, 28672, v2
    v_add_u32 v7, 57344, v2
    s_lshl_b32 s44, s13, 1
    s_min_u32 s45, s44, 6
    s_add_u32 s44, s44, 1
    s_min_u32 s46, s44, 6
    s_mul_i32 s47, s45, 28672
    s_add_u32 s47, s47, s41
    s_mul_i32 s48, s46, 28672
    s_add_u32 s48, s48, s41
    s_lshl_b32 s45, s45, 12
    s_lshl_b32 s46, s46, 12
    s_mov_b32 s49, s40
    s_add_u32 s50, s45, 0
    s_mov_b32 m0, s50
    s_nop 0
    buffer_load_dwordx4 v2, s[8:11], s47 offen sc1 lds
    buffer_load_dwordx4 v2, s[8:11], s47 offen offset:1024 sc1 lds
    buffer_load_dwordx4 v2, s[8:11], s47 offen offset:2048 sc1 lds
    buffer_load_dwordx4 v2, s[8:11], s47 offen offset:3072 sc1 lds
    s_add_u32 s47, s47, 4096
    s_add_u32 s50, s46, 0
    s_mov_b32 m0, s50
    s_nop 0
    buffer_load_dwordx4 v2, s[8:11], s48 offen sc1 lds
    buffer_load_dwordx4 v2, s[8:11], s48 offen offset:1024 sc1 lds
    buffer_load_dwordx4 v2, s[8:11], s48 offen offset:2048 sc1 lds
    buffer_load_dwordx4 v2, s[8:11], s48 offen offset:3072 sc1 lds
    s_add_u32 s48, s48, 4096
    buffer_load_dwordx4 a[0:3], v3, s[8:11], s49 offen offset:0 sc1
    buffer_load_dwordx4 a[8:11], v3, s[8:11], s49 offen offset:1024 sc1
    buffer_load_dwordx4 a[16:19], v3, s[8:11], s49 offen offset:2048 sc1
    buffer_load_dwordx4 a[24:27], v3, s[8:11], s49 offen offset:3072 sc1
    s_add_u32 s51, s49, 28672
    buffer_load_dwordx4 a[4:7], v3, s[8:11], s51 offen offset:0 sc1
    buffer_load_dwordx4 a[12:15], v3, s[8:11], s51 offen offset:1024 sc1
    buffer_load_dwordx4 a[20:23], v3, s[8:11], s51 offen offset:2048 sc1
    buffer_load_dwordx4 a[28:31], v3, s[8:11], s51 offen offset:3072 sc1
    s_add_u32 s49, s49, 4096
    s_add_u32 s50, s45, 28672
    s_mov_b32 m0, s50
    s_nop 0
    buffer_load_dwordx4 v2, s[8:11], s47 offen sc1 lds
    buffer_load_dwordx4 v2, s[8:11], s47 offen offset:1024 sc1 lds
    buffer_load_dwordx4 v2, s[8:11], s47 offen offset:2048 sc1 lds
    buffer_load_dwordx4 v2, s[8:11], s47 offen offset:3072 sc1 lds
    s_add_u32 s47, s47, 4096
    s_add_u32 s50, s46, 28672
    s_mov_b32 m0, s50
    s_nop 0
    buffer_load_dwordx4 v2, s[8:11], s48 offen sc1 lds
    buffer_load_dwordx4 v2, s[8:11], s48 offen offset:1024 sc1 lds
    buffer_load_dwordx4 v2, s[8:11], s48 offen offset:2048 sc1 lds
    buffer_load_dwordx4 v2, s[8:11], s48 offen offset:3072 sc1 lds
    s_add_u32 s48, s48, 4096
    buffer_load_dwordx4 a[32:35], v3, s[8:11], s49 offen offset:0 sc1
    buffer_load_dwordx4 a[40:43], v3, s[8:11], s49 offen offset:1024 sc1
    buffer_load_dwordx4 a[48:51], v3, s[8:11], s49 offen offset:2048 sc1
    buffer_load_dwordx4 a[56:59], v3, s[8:11], s49 offen offset:3072 sc1
    s_add_u32 s51, s49, 28672
    buffer_load_dwordx4 a[36:39], v3, s[8:11], s51 offen offset:0 sc1
    buffer_load_dwordx4 a[44:47], v3, s[8:11], s51 offen offset:1024 sc1
    buffer_load_dwordx4 a[52:55], v3, s[8:11], s51 offen offset:2048 sc1
    buffer_load_dwordx4 a[60:63], v3, s[8:11], s51 offen offset:3072 sc1
    s_add_u32 s49, s49, 4096
    v_mov_b32 v32, 0
    v_mov_b32 v33, 0
    v_mov_b32 v34, 0
    v_mov_b32 v35, 0
    v_mov_b32 v36, 0
    v_mov_b32 v37, 0
    v_mov_b32 v38, 0
    v_mov_b32 v39, 0
    v_mov_b32 v40, 0
    v_mov_b32 v41, 0
    v_mov_b32 v42, 0
    v_mov_b32 v43, 0
    v_mov_b32 v44, 0
    v_mov_b32 v45, 0
    v_mov_b32 v46, 0
    v_mov_b32 v47, 0
    v_mov_b32 v48, 0
    v_mov_b32 v49, 0
    v_mov_b32 v50, 0
    v_mov_b32 v51, 0
    v_mov_b32 v52, 0
    v_mov_b32 v53, 0
    v_mov_b32 v54, 0
    v_mov_b32 v55, 0
    v_mov_b32 v56, 0
    v_mov_b32 v57, 0
    v_mov_b32 v58, 0
    v_mov_b32 v59, 0
    v_mov_b32 v60, 0
    v_mov_b32 v61, 0
    v_mov_b32 v62, 0
    v_mov_b32 v63, 0
    v_mov_b32 v64, 0
    v_mov_b32 v65, 0
    v_mov_b32 v66, 0
    v_mov_b32 v67, 0
    v_mov_b32 v68, 0
    v_mov_b32 v69, 0
    v_mov_b32 v70, 0
    v_mov_b32 v71, 0
    v_mov_b32 v72, 0
    v_mov_b32 v73, 0
    v_mov_b32 v74, 0
    v_mov_b32 v75, 0
    v_mov_b32 v76, 0
    v_mov_b32 v77, 0
    v_mov_b32 v78, 0
    v_mov_b32 v79, 0
    v_mov_b32 v80, 0
    v_mov_b32 v81, 0
    v_mov_b32 v82, 0
    v_mov_b32 v83, 0
    v_mov_b32 v84, 0
    v_mov_b32 v85, 0
    v_mov_b32 v86, 0
    v_mov_b32 v87, 0
    v_mov_b32 v88, 0
    v_mov_b32 v89, 0
    v_mov_b32 v90, 0
    v_mov_b32 v91, 0
    v_mov_b32 v92, 0
    v_mov_b32 v93, 0
    v_mov_b32 v94, 0
    v_mov_b32 v95, 0
    v_mov_b32 v96, 0
    v_mov_b32 v97, 0
    v_mov_b32 v98, 0
    v_mov_b32 v99, 0
    v_mov_b32 v100, 0
    v_mov_b32 v101, 0
    v_mov_b32 v102, 0
    v_mov_b32 v103, 0
    v_mov_b32 v104, 0
    v_mov_b32 v105, 0
    v_mov_b32 v106, 0
    v_mov_b32 v107, 0
    v_mov_b32 v108, 0
    v_mov_b32 v109, 0
    v_mov_b32 v110, 0
    v_mov_b32 v111, 0
    v_mov_b32 v112, 0
    v_mov_b32 v113, 0
    v_mov_b32 v114, 0
    v_mov_b32 v115, 0
    v_mov_b32 v116, 0
    v_mov_b32 v117, 0
    v_mov_b32 v118, 0
    v_mov_b32 v119, 0
    v_mov_b32 v120, 0
    v_mov_b32 v121, 0
    v_mov_b32 v122, 0
    v_mov_b32 v123, 0
    v_mov_b32 v124, 0
    v_mov_b32 v125, 0
    v_mov_b32 v126, 0
    v_mov_b32 v127, 0
    v_mov_b32 v128, 0
    v_mov_b32 v129, 0
    v_mov_b32 v130, 0
    v_mov_b32 v131, 0
    v_mov_b32 v132, 0
    v_mov_b32 v133, 0
    v_mov_b32 v134, 0
    v_mov_b32 v135, 0
    v_mov_b32 v136, 0
    v_mov_b32 v137, 0
    v_mov_b32 v138, 0
    v_mov_b32 v139, 0
    v_mov_b32 v140, 0
    v_mov_b32 v141, 0
    v_mov_b32 v142, 0
    v_mov_b32 v143, 0
    v_mov_b32 v144, 0
    v_mov_b32 v145, 0
    v_mov_b32 v146, 0
    v_mov_b32 v147, 0
    v_mov_b32 v148, 0
    v_mov_b32 v149, 0
    v_mov_b32 v150, 0
    v_mov_b32 v151, 0
    v_mov_b32 v152, 0
    v_mov_b32 v153, 0
    v_mov_b32 v154, 0
    v_mov_b32 v155, 0
    v_mov_b32 v156, 0
    v_mov_b32 v157, 0
    v_mov_b32 v158, 0
    v_mov_b32 v159, 0
    v_mov_b32 v160, 0
    v_mov_b32 v161, 0
    v_mov_b32 v162, 0
    v_mov_b32 v163, 0
    v_mov_b32 v164, 0
    v_mov_b32 v165, 0
    v_mov_b32 v166, 0
    v_mov_b32 v167, 0
    v_mov_b32 v168, 0
    v_mov_b32 v169, 0
    v_mov_b32 v170, 0
    v_mov_b32 v171, 0
    v_mov_b32 v172, 0
    v_mov_b32 v173, 0
    v_mov_b32 v174, 0
    v_mov_b32 v175, 0
    v_mov_b32 v176, 0
    v_mov_b32 v177, 0
    v_mov_b32 v178, 0
    v_mov_b32 v179, 0
    v_mov_b32 v180, 0
    v_mov_b32 v181, 0
    v_mov_b32 v182, 0
    v_mov_b32 v183, 0
    v_mov_b32 v184, 0
    v_mov_b32 v185, 0
    v_mov_b32 v186, 0
    v_mov_b32 v187, 0
    v_mov_b32 v188, 0
    v_mov_b32 v189, 0
    v_mov_b32 v190, 0
    v_mov_b32 v191, 0
    v_mov_b32 v192, 0
    v_mov_b32 v193, 0
    v_mov_b32 v194, 0
    v_mov_b32 v195, 0
    v_mov_b32 v196, 0
    v_mov_b32 v197, 0
    v_mov_b32 v198, 0
    v_mov_b32 v199, 0
    v_mov_b32 v200, 0
    v_mov_b32 v201, 0
    v_mov_b32 v202, 0
    v_mov_b32 v203, 0
    v_mov_b32 v204, 0
    v_mov_b32 v205, 0
    v_mov_b32 v206, 0
    v_mov_b32 v207, 0
    v_mov_b32 v208, 0
    v_mov_b32 v209, 0
    v_mov_b32 v210, 0
    v_mov_b32 v211, 0
    v_mov_b32 v212, 0
    v_mov_b32 v213, 0
    v_mov_b32 v214, 0
    v_mov_b32 v215, 0
    v_mov_b32 v216, 0
    v_mov_b32 v217, 0
    v_mov_b32 v218, 0
    v_mov_b32 v219, 0
    v_mov_b32 v220, 0
    v_mov_b32 v221, 0
    v_mov_b32 v222, 0
    v_mov_b32 v223, 0
    v_mov_b32 v224, 0
    v_mov_b32 v225, 0
    v_mov_b32 v226, 0
    v_mov_b32 v227, 0
    v_mov_b32 v228, 0
    v_mov_b32 v229, 0
    v_mov_b32 v230, 0
    v_mov_b32 v231, 0
    v_mov_b32 v232, 0
    v_mov_b32 v233, 0
    v_mov_b32 v234, 0
    v_mov_b32 v235, 0
    v_mov_b32 v236, 0
    v_mov_b32 v237, 0
    v_mov_b32 v238, 0
    v_mov_b32 v239, 0
    v_mov_b32 v240, 0
    v_mov_b32 v241, 0
    v_mov_b32 v242, 0
    v_mov_b32 v243, 0
    v_mov_b32 v244, 0
    v_mov_b32 v245, 0
    v_mov_b32 v246, 0
    v_mov_b32 v247, 0
    v_mov_b32 v248, 0
    v_mov_b32 v249, 0
    v_mov_b32 v250, 0
    v_mov_b32 v251, 0
    v_mov_b32 v252, 0
    v_mov_b32 v253, 0
    v_mov_b32 v254, 0
    v_mov_b32 v255, 0
    s_waitcnt vmcnt(16)
    s_barrier
    ds_read_b128 a[96:99], v5 offset:0
    ds_read_b128 a[100:103], v5 offset:4096
    ds_read_b128 a[104:107], v5 offset:8192
    ds_read_b128 a[108:111], v5 offset:12288
    ds_read_b128 a[112:115], v5 offset:16384
    ds_read_b128 a[116:119], v5 offset:20480
    ds_read_b128 a[120:123], v5 offset:24576
    s_waitcnt lgkmcnt(6)
    v_mfma_f32_32x32x16_bf16 v[32:47], a[0:3], a[96:99], v[32:47]
    ds_read_b128 a[124:127], v5 offset:1024
    v_mfma_f32_32x32x16_bf16 v[144:159], a[4:7], a[96:99], v[144:159]
    s_add_u32 s50, s45, 57344
    s_mov_b32 m0, s50
    s_nop 0
    buffer_load_dwordx4 v2, s[8:11], s47 offen sc1 lds
    s_waitcnt lgkmcnt(6)
    v_mfma_f32_32x32x16_bf16 v[48:63], a[0:3], a[100:103], v[48:63]
    ds_read_b128 a[128:131], v5 offset:5120
    v_mfma_f32_32x32x16_bf16 v[160:175], a[4:7], a[100:103], v[160:175]
    s_waitcnt lgkmcnt(6)
    v_mfma_f32_32x32x16_bf16 v[64:79], a[0:3], a[104:107], v[64:79]
    ds_read_b128 a[132:135], v5 offset:9216
    v_mfma_f32_32x32x16_bf16 v[176:191], a[4:7], a[104:107], v[176:191]
    buffer_load_dwordx4 v2, s[8:11], s47 offen offset:1024 sc1 lds
    s_waitcnt lgkmcnt(6)
    v_mfma_f32_32x32x16_bf16 v[80:95], a[0:3], a[108:111], v[80:95]
    ds_read_b128 a[136:139], v5 offset:13312
    v_mfma_f32_32x32x16_bf16 v[192:207], a[4:7], a[108:111], v[192:207]
    s_waitcnt lgkmcnt(6)
    v_mfma_f32_32x32x16_bf16 v[96:111], a[0:3], a[112:115], v[96:111]
    ds_read_b128 a[140:143], v5 offset:17408
    v_mfma_f32_32x32x16_bf16 v[208:223], a[4:7], a[112:115], v[208:223]
    buffer_load_dwordx4 v2, s[8:11], s47 offen offset:2048 sc1 lds
    s_waitcnt lgkmcnt(6)
    v_mfma_f32_32x32x16_bf16 v[112:127], a[0:3], a[116:119], v[112:127]
    ds_read_b128 a[144:147], v5 offset:21504
    v_mfma_f32_32x32x16_bf16 v[224:239], a[4:7], a[116:119], v[224:239]
    s_waitcnt lgkmcnt(6)
    v_mfma_f32_32x32x16_bf16 v[128:143], a[0:3], a[120:123], v[128:143]
    ds_read_b128 a[148:151], v5 offset:25600
    v_mfma_f32_32x32x16_bf16 v[240:255], a[4:7], a[120:123], v[240:255]
    buffer_load_dwordx4 v2, s[8:11], s47 offen offset:3072 sc1 lds
    s_add_u32 s47, s47, 4096
    s_waitcnt lgkmcnt(6)
    v_mfma_f32_32x32x16_bf16 v[32:47], a[8:11], a[124:127], v[32:47]
    ds_read_b128 a[96:99], v5 offset:2048
    v_mfma_f32_32x32x16_bf16 v[144:159], a[12:15], a[124:127], v[144:159]
    s_add_u32 s50, s46, 57344
    s_mov_b32 m0, s50
    s_nop 0
    buffer_load_dwordx4 v2, s[8:11], s48 offen sc1 lds
    s_waitcnt lgkmcnt(6)
    v_mfma_f32_32x32x16_bf16 v[48:63], a[8:11], a[128:131], v[48:63]
    ds_read_b128 a[100:103], v5 offset:6144
    v_mfma_f32_32x32x16_bf16 v[160:175], a[12:15], a[128:131], v[160:175]
    s_waitcnt lgkmcnt(6)
    v_mfma_f32_32x32x16_bf16 v[64:79], a[8:11], a[132:135], v[64:79]
    ds_read_b128 a[104:107], v5 offset:10240
    v_mfma_f32_32x32x16_bf16 v[176:191], a[12:15], a[132:135], v[176:191]
    buffer_load_dwordx4 v2, s[8:11], s48 offen offset:1024 sc1 lds
    s_waitcnt lgkmcnt(6)
    v_mfma_f32_32x32x16_bf16 v[80:95], a[8:11], a[136:139], v[80:95]
    ds_read_b128 a[108:111], v5 offset:14336
    v_mfma_f32_32x32x16_bf16 v[192:207], a[12:15], a[136:139], v[192:207]
    s_waitcnt lgkmcnt(6)
    v_mfma_f32_32x32x16_bf16 v[96:111], a[8:11], a[140:143], v[96:111]
    ds_read_b128 a[112:115], v5 offset:18432
    v_mfma_f32_32x32x16_bf16 v[208:223], a[12:15], a[140:143], v[208:223]
    buffer_load_dwordx4 v2, s[8:11], s48 offen offset:2048 sc1 lds
    s_waitcnt lgkmcnt(6)
    v_mfma_f32_32x32x16_bf16 v[112:127], a[8:11], a[144:147], v[112:127]
    ds_read_b128 a[116:119], v5 offset:22528
    v_mfma_f32_32x32x16_bf16 v[224:239], a[12:15], a[144:147], v[224:239]
    s_waitcnt lgkmcnt(6)
    v_mfma_f32_32x32x16_bf16 v[128:143], a[8:11], a[148:151], v[128:143]
    ds_read_b128 a[120:123], v5 offset:26624
    v_mfma_f32_32x32x16_bf16 v[240:255], a[12:15], a[148:151], v[240:255]
    buffer_load_dwordx4 v2, s[8:11], s48 offen offset:3072 sc1 lds
    s_add_u32 s48, s48, 4096
    s_waitcnt lgkmcnt(6)
    v_mfma_f32_32x32x16_bf16 v[32:47], a[16:19], a[96:99], v[32:47]
    ds_read_b128 a[124:127], v5 offset:3072
    v_mfma_f32_32x32x16_bf16 v[144:159], a[20:23], a[96:99], v[144:159]
    buffer_load_dwordx4 a[64:67], v3, s[8:11], s49 offen offset:0 sc1
    s_waitcnt lgkmcnt(6)
    v_mfma_f32_32x32x16_bf16 v[48:63], a[16:19], a[100:103], v[48:63]
    ds_read_b128 a[128:131], v5 offset:7168
    v_mfma_f32_32x32x16_bf16 v[160:175], a[20:23], a[100:103], v[160:175]
    s_waitcnt lgkmcnt(6)
    v_mfma_f32_32x32x16_bf16 v[64:79], a[16:19], a[104:107], v[64:79]
    ds_read_b128 a[132:135], v5 offset:11264
    v_mfma_f32_32x32x16_bf16 v[176:191], a[20:23], a[104:107], v[176:191]
    buffer_load_dwordx4 a[72:75], v3, s[8:11], s49 offen offset:1024 sc1
    s_waitcnt lgkmcnt(6)
    v_mfma_f32_32x32x16_bf16 v[80:95], a[16:19], a[108:111], v[80:95]
    ds_read_b128 a[136:139], v5 offset:15360
    v_mfma_f32_32x32x16_bf16 v[192:207], a[20:23], a[108:111], v[192:207]
    s_waitcnt lgkmcnt(6)
    v_mfma_f32_32x32x16_bf16 v[96:111], a[16:19], a[112:115], v[96:111]
    ds_read_b128 a[140:143], v5 offset:19456
    v_mfma_f32_32x32x16_bf16 v[208:223], a[20:23], a[112:115], v[208:223]
    buffer_load_dwordx4 a[80:83], v3, s[8:11], s49 offen offset:2048 sc1
    s_waitcnt lgkmcnt(6)
    v_mfma_f32_32x32x16_bf16 v[112:127], a[16:19], a[116:119], v[112:127]
    ds_read_b128 a[144:147], v5 offset:23552
    v_mfma_f32_32x32x16_bf16 v[224:239], a[20:23], a[116:119], v[224:239]
    s_waitcnt lgkmcnt(6)
    v_mfma_f32_32x32x16_bf16 v[128:143], a[16:19], a[120:123], v[128:143]
    ds_read_b128 a[148:151], v5 offset:27648
    v_mfma_f32_32x32x16_bf16 v[240:255], a[20:23], a[120:123], v[240:255]
    buffer_load_dwordx4 a[88:91], v3, s[8:11], s49 offen offset:3072 sc1
    s_waitcnt lgkmcnt(6)
    v_mfma_f32_32x32x16_bf16 v[32:47], a[24:27], a[124:127], v[32:47]
    v_mfma_f32_32x32x16_bf16 v[144:159], a[28:31], a[124:127], v[144:159]
    s_add_u32 s51, s49, 28672
    buffer_load_dwordx4 a[68:71], v3, s[8:11], s51 offen offset:0 sc1
    s_waitcnt lgkmcnt(5)
    v_mfma_f32_32x32x16_bf16 v[48:63], a[24:27], a[128:131], v[48:63]
    v_mfma_f32_32x32x16_bf16 v[160:175], a[28:31], a[128:131], v[160:175]
    s_waitcnt lgkmcnt(4)
    v_mfma_f32_32x32x16_bf16 v[64:79], a[24:27], a[132:135], v[64:79]
    v_mfma_f32_32x32x16_bf16 v[176:191], a[28:31], a[132:135], v[176:191]
    buffer_load_dwordx4 a[76:79], v3, s[8:11], s51 offen offset:1024 sc1
    s_waitcnt lgkmcnt(3)
    v_mfma_f32_32x32x16_bf16 v[80:95], a[24:27], a[136:139], v[80:95]
    v_mfma_f32_32x32x16_bf16 v[192:207], a[28:31], a[136:139], v[192:207]
    s_waitcnt lgkmcnt(2)
    v_mfma_f32_32x32x16_bf16 v[96:111], a[24:27], a[140:143], v[96:111]
    v_mfma_f32_32x32x16_bf16 v[208:223], a[28:31], a[140:143], v[208:223]
    buffer_load_dwordx4 a[84:87], v3, s[8:11], s51 offen offset:2048 sc1
    s_waitcnt lgkmcnt(1)
    v_mfma_f32_32x32x16_bf16 v[112:127], a[24:27], a[144:147], v[112:127]
    v_mfma_f32_32x32x16_bf16 v[224:239], a[28:31], a[144:147], v[224:239]
    s_waitcnt lgkmcnt(0)
    v_mfma_f32_32x32x16_bf16 v[128:143], a[24:27], a[148:151], v[128:143]
    v_mfma_f32_32x32x16_bf16 v[240:255], a[28:31], a[148:151], v[240:255]
    buffer_load_dwordx4 a[92:95], v3, s[8:11], s51 offen offset:3072 sc1
    s_add_u32 s49, s49, 4096
    s_waitcnt vmcnt(16)
    s_barrier
    ds_read_b128 a[96:99], v6 offset:0
    ds_read_b128 a[100:103], v6 offset:4096
    ds_read_b128 a[104:107], v6 offset:8192
    ds_read_b128 a[108:111], v6 offset:12288
    ds_read_b128 a[112:115], v6 offset:16384
    ds_read_b128 a[116:119], v6 offset:20480
    ds_read_b128 a[120:123], v6 offset:24576
    s_waitcnt lgkmcnt(6)
    v_mfma_f32_32x32x16_bf16 v[32:47], a[32:35], a[96:99], v[32:47]
    ds_read_b128 a[124:127], v6 offset:1024
    v_mfma_f32_32x32x16_bf16 v[144:159], a[36:39], a[96:99], v[144:159]
    s_add_u32 s50, s45, 0
    s_mov_b32 m0, s50
    s_nop 0
    buffer_load_dwordx4 v2, s[8:11], s47 offen sc1 lds
    s_waitcnt lgkmcnt(6)
    v_mfma_f32_32x32x16_bf16 v[48:63], a[32:35], a[100:103], v[48:63]
    ds_read_b128 a[128:131], v6 offset:5120
    v_mfma_f32_32x32x16_bf16 v[160:175], a[36:39], a[100:103], v[160:175]
    s_waitcnt lgkmcnt(6)
    v_mfma_f32_32x32x16_bf16 v[64:79], a[32:35], a[104:107], v[64:79]
    ds_read_b128 a[132:135], v6 offset:9216
    v_mfma_f32_32x32x16_bf16 v[176:191], a[36:39], a[104:107], v[176:191]
    buffer_load_dwordx4 v2, s[8:11], s47 offen offset:1024 sc1 lds
    s_waitcnt lgkmcnt(6)
    v_mfma_f32_32x32x16_bf16 v[80:95], a[32:35], a[108:111], v[80:95]
    ds_read_b128 a[136:139], v6 offset:13312
    v_mfma_f32_32x32x16_bf16 v[192:207], a[36:39], a[108:111], v[192:207]
    s_waitcnt lgkmcnt(6)
    v_mfma_f32_32x32x16_bf16 v[96:111], a[32:35], a[112:115], v[96:111]
    ds_read_b128 a[140:143], v6 offset:17408
    v_mfma_f32_32x32x16_bf16 v[208:223], a[36:39], a[112:115], v[208:223]
    buffer_load_dwordx4 v2, s[8:11], s47 offen offset:2048 sc1 lds
    s_waitcnt lgkmcnt(6)
    v_mfma_f32_32x32x16_bf16 v[112:127], a[32:35], a[116:119], v[112:127]
    ds_read_b128 a[144:147], v6 offset:21504
    v_mfma_f32_32x32x16_bf16 v[224:239], a[36:39], a[116:119], v[224:239]
    s_waitcnt lgkmcnt(6)
    v_mfma_f32_32x32x16_bf16 v[128:143], a[32:35], a[120:123], v[128:143]
    ds_read_b128 a[148:151], v6 offset:25600
    v_mfma_f32_32x32x16_bf16 v[240:255], a[36:39], a[120:123], v[240:255]
    buffer_load_dwordx4 v2, s[8:11], s47 offen offset:3072 sc1 lds
    s_add_u32 s47, s47, 4096
    s_waitcnt lgkmcnt(6)
    v_mfma_f32_32x32x16_bf16 v[32:47], a[40:43], a[124:127], v[32:47]
    ds_read_b128 a[96:99], v6 offset:2048
    v_mfma_f32_32x32x16_bf16 v[144:159], a[44:47], a[124:127], v[144:159]
    s_add_u32 s50, s46, 0
    s_mov_b32 m0, s50
    s_nop 0
    buffer_load_dwordx4 v2, s[8:11], s48 offen sc1 lds
    s_waitcnt lgkmcnt(6)
    v_mfma_f32_32x32x16_bf16 v[48:63], a[40:43], a[128:131], v[48:63]
    ds_read_b128 a[100:103], v6 offset:6144
    v_mfma_f32_32x32x16_bf16 v[160:175], a[44:47], a[128:131], v[160:175]
    s_waitcnt lgkmcnt(6)
    v_mfma_f32_32x32x16_bf16 v[64:79], a[40:43], a[132:135], v[64:79]
    ds_read_b128 a[104:107], v6 offset:10240
    v_mfma_f32_32x32x16_bf16 v[176:191], a[44:47], a[132:135], v[176:191]
    buffer_load_dwordx4 v2, s[8:11], s48 offen offset:1024 sc1 lds
    s_waitcnt lgkmcnt(6)
    v_mfma_f32_32x32x16_bf16 v[80:95], a[40:43], a[136:139], v[80:95]
    ds_read_b128 a[108:111], v6 offset:14336
    v_mfma_f32_32x32x16_bf16 v[192:207], a[44:47], a[136:139], v[192:207]
    s_waitcnt lgkmcnt(6)
    v_mfma_f32_32x32x16_bf16 v[96:111], a[40:43], a[140:143], v[96:111]
    ds_read_b128 a[112:115], v6 offset:18432
    v_mfma_f32_32x32x16_bf16 v[208:223], a[44:47], a[140:143], v[208:223]
    buffer_load_dwordx4 v2, s[8:11], s48 offen offset:2048 sc1 lds
    s_waitcnt lgkmcnt(6)
    v_mfma_f32_32x32x16_bf16 v[112:127], a[40:43], a[144:147], v[112:127]
    ds_read_b128 a[116:119], v6 offset:22528
    v_mfma_f32_32x32x16_bf16 v[224:239], a[44:47], a[144:147], v[224:239]
    s_waitcnt lgkmcnt(6)
    v_mfma_f32_32x32x16_bf16 v[128:143], a[40:43], a[148:151], v[128:143]
    ds_read_b128 a[120:123], v6 offset:26624
    v_mfma_f32_32x32x16_bf16 v[240:255], a[44:47], a[148:151], v[240:255]
    buffer_load_dwordx4 v2, s[8:11], s48 offen offset:3072 sc1 lds
    s_add_u32 s48, s48, 4096
    s_waitcnt lgkmcnt(6)
    v_mfma_f32_32x32x16_bf16 v[32:47], a[48:51], a[96:99], v[32:47]
    ds_read_b128 a[124:127], v6 offset:3072
    v_mfma_f32_32x32x16_bf16 v[144:159], a[52:55], a[96:99], v[144:159]
    buffer_load_dwordx4 a[0:3], v3, s[8:11], s49 offen offset:0 sc1
    s_waitcnt lgkmcnt(6)
    v_mfma_f32_32x32x16_bf16 v[48:63], a[48:51], a[100:103], v[48:63]
    ds_read_b128 a[128:131], v6 offset:7168
    v_mfma_f32_32x32x16_bf16 v[160:175], a[52:55], a[100:103], v[160:175]
    s_waitcnt lgkmcnt(6)
    v_mfma_f32_32x32x16_bf16 v[64:79], a[48:51], a[104:107], v[64:79]
    ds_read_b128 a[132:135], v6 offset:11264
    v_mfma_f32_32x32x16_bf16 v[176:191], a[52:55], a[104:107], v[176:191]
    buffer_load_dwordx4 a[8:11], v3, s[8:11], s49 offen offset:1024 sc1
    s_waitcnt lgkmcnt(6)
    v_mfma_f32_32x32x16_bf16 v[80:95], a[48:51], a[108:111], v[80:95]
    ds_read_b128 a[136:139], v6 offset:15360
    v_mfma_f32_32x32x16_bf16 v[192:207], a[52:55], a[108:111], v[192:207]
    s_waitcnt lgkmcnt(6)
    v_mfma_f32_32x32x16_bf16 v[96:111], a[48:51], a[112:115], v[96:111]
    ds_read_b128 a[140:143], v6 offset:19456
    v_mfma_f32_32x32x16_bf16 v[208:223], a[52:55], a[112:115], v[208:223]
    buffer_load_dwordx4 a[16:19], v3, s[8:11], s49 offen offset:2048 sc1
    s_waitcnt lgkmcnt(6)
    v_mfma_f32_32x32x16_bf16 v[112:127], a[48:51], a[116:119], v[112:127]
    ds_read_b128 a[144:147], v6 offset:23552
    v_mfma_f32_32x32x16_bf16 v[224:239], a[52:55], a[116:119], v[224:239]
    s_waitcnt lgkmcnt(6)
    v_mfma_f32_32x32x16_bf16 v[128:143], a[48:51], a[120:123], v[128:143]
    ds_read_b128 a[148:151], v6 offset:27648
    v_mfma_f32_32x32x16_bf16 v[240:255], a[52:55], a[120:123], v[240:255]
    buffer_load_dwordx4 a[24:27], v3, s[8:11], s49 offen offset:3072 sc1
    s_waitcnt lgkmcnt(6)
    v_mfma_f32_32x32x16_bf16 v[32:47], a[56:59], a[124:127], v[32:47]
    v_mfma_f32_32x32x16_bf16 v[144:159], a[60:63], a[124:127], v[144:159]
    s_add_u32 s51, s49, 28672
    buffer_load_dwordx4 a[4:7], v3, s[8:11], s51 offen offset:0 sc1
    s_waitcnt lgkmcnt(5)
    v_mfma_f32_32x32x16_bf16 v[48:63], a[56:59], a[128:131], v[48:63]
    v_mfma_f32_32x32x16_bf16 v[160:175], a[60:63], a[128:131], v[160:175]
    s_waitcnt lgkmcnt(4)
    v_mfma_f32_32x32x16_bf16 v[64:79], a[56:59], a[132:135], v[64:79]
    v_mfma_f32_32x32x16_bf16 v[176:191], a[60:63], a[132:135], v[176:191]
    buffer_load_dwordx4 a[12:15], v3, s[8:11], s51 offen offset:1024 sc1
    s_waitcnt lgkmcnt(3)
    v_mfma_f32_32x32x16_bf16 v[80:95], a[56:59], a[136:139], v[80:95]
    v_mfma_f32_32x32x16_bf16 v[192:207], a[60:63], a[136:139], v[192:207]
    s_waitcnt lgkmcnt(2)
    v_mfma_f32_32x32x16_bf16 v[96:111], a[56:59], a[140:143], v[96:111]
    v_mfma_f32_32x32x16_bf16 v[208:223], a[60:63], a[140:143], v[208:223]
    buffer_load_dwordx4 a[20:23], v3, s[8:11], s51 offen offset:2048 sc1
    s_waitcnt lgkmcnt(1)
    v_mfma_f32_32x32x16_bf16 v[112:127], a[56:59], a[144:147], v[112:127]
    v_mfma_f32_32x32x16_bf16 v[224:239], a[60:63], a[144:147], v[224:239]
    s_waitcnt lgkmcnt(0)
    v_mfma_f32_32x32x16_bf16 v[128:143], a[56:59], a[148:151], v[128:143]
    v_mfma_f32_32x32x16_bf16 v[240:255], a[60:63], a[148:151], v[240:255]
    buffer_load_dwordx4 a[28:31], v3, s[8:11], s51 offen offset:3072 sc1
    s_add_u32 s49, s49, 4096
    s_waitcnt vmcnt(16)
    s_barrier
    ds_read_b128 a[96:99], v7 offset:0
    ds_read_b128 a[100:103], v7 offset:4096
    ds_read_b128 a[104:107], v7 offset:8192
    ds_read_b128 a[108:111], v7 offset:12288
    ds_read_b128 a[112:115], v7 offset:16384
    ds_read_b128 a[116:119], v7 offset:20480
    ds_read_b128 a[120:123], v7 offset:24576
    s_waitcnt lgkmcnt(6)
    v_mfma_f32_32x32x16_bf16 v[32:47], a[64:67], a[96:99], v[32:47]
    ds_read_b128 a[124:127], v7 offset:1024
    v_mfma_f32_32x32x16_bf16 v[144:159], a[68:71], a[96:99], v[144:159]
    s_add_u32 s50, s45, 28672
    s_mov_b32 m0, s50
    s_nop 0
    buffer_load_dwordx4 v2, s[8:11], s47 offen sc1 lds
    s_waitcnt lgkmcnt(6)
    v_mfma_f32_32x32x16_bf16 v[48:63], a[64:67], a[100:103], v[48:63]
    ds_read_b128 a[128:131], v7 offset:5120
    v_mfma_f32_32x32x16_bf16 v[160:175], a[68:71], a[100:103], v[160:175]
    s_waitcnt lgkmcnt(6)
    v_mfma_f32_32x32x16_bf16 v[64:79], a[64:67], a[104:107], v[64:79]
    ds_read_b128 a[132:135], v7 offset:9216
    v_mfma_f32_32x32x16_bf16 v[176:191], a[68:71], a[104:107], v[176:191]
    buffer_load_dwordx4 v2, s[8:11], s47 offen offset:1024 sc1 lds
    s_waitcnt lgkmcnt(6)
    v_mfma_f32_32x32x16_bf16 v[80:95], a[64:67], a[108:111], v[80:95]
    ds_read_b128 a[136:139], v7 offset:13312
    v_mfma_f32_32x32x16_bf16 v[192:207], a[68:71], a[108:111], v[192:207]
    s_waitcnt lgkmcnt(6)
    v_mfma_f32_32x32x16_bf16 v[96:111], a[64:67], a[112:115], v[96:111]
    ds_read_b128 a[140:143], v7 offset:17408
    v_mfma_f32_32x32x16_bf16 v[208:223], a[68:71], a[112:115], v[208:223]
    buffer_load_dwordx4 v2, s[8:11], s47 offen offset:2048 sc1 lds
    s_waitcnt lgkmcnt(6)
    v_mfma_f32_32x32x16_bf16 v[112:127], a[64:67], a[116:119], v[112:127]
    ds_read_b128 a[144:147], v7 offset:21504
    v_mfma_f32_32x32x16_bf16 v[224:239], a[68:71], a[116:119], v[224:239]
    s_waitcnt lgkmcnt(6)
    v_mfma_f32_32x32x16_bf16 v[128:143], a[64:67], a[120:123], v[128:143]
    ds_read_b128 a[148:151], v7 offset:25600
    v_mfma_f32_32x32x16_bf16 v[240:255], a[68:71], a[120:123], v[240:255]
    buffer_load_dwordx4 v2, s[8:11], s47 offen offset:3072 sc1 lds
    s_add_u32 s47, s47, 4096
    s_waitcnt lgkmcnt(6)
    v_mfma_f32_32x32x16_bf16 v[32:47], a[72:75], a[124:127], v[32:47]
    ds_read_b128 a[96:99], v7 offset:2048
    v_mfma_f32_32x32x16_bf16 v[144:159], a[76:79], a[124:127], v[144:159]
    s_add_u32 s50, s46, 28672
    s_mov_b32 m0, s50
    s_nop 0
    buffer_load_dwordx4 v2, s[8:11], s48 offen sc1 lds
    s_waitcnt lgkmcnt(6)
    v_mfma_f32_32x32x16_bf16 v[48:63], a[72:75], a[128:131], v[48:63]
    ds_read_b128 a[100:103], v7 offset:6144
    v_mfma_f32_32x32x16_bf16 v[160:175], a[76:79], a[128:131], v[160:175]
    s_waitcnt lgkmcnt(6)
    v_mfma_f32_32x32x16_bf16 v[64:79], a[72:75], a[132:135], v[64:79]
    ds_read_b128 a[104:107], v7 offset:10240
    v_mfma_f32_32x32x16_bf16 v[176:191], a[76:79], a[132:135], v[176:191]
    buffer_load_dwordx4 v2, s[8:11], s48 offen offset:1024 sc1 lds
    s_waitcnt lgkmcnt(6)
    v_mfma_f32_32x32x16_bf16 v[80:95], a[72:75], a[136:139], v[80:95]
    ds_read_b128 a[108:111], v7 offset:14336
    v_mfma_f32_32x32x16_bf16 v[192:207], a[76:79], a[136:139], v[192:207]
    s_waitcnt lgkmcnt(6)
    v_mfma_f32_32x32x16_bf16 v[96:111], a[72:75], a[140:143], v[96:111]
    ds_read_b128 a[112:115], v7 offset:18432
    v_mfma_f32_32x32x16_bf16 v[208:223], a[76:79], a[140:143], v[208:223]
    buffer_load_dwordx4 v2, s[8:11], s48 offen offset:2048 sc1 lds
    s_waitcnt lgkmcnt(6)
    v_mfma_f32_32x32x16_bf16 v[112:127], a[72:75], a[144:147], v[112:127]
    ds_read_b128 a[116:119], v7 offset:22528
    v_mfma_f32_32x32x16_bf16 v[224:239], a[76:79], a[144:147], v[224:239]
    s_waitcnt lgkmcnt(6)
    v_mfma_f32_32x32x16_bf16 v[128:143], a[72:75], a[148:151], v[128:143]
    ds_read_b128 a[120:123], v7 offset:26624
    v_mfma_f32_32x32x16_bf16 v[240:255], a[76:79], a[148:151], v[240:255]
    buffer_load_dwordx4 v2, s[8:11], s48 offen offset:3072 sc1 lds
    s_add_u32 s48, s48, 4096
    s_waitcnt lgkmcnt(6)
    v_mfma_f32_32x32x16_bf16 v[32:47], a[80:83], a[96:99], v[32:47]
    ds_read_b128 a[124:127], v7 offset:3072
    v_mfma_f32_32x32x16_bf16 v[144:159], a[84:87], a[96:99], v[144:159]
    buffer_load_dwordx4 a[32:35], v3, s[8:11], s49 offen offset:0 sc1
    s_waitcnt lgkmcnt(6)
    v_mfma_f32_32x32x16_bf16 v[48:63], a[80:83], a[100:103], v[48:63]
    ds_read_b128 a[128:131], v7 offset:7168
    v_mfma_f32_32x32x16_bf16 v[160:175], a[84:87], a[100:103], v[160:175]
    s_waitcnt lgkmcnt(6)
    v_mfma_f32_32x32x16_bf16 v[64:79], a[80:83], a[104:107], v[64:79]
    ds_read_b128 a[132:135], v7 offset:11264
    v_mfma_f32_32x32x16_bf16 v[176:191], a[84:87], a[104:107], v[176:191]
    buffer_load_dwordx4 a[40:43], v3, s[8:11], s49 offen offset:1024 sc1
    s_waitcnt lgkmcnt(6)
    v_mfma_f32_32x32x16_bf16 v[80:95], a[80:83], a[108:111], v[80:95]
    ds_read_b128 a[136:139], v7 offset:15360
    v_mfma_f32_32x32x16_bf16 v[192:207], a[84:87], a[108:111], v[192:207]
    s_waitcnt lgkmcnt(6)
    v_mfma_f32_32x32x16_bf16 v[96:111], a[80:83], a[112:115], v[96:111]
    ds_read_b128 a[140:143], v7 offset:19456
    v_mfma_f32_32x32x16_bf16 v[208:223], a[84:87], a[112:115], v[208:223]
    buffer_load_dwordx4 a[48:51], v3, s[8:11], s49 offen offset:2048 sc1
    s_waitcnt lgkmcnt(6)
    v_mfma_f32_32x32x16_bf16 v[112:127], a[80:83], a[116:119], v[112:127]
    ds_read_b128 a[144:147], v7 offset:23552
    v_mfma_f32_32x32x16_bf16 v[224:239], a[84:87], a[116:119], v[224:239]
    s_waitcnt lgkmcnt(6)
    v_mfma_f32_32x32x16_bf16 v[128:143], a[80:83], a[120:123], v[128:143]
    ds_read_b128 a[148:151], v7 offset:27648
    v_mfma_f32_32x32x16_bf16 v[240:255], a[84:87], a[120:123], v[240:255]
    buffer_load_dwordx4 a[56:59], v3, s[8:11], s49 offen offset:3072 sc1
    s_waitcnt lgkmcnt(6)
    v_mfma_f32_32x32x16_bf16 v[32:47], a[88:91], a[124:127], v[32:47]
    v_mfma_f32_32x32x16_bf16 v[144:159], a[92:95], a[124:127], v[144:159]
    s_add_u32 s51, s49, 28672
    buffer_load_dwordx4 a[36:39], v3, s[8:11], s51 offen offset:0 sc1
    s_waitcnt lgkmcnt(5)
    v_mfma_f32_32x32x16_bf16 v[48:63], a[88:91], a[128:131], v[48:63]
    v_mfma_f32_32x32x16_bf16 v[160:175], a[92:95], a[128:131], v[160:175]
    s_waitcnt lgkmcnt(4)
    v_mfma_f32_32x32x16_bf16 v[64:79], a[88:91], a[132:135], v[64:79]
    v_mfma_f32_32x32x16_bf16 v[176:191], a[92:95], a[132:135], v[176:191]
    buffer_load_dwordx4 a[44:47], v3, s[8:11], s51 offen offset:1024 sc1
    s_waitcnt lgkmcnt(3)
    v_mfma_f32_32x32x16_bf16 v[80:95], a[88:91], a[136:139], v[80:95]
    v_mfma_f32_32x32x16_bf16 v[192:207], a[92:95], a[136:139], v[192:207]
    s_waitcnt lgkmcnt(2)
    v_mfma_f32_32x32x16_bf16 v[96:111], a[88:91], a[140:143], v[96:111]
    v_mfma_f32_32x32x16_bf16 v[208:223], a[92:95], a[140:143], v[208:223]
    buffer_load_dwordx4 a[52:55], v3, s[8:11], s51 offen offset:2048 sc1
    s_waitcnt lgkmcnt(1)
    v_mfma_f32_32x32x16_bf16 v[112:127], a[88:91], a[144:147], v[112:127]
    v_mfma_f32_32x32x16_bf16 v[224:239], a[92:95], a[144:147], v[224:239]
    s_waitcnt lgkmcnt(0)
    v_mfma_f32_32x32x16_bf16 v[128:143], a[88:91], a[148:151], v[128:143]
    v_mfma_f32_32x32x16_bf16 v[240:255], a[92:95], a[148:151], v[240:255]
    buffer_load_dwordx4 a[60:63], v3, s[8:11], s51 offen offset:3072 sc1
    s_add_u32 s49, s49, 4096
    s_waitcnt vmcnt(16)
    s_barrier
    ds_read_b128 a[96:99], v5 offset:0
    ds_read_b128 a[100:103], v5 offset:4096
    ds_read_b128 a[104:107], v5 offset:8192
    ds_read_b128 a[108:111], v5 offset:12288
    ds_read_b128 a[112:115], v5 offset:16384
    ds_read_b128 a[116:119], v5 offset:20480
    ds_read_b128 a[120:123], v5 offset:24576
    s_waitcnt lgkmcnt(6)
    v_mfma_f32_32x32x16_bf16 v[32:47], a[0:3], a[96:99], v[32:47]
    ds_read_b128 a[124:127], v5 offset:1024
    v_mfma_f32_32x32x16_bf16 v[144:159], a[4:7], a[96:99], v[144:159]
    s_add_u32 s50, s45, 57344
    s_mov_b32 m0, s50
    s_nop 0
    buffer_load_dwordx4 v2, s[8:11], s47 offen sc1 lds
    s_waitcnt lgkmcnt(6)
    v_mfma_f32_32x32x16_bf16 v[48:63], a[0:3], a[100:103], v[48:63]
    ds_read_b128 a[128:131], v5 offset:5120
    v_mfma_f32_32x32x16_bf16 v[160:175], a[4:7], a[100:103], v[160:175]
    s_waitcnt lgkmcnt(6)
    v_mfma_f32_32x32x16_bf16 v[64:79], a[0:3], a[104:107], v[64:79]
    ds_read_b128 a[132:135], v5 offset:9216
    v_mfma_f32_32x32x16_bf16 v[176:191], a[4:7], a[104:107], v[176:191]
    buffer_load_dwordx4 v2, s[8:11], s47 offen offset:1024 sc1 lds
    s_waitcnt lgkmcnt(6)
    v_mfma_f32_32x32x16_bf16 v[80:95], a[0:3], a[108:111], v[80:95]
    ds_read_b128 a[136:139], v5 offset:13312
    v_mfma_f32_32x32x16_bf16 v[192:207], a[4:7], a[108:111], v[192:207]
    s_waitcnt lgkmcnt(6)
    v_mfma_f32_32x32x16_bf16 v[96:111], a[0:3], a[112:115], v[96:111]
    ds_read_b128 a[140:143], v5 offset:17408
    v_mfma_f32_32x32x16_bf16 v[208:223], a[4:7], a[112:115], v[208:223]
    buffer_load_dwordx4 v2, s[8:11], s47 offen offset:2048 sc1 lds
    s_waitcnt lgkmcnt(6)
    v_mfma_f32_32x32x16_bf16 v[112:127], a[0:3], a[116:119], v[112:127]
    ds_read_b128 a[144:147], v5 offset:21504
    v_mfma_f32_32x32x16_bf16 v[224:239], a[4:7], a[116:119], v[224:239]
    s_waitcnt lgkmcnt(6)
    v_mfma_f32_32x32x16_bf16 v[128:143], a[0:3], a[120:123], v[128:143]
    ds_read_b128 a[148:151], v5 offset:25600
    v_mfma_f32_32x32x16_bf16 v[240:255], a[4:7], a[120:123], v[240:255]
    buffer_load_dwordx4 v2, s[8:11], s47 offen offset:3072 sc1 lds
    s_add_u32 s47, s47, 4096
    s_waitcnt lgkmcnt(6)
    v_mfma_f32_32x32x16_bf16 v[32:47], a[8:11], a[124:127], v[32:47]
    ds_read_b128 a[96:99], v5 offset:2048
    v_mfma_f32_32x32x16_bf16 v[144:159], a[12:15], a[124:127], v[144:159]
    s_add_u32 s50, s46, 57344
    s_mov_b32 m0, s50
    s_nop 0
    buffer_load_dwordx4 v2, s[8:11], s48 offen sc1 lds
    s_waitcnt lgkmcnt(6)
    v_mfma_f32_32x32x16_bf16 v[48:63], a[8:11], a[128:131], v[48:63]
    ds_read_b128 a[100:103], v5 offset:6144
    v_mfma_f32_32x32x16_bf16 v[160:175], a[12:15], a[128:131], v[160:175]
    s_waitcnt lgkmcnt(6)
    v_mfma_f32_32x32x16_bf16 v[64:79], a[8:11], a[132:135], v[64:79]
    ds_read_b128 a[104:107], v5 offset:10240
    v_mfma_f32_32x32x16_bf16 v[176:191], a[12:15], a[132:135], v[176:191]
    buffer_load_dwordx4 v2, s[8:11], s48 offen offset:1024 sc1 lds
    s_waitcnt lgkmcnt(6)
    v_mfma_f32_32x32x16_bf16 v[80:95], a[8:11], a[136:139], v[80:95]
    ds_read_b128 a[108:111], v5 offset:14336
    v_mfma_f32_32x32x16_bf16 v[192:207], a[12:15], a[136:139], v[192:207]
    s_waitcnt lgkmcnt(6)
    v_mfma_f32_32x32x16_bf16 v[96:111], a[8:11], a[140:143], v[96:111]
    ds_read_b128 a[112:115], v5 offset:18432
    v_mfma_f32_32x32x16_bf16 v[208:223], a[12:15], a[140:143], v[208:223]
    buffer_load_dwordx4 v2, s[8:11], s48 offen offset:2048 sc1 lds
    s_waitcnt lgkmcnt(6)
    v_mfma_f32_32x32x16_bf16 v[112:127], a[8:11], a[144:147], v[112:127]
    ds_read_b128 a[116:119], v5 offset:22528
    v_mfma_f32_32x32x16_bf16 v[224:239], a[12:15], a[144:147], v[224:239]
    s_waitcnt lgkmcnt(6)
    v_mfma_f32_32x32x16_bf16 v[128:143], a[8:11], a[148:151], v[128:143]
    ds_read_b128 a[120:123], v5 offset:26624
    v_mfma_f32_32x32x16_bf16 v[240:255], a[12:15], a[148:151], v[240:255]
    buffer_load_dwordx4 v2, s[8:11], s48 offen offset:3072 sc1 lds
    s_add_u32 s48, s48, 4096
    s_waitcnt lgkmcnt(6)
    v_mfma_f32_32x32x16_bf16 v[32:47], a[16:19], a[96:99], v[32:47]
    ds_read_b128 a[124:127], v5 offset:3072
    v_mfma_f32_32x32x16_bf16 v[144:159], a[20:23], a[96:99], v[144:159]
    buffer_load_dwordx4 a[64:67], v3, s[8:11], s49 offen offset:0 sc1
    s_waitcnt lgkmcnt(6)
    v_mfma_f32_32x32x16_bf16 v[48:63], a[16:19], a[100:103], v[48:63]
    ds_read_b128 a[128:131], v5 offset:7168
    v_mfma_f32_32x32x16_bf16 v[160:175], a[20:23], a[100:103], v[160:175]
    s_waitcnt lgkmcnt(6)
    v_mfma_f32_32x32x16_bf16 v[64:79], a[16:19], a[104:107], v[64:79]
    ds_read_b128 a[132:135], v5 offset:11264
    v_mfma_f32_32x32x16_bf16 v[176:191], a[20:23], a[104:107], v[176:191]
    buffer_load_dwordx4 a[72:75], v3, s[8:11], s49 offen offset:1024 sc1
    s_waitcnt lgkmcnt(6)
    v_mfma_f32_32x32x16_bf16 v[80:95], a[16:19], a[108:111], v[80:95]
    ds_read_b128 a[136:139], v5 offset:15360
    v_mfma_f32_32x32x16_bf16 v[192:207], a[20:23], a[108:111], v[192:207]
    s_waitcnt lgkmcnt(6)
    v_mfma_f32_32x32x16_bf16 v[96:111], a[16:19], a[112:115], v[96:111]
    ds_read_b128 a[140:143], v5 offset:19456
    v_mfma_f32_32x32x16_bf16 v[208:223], a[20:23], a[112:115], v[208:223]
    buffer_load_dwordx4 a[80:83], v3, s[8:11], s49 offen offset:2048 sc1
    s_waitcnt lgkmcnt(6)
    v_mfma_f32_32x32x16_bf16 v[112:127], a[16:19], a[116:119], v[112:127]
    ds_read_b128 a[144:147], v5 offset:23552
    v_mfma_f32_32x32x16_bf16 v[224:239], a[20:23], a[116:119], v[224:239]
    s_waitcnt lgkmcnt(6)
    v_mfma_f32_32x32x16_bf16 v[128:143], a[16:19], a[120:123], v[128:143]
    ds_read_b128 a[148:151], v5 offset:27648
    v_mfma_f32_32x32x16_bf16 v[240:255], a[20:23], a[120:123], v[240:255]
    buffer_load_dwordx4 a[88:91], v3, s[8:11], s49 offen offset:3072 sc1
    s_waitcnt lgkmcnt(6)
    v_mfma_f32_32x32x16_bf16 v[32:47], a[24:27], a[124:127], v[32:47]
    v_mfma_f32_32x32x16_bf16 v[144:159], a[28:31], a[124:127], v[144:159]
    s_add_u32 s51, s49, 28672
    buffer_load_dwordx4 a[68:71], v3, s[8:11], s51 offen offset:0 sc1
    s_waitcnt lgkmcnt(5)
    v_mfma_f32_32x32x16_bf16 v[48:63], a[24:27], a[128:131], v[48:63]
    v_mfma_f32_32x32x16_bf16 v[160:175], a[28:31], a[128:131], v[160:175]
    s_waitcnt lgkmcnt(4)
    v_mfma_f32_32x32x16_bf16 v[64:79], a[24:27], a[132:135], v[64:79]
    v_mfma_f32_32x32x16_bf16 v[176:191], a[28:31], a[132:135], v[176:191]
    buffer_load_dwordx4 a[76:79], v3, s[8:11], s51 offen offset:1024 sc1
    s_waitcnt lgkmcnt(3)
    v_mfma_f32_32x32x16_bf16 v[80:95], a[24:27], a[136:139], v[80:95]
    v_mfma_f32_32x32x16_bf16 v[192:207], a[28:31], a[136:139], v[192:207]
    s_waitcnt lgkmcnt(2)
    v_mfma_f32_32x32x16_bf16 v[96:111], a[24:27], a[140:143], v[96:111]
    v_mfma_f32_32x32x16_bf16 v[208:223], a[28:31], a[140:143], v[208:223]
    buffer_load_dwordx4 a[84:87], v3, s[8:11], s51 offen offset:2048 sc1
    s_waitcnt lgkmcnt(1)
    v_mfma_f32_32x32x16_bf16 v[112:127], a[24:27], a[144:147], v[112:127]
    v_mfma_f32_32x32x16_bf16 v[224:239], a[28:31], a[144:147], v[224:239]
    s_waitcnt lgkmcnt(0)
    v_mfma_f32_32x32x16_bf16 v[128:143], a[24:27], a[148:151], v[128:143]
    v_mfma_f32_32x32x16_bf16 v[240:255], a[28:31], a[148:151], v[240:255]
    buffer_load_dwordx4 a[92:95], v3, s[8:11], s51 offen offset:3072 sc1
    s_add_u32 s49, s49, 4096
    s_waitcnt vmcnt(16)
    s_barrier
    ds_read_b128 a[96:99], v6 offset:0
    ds_read_b128 a[100:103], v6 offset:4096
    ds_read_b128 a[104:107], v6 offset:8192
    ds_read_b128 a[108:111], v6 offset:12288
    ds_read_b128 a[112:115], v6 offset:16384
    ds_read_b128 a[116:119], v6 offset:20480
    ds_read_b128 a[120:123], v6 offset:24576
    s_waitcnt lgkmcnt(6)
    v_mfma_f32_32x32x16_bf16 v[32:47], a[32:35], a[96:99], v[32:47]
    ds_read_b128 a[124:127], v6 offset:1024
    v_mfma_f32_32x32x16_bf16 v[144:159], a[36:39], a[96:99], v[144:159]
    s_add_u32 s50, s45, 0
    s_mov_b32 m0, s50
    s_nop 0
    buffer_load_dwordx4 v2, s[8:11], s47 offen sc1 lds
    s_waitcnt lgkmcnt(6)
    v_mfma_f32_32x32x16_bf16 v[48:63], a[32:35], a[100:103], v[48:63]
    ds_read_b128 a[128:131], v6 offset:5120
    v_mfma_f32_32x32x16_bf16 v[160:175], a[36:39], a[100:103], v[160:175]
    s_waitcnt lgkmcnt(6)
    v_mfma_f32_32x32x16_bf16 v[64:79], a[32:35], a[104:107], v[64:79]
    ds_read_b128 a[132:135], v6 offset:9216
    v_mfma_f32_32x32x16_bf16 v[176:191], a[36:39], a[104:107], v[176:191]
    buffer_load_dwordx4 v2, s[8:11], s47 offen offset:1024 sc1 lds
    s_waitcnt lgkmcnt(6)
    v_mfma_f32_32x32x16_bf16 v[80:95], a[32:35], a[108:111], v[80:95]
    ds_read_b128 a[136:139], v6 offset:13312
    v_mfma_f32_32x32x16_bf16 v[192:207], a[36:39], a[108:111], v[192:207]
    s_waitcnt lgkmcnt(6)
    v_mfma_f32_32x32x16_bf16 v[96:111], a[32:35], a[112:115], v[96:111]
    ds_read_b128 a[140:143], v6 offset:17408
    v_mfma_f32_32x32x16_bf16 v[208:223], a[36:39], a[112:115], v[208:223]
    buffer_load_dwordx4 v2, s[8:11], s47 offen offset:2048 sc1 lds
    s_waitcnt lgkmcnt(6)
    v_mfma_f32_32x32x16_bf16 v[112:127], a[32:35], a[116:119], v[112:127]
    ds_read_b128 a[144:147], v6 offset:21504
    v_mfma_f32_32x32x16_bf16 v[224:239], a[36:39], a[116:119], v[224:239]
    s_waitcnt lgkmcnt(6)
    v_mfma_f32_32x32x16_bf16 v[128:143], a[32:35], a[120:123], v[128:143]
    ds_read_b128 a[148:151], v6 offset:25600
    v_mfma_f32_32x32x16_bf16 v[240:255], a[36:39], a[120:123], v[240:255]
    buffer_load_dwordx4 v2, s[8:11], s47 offen offset:3072 sc1 lds
    s_add_u32 s47, s47, 4096
    s_waitcnt lgkmcnt(6)
    v_mfma_f32_32x32x16_bf16 v[32:47], a[40:43], a[124:127], v[32:47]
    ds_read_b128 a[96:99], v6 offset:2048
    v_mfma_f32_32x32x16_bf16 v[144:159], a[44:47], a[124:127], v[144:159]
    s_add_u32 s50, s46, 0
    s_mov_b32 m0, s50
    s_nop 0
    buffer_load_dwordx4 v2, s[8:11], s48 offen sc1 lds
    s_waitcnt lgkmcnt(6)
    v_mfma_f32_32x32x16_bf16 v[48:63], a[40:43], a[128:131], v[48:63]
    ds_read_b128 a[100:103], v6 offset:6144
    v_mfma_f32_32x32x16_bf16 v[160:175], a[44:47], a[128:131], v[160:175]
    s_waitcnt lgkmcnt(6)
    v_mfma_f32_32x32x16_bf16 v[64:79], a[40:43], a[132:135], v[64:79]
    ds_read_b128 a[104:107], v6 offset:10240
    v_mfma_f32_32x32x16_bf16 v[176:191], a[44:47], a[132:135], v[176:191]
    buffer_load_dwordx4 v2, s[8:11], s48 offen offset:1024 sc1 lds
    s_waitcnt lgkmcnt(6)
    v_mfma_f32_32x32x16_bf16 v[80:95], a[40:43], a[136:139], v[80:95]
    ds_read_b128 a[108:111], v6 offset:14336
    v_mfma_f32_32x32x16_bf16 v[192:207], a[44:47], a[136:139], v[192:207]
    s_waitcnt lgkmcnt(6)
    v_mfma_f32_32x32x16_bf16 v[96:111], a[40:43], a[140:143], v[96:111]
    ds_read_b128 a[112:115], v6 offset:18432
    v_mfma_f32_32x32x16_bf16 v[208:223], a[44:47], a[140:143], v[208:223]
    buffer_load_dwordx4 v2, s[8:11], s48 offen offset:2048 sc1 lds
    s_waitcnt lgkmcnt(6)
    v_mfma_f32_32x32x16_bf16 v[112:127], a[40:43], a[144:147], v[112:127]
    ds_read_b128 a[116:119], v6 offset:22528
    v_mfma_f32_32x32x16_bf16 v[224:239], a[44:47], a[144:147], v[224:239]
    s_waitcnt lgkmcnt(6)
    v_mfma_f32_32x32x16_bf16 v[128:143], a[40:43], a[148:151], v[128:143]
    ds_read_b128 a[120:123], v6 offset:26624
    v_mfma_f32_32x32x16_bf16 v[240:255], a[44:47], a[148:151], v[240:255]
    buffer_load_dwordx4 v2, s[8:11], s48 offen offset:3072 sc1 lds
    s_add_u32 s48, s48, 4096
    s_waitcnt lgkmcnt(6)
    v_mfma_f32_32x32x16_bf16 v[32:47], a[48:51], a[96:99], v[32:47]
    ds_read_b128 a[124:127], v6 offset:3072
    v_mfma_f32_32x32x16_bf16 v[144:159], a[52:55], a[96:99], v[144:159]
    buffer_load_dwordx4 a[0:3], v3, s[8:11], s49 offen offset:0 sc1
    s_waitcnt lgkmcnt(6)
    v_mfma_f32_32x32x16_bf16 v[48:63], a[48:51], a[100:103], v[48:63]
    ds_read_b128 a[128:131], v6 offset:7168
    v_mfma_f32_32x32x16_bf16 v[160:175], a[52:55], a[100:103], v[160:175]
    s_waitcnt lgkmcnt(6)
    v_mfma_f32_32x32x16_bf16 v[64:79], a[48:51], a[104:107], v[64:79]
    ds_read_b128 a[132:135], v6 offset:11264
    v_mfma_f32_32x32x16_bf16 v[176:191], a[52:55], a[104:107], v[176:191]
    buffer_load_dwordx4 a[8:11], v3, s[8:11], s49 offen offset:1024 sc1
    s_waitcnt lgkmcnt(6)
    v_mfma_f32_32x32x16_bf16 v[80:95], a[48:51], a[108:111], v[80:95]
    ds_read_b128 a[136:139], v6 offset:15360
    v_mfma_f32_32x32x16_bf16 v[192:207], a[52:55], a[108:111], v[192:207]
    s_waitcnt lgkmcnt(6)
    v_mfma_f32_32x32x16_bf16 v[96:111], a[48:51], a[112:115], v[96:111]
    ds_read_b128 a[140:143], v6 offset:19456
    v_mfma_f32_32x32x16_bf16 v[208:223], a[52:55], a[112:115], v[208:223]
    buffer_load_dwordx4 a[16:19], v3, s[8:11], s49 offen offset:2048 sc1
    s_waitcnt lgkmcnt(6)
    v_mfma_f32_32x32x16_bf16 v[112:127], a[48:51], a[116:119], v[112:127]
    ds_read_b128 a[144:147], v6 offset:23552
    v_mfma_f32_32x32x16_bf16 v[224:239], a[52:55], a[116:119], v[224:239]
    s_waitcnt lgkmcnt(6)
    v_mfma_f32_32x32x16_bf16 v[128:143], a[48:51], a[120:123], v[128:143]
    ds_read_b128 a[148:151], v6 offset:27648
    v_mfma_f32_32x32x16_bf16 v[240:255], a[52:55], a[120:123], v[240:255]
    buffer_load_dwordx4 a[24:27], v3, s[8:11], s49 offen offset:3072 sc1
    s_waitcnt lgkmcnt(6)
    v_mfma_f32_32x32x16_bf16 v[32:47], a[56:59], a[124:127], v[32:47]
    v_mfma_f32_32x32x16_bf16 v[144:159], a[60:63], a[124:127], v[144:159]
    s_add_u32 s51, s49, 28672
    buffer_load_dwordx4 a[4:7], v3, s[8:11], s51 offen offset:0 sc1
    s_waitcnt lgkmcnt(5)
    v_mfma_f32_32x32x16_bf16 v[48:63], a[56:59], a[128:131], v[48:63]
    v_mfma_f32_32x32x16_bf16 v[160:175], a[60:63], a[128:131], v[160:175]
    s_waitcnt lgkmcnt(4)
    v_mfma_f32_32x32x16_bf16 v[64:79], a[56:59], a[132:135], v[64:79]
    v_mfma_f32_32x32x16_bf16 v[176:191], a[60:63], a[132:135], v[176:191]
    buffer_load_dwordx4 a[12:15], v3, s[8:11], s51 offen offset:1024 sc1
    s_waitcnt lgkmcnt(3)
    v_mfma_f32_32x32x16_bf16 v[80:95], a[56:59], a[136:139], v[80:95]
    v_mfma_f32_32x32x16_bf16 v[192:207], a[60:63], a[136:139], v[192:207]
    s_waitcnt lgkmcnt(2)
    v_mfma_f32_32x32x16_bf16 v[96:111], a[56:59], a[140:143], v[96:111]
    v_mfma_f32_32x32x16_bf16 v[208:223], a[60:63], a[140:143], v[208:223]
    buffer_load_dwordx4 a[20:23], v3, s[8:11], s51 offen offset:2048 sc1
    s_waitcnt lgkmcnt(1)
    v_mfma_f32_32x32x16_bf16 v[112:127], a[56:59], a[144:147], v[112:127]
    v_mfma_f32_32x32x16_bf16 v[224:239], a[60:63], a[144:147], v[224:239]
    s_waitcnt lgkmcnt(0)
    v_mfma_f32_32x32x16_bf16 v[128:143], a[56:59], a[148:151], v[128:143]
    v_mfma_f32_32x32x16_bf16 v[240:255], a[60:63], a[148:151], v[240:255]
    buffer_load_dwordx4 a[28:31], v3, s[8:11], s51 offen offset:3072 sc1
    s_add_u32 s49, s49, 4096
    s_waitcnt vmcnt(16)
    s_barrier
    ds_read_b128 a[96:99], v7 offset:0
    ds_read_b128 a[100:103], v7 offset:4096
    ds_read_b128 a[104:107], v7 offset:8192
    ds_read_b128 a[108:111], v7 offset:12288
    ds_read_b128 a[112:115], v7 offset:16384
    ds_read_b128 a[116:119], v7 offset:20480
    ds_read_b128 a[120:123], v7 offset:24576
    s_waitcnt lgkmcnt(6)
    v_mfma_f32_32x32x16_bf16 v[32:47], a[64:67], a[96:99], v[32:47]
    ds_read_b128 a[124:127], v7 offset:1024
    v_mfma_f32_32x32x16_bf16 v[144:159], a[68:71], a[96:99], v[144:159]
    s_waitcnt lgkmcnt(6)
    v_mfma_f32_32x32x16_bf16 v[48:63], a[64:67], a[100:103], v[48:63]
    ds_read_b128 a[128:131], v7 offset:5120
    v_mfma_f32_32x32x16_bf16 v[160:175], a[68:71], a[100:103], v[160:175]
    s_waitcnt lgkmcnt(6)
    v_mfma_f32_32x32x16_bf16 v[64:79], a[64:67], a[104:107], v[64:79]
    ds_read_b128 a[132:135], v7 offset:9216
    v_mfma_f32_32x32x16_bf16 v[176:191], a[68:71], a[104:107], v[176:191]
    s_waitcnt lgkmcnt(6)
    v_mfma_f32_32x32x16_bf16 v[80:95], a[64:67], a[108:111], v[80:95]
    ds_read_b128 a[136:139], v7 offset:13312
    v_mfma_f32_32x32x16_bf16 v[192:207], a[68:71], a[108:111], v[192:207]
    s_waitcnt lgkmcnt(6)
    v_mfma_f32_32x32x16_bf16 v[96:111], a[64:67], a[112:115], v[96:111]
    ds_read_b128 a[140:143], v7 offset:17408
    v_mfma_f32_32x32x16_bf16 v[208:223], a[68:71], a[112:115], v[208:223]
    s_waitcnt lgkmcnt(6)
    v_mfma_f32_32x32x16_bf16 v[112:127], a[64:67], a[116:119], v[112:127]
    ds_read_b128 a[144:147], v7 offset:21504
    v_mfma_f32_32x32x16_bf16 v[224:239], a[68:71], a[116:119], v[224:239]
    s_waitcnt lgkmcnt(6)
    v_mfma_f32_32x32x16_bf16 v[128:143], a[64:67], a[120:123], v[128:143]
    ds_read_b128 a[148:151], v7 offset:25600
    v_mfma_f32_32x32x16_bf16 v[240:255], a[68:71], a[120:123], v[240:255]
    s_waitcnt lgkmcnt(6)
    v_mfma_f32_32x32x16_bf16 v[32:47], a[72:75], a[124:127], v[32:47]
    ds_read_b128 a[96:99], v7 offset:2048
    v_mfma_f32_32x32x16_bf16 v[144:159], a[76:79], a[124:127], v[144:159]
    s_waitcnt lgkmcnt(6)
    v_mfma_f32_32x32x16_bf16 v[48:63], a[72:75], a[128:131], v[48:63]
    ds_read_b128 a[100:103], v7 offset:6144
    v_mfma_f32_32x32x16_bf16 v[160:175], a[76:79], a[128:131], v[160:175]
    s_waitcnt lgkmcnt(6)
    v_mfma_f32_32x32x16_bf16 v[64:79], a[72:75], a[132:135], v[64:79]
    ds_read_b128 a[104:107], v7 offset:10240
    v_mfma_f32_32x32x16_bf16 v[176:191], a[76:79], a[132:135], v[176:191]
    s_waitcnt lgkmcnt(6)
    v_mfma_f32_32x32x16_bf16 v[80:95], a[72:75], a[136:139], v[80:95]
    ds_read_b128 a[108:111], v7 offset:14336
    v_mfma_f32_32x32x16_bf16 v[192:207], a[76:79], a[136:139], v[192:207]
    s_waitcnt lgkmcnt(6)
    v_mfma_f32_32x32x16_bf16 v[96:111], a[72:75], a[140:143], v[96:111]
    ds_read_b128 a[112:115], v7 offset:18432
    v_mfma_f32_32x32x16_bf16 v[208:223], a[76:79], a[140:143], v[208:223]
    s_waitcnt lgkmcnt(6)
    v_mfma_f32_32x32x16_bf16 v[112:127], a[72:75], a[144:147], v[112:127]
    ds_read_b128 a[116:119], v7 offset:22528
    v_mfma_f32_32x32x16_bf16 v[224:239], a[76:79], a[144:147], v[224:239]
    s_waitcnt lgkmcnt(6)
    v_mfma_f32_32x32x16_bf16 v[128:143], a[72:75], a[148:151], v[128:143]
    ds_read_b128 a[120:123], v7 offset:26624
    v_mfma_f32_32x32x16_bf16 v[240:255], a[76:79], a[148:151], v[240:255]
    s_waitcnt lgkmcnt(6)
    v_mfma_f32_32x32x16_bf16 v[32:47], a[80:83], a[96:99], v[32:47]
    ds_read_b128 a[124:127], v7 offset:3072
    v_mfma_f32_32x32x16_bf16 v[144:159], a[84:87], a[96:99], v[144:159]
    s_waitcnt lgkmcnt(6)
    v_mfma_f32_32x32x16_bf16 v[48:63], a[80:83], a[100:103], v[48:63]
    ds_read_b128 a[128:131], v7 offset:7168
    v_mfma_f32_32x32x16_bf16 v[160:175], a[84:87], a[100:103], v[160:175]
    s_waitcnt lgkmcnt(6)
    v_mfma_f32_32x32x16_bf16 v[64:79], a[80:83], a[104:107], v[64:79]
    ds_read_b128 a[132:135], v7 offset:11264
    v_mfma_f32_32x32x16_bf16 v[176:191], a[84:87], a[104:107], v[176:191]
    s_waitcnt lgkmcnt(6)
    v_mfma_f32_32x32x16_bf16 v[80:95], a[80:83], a[108:111], v[80:95]
    ds_read_b128 a[136:139], v7 offset:15360
    v_mfma_f32_32x32x16_bf16 v[192:207], a[84:87], a[108:111], v[192:207]
    s_waitcnt lgkmcnt(6)
    v_mfma_f32_32x32x16_bf16 v[96:111], a[80:83], a[112:115], v[96:111]
    ds_read_b128 a[140:143], v7 offset:19456
    v_mfma_f32_32x32x16_bf16 v[208:223], a[84:87], a[112:115], v[208:223]
    s_waitcnt lgkmcnt(6)
    v_mfma_f32_32x32x16_bf16 v[112:127], a[80:83], a[116:119], v[112:127]
    ds_read_b128 a[144:147], v7 offset:23552
    v_mfma_f32_32x32x16_bf16 v[224:239], a[84:87], a[116:119], v[224:239]
    s_waitcnt lgkmcnt(6)
    v_mfma_f32_32x32x16_bf16 v[128:143], a[80:83], a[120:123], v[128:143]
    ds_read_b128 a[148:151], v7 offset:27648
    v_mfma_f32_32x32x16_bf16 v[240:255], a[84:87], a[120:123], v[240:255]
    s_waitcnt lgkmcnt(6)
    v_mfma_f32_32x32x16_bf16 v[32:47], a[88:91], a[124:127], v[32:47]
    v_mfma_f32_32x32x16_bf16 v[144:159], a[92:95], a[124:127], v[144:159]
    s_waitcnt lgkmcnt(5)
    v_mfma_f32_32x32x16_bf16 v[48:63], a[88:91], a[128:131], v[48:63]
    v_mfma_f32_32x32x16_bf16 v[160:175], a[92:95], a[128:131], v[160:175]
    s_waitcnt lgkmcnt(4)
    v_mfma_f32_32x32x16_bf16 v[64:79], a[88:91], a[132:135], v[64:79]
    v_mfma_f32_32x32x16_bf16 v[176:191], a[92:95], a[132:135], v[176:191]
    s_waitcnt lgkmcnt(3)
    v_mfma_f32_32x32x16_bf16 v[80:95], a[88:91], a[136:139], v[80:95]
    v_mfma_f32_32x32x16_bf16 v[192:207], a[92:95], a[136:139], v[192:207]
    s_waitcnt lgkmcnt(2)
    v_mfma_f32_32x32x16_bf16 v[96:111], a[88:91], a[140:143], v[96:111]
    v_mfma_f32_32x32x16_bf16 v[208:223], a[92:95], a[140:143], v[208:223]
    s_waitcnt lgkmcnt(1)
    v_mfma_f32_32x32x16_bf16 v[112:127], a[88:91], a[144:147], v[112:127]
    v_mfma_f32_32x32x16_bf16 v[224:239], a[92:95], a[144:147], v[224:239]
    s_waitcnt lgkmcnt(0)
    v_mfma_f32_32x32x16_bf16 v[128:143], a[88:91], a[148:151], v[128:143]
    v_mfma_f32_32x32x16_bf16 v[240:255], a[92:95], a[148:151], v[240:255]
    s_waitcnt vmcnt(0)
    s_barrier
    ds_read_b128 a[96:99], v5 offset:0
    ds_read_b128 a[100:103], v5 offset:4096
    ds_read_b128 a[104:107], v5 offset:8192
    ds_read_b128 a[108:111], v5 offset:12288
    ds_read_b128 a[112:115], v5 offset:16384
    ds_read_b128 a[116:119], v5 offset:20480
    ds_read_b128 a[120:123], v5 offset:24576
    s_waitcnt lgkmcnt(6)
    v_mfma_f32_32x32x16_bf16 v[32:47], a[0:3], a[96:99], v[32:47]
    ds_read_b128 a[124:127], v5 offset:1024
    v_mfma_f32_32x32x16_bf16 v[144:159], a[4:7], a[96:99], v[144:159]
    s_waitcnt lgkmcnt(6)
    v_mfma_f32_32x32x16_bf16 v[48:63], a[0:3], a[100:103], v[48:63]
    ds_read_b128 a[128:131], v5 offset:5120
    v_mfma_f32_32x32x16_bf16 v[160:175], a[4:7], a[100:103], v[160:175]
    s_waitcnt lgkmcnt(6)
    v_mfma_f32_32x32x16_bf16 v[64:79], a[0:3], a[104:107], v[64:79]
    ds_read_b128 a[132:135], v5 offset:9216
    v_mfma_f32_32x32x16_bf16 v[176:191], a[4:7], a[104:107], v[176:191]
    s_waitcnt lgkmcnt(6)
    v_mfma_f32_32x32x16_bf16 v[80:95], a[0:3], a[108:111], v[80:95]
    ds_read_b128 a[136:139], v5 offset:13312
    v_mfma_f32_32x32x16_bf16 v[192:207], a[4:7], a[108:111], v[192:207]
    s_waitcnt lgkmcnt(6)
    v_mfma_f32_32x32x16_bf16 v[96:111], a[0:3], a[112:115], v[96:111]
    ds_read_b128 a[140:143], v5 offset:17408
    v_mfma_f32_32x32x16_bf16 v[208:223], a[4:7], a[112:115], v[208:223]
    s_waitcnt lgkmcnt(6)
    v_mfma_f32_32x32x16_bf16 v[112:127], a[0:3], a[116:119], v[112:127]
    ds_read_b128 a[144:147], v5 offset:21504
    v_mfma_f32_32x32x16_bf16 v[224:239], a[4:7], a[116:119], v[224:239]
    s_waitcnt lgkmcnt(6)
    v_mfma_f32_32x32x16_bf16 v[128:143], a[0:3], a[120:123], v[128:143]
    ds_read_b128 a[148:151], v5 offset:25600
    v_mfma_f32_32x32x16_bf16 v[240:255], a[4:7], a[120:123], v[240:255]
    s_waitcnt lgkmcnt(6)
    v_mfma_f32_32x32x16_bf16 v[32:47], a[8:11], a[124:127], v[32:47]
    ds_read_b128 a[96:99], v5 offset:2048
    v_mfma_f32_32x32x16_bf16 v[144:159], a[12:15], a[124:127], v[144:159]
    s_waitcnt lgkmcnt(6)
    v_mfma_f32_32x32x16_bf16 v[48:63], a[8:11], a[128:131], v[48:63]
    ds_read_b128 a[100:103], v5 offset:6144
    v_mfma_f32_32x32x16_bf16 v[160:175], a[12:15], a[128:131], v[160:175]
    s_waitcnt lgkmcnt(6)
    v_mfma_f32_32x32x16_bf16 v[64:79], a[8:11], a[132:135], v[64:79]
    ds_read_b128 a[104:107], v5 offset:10240
    v_mfma_f32_32x32x16_bf16 v[176:191], a[12:15], a[132:135], v[176:191]
    s_waitcnt lgkmcnt(6)
    v_mfma_f32_32x32x16_bf16 v[80:95], a[8:11], a[136:139], v[80:95]
    ds_read_b128 a[108:111], v5 offset:14336
    v_mfma_f32_32x32x16_bf16 v[192:207], a[12:15], a[136:139], v[192:207]
    s_waitcnt lgkmcnt(6)
    v_mfma_f32_32x32x16_bf16 v[96:111], a[8:11], a[140:143], v[96:111]
    ds_read_b128 a[112:115], v5 offset:18432
    v_mfma_f32_32x32x16_bf16 v[208:223], a[12:15], a[140:143], v[208:223]
    s_waitcnt lgkmcnt(6)
    v_mfma_f32_32x32x16_bf16 v[112:127], a[8:11], a[144:147], v[112:127]
    ds_read_b128 a[116:119], v5 offset:22528
    v_mfma_f32_32x32x16_bf16 v[224:239], a[12:15], a[144:147], v[224:239]
    s_waitcnt lgkmcnt(6)
    v_mfma_f32_32x32x16_bf16 v[128:143], a[8:11], a[148:151], v[128:143]
    ds_read_b128 a[120:123], v5 offset:26624
    v_mfma_f32_32x32x16_bf16 v[240:255], a[12:15], a[148:151], v[240:255]
    s_waitcnt lgkmcnt(6)
    v_mfma_f32_32x32x16_bf16 v[32:47], a[16:19], a[96:99], v[32:47]
    ds_read_b128 a[124:127], v5 offset:3072
    v_mfma_f32_32x32x16_bf16 v[144:159], a[20:23], a[96:99], v[144:159]
    s_waitcnt lgkmcnt(6)
    v_mfma_f32_32x32x16_bf16 v[48:63], a[16:19], a[100:103], v[48:63]
    ds_read_b128 a[128:131], v5 offset:7168
    v_mfma_f32_32x32x16_bf16 v[160:175], a[20:23], a[100:103], v[160:175]
    s_waitcnt lgkmcnt(6)
    v_mfma_f32_32x32x16_bf16 v[64:79], a[16:19], a[104:107], v[64:79]
    ds_read_b128 a[132:135], v5 offset:11264
    v_mfma_f32_32x32x16_bf16 v[176:191], a[20:23], a[104:107], v[176:191]
    s_waitcnt lgkmcnt(6)
    v_mfma_f32_32x32x16_bf16 v[80:95], a[16:19], a[108:111], v[80:95]
    ds_read_b128 a[136:139], v5 offset:15360
    v_mfma_f32_32x32x16_bf16 v[192:207], a[20:23], a[108:111], v[192:207]
    s_waitcnt lgkmcnt(6)
    v_mfma_f32_32x32x16_bf16 v[96:111], a[16:19], a[112:115], v[96:111]
    ds_read_b128 a[140:143], v5 offset:19456
    v_mfma_f32_32x32x16_bf16 v[208:223], a[20:23], a[112:115], v[208:223]
    s_waitcnt lgkmcnt(6)
    v_mfma_f32_32x32x16_bf16 v[112:127], a[16:19], a[116:119], v[112:127]
    ds_read_b128 a[144:147], v5 offset:23552
    v_mfma_f32_32x32x16_bf16 v[224:239], a[20:23], a[116:119], v[224:239]
    s_waitcnt lgkmcnt(6)
    v_mfma_f32_32x32x16_bf16 v[128:143], a[16:19], a[120:123], v[128:143]
    ds_read_b128 a[148:151], v5 offset:27648
    v_mfma_f32_32x32x16_bf16 v[240:255], a[20:23], a[120:123], v[240:255]
    s_waitcnt lgkmcnt(6)
    v_mfma_f32_32x32x16_bf16 v[32:47], a[24:27], a[124:127], v[32:47]
    v_mfma_f32_32x32x16_bf16 v[144:159], a[28:31], a[124:127], v[144:159]
    s_waitcnt lgkmcnt(5)
    v_mfma_f32_32x32x16_bf16 v[48:63], a[24:27], a[128:131], v[48:63]
    v_mfma_f32_32x32x16_bf16 v[160:175], a[28:31], a[128:131], v[160:175]
    s_waitcnt lgkmcnt(4)
    v_mfma_f32_32x32x16_bf16 v[64:79], a[24:27], a[132:135], v[64:79]
    v_mfma_f32_32x32x16_bf16 v[176:191], a[28:31], a[132:135], v[176:191]
    s_waitcnt lgkmcnt(3)
    v_mfma_f32_32x32x16_bf16 v[80:95], a[24:27], a[136:139], v[80:95]
    v_mfma_f32_32x32x16_bf16 v[192:207], a[28:31], a[136:139], v[192:207]
    s_waitcnt lgkmcnt(2)
    v_mfma_f32_32x32x16_bf16 v[96:111], a[24:27], a[140:143], v[96:111]
    v_mfma_f32_32x32x16_bf16 v[208:223], a[28:31], a[140:143], v[208:223]
    s_waitcnt lgkmcnt(1)
    v_mfma_f32_32x32x16_bf16 v[112:127], a[24:27], a[144:147], v[112:127]
    v_mfma_f32_32x32x16_bf16 v[224:239], a[28:31], a[144:147], v[224:239]
    s_waitcnt lgkmcnt(0)
    v_mfma_f32_32x32x16_bf16 v[128:143], a[24:27], a[148:151], v[128:143]
    v_mfma_f32_32x32x16_bf16 v[240:255], a[28:31], a[148:151], v[240:255]
    s_add_u32 s50, s42, 0
    v_cvt_pk_bf16_f32 v8, v32, v33
    v_cvt_pk_bf16_f32 v9, v34, v35
    v_cvt_pk_bf16_f32 v10, v36, v37
    v_cvt_pk_bf16_f32 v11, v38, v39
    buffer_store_dwordx4 v[8:11], v2, s[8:11], s50 offen offset:0 sc1
    v_cvt_pk_bf16_f32 v12, v40, v41
    v_cvt_pk_bf16_f32 v13, v42, v43
    v_cvt_pk_bf16_f32 v14, v44, v45
    v_cvt_pk_bf16_f32 v15, v46, v47
    buffer_store_dwordx4 v[12:15], v2, s[8:11], s50 offen offset:1024 sc1
    v_cvt_pk_bf16_f32 v16, v48, v49
    v_cvt_pk_bf16_f32 v17, v50, v51
    v_cvt_pk_bf16_f32 v18, v52, v53
    v_cvt_pk_bf16_f32 v19, v54, v55
    buffer_store_dwordx4 v[16:19], v2, s[8:11], s50 offen offset:2048 sc1
    v_cvt_pk_bf16_f32 v20, v56, v57
    v_cvt_pk_bf16_f32 v21, v58, v59
    v_cvt_pk_bf16_f32 v22, v60, v61
    v_cvt_pk_bf16_f32 v23, v62, v63
    buffer_store_dwordx4 v[20:23], v2, s[8:11], s50 offen offset:3072 sc1
    s_add_u32 s50, s50, 4096
    v_cvt_pk_bf16_f32 v8, v64, v65
    v_cvt_pk_bf16_f32 v9, v66, v67
    v_cvt_pk_bf16_f32 v10, v68, v69
    v_cvt_pk_bf16_f32 v11, v70, v71
    buffer_store_dwordx4 v[8:11], v2, s[8:11], s50 offen offset:0 sc1
    v_cvt_pk_bf16_f32 v12, v72, v73
    v_cvt_pk_bf16_f32 v13, v74, v75
    v_cvt_pk_bf16_f32 v14, v76, v77
    v_cvt_pk_bf16_f32 v15, v78, v79
    buffer_store_dwordx4 v[12:15], v2, s[8:11], s50 offen offset:1024 sc1
    v_cvt_pk_bf16_f32 v16, v80, v81
    v_cvt_pk_bf16_f32 v17, v82, v83
    v_cvt_pk_bf16_f32 v18, v84, v85
    v_cvt_pk_bf16_f32 v19, v86, v87
    buffer_store_dwordx4 v[16:19], v2, s[8:11], s50 offen offset:2048 sc1
    v_cvt_pk_bf16_f32 v20, v88, v89
    v_cvt_pk_bf16_f32 v21, v90, v91
    v_cvt_pk_bf16_f32 v22, v92, v93
    v_cvt_pk_bf16_f32 v23, v94, v95
    buffer_store_dwordx4 v[20:23], v2, s[8:11], s50 offen offset:3072 sc1
    s_add_u32 s50, s50, 4096
    v_cvt_pk_bf16_f32 v8, v96, v97
    v_cvt_pk_bf16_f32 v9, v98, v99
    v_cvt_pk_bf16_f32 v10, v100, v101
    v_cvt_pk_bf16_f32 v11, v102, v103
    buffer_store_dwordx4 v[8:11], v2, s[8:11], s50 offen offset:0 sc1
    v_cvt_pk_bf16_f32 v12, v104, v105
    v_cvt_pk_bf16_f32 v13, v106, v107
    v_cvt_pk_bf16_f32 v14, v108, v109
    v_cvt_pk_bf16_f32 v15, v110, v111
    buffer_store_dwordx4 v[12:15], v2, s[8:11], s50 offen offset:1024 sc1
    v_cvt_pk_bf16_f32 v16, v112, v113
    v_cvt_pk_bf16_f32 v17, v114, v115
    v_cvt_pk_bf16_f32 v18, v116, v117
    v_cvt_pk_bf16_f32 v19, v118, v119
    buffer_store_dwordx4 v[16:19], v2, s[8:11], s50 offen offset:2048 sc1
    v_cvt_pk_bf16_f32 v20, v120, v121
    v_cvt_pk_bf16_f32 v21, v122, v123
    v_cvt_pk_bf16_f32 v22, v124, v125
    v_cvt_pk_bf16_f32 v23, v126, v127
    buffer_store_dwordx4 v[20:23], v2, s[8:11], s50 offen offset:3072 sc1
    s_add_u32 s50, s50, 4096
    v_cvt_pk_bf16_f32 v8, v128, v129
    v_cvt_pk_bf16_f32 v9, v130, v131
    v_cvt_pk_bf16_f32 v10, v132, v133
    v_cvt_pk_bf16_f32 v11, v134, v135
    buffer_store_dwordx4 v[8:11], v2, s[8:11], s50 offen offset:0 sc1
    v_cvt_pk_bf16_f32 v12, v136, v137
    v_cvt_pk_bf16_f32 v13, v138, v139
    v_cvt_pk_bf16_f32 v14, v140, v141
    v_cvt_pk_bf16_f32 v15, v142, v143
    buffer_store_dwordx4 v[12:15], v2, s[8:11], s50 offen offset:1024 sc1
    s_add_u32 s50, s42, 458752
    v_cvt_pk_bf16_f32 v16, v144, v145
    v_cvt_pk_bf16_f32 v17, v146, v147
    v_cvt_pk_bf16_f32 v18, v148, v149
    v_cvt_pk_bf16_f32 v19, v150, v151
    buffer_store_dwordx4 v[16:19], v2, s[8:11], s50 offen offset:0 sc1
    v_cvt_pk_bf16_f32 v20, v152, v153
    v_cvt_pk_bf16_f32 v21, v154, v155
    v_cvt_pk_bf16_f32 v22, v156, v157
    v_cvt_pk_bf16_f32 v23, v158, v159
    buffer_store_dwordx4 v[20:23], v2, s[8:11], s50 offen offset:1024 sc1
    v_cvt_pk_bf16_f32 v8, v160, v161
    v_cvt_pk_bf16_f32 v9, v162, v163
    v_cvt_pk_bf16_f32 v10, v164, v165
    v_cvt_pk_bf16_f32 v11, v166, v167
    buffer_store_dwordx4 v[8:11], v2, s[8:11], s50 offen offset:2048 sc1
    v_cvt_pk_bf16_f32 v12, v168, v169
    v_cvt_pk_bf16_f32 v13, v170, v171
    v_cvt_pk_bf16_f32 v14, v172, v173
    v_cvt_pk_bf16_f32 v15, v174, v175
    buffer_store_dwordx4 v[12:15], v2, s[8:11], s50 offen offset:3072 sc1
    s_add_u32 s50, s50, 4096
    v_cvt_pk_bf16_f32 v16, v176, v177
    v_cvt_pk_bf16_f32 v17, v178, v179
    v_cvt_pk_bf16_f32 v18, v180, v181
    v_cvt_pk_bf16_f32 v19, v182, v183
    buffer_store_dwordx4 v[16:19], v2, s[8:11], s50 offen offset:0 sc1
    v_cvt_pk_bf16_f32 v20, v184, v185
    v_cvt_pk_bf16_f32 v21, v186, v187
    v_cvt_pk_bf16_f32 v22, v188, v189
    v_cvt_pk_bf16_f32 v23, v190, v191
    buffer_store_dwordx4 v[20:23], v2, s[8:11], s50 offen offset:1024 sc1
    v_cvt_pk_bf16_f32 v8, v192, v193
    v_cvt_pk_bf16_f32 v9, v194, v195
    v_cvt_pk_bf16_f32 v10, v196, v197
    v_cvt_pk_bf16_f32 v11, v198, v199
    buffer_store_dwordx4 v[8:11], v2, s[8:11], s50 offen offset:2048 sc1
    v_cvt_pk_bf16_f32 v12, v200, v201
    v_cvt_pk_bf16_f32 v13, v202, v203
    v_cvt_pk_bf16_f32 v14, v204, v205
    v_cvt_pk_bf16_f32 v15, v206, v207
    buffer_store_dwordx4 v[12:15], v2, s[8:11], s50 offen offset:3072 sc1
    s_add_u32 s50, s50, 4096
    v_cvt_pk_bf16_f32 v16, v208, v209
    v_cvt_pk_bf16_f32 v17, v210, v211
    v_cvt_pk_bf16_f32 v18, v212, v213
    v_cvt_pk_bf16_f32 v19, v214, v215
    buffer_store_dwordx4 v[16:19], v2, s[8:11], s50 offen offset:0 sc1
    v_cvt_pk_bf16_f32 v20, v216, v217
    v_cvt_pk_bf16_f32 v21, v218, v219
    v_cvt_pk_bf16_f32 v22, v220, v221
    v_cvt_pk_bf16_f32 v23, v222, v223
    buffer_store_dwordx4 v[20:23], v2, s[8:11], s50 offen offset:1024 sc1
    v_cvt_pk_bf16_f32 v8, v224, v225
    v_cvt_pk_bf16_f32 v9, v226, v227
    v_cvt_pk_bf16_f32 v10, v228, v229
    v_cvt_pk_bf16_f32 v11, v230, v231
    buffer_store_dwordx4 v[8:11], v2, s[8:11], s50 offen offset:2048 sc1
    v_cvt_pk_bf16_f32 v12, v232, v233
    v_cvt_pk_bf16_f32 v13, v234, v235
    v_cvt_pk_bf16_f32 v14, v236, v237
    v_cvt_pk_bf16_f32 v15, v238, v239
    buffer_store_dwordx4 v[12:15], v2, s[8:11], s50 offen offset:3072 sc1
    s_add_u32 s50, s50, 4096
    v_cvt_pk_bf16_f32 v16, v240, v241
    v_cvt_pk_bf16_f32 v17, v242, v243
    v_cvt_pk_bf16_f32 v18, v244, v245
    v_cvt_pk_bf16_f32 v19, v246, v247
    buffer_store_dwordx4 v[16:19], v2, s[8:11], s50 offen offset:0 sc1
    v_cvt_pk_bf16_f32 v20, v248, v249
    v_cvt_pk_bf16_f32 v21, v250, v251
    v_cvt_pk_bf16_f32 v22, v252, v253
    v_cvt_pk_bf16_f32 v23, v254, v255
    buffer_store_dwordx4 v[20:23], v2, s[8:11], s50 offen offset:1024 sc1
    s_branch W_end
W_gu:
    s_mul_i32 s73, s68, s72
    s_lshr_b32 s73, s73, 16
    s_mul_i32 s74, s73, s71
    s_sub_u32 s74, s68, s74
    s_mul_i32 s74, s74, 7
    s_add_u32 s74, s74, s70
    s_lshl_b32 s39, s73, 4
    s_add_u32 s39, s39, s74
    s_add_u32 s69, s39, 256
    s_lshl_b32 s70, s73, 5
    s_add_u32 s70, s70, 1792
    v_and_b32 v8, 63, v0
    v_min_u32 v8, 31, v8
    v_lshlrev_b32 v8, 3, v8
    s_lshl_b32 s38, s70, 3
    s_add_u32 s38, s38, 117440512
FW_66:
    s_add_u32 s33, s33, 1
    s_cmp_gt_u32 s33, 0x200000
    s_cbranch_scc1 L_bail
    buffer_load_dwordx2 v[10:11], v8, s[8:11], s38 offen sc1
    s_waitcnt vmcnt(0)
    v_cmp_ne_u64 vcc, s[96:97], v[10:11]
    s_cbranch_vccz FWok_67
    s_sleep 4
    s_branch FW_66
FWok_67:
    s_mul_i32 s74, s74, 7
    s_lshl_b32 s70, s74, 0
    s_add_u32 s70, s70, 2048
    v_and_b32 v8, 63, v0
    v_min_u32 v8, 6, v8
    v_lshlrev_b32 v8, 3, v8
    s_lshl_b32 s38, s70, 3
    s_add_u32 s38, s38, 117440512
FW_68:
    s_add_u32 s33, s33, 1
    s_cmp_gt_u32 s33, 0x200000
    s_cbranch_scc1 L_bail
    buffer_load_dwordx2 v[10:11], v8, s[8:11], s38 offen sc1
    s_waitcnt vmcnt(0)
    v_cmp_ne_u64 vcc, s[96:97], v[10:11]
    s_cbranch_vccz FWok_69
    s_sleep 4
    s_branch FW_68
FWok_69:
    s_lshr_b32 s53, s39, 4
    s_and_b32 s54, s39, 15
    s_lshl_b32 s55, s53, 3
    s_lshl_b32 s50, s13, 1
    s_add_u32 s55, s55, s50
    s_mul_i32 s40, s55, 28672
    s_add_u32 s40, s40, 0
    s_mul_i32 s41, s54, 200704
    s_add_u32 s41, s41, 14942208
    s_mul_i32 s42, s55, 114688
    s_mul_i32 s50, s54, 7168
    s_add_u32 s42, s42, s50
    s_add_u32 s42, s42, 79691776
    v_add_u32 v5, 0, v3
    v_add_u32 v6, 28672, v3
    v_add_u32 v7, 57344, v3
    s_lshl_b32 s44, s13, 1
    s_min_u32 s45, s44, 6
    s_add_u32 s44, s44, 1
    s_min_u32 s46, s44, 6
    s_mul_i32 s47, s45, 28672
    s_add_u32 s47, s47, s41
    s_mul_i32 s48, s46, 28672
    s_add_u32 s48, s48, s41
    s_lshl_b32 s45, s45, 12
    s_lshl_b32 s46, s46, 12
    s_mov_b32 s49, s40
    s_add_u32 s50, s45, 0
    s_mov_b32 m0, s50
    s_nop 0
    buffer_load_dwordx4 v2, s[8:11], s47 offen sc1 lds
    buffer_load_dwordx4 v2, s[8:11], s47 offen offset:1024 sc1 lds
    buffer_load_dwordx4 v2, s[8:11], s47 offen offset:2048 sc1 lds
    buffer_load_dwordx4 v2, s[8:11], s47 offen offset:3072 sc1 lds
    s_add_u32 s47, s47, 4096
    s_add_u32 s50, s46, 0
    s_mov_b32 m0, s50
    s_nop 0
    buffer_load_dwordx4 v2, s[8:11], s48 offen sc1 lds
    buffer_load_dwordx4 v2, s[8:11], s48 offen offset:1024 sc1 lds
    buffer_load_dwordx4 v2, s[8:11], s48 offen offset:2048 sc1 lds
    buffer_load_dwordx4 v2, s[8:11], s48 offen offset:3072 sc1 lds
    s_add_u32 s48, s48, 4096
    buffer_load_dwordx4 a[0:3], v2, s[8:11], s49 offen offset:0 sc1
    buffer_load_dwordx4 a[8:11], v2, s[8:11], s49 offen offset:1024 sc1
    buffer_load_dwordx4 a[16:19], v2, s[8:11], s49 offen offset:2048 sc1
    buffer_load_dwordx4 a[24:27], v2, s[8:11], s49 offen offset:3072 sc1
    s_add_u32 s51, s49, 28672
    buffer_load_dwordx4 a[4:7], v2, s[8:11], s51 offen offset:0 sc1
    buffer_load_dwordx4 a[12:15], v2, s[8:11], s51 offen offset:1024 sc1
    buffer_load_dwordx4 a[20:23], v2, s[8:11], s51 offen offset:2048 sc1
    buffer_load_dwordx4 a[28:31], v2, s[8:11], s51 offen offset:3072 sc1
    s_add_u32 s49, s49, 4096
    s_add_u32 s50, s45, 28672
    s_mov_b32 m0, s50
    s_nop 0
    buffer_load_dwordx4 v2, s[8:11], s47 offen sc1 lds
    buffer_load_dwordx4 v2, s[8:11], s47 offen offset:1024 sc1 lds
    buffer_load_dwordx4 v2, s[8:11], s47 offen offset:2048 sc1 lds
    buffer_load_dwordx4 v2, s[8:11], s47 offen offset:3072 sc1 lds
    s_add_u32 s47, s47, 4096
    s_add_u32 s50, s46, 28672
    s_mov_b32 m0, s50
    s_nop 0
    buffer_load_dwordx4 v2, s[8:11], s48 offen sc1 lds
    buffer_load_dwordx4 v2, s[8:11], s48 offen offset:1024 sc1 lds
    buffer_load_dwordx4 v2, s[8:11], s48 offen offset:2048 sc1 lds
    buffer_load_dwordx4 v2, s[8:11], s48 offen offset:3072 sc1 lds
    s_add_u32 s48, s48, 4096
    buffer_load_dwordx4 a[32:35], v2, s[8:11], s49 offen offset:0 sc1
    buffer_load_dwordx4 a[40:43], v2, s[8:11], s49 offen offset:1024 sc1
    buffer_load_dwordx4 a[48:51], v2, s[8:11], s49 offen offset:2048 sc1
    buffer_load_dwordx4 a[56:59], v2, s[8:11], s49 offen offset:3072 sc1
    s_add_u32 s51, s49, 28672
    buffer_load_dwordx4 a[36:39], v2, s[8:11], s51 offen offset:0 sc1
    buffer_load_dwordx4 a[44:47], v2, s[8:11], s51 offen offset:1024 sc1
    buffer_load_dwordx4 a[52:55], v2, s[8:11], s51 offen offset:2048 sc1
    buffer_load_dwordx4 a[60:63], v2, s[8:11], s51 offen offset:3072 sc1
    s_add_u32 s49, s49, 4096
    v_mov_b32 v32, 0
    v_mov_b32 v33, 0
    v_mov_b32 v34, 0
    v_mov_b32 v35, 0
    v_mov_b32 v36, 0
    v_mov_b32 v37, 0
    v_mov_b32 v38, 0
    v_mov_b32 v39, 0
    v_mov_b32 v40, 0
    v_mov_b32 v41, 0
    v_mov_b32 v42, 0
    v_mov_b32 v43, 0
    v_mov_b32 v44, 0
    v_mov_b32 v45, 0
    v_mov_b32 v46, 0
    v_mov_b32 v47, 0
    v_mov_b32 v48, 0
    v_mov_b32 v49, 0
    v_mov_b32 v50, 0
    v_mov_b32 v51, 0
    v_mov_b32 v52, 0
    v_mov_b32 v53, 0
    v_mov_b32 v54, 0
    v_mov_b32 v55, 0
    v_mov_b32 v56, 0
    v_mov_b32 v57, 0
    v_mov_b32 v58, 0
    v_mov_b32 v59, 0
    v_mov_b32 v60, 0
    v_mov_b32 v61, 0
    v_mov_b32 v62, 0
    v_mov_b32 v63, 0
    v_mov_b32 v64, 0
    v_mov_b32 v65, 0
    v_mov_b32 v66, 0
    v_mov_b32 v67, 0
    v_mov_b32 v68, 0
    v_mov_b32 v69, 0
    v_mov_b32 v70, 0
    v_mov_b32 v71, 0
    v_mov_b32 v72, 0
    v_mov_b32 v73, 0
    v_mov_b32 v74, 0
    v_mov_b32 v75, 0
    v_mov_b32 v76, 0
    v_mov_b32 v77, 0
    v_mov_b32 v78, 0
    v_mov_b32 v79, 0
    v_mov_b32 v80, 0
    v_mov_b32 v81, 0
    v_mov_b32 v82, 0
    v_mov_b32 v83, 0
    v_mov_b32 v84, 0
    v_mov_b32 v85, 0
    v_mov_b32 v86, 0
    v_mov_b32 v87, 0
    v_mov_b32 v88, 0
    v_mov_b32 v89, 0
    v_mov_b32 v90, 0
    v_mov_b32 v91, 0
    v_mov_b32 v92, 0
    v_mov_b32 v93, 0
    v_mov_b32 v94, 0
    v_mov_b32 v95, 0
    v_mov_b32 v96, 0
    v_mov_b32 v97, 0
    v_mov_b32 v98, 0
    v_mov_b32 v99, 0
    v_mov_b32 v100, 0
    v_mov_b32 v101, 0
    v_mov_b32 v102, 0
    v_mov_b32 v103, 0
    v_mov_b32 v104, 0
    v_mov_b32 v105, 0
    v_mov_b32 v106, 0
    v_mov_b32 v107, 0
    v_mov_b32 v108, 0
    v_mov_b32 v109, 0
    v_mov_b32 v110, 0
    v_mov_b32 v111, 0
    v_mov_b32 v112, 0
    v_mov_b32 v113, 0
    v_mov_b32 v114, 0
    v_mov_b32 v115, 0
    v_mov_b32 v116, 0
    v_mov_b32 v117, 0
    v_mov_b32 v118, 0
    v_mov_b32 v119, 0
    v_mov_b32 v120, 0
    v_mov_b32 v121, 0
    v_mov_b32 v122, 0
    v_mov_b32 v123, 0
    v_mov_b32 v124, 0
    v_mov_b32 v125, 0
    v_mov_b32 v126, 0
    v_mov_b32 v127, 0
    v_mov_b32 v128, 0
    v_mov_b32 v129, 0
    v_mov_b32 v130, 0
    v_mov_b32 v131, 0
    v_mov_b32 v132, 0
    v_mov_b32 v133, 0
    v_mov_b32 v134, 0
    v_mov_b32 v135, 0
    v_mov_b32 v136, 0
    v_mov_b32 v137, 0
    v_mov_b32 v138, 0
    v_mov_b32 v139, 0
    v_mov_b32 v140, 0
    v_mov_b32 v141, 0
    v_mov_b32 v142, 0
    v_mov_b32 v143, 0
    v_mov_b32 v144, 0
    v_mov_b32 v145, 0
    v_mov_b32 v146, 0
    v_mov_b32 v147, 0
    v_mov_b32 v148, 0
    v_mov_b32 v149, 0
    v_mov_b32 v150, 0
    v_mov_b32 v151, 0
    v_mov_b32 v152, 0
    v_mov_b32 v153, 0
    v_mov_b32 v154, 0
    v_mov_b32 v155, 0
    v_mov_b32 v156, 0
    v_mov_b32 v157, 0
    v_mov_b32 v158, 0
    v_mov_b32 v159, 0
    v_mov_b32 v160, 0
    v_mov_b32 v161, 0
    v_mov_b32 v162, 0
    v_mov_b32 v163, 0
    v_mov_b32 v164, 0
    v_mov_b32 v165, 0
    v_mov_b32 v166, 0
    v_mov_b32 v167, 0
    v_mov_b32 v168, 0
    v_mov_b32 v169, 0
    v_mov_b32 v170, 0
    v_mov_b32 v171, 0
    v_mov_b32 v172, 0
    v_mov_b32 v173, 0
    v_mov_b32 v174, 0
    v_mov_b32 v175, 0
    v_mov_b32 v176, 0
    v_mov_b32 v177, 0
    v_mov_b32 v178, 0
    v_mov_b32 v179, 0
    v_mov_b32 v180, 0
    v_mov_b32 v181, 0
    v_mov_b32 v182, 0
    v_mov_b32 v183, 0
    v_mov_b32 v184, 0
    v_mov_b32 v185, 0
    v_mov_b32 v186, 0
    v_mov_b32 v187, 0
    v_mov_b32 v188, 0
    v_mov_b32 v189, 0
    v_mov_b32 v190, 0
    v_mov_b32 v191, 0
    v_mov_b32 v192, 0
    v_mov_b32 v193, 0
    v_mov_b32 v194, 0
    v_mov_b32 v195, 0
    v_mov_b32 v196, 0
    v_mov_b32 v197, 0
    v_mov_b32 v198, 0
    v_mov_b32 v199, 0
    v_mov_b32 v200, 0
    v_mov_b32 v201, 0
    v_mov_b32 v202, 0
    v_mov_b32 v203, 0
    v_mov_b32 v204, 0
    v_mov_b32 v205, 0
    v_mov_b32 v206, 0
    v_mov_b32 v207, 0
    v_mov_b32 v208, 0
    v_mov_b32 v209, 0
    v_mov_b32 v210, 0
    v_mov_b32 v211, 0
    v_mov_b32 v212, 0
    v_mov_b32 v213, 0
    v_mov_b32 v214, 0
    v_mov_b32 v215, 0
    v_mov_b32 v216, 0
    v_mov_b32 v217, 0
    v_mov_b32 v218, 0
    v_mov_b32 v219, 0
    v_mov_b32 v220, 0
    v_mov_b32 v221, 0
    v_mov_b32 v222, 0
    v_mov_b32 v223, 0
    v_mov_b32 v224, 0
    v_mov_b32 v225, 0
    v_mov_b32 v226, 0
    v_mov_b32 v227, 0
    v_mov_b32 v228, 0
    v_mov_b32 v229, 0
    v_mov_b32 v230, 0
    v_mov_b32 v231, 0
    v_mov_b32 v232, 0
    v_mov_b32 v233, 0
    v_mov_b32 v234, 0
    v_mov_b32 v235, 0
    v_mov_b32 v236, 0
    v_mov_b32 v237, 0
    v_mov_b32 v238, 0
    v_mov_b32 v239, 0
    v_mov_b32 v240, 0
    v_mov_b32 v241, 0
    v_mov_b32 v242, 0
    v_mov_b32 v243, 0
    v_mov_b32 v244, 0
    v_mov_b32 v245, 0
    v_mov_b32 v246, 0
    v_mov_b32 v247, 0
    v_mov_b32 v248, 0
    v_mov_b32 v249, 0
    v_mov_b32 v250, 0
    v_mov_b32 v251, 0
    v_mov_b32 v252, 0
    v_mov_b32 v253, 0
    v_mov_b32 v254, 0
    v_mov_b32 v255, 0
    s_waitcnt vmcnt(16)
    s_barrier
    ds_read_b128 a[96:99], v5 offset:0
    ds_read_b128 a[100:103], v5 offset:4096
    ds_read_b128 a[104:107], v5 offset:8192
    ds_read_b128 a[108:111], v5 offset:12288
    ds_read_b128 a[112:115], v5 offset:16384
    ds_read_b128 a[116:119], v5 offset:20480
    ds_read_b128 a[120:123], v5 offset:24576
    s_waitcnt lgkmcnt(6)
    v_mfma_f32_32x32x16_bf16 v[32:47], a[96:99], a[0:3], v[32:47]
    ds_read_b128 a[124:127], v5 offset:1024
    v_mfma_f32_32x32x16_bf16 v[144:159], a[96:99], a[4:7], v[144:159]
    s_add_u32 s50, s45, 57344
    s_mov_b32 m0, s50
    s_nop 0
    buffer_load_dwordx4 v2, s[8:11], s47 offen sc1 lds
    s_waitcnt lgkmcnt(6)
    v_mfma_f32_32x32x16_bf16 v[48:63], a[100:103], a[0:3], v[48:63]
    ds_read_b128 a[128:131], v5 offset:5120
    v_mfma_f32_32x32x16_bf16 v[160:175], a[100:103], a[4:7], v[160:175]
    s_waitcnt lgkmcnt(6)
    v_mfma_f32_32x32x16_bf16 v[64:79], a[104:107], a[0:3], v[64:79]
    ds_read_b128 a[132:135], v5 offset:9216
    v_mfma_f32_32x32x16_bf16 v[176:191], a[104:107], a[4:7], v[176:191]
    buffer_load_dwordx4 v2, s[8:11], s47 offen offset:1024 sc1 lds
    s_waitcnt lgkmcnt(6)
    v_mfma_f32_32x32x16_bf16 v[80:95], a[108:111], a[0:3], v[80:95]
    ds_read_b128 a[136:139], v5 offset:13312
    v_mfma_f32_32x32x16_bf16 v[192:207], a[108:111], a[4:7], v[192:207]
    s_waitcnt lgkmcnt(6)
    v_mfma_f32_32x32x16_bf16 v[96:111], a[112:115], a[0:3], v[96:111]
    ds_read_b128 a[140:143], v5 offset:17408
    v_mfma_f32_32x32x16_bf16 v[208:223], a[112:115], a[4:7], v[208:223]
    buffer_load_dwordx4 v2, s[8:11], s47 offen offset:2048 sc1 lds
    s_waitcnt lgkmcnt(6)
    v_mfma_f32_32x32x16_bf16 v[112:127], a[116:119], a[0:3], v[112:127]
    ds_read_b128 a[144:147], v5 offset:21504
    v_mfma_f32_32x32x16_bf16 v[224:239], a[116:119], a[4:7], v[224:239]
    s_waitcnt lgkmcnt(6)
    v_mfma_f32_32x32x16_bf16 v[128:143], a[120:123], a[0:3], v[128:143]
    ds_read_b128 a[148:151], v5 offset:25600
    v_mfma_f32_32x32x16_bf16 v[240:255], a[120:123], a[4:7], v[240:255]
    buffer_load_dwordx4 v2, s[8:11], s47 offen offset:3072 sc1 lds
    s_add_u32 s47, s47, 4096
    s_waitcnt lgkmcnt(6)
    v_mfma_f32_32x32x16_bf16 v[32:47], a[124:127], a[8:11], v[32:47]
    ds_read_b128 a[96:99], v5 offset:2048
    v_mfma_f32_32x32x16_bf16 v[144:159], a[124:127], a[12:15], v[144:159]
    s_add_u32 s50, s46, 57344
    s_mov_b32 m0, s50
    s_nop 0
    buffer_load_dwordx4 v2, s[8:11], s48 offen sc1 lds
    s_waitcnt lgkmcnt(6)
    v_mfma_f32_32x32x16_bf16 v[48:63], a[128:131], a[8:11], v[48:63]
    ds_read_b128 a[100:103], v5 offset:6144
    v_mfma_f32_32x32x16_bf16 v[160:175], a[128:131], a[12:15], v[160:175]
    s_waitcnt lgkmcnt(6)
    v_mfma_f32_32x32x16_bf16 v[64:79], a[132:135], a[8:11], v[64:79]
    ds_read_b128 a[104:107], v5 offset:10240
    v_mfma_f32_32x32x16_bf16 v[176:191], a[132:135], a[12:15], v[176:191]
    buffer_load_dwordx4 v2, s[8:11], s48 offen offset:1024 sc1 lds
    s_waitcnt lgkmcnt(6)
    v_mfma_f32_32x32x16_bf16 v[80:95], a[136:139], a[8:11], v[80:95]
    ds_read_b128 a[108:111], v5 offset:14336
    v_mfma_f32_32x32x16_bf16 v[192:207], a[136:139], a[12:15], v[192:207]
    s_waitcnt lgkmcnt(6)
    v_mfma_f32_32x32x16_bf16 v[96:111], a[140:143], a[8:11], v[96:111]
    ds_read_b128 a[112:115], v5 offset:18432
    v_mfma_f32_32x32x16_bf16 v[208:223], a[140:143], a[12:15], v[208:223]
    buffer_load_dwordx4 v2, s[8:11], s48 offen offset:2048 sc1 lds
    s_waitcnt lgkmcnt(6)
    v_mfma_f32_32x32x16_bf16 v[112:127], a[144:147], a[8:11], v[112:127]
    ds_read_b128 a[116:119], v5 offset:22528
    v_mfma_f32_32x32x16_bf16 v[224:239], a[144:147], a[12:15], v[224:239]
    s_waitcnt lgkmcnt(6)
    v_mfma_f32_32x32x16_bf16 v[128:143], a[148:151], a[8:11], v[128:143]
    ds_read_b128 a[120:123], v5 offset:26624
    v_mfma_f32_32x32x16_bf16 v[240:255], a[148:151], a[12:15], v[240:255]
    buffer_load_dwordx4 v2, s[8:11], s48 offen offset:3072 sc1 lds
    s_add_u32 s48, s48, 4096
    s_waitcnt lgkmcnt(6)
    v_mfma_f32_32x32x16_bf16 v[32:47], a[96:99], a[16:19], v[32:47]
    ds_read_b128 a[124:127], v5 offset:3072
    v_mfma_f32_32x32x16_bf16 v[144:159], a[96:99], a[20:23], v[144:159]
    buffer_load_dwordx4 a[64:67], v2, s[8:11], s49 offen offset:0 sc1
    s_waitcnt lgkmcnt(6)
    v_mfma_f32_32x32x16_bf16 v[48:63], a[100:103], a[16:19], v[48:63]
    ds_read_b128 a[128:131], v5 offset:7168
    v_mfma_f32_32x32x16_bf16 v[160:175], a[100:103], a[20:23], v[160:175]
    s_waitcnt lgkmcnt(6)
    v_mfma_f32_32x32x16_bf16 v[64:79], a[104:107], a[16:19], v[64:79]
    ds_read_b128 a[132:135], v5 offset:11264
    v_mfma_f32_32x32x16_bf16 v[176:191], a[104:107], a[20:23], v[176:191]
    buffer_load_dwordx4 a[72:75], v2, s[8:11], s49 offen offset:1024 sc1
    s_waitcnt lgkmcnt(6)
    v_mfma_f32_32x32x16_bf16 v[80:95], a[108:111], a[16:19], v[80:95]
    ds_read_b128 a[136:139], v5 offset:15360
    v_mfma_f32_32x32x16_bf16 v[192:207], a[108:111], a[20:23], v[192:207]
    s_waitcnt lgkmcnt(6)
    v_mfma_f32_32x32x16_bf16 v[96:111], a[112:115], a[16:19], v[96:111]
    ds_read_b128 a[140:143], v5 offset:19456
    v_mfma_f32_32x32x16_bf16 v[208:223], a[112:115], a[20:23], v[208:223]
    buffer_load_dwordx4 a[80:83], v2, s[8:11], s49 offen offset:2048 sc1
    s_waitcnt lgkmcnt(6)
    v_mfma_f32_32x32x16_bf16 v[112:127], a[116:119], a[16:19], v[112:127]
    ds_read_b128 a[144:147], v5 offset:23552
    v_mfma_f32_32x32x16_bf16 v[224:239], a[116:119], a[20:23], v[224:239]
    s_waitcnt lgkmcnt(6)
    v_mfma_f32_32x32x16_bf16 v[128:143], a[120:123], a[16:19], v[128:143]
    ds_read_b128 a[148:151], v5 offset:27648
    v_mfma_f32_32x32x16_bf16 v[240:255], a[120:123], a[20:23], v[240:255]
    buffer_load_dwordx4 a[88:91], v2, s[8:11], s49 offen offset:3072 sc1
    s_waitcnt lgkmcnt(6)
    v_mfma_f32_32x32x16_bf16 v[32:47], a[124:127], a[24:27], v[32:47]
    v_mfma_f32_32x32x16_bf16 v[144:159], a[124:127], a[28:31], v[144:159]
    s_add_u32 s51, s49, 28672
    buffer_load_dwordx4 a[68:71], v2, s[8:11], s51 offen offset:0 sc1
    s_waitcnt lgkmcnt(5)
    v_mfma_f32_32x32x16_bf16 v[48:63], a[128:131], a[24:27], v[48:63]
    v_mfma_f32_32x32x16_bf16 v[160:175], a[128:131], a[28:31], v[160:175]
    s_waitcnt lgkmcnt(4)
    v_mfma_f32_32x32x16_bf16 v[64:79], a[132:135], a[24:27], v[64:79]
    v_mfma_f32_32x32x16_bf16 v[176:191], a[132:135], a[28:31], v[176:191]
    buffer_load_dwordx4 a[76:79], v2, s[8:11], s51 offen offset:1024 sc1
    s_waitcnt lgkmcnt(3)
    v_mfma_f32_32x32x16_bf16 v[80:95], a[136:139], a[24:27], v[80:95]
    v_mfma_f32_32x32x16_bf16 v[192:207], a[136:139], a[28:31], v[192:207]
    s_waitcnt lgkmcnt(2)
    v_mfma_f32_32x32x16_bf16 v[96:111], a[140:143], a[24:27], v[96:111]
    v_mfma_f32_32x32x16_bf16 v[208:223], a[140:143], a[28:31], v[208:223]
    buffer_load_dwordx4 a[84:87], v2, s[8:11], s51 offen offset:2048 sc1
    s_waitcnt lgkmcnt(1)
    v_mfma_f32_32x32x16_bf16 v[112:127], a[144:147], a[24:27], v[112:127]
    v_mfma_f32_32x32x16_bf16 v[224:239], a[144:147], a[28:31], v[224:239]
    s_waitcnt lgkmcnt(0)
    v_mfma_f32_32x32x16_bf16 v[128:143], a[148:151], a[24:27], v[128:143]
    v_mfma_f32_32x32x16_bf16 v[240:255], a[148:151], a[28:31], v[240:255]
    buffer_load_dwordx4 a[92:95], v2, s[8:11], s51 offen offset:3072 sc1
    s_add_u32 s49, s49, 4096
    s_waitcnt vmcnt(16)
    s_barrier
    ds_read_b128 a[96:99], v6 offset:0
    ds_read_b128 a[100:103], v6 offset:4096
    ds_read_b128 a[104:107], v6 offset:8192
    ds_read_b128 a[108:111], v6 offset:12288
    ds_read_b128 a[112:115], v6 offset:16384
    ds_read_b128 a[116:119], v6 offset:20480
    ds_read_b128 a[120:123], v6 offset:24576
    s_waitcnt lgkmcnt(6)
    v_mfma_f32_32x32x16_bf16 v[32:47], a[96:99], a[32:35], v[32:47]
    ds_read_b128 a[124:127], v6 offset:1024
    v_mfma_f32_32x32x16_bf16 v[144:159], a[96:99], a[36:39], v[144:159]
    s_add_u32 s50, s45, 0
    s_mov_b32 m0, s50
    s_nop 0
    buffer_load_dwordx4 v2, s[8:11], s47 offen sc1 lds
    s_waitcnt lgkmcnt(6)
    v_mfma_f32_32x32x16_bf16 v[48:63], a[100:103], a[32:35], v[48:63]
    ds_read_b128 a[128:131], v6 offset:5120
    v_mfma_f32_32x32x16_bf16 v[160:175], a[100:103], a[36:39], v[160:175]
    s_waitcnt lgkmcnt(6)
    v_mfma_f32_32x32x16_bf16 v[64:79], a[104:107], a[32:35], v[64:79]
    ds_read_b128 a[132:135], v6 offset:9216
    v_mfma_f32_32x32x16_bf16 v[176:191], a[104:107], a[36:39], v[176:191]
    buffer_load_dwordx4 v2, s[8:11], s47 offen offset:1024 sc1 lds
    s_waitcnt lgkmcnt(6)
    v_mfma_f32_32x32x16_bf16 v[80:95], a[108:111], a[32:35], v[80:95]
    ds_read_b128 a[136:139], v6 offset:13312
    v_mfma_f32_32x32x16_bf16 v[192:207], a[108:111], a[36:39], v[192:207]
    s_waitcnt lgkmcnt(6)
    v_mfma_f32_32x32x16_bf16 v[96:111], a[112:115], a[32:35], v[96:111]
    ds_read_b128 a[140:143], v6 offset:17408
    v_mfma_f32_32x32x16_bf16 v[208:223], a[112:115], a[36:39], v[208:223]
    buffer_load_dwordx4 v2, s[8:11], s47 offen offset:2048 sc1 lds
    s_waitcnt lgkmcnt(6)
    v_mfma_f32_32x32x16_bf16 v[112:127], a[116:119], a[32:35], v[112:127]
    ds_read_b128 a[144:147], v6 offset:21504
    v_mfma_f32_32x32x16_bf16 v[224:239], a[116:119], a[36:39], v[224:239]
    s_waitcnt lgkmcnt(6)
    v_mfma_f32_32x32x16_bf16 v[128:143], a[120:123], a[32:35], v[128:143]
    ds_read_b128 a[148:151], v6 offset:25600
    v_mfma_f32_32x32x16_bf16 v[240:255], a[120:123], a[36:39], v[240:255]
    buffer_load_dwordx4 v2, s[8:11], s47 offen offset:3072 sc1 lds
    s_add_u32 s47, s47, 4096
    s_waitcnt lgkmcnt(6)
    v_mfma_f32_32x32x16_bf16 v[32:47], a[124:127], a[40:43], v[32:47]
    ds_read_b128 a[96:99], v6 offset:2048
    v_mfma_f32_32x32x16_bf16 v[144:159], a[124:127], a[44:47], v[144:159]
    s_add_u32 s50, s46, 0
    s_mov_b32 m0, s50
    s_nop 0
    buffer_load_dwordx4 v2, s[8:11], s48 offen sc1 lds
    s_waitcnt lgkmcnt(6)
    v_mfma_f32_32x32x16_bf16 v[48:63], a[128:131], a[40:43], v[48:63]
    ds_read_b128 a[100:103], v6 offset:6144
    v_mfma_f32_32x32x16_bf16 v[160:175], a[128:131], a[44:47], v[160:175]
    s_waitcnt lgkmcnt(6)
    v_mfma_f32_32x32x16_bf16 v[64:79], a[132:135], a[40:43], v[64:79]
    ds_read_b128 a[104:107], v6 offset:10240
    v_mfma_f32_32x32x16_bf16 v[176:191], a[132:135], a[44:47], v[176:191]
    buffer_load_dwordx4 v2, s[8:11], s48 offen offset:1024 sc1 lds
    s_waitcnt lgkmcnt(6)
    v_mfma_f32_32x32x16_bf16 v[80:95], a[136:139], a[40:43], v[80:95]
    ds_read_b128 a[108:111], v6 offset:14336
    v_mfma_f32_32x32x16_bf16 v[192:207], a[136:139], a[44:47], v[192:207]
    s_waitcnt lgkmcnt(6)
    v_mfma_f32_32x32x16_bf16 v[96:111], a[140:143], a[40:43], v[96:111]
    ds_read_b128 a[112:115], v6 offset:18432
    v_mfma_f32_32x32x16_bf16 v[208:223], a[140:143], a[44:47], v[208:223]
    buffer_load_dwordx4 v2, s[8:11], s48 offen offset:2048 sc1 lds
    s_waitcnt lgkmcnt(6)
    v_mfma_f32_32x32x16_bf16 v[112:127], a[144:147], a[40:43], v[112:127]
    ds_read_b128 a[116:119], v6 offset:22528
    v_mfma_f32_32x32x16_bf16 v[224:239], a[144:147], a[44:47], v[224:239]
    s_waitcnt lgkmcnt(6)
    v_mfma_f32_32x32x16_bf16 v[128:143], a[148:151], a[40:43], v[128:143]
    ds_read_b128 a[120:123], v6 offset:26624
    v_mfma_f32_32x32x16_bf16 v[240:255], a[148:151], a[44:47], v[240:255]
    buffer_load_dwordx4 v2, s[8:11], s48 offen offset:3072 sc1 lds
    s_add_u32 s48, s48, 4096
    s_waitcnt lgkmcnt(6)
    v_mfma_f32_32x32x16_bf16 v[32:47], a[96:99], a[48:51], v[32:47]
    ds_read_b128 a[124:127], v6 offset:3072
    v_mfma_f32_32x32x16_bf16 v[144:159], a[96:99], a[52:55], v[144:159]
    buffer_load_dwordx4 a[0:3], v2, s[8:11], s49 offen offset:0 sc1
    s_waitcnt lgkmcnt(6)
    v_mfma_f32_32x32x16_bf16 v[48:63], a[100:103], a[48:51], v[48:63]
    ds_read_b128 a[128:131], v6 offset:7168
    v_mfma_f32_32x32x16_bf16 v[160:175], a[100:103], a[52:55], v[160:175]
    s_waitcnt lgkmcnt(6)
    v_mfma_f32_32x32x16_bf16 v[64:79], a[104:107], a[48:51], v[64:79]
    ds_read_b128 a[132:135], v6 offset:11264
    v_mfma_f32_32x32x16_bf16 v[176:191], a[104:107], a[52:55], v[176:191]
    buffer_load_dwordx4 a[8:11], v2, s[8:11], s49 offen offset:1024 sc1
    s_waitcnt lgkmcnt(6)
    v_mfma_f32_32x32x16_bf16 v[80:95], a[108:111], a[48:51], v[80:95]
    ds_read_b128 a[136:139], v6 offset:15360
    v_mfma_f32_32x32x16_bf16 v[192:207], a[108:111], a[52:55], v[192:207]
    s_waitcnt lgkmcnt(6)
    v_mfma_f32_32x32x16_bf16 v[96:111], a[112:115], a[48:51], v[96:111]
    ds_read_b128 a[140:143], v6 offset:19456
    v_mfma_f32_32x32x16_bf16 v[208:223], a[112:115], a[52:55], v[208:223]
    buffer_load_dwordx4 a[16:19], v2, s[8:11], s49 offen offset:2048 sc1
    s_waitcnt lgkmcnt(6)
    v_mfma_f32_32x32x16_bf16 v[112:127], a[116:119], a[48:51], v[112:127]
    ds_read_b128 a[144:147], v6 offset:23552
    v_mfma_f32_32x32x16_bf16 v[224:239], a[116:119], a[52:55], v[224:239]
    s_waitcnt lgkmcnt(6)
    v_mfma_f32_32x32x16_bf16 v[128:143], a[120:123], a[48:51], v[128:143]
    ds_read_b128 a[148:151], v6 offset:27648
    v_mfma_f32_32x32x16_bf16 v[240:255], a[120:123], a[52:55], v[240:255]
    buffer_load_dwordx4 a[24:27], v2, s[8:11], s49 offen offset:3072 sc1
    s_waitcnt lgkmcnt(6)
    v_mfma_f32_32x32x16_bf16 v[32:47], a[124:127], a[56:59], v[32:47]
    v_mfma_f32_32x32x16_bf16 v[144:159], a[124:127], a[60:63], v[144:159]
    s_add_u32 s51, s49, 28672
    buffer_load_dwordx4 a[4:7], v2, s[8:11], s51 offen offset:0 sc1
    s_waitcnt lgkmcnt(5)
    v_mfma_f32_32x32x16_bf16 v[48:63], a[128:131], a[56:59], v[48:63]
    v_mfma_f32_32x32x16_bf16 v[160:175], a[128:131], a[60:63], v[160:175]
    s_waitcnt lgkmcnt(4)
    v_mfma_f32_32x32x16_bf16 v[64:79], a[132:135], a[56:59], v[64:79]
    v_mfma_f32_32x32x16_bf16 v[176:191], a[132:135], a[60:63], v[176:191]
    buffer_load_dwordx4 a[12:15], v2, s[8:11], s51 offen offset:1024 sc1
    s_waitcnt lgkmcnt(3)
    v_mfma_f32_32x32x16_bf16 v[80:95], a[136:139], a[56:59], v[80:95]
    v_mfma_f32_32x32x16_bf16 v[192:207], a[136:139], a[60:63], v[192:207]
    s_waitcnt lgkmcnt(2)
    v_mfma_f32_32x32x16_bf16 v[96:111], a[140:143], a[56:59], v[96:111]
    v_mfma_f32_32x32x16_bf16 v[208:223], a[140:143], a[60:63], v[208:223]
    buffer_load_dwordx4 a[20:23], v2, s[8:11], s51 offen offset:2048 sc1
    s_waitcnt lgkmcnt(1)
    v_mfma_f32_32x32x16_bf16 v[112:127], a[144:147], a[56:59], v[112:127]
    v_mfma_f32_32x32x16_bf16 v[224:239], a[144:147], a[60:63], v[224:239]
    s_waitcnt lgkmcnt(0)
    v_mfma_f32_32x32x16_bf16 v[128:143], a[148:151], a[56:59], v[128:143]
    v_mfma_f32_32x32x16_bf16 v[240:255], a[148:151], a[60:63], v[240:255]
    buffer_load_dwordx4 a[28:31], v2, s[8:11], s51 offen offset:3072 sc1
    s_add_u32 s49, s49, 4096
    s_waitcnt vmcnt(16)
    s_barrier
    ds_read_b128 a[96:99], v7 offset:0
    ds_read_b128 a[100:103], v7 offset:4096
    ds_read_b128 a[104:107], v7 offset:8192
    ds_read_b128 a[108:111], v7 offset:12288
    ds_read_b128 a[112:115], v7 offset:16384
    ds_read_b128 a[116:119], v7 offset:20480
    ds_read_b128 a[120:123], v7 offset:24576
    s_waitcnt lgkmcnt(6)
    v_mfma_f32_32x32x16_bf16 v[32:47], a[96:99], a[64:67], v[32:47]
    ds_read_b128 a[124:127], v7 offset:1024
    v_mfma_f32_32x32x16_bf16 v[144:159], a[96:99], a[68:71], v[144:159]
    s_add_u32 s50, s45, 28672
    s_mov_b32 m0, s50
    s_nop 0
    buffer_load_dwordx4 v2, s[8:11], s47 offen sc1 lds
    s_waitcnt lgkmcnt(6)
    v_mfma_f32_32x32x16_bf16 v[48:63], a[100:103], a[64:67], v[48:63]
    ds_read_b128 a[128:131], v7 offset:5120
    v_mfma_f32_32x32x16_bf16 v[160:175], a[100:103], a[68:71], v[160:175]
    s_waitcnt lgkmcnt(6)
    v_mfma_f32_32x32x16_bf16 v[64:79], a[104:107], a[64:67], v[64:79]
    ds_read_b128 a[132:135], v7 offset:9216
    v_mfma_f32_32x32x16_bf16 v[176:191], a[104:107], a[68:71], v[176:191]
    buffer_load_dwordx4 v2, s[8:11], s47 offen offset:1024 sc1 lds
    s_waitcnt lgkmcnt(6)
    v_mfma_f32_32x32x16_bf16 v[80:95], a[108:111], a[64:67], v[80:95]
    ds_read_b128 a[136:139], v7 offset:13312
    v_mfma_f32_32x32x16_bf16 v[192:207], a[108:111], a[68:71], v[192:207]
    s_waitcnt lgkmcnt(6)
    v_mfma_f32_32x32x16_bf16 v[96:111], a[112:115], a[64:67], v[96:111]
    ds_read_b128 a[140:143], v7 offset:17408
    v_mfma_f32_32x32x16_bf16 v[208:223], a[112:115], a[68:71], v[208:223]
    buffer_load_dwordx4 v2, s[8:11], s47 offen offset:2048 sc1 lds
    s_waitcnt lgkmcnt(6)
    v_mfma_f32_32x32x16_bf16 v[112:127], a[116:119], a[64:67], v[112:127]
    ds_read_b128 a[144:147], v7 offset:21504
    v_mfma_f32_32x32x16_bf16 v[224:239], a[116:119], a[68:71], v[224:239]
    s_waitcnt lgkmcnt(6)
    v_mfma_f32_32x32x16_bf16 v[128:143], a[120:123], a[64:67], v[128:143]
    ds_read_b128 a[148:151], v7 offset:25600
    v_mfma_f32_32x32x16_bf16 v[240:255], a[120:123], a[68:71], v[240:255]
    buffer_load_dwordx4 v2, s[8:11], s47 offen offset:3072 sc1 lds
    s_add_u32 s47, s47, 4096
    s_waitcnt lgkmcnt(6)
    v_mfma_f32_32x32x16_bf16 v[32:47], a[124:127], a[72:75], v[32:47]
    ds_read_b128 a[96:99], v7 offset:2048
    v_mfma_f32_32x32x16_bf16 v[144:159], a[124:127], a[76:79], v[144:159]
    s_add_u32 s50, s46, 28672
    s_mov_b32 m0, s50
    s_nop 0
    buffer_load_dwordx4 v2, s[8:11], s48 offen sc1 lds
    s_waitcnt lgkmcnt(6)
    v_mfma_f32_32x32x16_bf16 v[48:63], a[128:131], a[72:75], v[48:63]
    ds_read_b128 a[100:103], v7 offset:6144
    v_mfma_f32_32x32x16_bf16 v[160:175], a[128:131], a[76:79], v[160:175]
    s_waitcnt lgkmcnt(6)
    v_mfma_f32_32x32x16_bf16 v[64:79], a[132:135], a[72:75], v[64:79]
    ds_read_b128 a[104:107], v7 offset:10240
    v_mfma_f32_32x32x16_bf16 v[176:191], a[132:135], a[76:79], v[176:191]
    buffer_load_dwordx4 v2, s[8:11], s48 offen offset:1024 sc1 lds
    s_waitcnt lgkmcnt(6)
    v_mfma_f32_32x32x16_bf16 v[80:95], a[136:139], a[72:75], v[80:95]
    ds_read_b128 a[108:111], v7 offset:14336
    v_mfma_f32_32x32x16_bf16 v[192:207], a[136:139], a[76:79], v[192:207]
    s_waitcnt lgkmcnt(6)
    v_mfma_f32_32x32x16_bf16 v[96:111], a[140:143], a[72:75], v[96:111]
    ds_read_b128 a[112:115], v7 offset:18432
    v_mfma_f32_32x32x16_bf16 v[208:223], a[140:143], a[76:79], v[208:223]
    buffer_load_dwordx4 v2, s[8:11], s48 offen offset:2048 sc1 lds
    s_waitcnt lgkmcnt(6)
    v_mfma_f32_32x32x16_bf16 v[112:127], a[144:147], a[72:75], v[112:127]
    ds_read_b128 a[116:119], v7 offset:22528
    v_mfma_f32_32x32x16_bf16 v[224:239], a[144:147], a[76:79], v[224:239]
    s_waitcnt lgkmcnt(6)
    v_mfma_f32_32x32x16_bf16 v[128:143], a[148:151], a[72:75], v[128:143]
    ds_read_b128 a[120:123], v7 offset:26624
    v_mfma_f32_32x32x16_bf16 v[240:255], a[148:151], a[76:79], v[240:255]
    buffer_load_dwordx4 v2, s[8:11], s48 offen offset:3072 sc1 lds
    s_add_u32 s48, s48, 4096
    s_waitcnt lgkmcnt(6)
    v_mfma_f32_32x32x16_bf16 v[32:47], a[96:99], a[80:83], v[32:47]
    ds_read_b128 a[124:127], v7 offset:3072
    v_mfma_f32_32x32x16_bf16 v[144:159], a[96:99], a[84:87], v[144:159]
    buffer_load_dwordx4 a[32:35], v2, s[8:11], s49 offen offset:0 sc1
    s_waitcnt lgkmcnt(6)
    v_mfma_f32_32x32x16_bf16 v[48:63], a[100:103], a[80:83], v[48:63]
    ds_read_b128 a[128:131], v7 offset:7168
    v_mfma_f32_32x32x16_bf16 v[160:175], a[100:103], a[84:87], v[160:175]
    s_waitcnt lgkmcnt(6)
    v_mfma_f32_32x32x16_bf16 v[64:79], a[104:107], a[80:83], v[64:79]
    ds_read_b128 a[132:135], v7 offset:11264
    v_mfma_f32_32x32x16_bf16 v[176:191], a[104:107], a[84:87], v[176:191]
    buffer_load_dwordx4 a[40:43], v2, s[8:11], s49 offen offset:1024 sc1
    s_waitcnt lgkmcnt(6)
    v_mfma_f32_32x32x16_bf16 v[80:95], a[108:111], a[80:83], v[80:95]
    ds_read_b128 a[136:139], v7 offset:15360
    v_mfma_f32_32x32x16_bf16 v[192:207], a[108:111], a[84:87], v[192:207]
    s_waitcnt lgkmcnt(6)
    v_mfma_f32_32x32x16_bf16 v[96:111], a[112:115], a[80:83], v[96:111]
    ds_read_b128 a[140:143], v7 offset:19456
    v_mfma_f32_32x32x16_bf16 v[208:223], a[112:115], a[84:87], v[208:223]
    buffer_load_dwordx4 a[48:51], v2, s[8:11], s49 offen offset:2048 sc1
    s_waitcnt lgkmcnt(6)
    v_mfma_f32_32x32x16_bf16 v[112:127], a[116:119], a[80:83], v[112:127]
    ds_read_b128 a[144:147], v7 offset:23552
    v_mfma_f32_32x32x16_bf16 v[224:239], a[116:119], a[84:87], v[224:239]
    s_waitcnt lgkmcnt(6)
    v_mfma_f32_32x32x16_bf16 v[128:143], a[120:123], a[80:83], v[128:143]
    ds_read_b128 a[148:151], v7 offset:27648
    v_mfma_f32_32x32x16_bf16 v[240:255], a[120:123], a[84:87], v[240:255]
    buffer_load_dwordx4 a[56:59], v2, s[8:11], s49 offen offset:3072 sc1
    s_waitcnt lgkmcnt(6)
    v_mfma_f32_32x32x16_bf16 v[32:47], a[124:127], a[88:91], v[32:47]
    v_mfma_f32_32x32x16_bf16 v[144:159], a[124:127], a[92:95], v[144:159]
    s_add_u32 s51, s49, 28672
    buffer_load_dwordx4 a[36:39], v2, s[8:11], s51 offen offset:0 sc1
    s_waitcnt lgkmcnt(5)
    v_mfma_f32_32x32x16_bf16 v[48:63], a[128:131], a[88:91], v[48:63]
    v_mfma_f32_32x32x16_bf16 v[160:175], a[128:131], a[92:95], v[160:175]
    s_waitcnt lgkmcnt(4)
    v_mfma_f32_32x32x16_bf16 v[64:79], a[132:135], a[88:91], v[64:79]
    v_mfma_f32_32x32x16_bf16 v[176:191], a[132:135], a[92:95], v[176:191]
    buffer_load_dwordx4 a[44:47], v2, s[8:11], s51 offen offset:1024 sc1
    s_waitcnt lgkmcnt(3)
    v_mfma_f32_32x32x16_bf16 v[80:95], a[136:139], a[88:91], v[80:95]
    v_mfma_f32_32x32x16_bf16 v[192:207], a[136:139], a[92:95], v[192:207]
    s_waitcnt lgkmcnt(2)
    v_mfma_f32_32x32x16_bf16 v[96:111], a[140:143], a[88:91], v[96:111]
    v_mfma_f32_32x32x16_bf16 v[208:223], a[140:143], a[92:95], v[208:223]
    buffer_load_dwordx4 a[52:55], v2, s[8:11], s51 offen offset:2048 sc1
    s_waitcnt lgkmcnt(1)
    v_mfma_f32_32x32x16_bf16 v[112:127], a[144:147], a[88:91], v[112:127]
    v_mfma_f32_32x32x16_bf16 v[224:239], a[144:147], a[92:95], v[224:239]
    s_waitcnt lgkmcnt(0)
    v_mfma_f32_32x32x16_bf16 v[128:143], a[148:151], a[88:91], v[128:143]
    v_mfma_f32_32x32x16_bf16 v[240:255], a[148:151], a[92:95], v[240:255]
    buffer_load_dwordx4 a[60:63], v2, s[8:11], s51 offen offset:3072 sc1
    s_add_u32 s49, s49, 4096
    s_waitcnt vmcnt(16)
    s_barrier
    ds_read_b128 a[96:99], v5 offset:0
    ds_read_b128 a[100:103], v5 offset:4096
    ds_read_b128 a[104:107], v5 offset:8192
    ds_read_b128 a[108:111], v5 offset:12288
    ds_read_b128 a[112:115], v5 offset:16384
    ds_read_b128 a[116:119], v5 offset:20480
    ds_read_b128 a[120:123], v5 offset:24576
    s_waitcnt lgkmcnt(6)
    v_mfma_f32_32x32x16_bf16 v[32:47], a[96:99], a[0:3], v[32:47]
    ds_read_b128 a[124:127], v5 offset:1024
    v_mfma_f32_32x32x16_bf16 v[144:159], a[96:99], a[4:7], v[144:159]
    s_add_u32 s50, s45, 57344
    s_mov_b32 m0, s50
    s_nop 0
    buffer_load_dwordx4 v2, s[8:11], s47 offen sc1 lds
    s_waitcnt lgkmcnt(6)
    v_mfma_f32_32x32x16_bf16 v[48:63], a[100:103], a[0:3], v[48:63]
    ds_read_b128 a[128:131], v5 offset:5120
    v_mfma_f32_32x32x16_bf16 v[160:175], a[100:103], a[4:7], v[160:175]
    s_waitcnt lgkmcnt(6)
    v_mfma_f32_32x32x16_bf16 v[64:79], a[104:107], a[0:3], v[64:79]
    ds_read_b128 a[132:135], v5 offset:9216
    v_mfma_f32_32x32x16_bf16 v[176:191], a[104:107], a[4:7], v[176:191]
    buffer_load_dwordx4 v2, s[8:11], s47 offen offset:1024 sc1 lds
    s_waitcnt lgkmcnt(6)
    v_mfma_f32_32x32x16_bf16 v[80:95], a[108:111], a[0:3], v[80:95]
    ds_read_b128 a[136:139], v5 offset:13312
    v_mfma_f32_32x32x16_bf16 v[192:207], a[108:111], a[4:7], v[192:207]
    s_waitcnt lgkmcnt(6)
    v_mfma_f32_32x32x16_bf16 v[96:111], a[112:115], a[0:3], v[96:111]
    ds_read_b128 a[140:143], v5 offset:17408
    v_mfma_f32_32x32x16_bf16 v[208:223], a[112:115], a[4:7], v[208:223]
    buffer_load_dwordx4 v2, s[8:11], s47 offen offset:2048 sc1 lds
    s_waitcnt lgkmcnt(6)
    v_mfma_f32_32x32x16_bf16 v[112:127], a[116:119], a[0:3], v[112:127]
    ds_read_b128 a[144:147], v5 offset:21504
    v_mfma_f32_32x32x16_bf16 v[224:239], a[116:119], a[4:7], v[224:239]
    s_waitcnt lgkmcnt(6)
    v_mfma_f32_32x32x16_bf16 v[128:143], a[120:123], a[0:3], v[128:143]
    ds_read_b128 a[148:151], v5 offset:25600
    v_mfma_f32_32x32x16_bf16 v[240:255], a[120:123], a[4:7], v[240:255]
    buffer_load_dwordx4 v2, s[8:11], s47 offen offset:3072 sc1 lds
    s_add_u32 s47, s47, 4096
    s_waitcnt lgkmcnt(6)
    v_mfma_f32_32x32x16_bf16 v[32:47], a[124:127], a[8:11], v[32:47]
    ds_read_b128 a[96:99], v5 offset:2048
    v_mfma_f32_32x32x16_bf16 v[144:159], a[124:127], a[12:15], v[144:159]
    s_add_u32 s50, s46, 57344
    s_mov_b32 m0, s50
    s_nop 0
    buffer_load_dwordx4 v2, s[8:11], s48 offen sc1 lds
    s_waitcnt lgkmcnt(6)
    v_mfma_f32_32x32x16_bf16 v[48:63], a[128:131], a[8:11], v[48:63]
    ds_read_b128 a[100:103], v5 offset:6144
    v_mfma_f32_32x32x16_bf16 v[160:175], a[128:131], a[12:15], v[160:175]
    s_waitcnt lgkmcnt(6)
    v_mfma_f32_32x32x16_bf16 v[64:79], a[132:135], a[8:11], v[64:79]
    ds_read_b128 a[104:107], v5 offset:10240
    v_mfma_f32_32x32x16_bf16 v[176:191], a[132:135], a[12:15], v[176:191]
    buffer_load_dwordx4 v2, s[8:11], s48 offen offset:1024 sc1 lds
    s_waitcnt lgkmcnt(6)
    v_mfma_f32_32x32x16_bf16 v[80:95], a[136:139], a[8:11], v[80:95]
    ds_read_b128 a[108:111], v5 offset:14336
    v_mfma_f32_32x32x16_bf16 v[192:207], a[136:139], a[12:15], v[192:207]
    s_waitcnt lgkmcnt(6)
    v_mfma_f32_32x32x16_bf16 v[96:111], a[140:143], a[8:11], v[96:111]
    ds_read_b128 a[112:115], v5 offset:18432
    v_mfma_f32_32x32x16_bf16 v[208:223], a[140:143], a[12:15], v[208:223]
    buffer_load_dwordx4 v2, s[8:11], s48 offen offset:2048 sc1 lds
    s_waitcnt lgkmcnt(6)
    v_mfma_f32_32x32x16_bf16 v[112:127], a[144:147], a[8:11], v[112:127]
    ds_read_b128 a[116:119], v5 offset:22528
    v_mfma_f32_32x32x16_bf16 v[224:239], a[144:147], a[12:15], v[224:239]
    s_waitcnt lgkmcnt(6)
    v_mfma_f32_32x32x16_bf16 v[128:143], a[148:151], a[8:11], v[128:143]
    ds_read_b128 a[120:123], v5 offset:26624
    v_mfma_f32_32x32x16_bf16 v[240:255], a[148:151], a[12:15], v[240:255]
    buffer_load_dwordx4 v2, s[8:11], s48 offen offset:3072 sc1 lds
    s_add_u32 s48, s48, 4096
    s_waitcnt lgkmcnt(6)
    v_mfma_f32_32x32x16_bf16 v[32:47], a[96:99], a[16:19], v[32:47]
    ds_read_b128 a[124:127], v5 offset:3072
    v_mfma_f32_32x32x16_bf16 v[144:159], a[96:99], a[20:23], v[144:159]
    buffer_load_dwordx4 a[64:67], v2, s[8:11], s49 offen offset:0 sc1
    s_waitcnt lgkmcnt(6)
    v_mfma_f32_32x32x16_bf16 v[48:63], a[100:103], a[16:19], v[48:63]
    ds_read_b128 a[128:131], v5 offset:7168
    v_mfma_f32_32x32x16_bf16 v[160:175], a[100:103], a[20:23], v[160:175]
    s_waitcnt lgkmcnt(6)
    v_mfma_f32_32x32x16_bf16 v[64:79], a[104:107], a[16:19], v[64:79]
    ds_read_b128 a[132:135], v5 offset:11264
    v_mfma_f32_32x32x16_bf16 v[176:191], a[104:107], a[20:23], v[176:191]
    buffer_load_dwordx4 a[72:75], v2, s[8:11], s49 offen offset:1024 sc1
    s_waitcnt lgkmcnt(6)
    v_mfma_f32_32x32x16_bf16 v[80:95], a[108:111], a[16:19], v[80:95]
    ds_read_b128 a[136:139], v5 offset:15360
    v_mfma_f32_32x32x16_bf16 v[192:207], a[108:111], a[20:23], v[192:207]
    s_waitcnt lgkmcnt(6)
    v_mfma_f32_32x32x16_bf16 v[96:111], a[112:115], a[16:19], v[96:111]
    ds_read_b128 a[140:143], v5 offset:19456
    v_mfma_f32_32x32x16_bf16 v[208:223], a[112:115], a[20:23], v[208:223]
    buffer_load_dwordx4 a[80:83], v2, s[8:11], s49 offen offset:2048 sc1
    s_waitcnt lgkmcnt(6)
    v_mfma_f32_32x32x16_bf16 v[112:127], a[116:119], a[16:19], v[112:127]
    ds_read_b128 a[144:147], v5 offset:23552
    v_mfma_f32_32x32x16_bf16 v[224:239], a[116:119], a[20:23], v[224:239]
    s_waitcnt lgkmcnt(6)
    v_mfma_f32_32x32x16_bf16 v[128:143], a[120:123], a[16:19], v[128:143]
    ds_read_b128 a[148:151], v5 offset:27648
    v_mfma_f32_32x32x16_bf16 v[240:255], a[120:123], a[20:23], v[240:255]
    buffer_load_dwordx4 a[88:91], v2, s[8:11], s49 offen offset:3072 sc1
    s_waitcnt lgkmcnt(6)
    v_mfma_f32_32x32x16_bf16 v[32:47], a[124:127], a[24:27], v[32:47]
    v_mfma_f32_32x32x16_bf16 v[144:159], a[124:127], a[28:31], v[144:159]
    s_add_u32 s51, s49, 28672
    buffer_load_dwordx4 a[68:71], v2, s[8:11], s51 offen offset:0 sc1
    s_waitcnt lgkmcnt(5)
    v_mfma_f32_32x32x16_bf16 v[48:63], a[128:131], a[24:27], v[48:63]
    v_mfma_f32_32x32x16_bf16 v[160:175], a[128:131], a[28:31], v[160:175]
    s_waitcnt lgkmcnt(4)
    v_mfma_f32_32x32x16_bf16 v[64:79], a[132:135], a[24:27], v[64:79]
    v_mfma_f32_32x32x16_bf16 v[176:191], a[132:135], a[28:31], v[176:191]
    buffer_load_dwordx4 a[76:79], v2, s[8:11], s51 offen offset:1024 sc1
    s_waitcnt lgkmcnt(3)
    v_mfma_f32_32x32x16_bf16 v[80:95], a[136:139], a[24:27], v[80:95]
    v_mfma_f32_32x32x16_bf16 v[192:207], a[136:139], a[28:31], v[192:207]
    s_waitcnt lgkmcnt(2)
    v_mfma_f32_32x32x16_bf16 v[96:111], a[140:143], a[24:27], v[96:111]
    v_mfma_f32_32x32x16_bf16 v[208:223], a[140:143], a[28:31], v[208:223]
    buffer_load_dwordx4 a[84:87], v2, s[8:11], s51 offen offset:2048 sc1
    s_waitcnt lgkmcnt(1)
    v_mfma_f32_32x32x16_bf16 v[112:127], a[144:147], a[24:27], v[112:127]
    v_mfma_f32_32x32x16_bf16 v[224:239], a[144:147], a[28:31], v[224:239]
    s_waitcnt lgkmcnt(0)
    v_mfma_f32_32x32x16_bf16 v[128:143], a[148:151], a[24:27], v[128:143]
    v_mfma_f32_32x32x16_bf16 v[240:255], a[148:151], a[28:31], v[240:255]
    buffer_load_dwordx4 a[92:95], v2, s[8:11], s51 offen offset:3072 sc1
    s_add_u32 s49, s49, 4096
    s_waitcnt vmcnt(16)
    s_barrier
    ds_read_b128 a[96:99], v6 offset:0
    ds_read_b128 a[100:103], v6 offset:4096
    ds_read_b128 a[104:107], v6 offset:8192
    ds_read_b128 a[108:111], v6 offset:12288
    ds_read_b128 a[112:115], v6 offset:16384
    ds_read_b128 a[116:119], v6 offset:20480
    ds_read_b128 a[120:123], v6 offset:24576
    s_waitcnt lgkmcnt(6)
    v_mfma_f32_32x32x16_bf16 v[32:47], a[96:99], a[32:35], v[32:47]
    ds_read_b128 a[124:127], v6 offset:1024
    v_mfma_f32_32x32x16_bf16 v[144:159], a[96:99], a[36:39], v[144:159]
    s_add_u32 s50, s45, 0
    s_mov_b32 m0, s50
    s_nop 0
    buffer_load_dwordx4 v2, s[8:11], s47 offen sc1 lds
    s_waitcnt lgkmcnt(6)
    v_mfma_f32_32x32x16_bf16 v[48:63], a[100:103], a[32:35], v[48:63]
    ds_read_b128 a[128:131], v6 offset:5120
    v_mfma_f32_32x32x16_bf16 v[160:175], a[100:103], a[36:39], v[160:175]
    s_waitcnt lgkmcnt(6)
    v_mfma_f32_32x32x16_bf16 v[64:79], a[104:107], a[32:35], v[64:79]
    ds_read_b128 a[132:135], v6 offset:9216
    v_mfma_f32_32x32x16_bf16 v[176:191], a[104:107], a[36:39], v[176:191]
    buffer_load_dwordx4 v2, s[8:11], s47 offen offset:1024 sc1 lds
    s_waitcnt lgkmcnt(6)
    v_mfma_f32_32x32x16_bf16 v[80:95], a[108:111], a[32:35], v[80:95]
    ds_read_b128 a[136:139], v6 offset:13312
    v_mfma_f32_32x32x16_bf16 v[192:207], a[108:111], a[36:39], v[192:207]
    s_waitcnt lgkmcnt(6)
    v_mfma_f32_32x32x16_bf16 v[96:111], a[112:115], a[32:35], v[96:111]
    ds_read_b128 a[140:143], v6 offset:17408
    v_mfma_f32_32x32x16_bf16 v[208:223], a[112:115], a[36:39], v[208:223]
    buffer_load_dwordx4 v2, s[8:11], s47 offen offset:2048 sc1 lds
    s_waitcnt lgkmcnt(6)
    v_mfma_f32_32x32x16_bf16 v[112:127], a[116:119], a[32:35], v[112:127]
    ds_read_b128 a[144:147], v6 offset:21504
    v_mfma_f32_32x32x16_bf16 v[224:239], a[116:119], a[36:39], v[224:239]
    s_waitcnt lgkmcnt(6)
    v_mfma_f32_32x32x16_bf16 v[128:143], a[120:123], a[32:35], v[128:143]
    ds_read_b128 a[148:151], v6 offset:25600
    v_mfma_f32_32x32x16_bf16 v[240:255], a[120:123], a[36:39], v[240:255]
    buffer_load_dwordx4 v2, s[8:11], s47 offen offset:3072 sc1 lds
    s_add_u32 s47, s47, 4096
    s_waitcnt lgkmcnt(6)
    v_mfma_f32_32x32x16_bf16 v[32:47], a[124:127], a[40:43], v[32:47]
    ds_read_b128 a[96:99], v6 offset:2048
    v_mfma_f32_32x32x16_bf16 v[144:159], a[124:127], a[44:47], v[144:159]
    s_add_u32 s50, s46, 0
    s_mov_b32 m0, s50
    s_nop 0
    buffer_load_dwordx4 v2, s[8:11], s48 offen sc1 lds
    s_waitcnt lgkmcnt(6)
    v_mfma_f32_32x32x16_bf16 v[48:63], a[128:131], a[40:43], v[48:63]
    ds_read_b128 a[100:103], v6 offset:6144
    v_mfma_f32_32x32x16_bf16 v[160:175], a[128:131], a[44:47], v[160:175]
    s_waitcnt lgkmcnt(6)
    v_mfma_f32_32x32x16_bf16 v[64:79], a[132:135], a[40:43], v[64:79]
    ds_read_b128 a[104:107], v6 offset:10240
    v_mfma_f32_32x32x16_bf16 v[176:191], a[132:135], a[44:47], v[176:191]
    buffer_load_dwordx4 v2, s[8:11], s48 offen offset:1024 sc1 lds
    s_waitcnt lgkmcnt(6)
    v_mfma_f32_32x32x16_bf16 v[80:95], a[136:139], a[40:43], v[80:95]
    ds_read_b128 a[108:111], v6 offset:14336
    v_mfma_f32_32x32x16_bf16 v[192:207], a[136:139], a[44:47], v[192:207]
    s_waitcnt lgkmcnt(6)
    v_mfma_f32_32x32x16_bf16 v[96:111], a[140:143], a[40:43], v[96:111]
    ds_read_b128 a[112:115], v6 offset:18432
    v_mfma_f32_32x32x16_bf16 v[208:223], a[140:143], a[44:47], v[208:223]
    buffer_load_dwordx4 v2, s[8:11], s48 offen offset:2048 sc1 lds
    s_waitcnt lgkmcnt(6)
    v_mfma_f32_32x32x16_bf16 v[112:127], a[144:147], a[40:43], v[112:127]
    ds_read_b128 a[116:119], v6 offset:22528
    v_mfma_f32_32x32x16_bf16 v[224:239], a[144:147], a[44:47], v[224:239]
    s_waitcnt lgkmcnt(6)
    v_mfma_f32_32x32x16_bf16 v[128:143], a[148:151], a[40:43], v[128:143]
    ds_read_b128 a[120:123], v6 offset:26624
    v_mfma_f32_32x32x16_bf16 v[240:255], a[148:151], a[44:47], v[240:255]
    buffer_load_dwordx4 v2, s[8:11], s48 offen offset:3072 sc1 lds
    s_add_u32 s48, s48, 4096
    s_waitcnt lgkmcnt(6)
    v_mfma_f32_32x32x16_bf16 v[32:47], a[96:99], a[48:51], v[32:47]
    ds_read_b128 a[124:127], v6 offset:3072
    v_mfma_f32_32x32x16_bf16 v[144:159], a[96:99], a[52:55], v[144:159]
    buffer_load_dwordx4 a[0:3], v2, s[8:11], s49 offen offset:0 sc1
    s_waitcnt lgkmcnt(6)
    v_mfma_f32_32x32x16_bf16 v[48:63], a[100:103], a[48:51], v[48:63]
    ds_read_b128 a[128:131], v6 offset:7168
    v_mfma_f32_32x32x16_bf16 v[160:175], a[100:103], a[52:55], v[160:175]
    s_waitcnt lgkmcnt(6)
    v_mfma_f32_32x32x16_bf16 v[64:79], a[104:107], a[48:51], v[64:79]
    ds_read_b128 a[132:135], v6 offset:11264
    v_mfma_f32_32x32x16_bf16 v[176:191], a[104:107], a[52:55], v[176:191]
    buffer_load_dwordx4 a[8:11], v2, s[8:11], s49 offen offset:1024 sc1
    s_waitcnt lgkmcnt(6)
    v_mfma_f32_32x32x16_bf16 v[80:95], a[108:111], a[48:51], v[80:95]
    ds_read_b128 a[136:139], v6 offset:15360
    v_mfma_f32_32x32x16_bf16 v[192:207], a[108:111], a[52:55], v[192:207]
    s_waitcnt lgkmcnt(6)
    v_mfma_f32_32x32x16_bf16 v[96:111], a[112:115], a[48:51], v[96:111]
    ds_read_b128 a[140:143], v6 offset:19456
    v_mfma_f32_32x32x16_bf16 v[208:223], a[112:115], a[52:55], v[208:223]
    buffer_load_dwordx4 a[16:19], v2, s[8:11], s49 offen offset:2048 sc1
    s_waitcnt lgkmcnt(6)
    v_mfma_f32_32x32x16_bf16 v[112:127], a[116:119], a[48:51], v[112:127]
    ds_read_b128 a[144:147], v6 offset:23552
    v_mfma_f32_32x32x16_bf16 v[224:239], a[116:119], a[52:55], v[224:239]
    s_waitcnt lgkmcnt(6)
    v_mfma_f32_32x32x16_bf16 v[128:143], a[120:123], a[48:51], v[128:143]
    ds_read_b128 a[148:151], v6 offset:27648
    v_mfma_f32_32x32x16_bf16 v[240:255], a[120:123], a[52:55], v[240:255]
    buffer_load_dwordx4 a[24:27], v2, s[8:11], s49 offen offset:3072 sc1
    s_waitcnt lgkmcnt(6)
    v_mfma_f32_32x32x16_bf16 v[32:47], a[124:127], a[56:59], v[32:47]
    v_mfma_f32_32x32x16_bf16 v[144:159], a[124:127], a[60:63], v[144:159]
    s_add_u32 s51, s49, 28672
    buffer_load_dwordx4 a[4:7], v2, s[8:11], s51 offen offset:0 sc1
    s_waitcnt lgkmcnt(5)
    v_mfma_f32_32x32x16_bf16 v[48:63], a[128:131], a[56:59], v[48:63]
    v_mfma_f32_32x32x16_bf16 v[160:175], a[128:131], a[60:63], v[160:175]
    s_waitcnt lgkmcnt(4)
    v_mfma_f32_32x32x16_bf16 v[64:79], a[132:135], a[56:59], v[64:79]
    v_mfma_f32_32x32x16_bf16 v[176:191], a[132:135], a[60:63], v[176:191]
    buffer_load_dwordx4 a[12:15], v2, s[8:11], s51 offen offset:1024 sc1
    s_waitcnt lgkmcnt(3)
    v_mfma_f32_32x32x16_bf16 v[80:95], a[136:139], a[56:59], v[80:95]
    v_mfma_f32_32x32x16_bf16 v[192:207], a[136:139], a[60:63], v[192:207]
    s_waitcnt lgkmcnt(2)
    v_mfma_f32_32x32x16_bf16 v[96:111], a[140:143], a[56:59], v[96:111]
    v_mfma_f32_32x32x16_bf16 v[208:223], a[140:143], a[60:63], v[208:223]
    buffer_load_dwordx4 a[20:23], v2, s[8:11], s51 offen offset:2048 sc1
    s_waitcnt lgkmcnt(1)
    v_mfma_f32_32x32x16_bf16 v[112:127], a[144:147], a[56:59], v[112:127]
    v_mfma_f32_32x32x16_bf16 v[224:239], a[144:147], a[60:63], v[224:239]
    s_waitcnt lgkmcnt(0)
    v_mfma_f32_32x32x16_bf16 v[128:143], a[148:151], a[56:59], v[128:143]
    v_mfma_f32_32x32x16_bf16 v[240:255], a[148:151], a[60:63], v[240:255]
    buffer_load_dwordx4 a[28:31], v2, s[8:11], s51 offen offset:3072 sc1
    s_add_u32 s49, s49, 4096
    s_waitcnt vmcnt(16)
    s_barrier
    ds_read_b128 a[96:99], v7 offset:0
    ds_read_b128 a[100:103], v7 offset:4096
    ds_read_b128 a[104:107], v7 offset:8192
    ds_read_b128 a[108:111], v7 offset:12288
    ds_read_b128 a[112:115], v7 offset:16384
    ds_read_b128 a[116:119], v7 offset:20480
    ds_read_b128 a[120:123], v7 offset:24576
    s_waitcnt lgkmcnt(6)
    v_mfma_f32_32x32x16_bf16 v[32:47], a[96:99], a[64:67], v[32:47]
    ds_read_b128 a[124:127], v7 offset:1024
    v_mfma_f32_32x32x16_bf16 v[144:159], a[96:99], a[68:71], v[144:159]
    s_waitcnt lgkmcnt(6)
    v_mfma_f32_32x32x16_bf16 v[48:63], a[100:103], a[64:67], v[48:63]
    ds_read_b128 a[128:131], v7 offset:5120
    v_mfma_f32_32x32x16_bf16 v[160:175], a[100:103], a[68:71], v[160:175]
    s_waitcnt lgkmcnt(6)
    v_mfma_f32_32x32x16_bf16 v[64:79], a[104:107], a[64:67], v[64:79]
    ds_read_b128 a[132:135], v7 offset:9216
    v_mfma_f32_32x32x16_bf16 v[176:191], a[104:107], a[68:71], v[176:191]
    s_waitcnt lgkmcnt(6)
    v_mfma_f32_32x32x16_bf16 v[80:95], a[108:111], a[64:67], v[80:95]
    ds_read_b128 a[136:139], v7 offset:13312
    v_mfma_f32_32x32x16_bf16 v[192:207], a[108:111], a[68:71], v[192:207]
    s_waitcnt lgkmcnt(6)
    v_mfma_f32_32x32x16_bf16 v[96:111], a[112:115], a[64:67], v[96:111]
    ds_read_b128 a[140:143], v7 offset:17408
    v_mfma_f32_32x32x16_bf16 v[208:223], a[112:115], a[68:71], v[208:223]
    s_waitcnt lgkmcnt(6)
    v_mfma_f32_32x32x16_bf16 v[112:127], a[116:119], a[64:67], v[112:127]
    ds_read_b128 a[144:147], v7 offset:21504
    v_mfma_f32_32x32x16_bf16 v[224:239], a[116:119], a[68:71], v[224:239]
    s_waitcnt lgkmcnt(6)
    v_mfma_f32_32x32x16_bf16 v[128:143], a[120:123], a[64:67], v[128:143]
    ds_read_b128 a[148:151], v7 offset:25600
    v_mfma_f32_32x32x16_bf16 v[240:255], a[120:123], a[68:71], v[240:255]
    s_waitcnt lgkmcnt(6)
    v_mfma_f32_32x32x16_bf16 v[32:47], a[124:127], a[72:75], v[32:47]
    ds_read_b128 a[96:99], v7 offset:2048
    v_mfma_f32_32x32x16_bf16 v[144:159], a[124:127], a[76:79], v[144:159]
    s_waitcnt lgkmcnt(6)
    v_mfma_f32_32x32x16_bf16 v[48:63], a[128:131], a[72:75], v[48:63]
    ds_read_b128 a[100:103], v7 offset:6144
    v_mfma_f32_32x32x16_bf16 v[160:175], a[128:131], a[76:79], v[160:175]
    s_waitcnt lgkmcnt(6)
    v_mfma_f32_32x32x16_bf16 v[64:79], a[132:135], a[72:75], v[64:79]
    ds_read_b128 a[104:107], v7 offset:10240
    v_mfma_f32_32x32x16_bf16 v[176:191], a[132:135], a[76:79], v[176:191]
    s_waitcnt lgkmcnt(6)
    v_mfma_f32_32x32x16_bf16 v[80:95], a[136:139], a[72:75], v[80:95]
    ds_read_b128 a[108:111], v7 offset:14336
    v_mfma_f32_32x32x16_bf16 v[192:207], a[136:139], a[76:79], v[192:207]
    s_waitcnt lgkmcnt(6)
    v_mfma_f32_32x32x16_bf16 v[96:111], a[140:143], a[72:75], v[96:111]
    ds_read_b128 a[112:115], v7 offset:18432
    v_mfma_f32_32x32x16_bf16 v[208:223], a[140:143], a[76:79], v[208:223]
    s_waitcnt lgkmcnt(6)
    v_mfma_f32_32x32x16_bf16 v[112:127], a[144:147], a[72:75], v[112:127]
    ds_read_b128 a[116:119], v7 offset:22528
    v_mfma_f32_32x32x16_bf16 v[224:239], a[144:147], a[76:79], v[224:239]
    s_waitcnt lgkmcnt(6)
    v_mfma_f32_32x32x16_bf16 v[128:143], a[148:151], a[72:75], v[128:143]
    ds_read_b128 a[120:123], v7 offset:26624
    v_mfma_f32_32x32x16_bf16 v[240:255], a[148:151], a[76:79], v[240:255]
    s_waitcnt lgkmcnt(6)
    v_mfma_f32_32x32x16_bf16 v[32:47], a[96:99], a[80:83], v[32:47]
    ds_read_b128 a[124:127], v7 offset:3072
    v_mfma_f32_32x32x16_bf16 v[144:159], a[96:99], a[84:87], v[144:159]
    s_waitcnt lgkmcnt(6)
    v_mfma_f32_32x32x16_bf16 v[48:63], a[100:103], a[80:83], v[48:63]
    ds_read_b128 a[128:131], v7 offset:7168
    v_mfma_f32_32x32x16_bf16 v[160:175], a[100:103], a[84:87], v[160:175]
    s_waitcnt lgkmcnt(6)
    v_mfma_f32_32x32x16_bf16 v[64:79], a[104:107], a[80:83], v[64:79]
    ds_read_b128 a[132:135], v7 offset:11264
    v_mfma_f32_32x32x16_bf16 v[176:191], a[104:107], a[84:87], v[176:191]
    s_waitcnt lgkmcnt(6)
    v_mfma_f32_32x32x16_bf16 v[80:95], a[108:111], a[80:83], v[80:95]
    ds_read_b128 a[136:139], v7 offset:15360
    v_mfma_f32_32x32x16_bf16 v[192:207], a[108:111], a[84:87], v[192:207]
    s_waitcnt lgkmcnt(6)
    v_mfma_f32_32x32x16_bf16 v[96:111], a[112:115], a[80:83], v[96:111]
    ds_read_b128 a[140:143], v7 offset:19456
    v_mfma_f32_32x32x16_bf16 v[208:223], a[112:115], a[84:87], v[208:223]
    s_waitcnt lgkmcnt(6)
    v_mfma_f32_32x32x16_bf16 v[112:127], a[116:119], a[80:83], v[112:127]
    ds_read_b128 a[144:147], v7 offset:23552
    v_mfma_f32_32x32x16_bf16 v[224:239], a[116:119], a[84:87], v[224:239]
    s_waitcnt lgkmcnt(6)
    v_mfma_f32_32x32x16_bf16 v[128:143], a[120:123], a[80:83], v[128:143]
    ds_read_b128 a[148:151], v7 offset:27648
    v_mfma_f32_32x32x16_bf16 v[240:255], a[120:123], a[84:87], v[240:255]
    s_waitcnt lgkmcnt(6)
    v_mfma_f32_32x32x16_bf16 v[32:47], a[124:127], a[88:91], v[32:47]
    v_mfma_f32_32x32x16_bf16 v[144:159], a[124:127], a[92:95], v[144:159]
    s_waitcnt lgkmcnt(5)
    v_mfma_f32_32x32x16_bf16 v[48:63], a[128:131], a[88:91], v[48:63]
    v_mfma_f32_32x32x16_bf16 v[160:175], a[128:131], a[92:95], v[160:175]
    s_waitcnt lgkmcnt(4)
    v_mfma_f32_32x32x16_bf16 v[64:79], a[132:135], a[88:91], v[64:79]
    v_mfma_f32_32x32x16_bf16 v[176:191], a[132:135], a[92:95], v[176:191]
    s_waitcnt lgkmcnt(3)
    v_mfma_f32_32x32x16_bf16 v[80:95], a[136:139], a[88:91], v[80:95]
    v_mfma_f32_32x32x16_bf16 v[192:207], a[136:139], a[92:95], v[192:207]
    s_waitcnt lgkmcnt(2)
    v_mfma_f32_32x32x16_bf16 v[96:111], a[140:143], a[88:91], v[96:111]
    v_mfma_f32_32x32x16_bf16 v[208:223], a[140:143], a[92:95], v[208:223]
    s_waitcnt lgkmcnt(1)
    v_mfma_f32_32x32x16_bf16 v[112:127], a[144:147], a[88:91], v[112:127]
    v_mfma_f32_32x32x16_bf16 v[224:239], a[144:147], a[92:95], v[224:239]
    s_waitcnt lgkmcnt(0)
    v_mfma_f32_32x32x16_bf16 v[128:143], a[148:151], a[88:91], v[128:143]
    v_mfma_f32_32x32x16_bf16 v[240:255], a[148:151], a[92:95], v[240:255]
    s_waitcnt vmcnt(0)
    s_barrier
    ds_read_b128 a[96:99], v5 offset:0
    ds_read_b128 a[100:103], v5 offset:4096
    ds_read_b128 a[104:107], v5 offset:8192
    ds_read_b128 a[108:111], v5 offset:12288
    ds_read_b128 a[112:115], v5 offset:16384
    ds_read_b128 a[116:119], v5 offset:20480
    ds_read_b128 a[120:123], v5 offset:24576
    s_waitcnt lgkmcnt(6)
    v_mfma_f32_32x32x16_bf16 v[32:47], a[96:99], a[0:3], v[32:47]
    ds_read_b128 a[124:127], v5 offset:1024
    v_mfma_f32_32x32x16_bf16 v[144:159], a[96:99], a[4:7], v[144:159]
    s_waitcnt lgkmcnt(6)
    v_mfma_f32_32x32x16_bf16 v[48:63], a[100:103], a[0:3], v[48:63]
    ds_read_b128 a[128:131], v5 offset:5120
    v_mfma_f32_32x32x16_bf16 v[160:175], a[100:103], a[4:7], v[160:175]
    s_waitcnt lgkmcnt(6)
    v_mfma_f32_32x32x16_bf16 v[64:79], a[104:107], a[0:3], v[64:79]
    ds_read_b128 a[132:135], v5 offset:9216
    v_mfma_f32_32x32x16_bf16 v[176:191], a[104:107], a[4:7], v[176:191]
    s_waitcnt lgkmcnt(6)
    v_mfma_f32_32x32x16_bf16 v[80:95], a[108:111], a[0:3], v[80:95]
    ds_read_b128 a[136:139], v5 offset:13312
    v_mfma_f32_32x32x16_bf16 v[192:207], a[108:111], a[4:7], v[192:207]
    s_waitcnt lgkmcnt(6)
    v_mfma_f32_32x32x16_bf16 v[96:111], a[112:115], a[0:3], v[96:111]
    ds_read_b128 a[140:143], v5 offset:17408
    v_mfma_f32_32x32x16_bf16 v[208:223], a[112:115], a[4:7], v[208:223]
    s_waitcnt lgkmcnt(6)
    v_mfma_f32_32x32x16_bf16 v[112:127], a[116:119], a[0:3], v[112:127]
    ds_read_b128 a[144:147], v5 offset:21504
    v_mfma_f32_32x32x16_bf16 v[224:239], a[116:119], a[4:7], v[224:239]
    s_waitcnt lgkmcnt(6)
    v_mfma_f32_32x32x16_bf16 v[128:143], a[120:123], a[0:3], v[128:143]
    ds_read_b128 a[148:151], v5 offset:25600
    v_mfma_f32_32x32x16_bf16 v[240:255], a[120:123], a[4:7], v[240:255]
    s_waitcnt lgkmcnt(6)
    v_mfma_f32_32x32x16_bf16 v[32:47], a[124:127], a[8:11], v[32:47]
    ds_read_b128 a[96:99], v5 offset:2048
    v_mfma_f32_32x32x16_bf16 v[144:159], a[124:127], a[12:15], v[144:159]
    s_waitcnt lgkmcnt(6)
    v_mfma_f32_32x32x16_bf16 v[48:63], a[128:131], a[8:11], v[48:63]
    ds_read_b128 a[100:103], v5 offset:6144
    v_mfma_f32_32x32x16_bf16 v[160:175], a[128:131], a[12:15], v[160:175]
    s_waitcnt lgkmcnt(6)
    v_mfma_f32_32x32x16_bf16 v[64:79], a[132:135], a[8:11], v[64:79]
    ds_read_b128 a[104:107], v5 offset:10240
    v_mfma_f32_32x32x16_bf16 v[176:191], a[132:135], a[12:15], v[176:191]
    s_waitcnt lgkmcnt(6)
    v_mfma_f32_32x32x16_bf16 v[80:95], a[136:139], a[8:11], v[80:95]
    ds_read_b128 a[108:111], v5 offset:14336
    v_mfma_f32_32x32x16_bf16 v[192:207], a[136:139], a[12:15], v[192:207]
    s_waitcnt lgkmcnt(6)
    v_mfma_f32_32x32x16_bf16 v[96:111], a[140:143], a[8:11], v[96:111]
    ds_read_b128 a[112:115], v5 offset:18432
    v_mfma_f32_32x32x16_bf16 v[208:223], a[140:143], a[12:15], v[208:223]
    s_waitcnt lgkmcnt(6)
    v_mfma_f32_32x32x16_bf16 v[112:127], a[144:147], a[8:11], v[112:127]
    ds_read_b128 a[116:119], v5 offset:22528
    v_mfma_f32_32x32x16_bf16 v[224:239], a[144:147], a[12:15], v[224:239]
    s_waitcnt lgkmcnt(6)
    v_mfma_f32_32x32x16_bf16 v[128:143], a[148:151], a[8:11], v[128:143]
    ds_read_b128 a[120:123], v5 offset:26624
    v_mfma_f32_32x32x16_bf16 v[240:255], a[148:151], a[12:15], v[240:255]
    s_waitcnt lgkmcnt(6)
    v_mfma_f32_32x32x16_bf16 v[32:47], a[96:99], a[16:19], v[32:47]
    ds_read_b128 a[124:127], v5 offset:3072
    v_mfma_f32_32x32x16_bf16 v[144:159], a[96:99], a[20:23], v[144:159]
    s_waitcnt lgkmcnt(6)
    v_mfma_f32_32x32x16_bf16 v[48:63], a[100:103], a[16:19], v[48:63]
    ds_read_b128 a[128:131], v5 offset:7168
    v_mfma_f32_32x32x16_bf16 v[160:175], a[100:103], a[20:23], v[160:175]
    s_waitcnt lgkmcnt(6)
    v_mfma_f32_32x32x16_bf16 v[64:79], a[104:107], a[16:19], v[64:79]
    ds_read_b128 a[132:135], v5 offset:11264
    v_mfma_f32_32x32x16_bf16 v[176:191], a[104:107], a[20:23], v[176:191]
    s_waitcnt lgkmcnt(6)
    v_mfma_f32_32x32x16_bf16 v[80:95], a[108:111], a[16:19], v[80:95]
    ds_read_b128 a[136:139], v5 offset:15360
    v_mfma_f32_32x32x16_bf16 v[192:207], a[108:111], a[20:23], v[192:207]
    s_waitcnt lgkmcnt(6)
    v_mfma_f32_32x32x16_bf16 v[96:111], a[112:115], a[16:19], v[96:111]
    ds_read_b128 a[140:143], v5 offset:19456
    v_mfma_f32_32x32x16_bf16 v[208:223], a[112:115], a[20:23], v[208:223]
    s_waitcnt lgkmcnt(6)
    v_mfma_f32_32x32x16_bf16 v[112:127], a[116:119], a[16:19], v[112:127]
    ds_read_b128 a[144:147], v5 offset:23552
    v_mfma_f32_32x32x16_bf16 v[224:239], a[116:119], a[20:23], v[224:239]
    s_waitcnt lgkmcnt(6)
    v_mfma_f32_32x32x16_bf16 v[128:143], a[120:123], a[16:19], v[128:143]
    ds_read_b128 a[148:151], v5 offset:27648
    v_mfma_f32_32x32x16_bf16 v[240:255], a[120:123], a[20:23], v[240:255]
    s_waitcnt lgkmcnt(6)
    v_mfma_f32_32x32x16_bf16 v[32:47], a[124:127], a[24:27], v[32:47]
    v_mfma_f32_32x32x16_bf16 v[144:159], a[124:127], a[28:31], v[144:159]
    s_waitcnt lgkmcnt(5)
    v_mfma_f32_32x32x16_bf16 v[48:63], a[128:131], a[24:27], v[48:63]
    v_mfma_f32_32x32x16_bf16 v[160:175], a[128:131], a[28:31], v[160:175]
    s_waitcnt lgkmcnt(4)
    v_mfma_f32_32x32x16_bf16 v[64:79], a[132:135], a[24:27], v[64:79]
    v_mfma_f32_32x32x16_bf16 v[176:191], a[132:135], a[28:31], v[176:191]
    s_waitcnt lgkmcnt(3)
    v_mfma_f32_32x32x16_bf16 v[80:95], a[136:139], a[24:27], v[80:95]
    v_mfma_f32_32x32x16_bf16 v[192:207], a[136:139], a[28:31], v[192:207]
    s_waitcnt lgkmcnt(2)
    v_mfma_f32_32x32x16_bf16 v[96:111], a[140:143], a[24:27], v[96:111]
    v_mfma_f32_32x32x16_bf16 v[208:223], a[140:143], a[28:31], v[208:223]
    s_waitcnt lgkmcnt(1)
    v_mfma_f32_32x32x16_bf16 v[112:127], a[144:147], a[24:27], v[112:127]
    v_mfma_f32_32x32x16_bf16 v[224:239], a[144:147], a[28:31], v[224:239]
    s_waitcnt lgkmcnt(0)
    v_mfma_f32_32x32x16_bf16 v[128:143], a[148:151], a[24:27], v[128:143]
    v_mfma_f32_32x32x16_bf16 v[240:255], a[148:151], a[28:31], v[240:255]
    s_add_u32 s50, s42, 0
    v_pk_mul_f32 v[32:33], v[32:33], v[40:41]
    v_pk_mul_f32 v[34:35], v[34:35], v[42:43]
    v_pk_mul_f32 v[36:37], v[36:37], v[44:45]
    v_pk_mul_f32 v[38:39], v[38:39], v[46:47]
    v_cvt_pk_bf16_f32 v8, v32, v33
    v_cvt_pk_bf16_f32 v9, v34, v35
    v_cvt_pk_bf16_f32 v10, v36, v37
    v_cvt_pk_bf16_f32 v11, v38, v39
    buffer_store_dwordx4 v[8:11], v2, s[8:11], s50 offen offset:0 sc1
    v_pk_mul_f32 v[48:49], v[48:49], v[56:57]
    v_pk_mul_f32 v[50:51], v[50:51], v[58:59]
    v_pk_mul_f32 v[52:53], v[52:53], v[60:61]
    v_pk_mul_f32 v[54:55], v[54:55], v[62:63]
    v_cvt_pk_bf16_f32 v12, v48, v49
    v_cvt_pk_bf16_f32 v13, v50, v51
    v_cvt_pk_bf16_f32 v14, v52, v53
    v_cvt_pk_bf16_f32 v15, v54, v55
    buffer_store_dwordx4 v[12:15], v2, s[8:11], s50 offen offset:1024 sc1
    v_pk_mul_f32 v[64:65], v[64:65], v[72:73]
    v_pk_mul_f32 v[66:67], v[66:67], v[74:75]
    v_pk_mul_f32 v[68:69], v[68:69], v[76:77]
    v_pk_mul_f32 v[70:71], v[70:71], v[78:79]
    v_cvt_pk_bf16_f32 v16, v64, v65
    v_cvt_pk_bf16_f32 v17, v66, v67
    v_cvt_pk_bf16_f32 v18, v68, v69
    v_cvt_pk_bf16_f32 v19, v70, v71
    buffer_store_dwordx4 v[16:19], v2, s[8:11], s50 offen offset:2048 sc1
    v_pk_mul_f32 v[80:81], v[80:81], v[88:89]
    v_pk_mul_f32 v[82:83], v[82:83], v[90:91]
    v_pk_mul_f32 v[84:85], v[84:85], v[92:93]
    v_pk_mul_f32 v[86:87], v[86:87], v[94:95]
    v_cvt_pk_bf16_f32 v20, v80, v81
    v_cvt_pk_bf16_f32 v21, v82, v83
    v_cvt_pk_bf16_f32 v22, v84, v85
    v_cvt_pk_bf16_f32 v23, v86, v87
    buffer_store_dwordx4 v[20:23], v2, s[8:11], s50 offen offset:3072 sc1
    s_add_u32 s50, s50, 4096
    v_pk_mul_f32 v[96:97], v[96:97], v[104:105]
    v_pk_mul_f32 v[98:99], v[98:99], v[106:107]
    v_pk_mul_f32 v[100:101], v[100:101], v[108:109]
    v_pk_mul_f32 v[102:103], v[102:103], v[110:111]
    v_cvt_pk_bf16_f32 v8, v96, v97
    v_cvt_pk_bf16_f32 v9, v98, v99
    v_cvt_pk_bf16_f32 v10, v100, v101
    v_cvt_pk_bf16_f32 v11, v102, v103
    buffer_store_dwordx4 v[8:11], v2, s[8:11], s50 offen offset:0 sc1
    v_pk_mul_f32 v[112:113], v[112:113], v[120:121]
    v_pk_mul_f32 v[114:115], v[114:115], v[122:123]
    v_pk_mul_f32 v[116:117], v[116:117], v[124:125]
    v_pk_mul_f32 v[118:119], v[118:119], v[126:127]
    v_cvt_pk_bf16_f32 v12, v112, v113
    v_cvt_pk_bf16_f32 v13, v114, v115
    v_cvt_pk_bf16_f32 v14, v116, v117
    v_cvt_pk_bf16_f32 v15, v118, v119
    buffer_store_dwordx4 v[12:15], v2, s[8:11], s50 offen offset:1024 sc1
    v_pk_mul_f32 v[128:129], v[128:129], v[136:137]
    v_pk_mul_f32 v[130:131], v[130:131], v[138:139]
    v_pk_mul_f32 v[132:133], v[132:133], v[140:141]
    v_pk_mul_f32 v[134:135], v[134:135], v[142:143]
    v_cvt_pk_bf16_f32 v16, v128, v129
    v_cvt_pk_bf16_f32 v17, v130, v131
    v_cvt_pk_bf16_f32 v18, v132, v133
    v_cvt_pk_bf16_f32 v19, v134, v135
    buffer_store_dwordx4 v[16:19], v2, s[8:11], s50 offen offset:2048 sc1
    s_add_u32 s50, s42, 114688
    v_pk_mul_f32 v[144:145], v[144:145], v[152:153]
    v_pk_mul_f32 v[146:147], v[146:147], v[154:155]
    v_pk_mul_f32 v[148:149], v[148:149], v[156:157]
    v_pk_mul_f32 v[150:151], v[150:151], v[158:159]
    v_cvt_pk_bf16_f32 v20, v144, v145
    v_cvt_pk_bf16_f32 v21, v146, v147
    v_cvt_pk_bf16_f32 v22, v148, v149
    v_cvt_pk_bf16_f32 v23, v150, v151
    buffer_store_dwordx4 v[20:23], v2, s[8:11], s50 offen offset:0 sc1
    v_pk_mul_f32 v[160:161], v[160:161], v[168:169]
    v_pk_mul_f32 v[162:163], v[162:163], v[170:171]
    v_pk_mul_f32 v[164:165], v[164:165], v[172:173]
    v_pk_mul_f32 v[166:167], v[166:167], v[174:175]
    v_cvt_pk_bf16_f32 v8, v160, v161
    v_cvt_pk_bf16_f32 v9, v162, v163
    v_cvt_pk_bf16_f32 v10, v164, v165
    v_cvt_pk_bf16_f32 v11, v166, v167
    buffer_store_dwordx4 v[8:11], v2, s[8:11], s50 offen offset:1024 sc1
    v_pk_mul_f32 v[176:177], v[176:177], v[184:185]
    v_pk_mul_f32 v[178:179], v[178:179], v[186:187]
    v_pk_mul_f32 v[180:181], v[180:181], v[188:189]
    v_pk_mul_f32 v[182:183], v[182:183], v[190:191]
    v_cvt_pk_bf16_f32 v12, v176, v177
    v_cvt_pk_bf16_f32 v13, v178, v179
    v_cvt_pk_bf16_f32 v14, v180, v181
    v_cvt_pk_bf16_f32 v15, v182, v183
    buffer_store_dwordx4 v[12:15], v2, s[8:11], s50 offen offset:2048 sc1
    v_pk_mul_f32 v[192:193], v[192:193], v[200:201]
    v_pk_mul_f32 v[194:195], v[194:195], v[202:203]
    v_pk_mul_f32 v[196:197], v[196:197], v[204:205]
    v_pk_mul_f32 v[198:199], v[198:199], v[206:207]
    v_cvt_pk_bf16_f32 v16, v192, v193
    v_cvt_pk_bf16_f32 v17, v194, v195
    v_cvt_pk_bf16_f32 v18, v196, v197
    v_cvt_pk_bf16_f32 v19, v198, v199
    buffer_store_dwordx4 v[16:19], v2, s[8:11], s50 offen offset:3072 sc1
    s_add_u32 s50, s50, 4096
    v_pk_mul_f32 v[208:209], v[208:209], v[216:217]
    v_pk_mul_f32 v[210:211], v[210:211], v[218:219]
    v_pk_mul_f32 v[212:213], v[212:213], v[220:221]
    v_pk_mul_f32 v[214:215], v[214:215], v[222:223]
    v_cvt_pk_bf16_f32 v20, v208, v209
    v_cvt_pk_bf16_f32 v21, v210, v211
    v_cvt_pk_bf16_f32 v22, v212, v213
    v_cvt_pk_bf16_f32 v23, v214, v215
    buffer_store_dwordx4 v[20:23], v2, s[8:11], s50 offen offset:0 sc1
    v_pk_mul_f32 v[224:225], v[224:225], v[232:233]
    v_pk_mul_f32 v[226:227], v[226:227], v[234:235]
    v_pk_mul_f32 v[228:229], v[228:229], v[236:237]
    v_pk_mul_f32 v[230:231], v[230:231], v[238:239]
    v_cvt_pk_bf16_f32 v8, v224, v225
    v_cvt_pk_bf16_f32 v9, v226, v227
    v_cvt_pk_bf16_f32 v10, v228, v229
    v_cvt_pk_bf16_f32 v11, v230, v231
    buffer_store_dwordx4 v[8:11], v2, s[8:11], s50 offen offset:1024 sc1
    v_pk_mul_f32 v[240:241], v[240:241], v[248:249]
    v_pk_mul_f32 v[242:243], v[242:243], v[250:251]
    v_pk_mul_f32 v[244:245], v[244:245], v[252:253]
    v_pk_mul_f32 v[246:247], v[246:247], v[254:255]
    v_cvt_pk_bf16_f32 v12, v240, v241
    v_cvt_pk_bf16_f32 v13, v242, v243
    v_cvt_pk_bf16_f32 v14, v244, v245
    v_cvt_pk_bf16_f32 v15, v246, v247
    buffer_store_dwordx4 v[12:15], v2, s[8:11], s50 offen offset:2048 sc1
    s_branch W_end
W_pk:
    s_mul_i32 s73, s68, s72
    s_lshr_b32 s73, s73, 16
    s_mul_i32 s74, s73, s71
    s_sub_u32 s74, s68, s74
    s_mul_i32 s74, s74, 7
    s_add_u32 s74, s74, s70
    s_mul_i32 s74, s74, 7
    s_add_u32 s74, s74, s73
    s_add_u32 s43, s74, 2048
    s_lshl_b32 s39, s74, 2
    s_add_u32 s39, s39, s13
    s_mov_b64 s[46:47], s[74:75]
    s_mov_b32 s68, s34
    s_and_b32 s69, s35, 0xffff
    s_mov_b32 s70, 1605632
    s_mov_b32 s71, 0x20000
    s_mov_b32 s72, s36
    s_and_b32 s73, s37, 0xffff
    s_mov_b32 s74, 1605632
    s_mov_b32 s75, 0x20000
    v_lshrrev_b32 v8, 2, v1
    v_mul_u32_u24 v5, 3584, v8
    v_and_b32 v8, 1, v1
    v_lshl_add_u32 v5, v8, 4, v5
    s_mul_i32 s48, s13, 7168
    v_add_u32 v6, s48, v2
    v_lshrrev_b32 v8, 5, v1
    v_lshlrev_b32 v7, 9, v8
    v_bfe_u32 v8, v1, 2, 2
    v_lshl_add_u32 v7, v8, 6, v7
    v_bfe_u32 v8, v1, 4, 1
    v_lshl_add_u32 v7, v8, 5, v7
    v_and_b32 v8, 3, v1
    v_lshl_add_u32 v7, v8, 3, v7
    v_add_u32 v7, s48, v7
    s_lshr_b32 s53, s39, 2
    s_and_b32 s54, s39, 3
    s_mul_i32 s50, s54, 401408
    s_lshl_b32 s51, s53, 5
    s_add_u32 s50, s50, s51
    s_mov_b32 exec_lo, 0x33333333
    s_mov_b32 exec_hi, 0x33333333
    buffer_load_dwordx4 v[32:35], v5, s[68:71], s50 offen
    s_mov_b32 exec_lo, 0xcccccccc
    s_mov_b32 exec_hi, 0xcccccccc
    buffer_load_dwordx4 v[32:35], v5, s[72:75], s50 offen
    s_add_u32 s50, s50, 57344
    s_mov_b32 exec_lo, 0x33333333
    s_mov_b32 exec_hi, 0x33333333
    buffer_load_dwordx4 v[36:39], v5, s[68:71], s50 offen
    s_mov_b32 exec_lo, 0xcccccccc
    s_mov_b32 exec_hi, 0xcccccccc
    buffer_load_dwordx4 v[36:39], v5, s[72:75], s50 offen
    s_add_u32 s50, s50, 57344
    s_mov_b32 exec_lo, 0x33333333
    s_mov_b32 exec_hi, 0x33333333
    buffer_load_dwordx4 v[40:43], v5, s[68:71], s50 offen
    s_mov_b32 exec_lo, 0xcccccccc
    s_mov_b32 exec_hi, 0xcccccccc
    buffer_load_dwordx4 v[40:43], v5, s[72:75], s50 offen
    s_add_u32 s50, s50, 57344
    s_mov_b32 exec_lo, 0x33333333
    s_mov_b32 exec_hi, 0x33333333
    buffer_load_dwordx4 v[44:47], v5, s[68:71], s50 offen
    s_mov_b32 exec_lo, 0xcccccccc
    s_mov_b32 exec_hi, 0xcccccccc
    buffer_load_dwordx4 v[44:47], v5, s[72:75], s50 offen
    s_add_u32 s50, s50, 57344
    s_mov_b32 exec_lo, 0x33333333
    s_mov_b32 exec_hi, 0x33333333
    buffer_load_dwordx4 v[48:51], v5, s[68:71], s50 offen
    s_mov_b32 exec_lo, 0xcccccccc
    s_mov_b32 exec_hi, 0xcccccccc
    buffer_load_dwordx4 v[48:51], v5, s[72:75], s50 offen
    s_add_u32 s50, s50, 57344
    s_mov_b32 exec_lo, 0x33333333
    s_mov_b32 exec_hi, 0x33333333
    buffer_load_dwordx4 v[52:55], v5, s[68:71], s50 offen
    s_mov_b32 exec_lo, 0xcccccccc
    s_mov_b32 exec_hi, 0xcccccccc
    buffer_load_dwordx4 v[52:55], v5, s[72:75], s50 offen
    s_add_u32 s50, s50, 57344
    s_mov_b32 exec_lo, 0x33333333
    s_mov_b32 exec_hi, 0x33333333
    buffer_load_dwordx4 v[56:59], v5, s[68:71], s50 offen
    s_mov_b32 exec_lo, 0xcccccccc
    s_mov_b32 exec_hi, 0xcccccccc
    buffer_load_dwordx4 v[56:59], v5, s[72:75], s50 offen
    s_add_u32 s50, s50, 57344
    s_mov_b64 exec, -1
    s_mul_i32 s50, s53, 28672
    s_add_u32 s50, s50, 14942208
    s_mul_i32 s51, s54, 7168
    s_add_u32 s50, s50, s51
    s_waitcnt vmcnt(12)
    ds_write_b128 v6, v[32:35] offset:0
    ds_read_b64_tr_b16 v[32:33], v7 offset:0
    ds_read_b64_tr_b16 v[34:35], v7 offset:256
    s_waitcnt vmcnt(10)
    ds_write_b128 v6, v[36:39] offset:1024
    ds_read_b64_tr_b16 v[36:37], v7 offset:1024
    ds_read_b64_tr_b16 v[38:39], v7 offset:1280
    s_waitcnt vmcnt(8)
    ds_write_b128 v6, v[40:43] offset:2048
    ds_read_b64_tr_b16 v[40:41], v7 offset:2048
    ds_read_b64_tr_b16 v[42:43], v7 offset:2304
    s_waitcnt vmcnt(6)
    ds_write_b128 v6, v[44:47] offset:3072
    ds_read_b64_tr_b16 v[44:45], v7 offset:3072
    ds_read_b64_tr_b16 v[46:47], v7 offset:3328
    s_waitcnt vmcnt(4)
    ds_write_b128 v6, v[48:51] offset:4096
    ds_read_b64_tr_b16 v[48:49], v7 offset:4096
    ds_read_b64_tr_b16 v[50:51], v7 offset:4352
    s_waitcnt vmcnt(2)
    ds_write_b128 v6, v[52:55] offset:5120
    ds_read_b64_tr_b16 v[52:53], v7 offset:5120
    ds_read_b64_tr_b16 v[54:55], v7 offset:5376
    s_waitcnt vmcnt(0)
    ds_write_b128 v6, v[56:59] offset:6144
    ds_read_b64_tr_b16 v[56:57], v7 offset:6144
    ds_read_b64_tr_b16 v[58:59], v7 offset:6400
    s_waitcnt lgkmcnt(15)
    buffer_store_dwordx4 v[32:35], v2, s[8:11], s50 offen offset:0 sc1
    buffer_store_dwordx4 v[36:39], v2, s[8:11], s50 offen offset:1024 sc1
    s_waitcnt lgkmcnt(12)
    buffer_store_dwordx4 v[40:43], v2, s[8:11], s50 offen offset:2048 sc1
    s_waitcnt lgkmcnt(9)
    buffer_store_dwordx4 v[44:47], v2, s[8:11], s50 offen offset:3072 sc1
    s_add_u32 s50, s50, 4096
    s_waitcnt lgkmcnt(6)
    buffer_store_dwordx4 v[48:51], v2, s[8:11], s50 offen offset:0 sc1
    s_waitcnt lgkmcnt(3)
    buffer_store_dwordx4 v[52:55], v2, s[8:11], s50 offen offset:1024 sc1
    s_waitcnt lgkmcnt(0)
    buffer_store_dwordx4 v[56:59], v2, s[8:11], s50 offen offset:2048 sc1
    s_mov_b64 s[74:75], s[46:47]
    s_mov_b32 s69, s43
    s_barrier
    s_branch W_end
W_pw:
    s_mul_i32 s73, s68, s72
    s_lshr_b32 s73, s73, 16
    s_mul_i32 s74, s73, s71
    s_sub_u32 s74, s68, s74
    s_mul_i32 s74, s74, 7
    s_add_u32 s74, s74, s70
    s_add_u32 s43, s74, 2160
    s_lshl_b32 s39, s74, 2
    s_add_u32 s39, s39, s13
    s_mov_b32 s68, s64
    s_and_b32 s69, s65, 0xffff
    s_mov_b32 s70, 1605632
    s_mov_b32 s71, 0x20000
    v_lshrrev_b32 v8, 2, v1
    v_mul_u32_u24 v5, 896, v8
    v_and_b32 v8, 3, v1
    v_lshl_add_u32 v5, v8, 4, v5
    s_mul_i32 s48, s13, 7168
    v_add_u32 v6, s48, v2
    v_lshrrev_b32 v8, 5, v1
    v_lshlrev_b32 v7, 9, v8
    v_bfe_u32 v8, v1, 2, 2
    v_lshl_add_u32 v7, v8, 6, v7
    v_bfe_u32 v8, v1, 4, 1
    v_lshl_add_u32 v7, v8, 5, v7
    v_and_b32 v8, 3, v1
    v_lshl_add_u32 v7, v8, 3, v7
    v_add_u32 v7, s48, v7
    s_lshr_b32 s53, s39, 4
    s_and_b32 s54, s39, 15
    s_mul_i32 s50, s54, 100352
    s_lshl_b32 s51, s53, 6
    s_add_u32 s50, s50, s51
    buffer_load_dwordx4 v[32:35], v5, s[68:71], s50 offen
    s_add_u32 s50, s50, 14336
    buffer_load_dwordx4 v[36:39], v5, s[68:71], s50 offen
    s_add_u32 s50, s50, 14336
    buffer_load_dwordx4 v[40:43], v5, s[68:71], s50 offen
    s_add_u32 s50, s50, 14336
    buffer_load_dwordx4 v[44:47], v5, s[68:71], s50 offen
    s_add_u32 s50, s50, 14336
    buffer_load_dwordx4 v[48:51], v5, s[68:71], s50 offen
    s_add_u32 s50, s50, 14336
    buffer_load_dwordx4 v[52:55], v5, s[68:71], s50 offen
    s_add_u32 s50, s50, 14336
    buffer_load_dwordx4 v[56:59], v5, s[68:71], s50 offen
    s_add_u32 s50, s50, 14336
    s_mov_b64 exec, -1
    s_mul_i32 s50, s53, 114688
    s_add_u32 s50, s50, 18874368
    s_mul_i32 s51, s54, 7168
    s_add_u32 s50, s50, s51
    s_waitcnt vmcnt(6)
    ds_write_b128 v6, v[32:35] offset:0
    ds_read_b64_tr_b16 v[32:33], v7 offset:0
    ds_read_b64_tr_b16 v[34:35], v7 offset:256
    s_waitcnt vmcnt(5)
    ds_write_b128 v6, v[36:39] offset:1024
    ds_read_b64_tr_b16 v[36:37], v7 offset:1024
    ds_read_b64_tr_b16 v[38:39], v7 offset:1280
    s_waitcnt vmcnt(4)
    ds_write_b128 v6, v[40:43] offset:2048
    ds_read_b64_tr_b16 v[40:41], v7 offset:2048
    ds_read_b64_tr_b16 v[42:43], v7 offset:2304
    s_waitcnt vmcnt(3)
    ds_write_b128 v6, v[44:47] offset:3072
    ds_read_b64_tr_b16 v[44:45], v7 offset:3072
    ds_read_b64_tr_b16 v[46:47], v7 offset:3328
    s_waitcnt vmcnt(2)
    ds_write_b128 v6, v[48:51] offset:4096
    ds_read_b64_tr_b16 v[48:49], v7 offset:4096
    ds_read_b64_tr_b16 v[50:51], v7 offset:4352
    s_waitcnt vmcnt(1)
    ds_write_b128 v6, v[52:55] offset:5120
    ds_read_b64_tr_b16 v[52:53], v7 offset:5120
    ds_read_b64_tr_b16 v[54:55], v7 offset:5376
    s_waitcnt vmcnt(0)
    ds_write_b128 v6, v[56:59] offset:6144
    ds_read_b64_tr_b16 v[56:57], v7 offset:6144
    ds_read_b64_tr_b16 v[58:59], v7 offset:6400
    s_waitcnt lgkmcnt(15)
    buffer_store_dwordx4 v[32:35], v2, s[8:11], s50 offen offset:0 sc1
    buffer_store_dwordx4 v[36:39], v2, s[8:11], s50 offen offset:1024 sc1
    s_waitcnt lgkmcnt(12)
    buffer_store_dwordx4 v[40:43], v2, s[8:11], s50 offen offset:2048 sc1
    s_waitcnt lgkmcnt(9)
    buffer_store_dwordx4 v[44:47], v2, s[8:11], s50 offen offset:3072 sc1
    s_add_u32 s50, s50, 4096
    s_waitcnt lgkmcnt(6)
    buffer_store_dwordx4 v[48:51], v2, s[8:11], s50 offen offset:0 sc1
    s_waitcnt lgkmcnt(3)
    buffer_store_dwordx4 v[52:55], v2, s[8:11], s50 offen offset:1024 sc1
    s_waitcnt lgkmcnt(0)
    buffer_store_dwordx4 v[56:59], v2, s[8:11], s50 offen offset:2048 sc1
    s_mov_b32 s69, s43
    s_barrier
    s_branch W_end
W_g2:
    s_mul_i32 s73, s68, s72
    s_lshr_b32 s73, s73, 16
    s_mul_i32 s74, s73, s71
    s_sub_u32 s74, s68, s74
    s_mul_i32 s74, s74, 7
    s_add_u32 s74, s74, s70
    s_mov_b32 s39, s74
    s_add_u32 s69, s39, 640
    v_and_b32 v8, 63, v0
    v_min_u32 v8, 55, v8
    v_lshlrev_b32 v8, 3, v8
    s_mov_b32 s38, 117457792
FW_70:
    s_add_u32 s33, s33, 1
    s_cmp_gt_u32 s33, 0x200000
    s_cbranch_scc1 L_bail
    buffer_load_dwordx2 v[10:11], v8, s[8:11], s38 offen sc1
    s_waitcnt vmcnt(0)
    v_cmp_ne_u64 vcc, s[96:97], v[10:11]
    s_cbranch_vccz FWok_71
    s_sleep 8
    s_branch FW_70
FWok_71:
    s_lshr_b32 s70, s39, 3
    s_lshl_b32 s70, s70, 4
    s_and_b32 s38, s39, 1
    s_lshl_b32 s38, s38, 3
    s_add_u32 s70, s70, s38
    s_add_u32 s70, s70, 256
    v_and_b32 v8, 63, v0
    v_min_u32 v8, 7, v8
    v_lshlrev_b32 v8, 3, v8
    s_lshl_b32 s38, s70, 3
    s_add_u32 s38, s38, 117440512
FW_72:
    s_add_u32 s33, s33, 1
    s_cmp_gt_u32 s33, 0x200000
    s_cbranch_scc1 L_bail
    buffer_load_dwordx2 v[10:11], v8, s[8:11], s38 offen sc1
    s_waitcnt vmcnt(0)
    v_cmp_ne_u64 vcc, s[96:97], v[10:11]
    s_cbranch_vccz FWok_73
    s_sleep 16
    s_branch FW_72
FWok_73:
    s_and_b32 s52, s39, 1
    s_lshr_b32 s53, s39, 2
    s_bfe_u32 s54, s39, 0x10001
    s_lshl_b32 s55, s53, 2
    s_add_u32 s55, s55, s13
    s_mul_i32 s51, s52, 57344
    s_mul_i32 s40, s55, 114688
    s_add_u32 s40, s40, s51
    s_add_u32 s40, s40, 79691776
    s_mul_i32 s41, s54, 802816
    s_add_u32 s41, s41, s51
    s_add_u32 s41, s41, 18874368
    s_mul_i32 s42, s55, 28672
    s_mul_i32 s50, s54, 14336
    s_add_u32 s42, s42, s50
    s_mul_i32 s50, s52, 26214400
    s_add_u32 s42, s42, s50
    s_add_u32 s42, s42, 87031808
    v_add_u32 v5, 0, v3
    v_add_u32 v6, 28672, v3
    v_add_u32 v7, 57344, v3
    v_add_u32 v8, 86016, v3
    v_add_u32 v9, 114688, v3
    s_lshl_b32 s44, s13, 1
    s_min_u32 s45, s44, 6
    s_add_u32 s44, s44, 1
    s_min_u32 s46, s44, 6
    s_mul_i32 s47, s45, 114688
    s_add_u32 s47, s47, s41
    s_mul_i32 s48, s46, 114688
    s_add_u32 s48, s48, s41
    s_lshl_b32 s45, s45, 12
    s_lshl_b32 s46, s46, 12
    s_mov_b32 s49, s40
    s_add_u32 s50, s45, 0
    s_mov_b32 m0, s50
    s_nop 0
    buffer_load_dwordx4 v2, s[8:11], s47 offen sc1 lds
    buffer_load_dwordx4 v2, s[8:11], s47 offen offset:1024 sc1 lds
    buffer_load_dwordx4 v2, s[8:11], s47 offen offset:2048 sc1 lds
    buffer_load_dwordx4 v2, s[8:11], s47 offen offset:3072 sc1 lds
    s_add_u32 s47, s47, 4096
    s_add_u32 s50, s46, 0
    s_mov_b32 m0, s50
    s_nop 0
    buffer_load_dwordx4 v2, s[8:11], s48 offen sc1 lds
    buffer_load_dwordx4 v2, s[8:11], s48 offen offset:1024 sc1 lds
    buffer_load_dwordx4 v2, s[8:11], s48 offen offset:2048 sc1 lds
    buffer_load_dwordx4 v2, s[8:11], s48 offen offset:3072 sc1 lds
    s_add_u32 s48, s48, 4096
    buffer_load_dwordx4 a[0:3], v2, s[8:11], s49 offen offset:0 sc1
    buffer_load_dwordx4 a[4:7], v2, s[8:11], s49 offen offset:1024 sc1
    buffer_load_dwordx4 a[8:11], v2, s[8:11], s49 offen offset:2048 sc1
    buffer_load_dwordx4 a[12:15], v2, s[8:11], s49 offen offset:3072 sc1
    s_add_u32 s49, s49, 4096
    s_add_u32 s50, s45, 28672
    s_mov_b32 m0, s50
    s_nop 0
    buffer_load_dwordx4 v2, s[8:11], s47 offen sc1 lds
    buffer_load_dwordx4 v2, s[8:11], s47 offen offset:1024 sc1 lds
    buffer_load_dwordx4 v2, s[8:11], s47 offen offset:2048 sc1 lds
    buffer_load_dwordx4 v2, s[8:11], s47 offen offset:3072 sc1 lds
    s_add_u32 s47, s47, 4096
    s_add_u32 s50, s46, 28672
    s_mov_b32 m0, s50
    s_nop 0
    buffer_load_dwordx4 v2, s[8:11], s48 offen sc1 lds
    buffer_load_dwordx4 v2, s[8:11], s48 offen offset:1024 sc1 lds
    buffer_load_dwordx4 v2, s[8:11], s48 offen offset:2048 sc1 lds
    buffer_load_dwordx4 v2, s[8:11], s48 offen offset:3072 sc1 lds
    s_add_u32 s48, s48, 4096
    buffer_load_dwordx4 a[16:19], v2, s[8:11], s49 offen offset:0 sc1
    buffer_load_dwordx4 a[20:23], v2, s[8:11], s49 offen offset:1024 sc1
    buffer_load_dwordx4 a[24:27], v2, s[8:11], s49 offen offset:2048 sc1
    buffer_load_dwordx4 a[28:31], v2, s[8:11], s49 offen offset:3072 sc1
    s_add_u32 s49, s49, 4096
    s_add_u32 s50, s45, 57344
    s_mov_b32 m0, s50
    s_nop 0
    buffer_load_dwordx4 v2, s[8:11], s47 offen sc1 lds
    buffer_load_dwordx4 v2, s[8:11], s47 offen offset:1024 sc1 lds
    buffer_load_dwordx4 v2, s[8:11], s47 offen offset:2048 sc1 lds
    buffer_load_dwordx4 v2, s[8:11], s47 offen offset:3072 sc1 lds
    s_add_u32 s47, s47, 4096
    s_add_u32 s50, s46, 57344
    s_mov_b32 m0, s50
    s_nop 0
    buffer_load_dwordx4 v2, s[8:11], s48 offen sc1 lds
    buffer_load_dwordx4 v2, s[8:11], s48 offen offset:1024 sc1 lds
    buffer_load_dwordx4 v2, s[8:11], s48 offen offset:2048 sc1 lds
    buffer_load_dwordx4 v2, s[8:11], s48 offen offset:3072 sc1 lds
    s_add_u32 s48, s48, 4096
    buffer_load_dwordx4 a[32:35], v2, s[8:11], s49 offen offset:0 sc1
    buffer_load_dwordx4 a[36:39], v2, s[8:11], s49 offen offset:1024 sc1
    buffer_load_dwordx4 a[40:43], v2, s[8:11], s49 offen offset:2048 sc1
    buffer_load_dwordx4 a[44:47], v2, s[8:11], s49 offen offset:3072 sc1
    s_add_u32 s49, s49, 4096
    s_add_u32 s50, s45, 86016
    s_mov_b32 m0, s50
    s_nop 0
    buffer_load_dwordx4 v2, s[8:11], s47 offen sc1 lds
    buffer_load_dwordx4 v2, s[8:11], s47 offen offset:1024 sc1 lds
    buffer_load_dwordx4 v2, s[8:11], s47 offen offset:2048 sc1 lds
    buffer_load_dwordx4 v2, s[8:11], s47 offen offset:3072 sc1 lds
    s_add_u32 s47, s47, 4096
    s_add_u32 s50, s46, 86016
    s_mov_b32 m0, s50
    s_nop 0
    buffer_load_dwordx4 v2, s[8:11], s48 offen sc1 lds
    buffer_load_dwordx4 v2, s[8:11], s48 offen offset:1024 sc1 lds
    buffer_load_dwordx4 v2, s[8:11], s48 offen offset:2048 sc1 lds
    buffer_load_dwordx4 v2, s[8:11], s48 offen offset:3072 sc1 lds
    s_add_u32 s48, s48, 4096
    buffer_load_dwordx4 a[48:51], v2, s[8:11], s49 offen offset:0 sc1
    buffer_load_dwordx4 a[52:55], v2, s[8:11], s49 offen offset:1024 sc1
    buffer_load_dwordx4 a[56:59], v2, s[8:11], s49 offen offset:2048 sc1
    buffer_load_dwordx4 a[60:63], v2, s[8:11], s49 offen offset:3072 sc1
    s_add_u32 s49, s49, 4096
    v_mov_b32 v32, 0
    v_mov_b32 v33, 0
    v_mov_b32 v34, 0
    v_mov_b32 v35, 0
    v_mov_b32 v36, 0
    v_mov_b32 v37, 0
    v_mov_b32 v38, 0
    v_mov_b32 v39, 0
    v_mov_b32 v40, 0
    v_mov_b32 v41, 0
    v_mov_b32 v42, 0
    v_mov_b32 v43, 0
    v_mov_b32 v44, 0
    v_mov_b32 v45, 0
    v_mov_b32 v46, 0
    v_mov_b32 v47, 0
    v_mov_b32 v48, 0
    v_mov_b32 v49, 0
    v_mov_b32 v50, 0
    v_mov_b32 v51, 0
    v_mov_b32 v52, 0
    v_mov_b32 v53, 0
    v_mov_b32 v54, 0
    v_mov_b32 v55, 0
    v_mov_b32 v56, 0
    v_mov_b32 v57, 0
    v_mov_b32 v58, 0
    v_mov_b32 v59, 0
    v_mov_b32 v60, 0
    v_mov_b32 v61, 0
    v_mov_b32 v62, 0
    v_mov_b32 v63, 0
    v_mov_b32 v64, 0
    v_mov_b32 v65, 0
    v_mov_b32 v66, 0
    v_mov_b32 v67, 0
    v_mov_b32 v68, 0
    v_mov_b32 v69, 0
    v_mov_b32 v70, 0
    v_mov_b32 v71, 0
    v_mov_b32 v72, 0
    v_mov_b32 v73, 0
    v_mov_b32 v74, 0
    v_mov_b32 v75, 0
    v_mov_b32 v76, 0
    v_mov_b32 v77, 0
    v_mov_b32 v78, 0
    v_mov_b32 v79, 0
    v_mov_b32 v80, 0
    v_mov_b32 v81, 0
    v_mov_b32 v82, 0
    v_mov_b32 v83, 0
    v_mov_b32 v84, 0
    v_mov_b32 v85, 0
    v_mov_b32 v86, 0
    v_mov_b32 v87, 0
    v_mov_b32 v88, 0
    v_mov_b32 v89, 0
    v_mov_b32 v90, 0
    v_mov_b32 v91, 0
    v_mov_b32 v92, 0
    v_mov_b32 v93, 0
    v_mov_b32 v94, 0
    v_mov_b32 v95, 0
    v_mov_b32 v96, 0
    v_mov_b32 v97, 0
    v_mov_b32 v98, 0
    v_mov_b32 v99, 0
    v_mov_b32 v100, 0
    v_mov_b32 v101, 0
    v_mov_b32 v102, 0
    v_mov_b32 v103, 0
    v_mov_b32 v104, 0
    v_mov_b32 v105, 0
    v_mov_b32 v106, 0
    v_mov_b32 v107, 0
    v_mov_b32 v108, 0
    v_mov_b32 v109, 0
    v_mov_b32 v110, 0
    v_mov_b32 v111, 0
    v_mov_b32 v112, 0
    v_mov_b32 v113, 0
    v_mov_b32 v114, 0
    v_mov_b32 v115, 0
    v_mov_b32 v116, 0
    v_mov_b32 v117, 0
    v_mov_b32 v118, 0
    v_mov_b32 v119, 0
    v_mov_b32 v120, 0
    v_mov_b32 v121, 0
    v_mov_b32 v122, 0
    v_mov_b32 v123, 0
    v_mov_b32 v124, 0
    v_mov_b32 v125, 0
    v_mov_b32 v126, 0
    v_mov_b32 v127, 0
    v_mov_b32 v128, 0
    v_mov_b32 v129, 0
    v_mov_b32 v130, 0
    v_mov_b32 v131, 0
    v_mov_b32 v132, 0
    v_mov_b32 v133, 0
    v_mov_b32 v134, 0
    v_mov_b32 v135, 0
    v_mov_b32 v136, 0
    v_mov_b32 v137, 0
    v_mov_b32 v138, 0
    v_mov_b32 v139, 0
    v_mov_b32 v140, 0
    v_mov_b32 v141, 0
    v_mov_b32 v142, 0
    v_mov_b32 v143, 0
    s_mov_b32 s52, 2
g2_loop_74:
    s_waitcnt vmcnt(36)
    s_barrier
    ds_read_b128 a[80:83], v5 offset:0
    ds_read_b128 a[84:87], v5 offset:4096
    ds_read_b128 a[88:91], v5 offset:8192
    ds_read_b128 a[92:95], v5 offset:12288
    ds_read_b128 a[96:99], v5 offset:16384
    ds_read_b128 a[100:103], v5 offset:20480
    ds_read_b128 a[104:107], v5 offset:24576
    s_waitcnt lgkmcnt(6)
    v_mfma_f32_32x32x16_bf16 v[32:47], a[80:83], a[0:3], v[32:47]
    ds_read_b128 a[108:111], v5 offset:1024
    s_waitcnt lgkmcnt(6)
    v_mfma_f32_32x32x16_bf16 v[48:63], a[84:87], a[0:3], v[48:63]
    ds_read_b128 a[112:115], v5 offset:5120
    s_add_u32 s50, s45, 114688
    s_mov_b32 m0, s50
    s_nop 0
    buffer_load_dwordx4 v2, s[8:11], s47 offen sc1 lds
    s_waitcnt lgkmcnt(6)
    v_mfma_f32_32x32x16_bf16 v[64:79], a[88:91], a[0:3], v[64:79]
    ds_read_b128 a[116:119], v5 offset:9216
    s_waitcnt lgkmcnt(6)
    v_mfma_f32_32x32x16_bf16 v[80:95], a[92:95], a[0:3], v[80:95]
    ds_read_b128 a[120:123], v5 offset:13312
    buffer_load_dwordx4 v2, s[8:11], s47 offen offset:1024 sc1 lds
    s_waitcnt lgkmcnt(6)
    v_mfma_f32_32x32x16_bf16 v[96:111], a[96:99], a[0:3], v[96:111]
    ds_read_b128 a[124:127], v5 offset:17408
    s_waitcnt lgkmcnt(6)
    v_mfma_f32_32x32x16_bf16 v[112:127], a[100:103], a[0:3], v[112:127]
    ds_read_b128 a[128:131], v5 offset:21504
    buffer_load_dwordx4 v2, s[8:11], s47 offen offset:2048 sc1 lds
    s_waitcnt lgkmcnt(6)
    v_mfma_f32_32x32x16_bf16 v[128:143], a[104:107], a[0:3], v[128:143]
    ds_read_b128 a[132:135], v5 offset:25600
    s_waitcnt lgkmcnt(6)
    v_mfma_f32_32x32x16_bf16 v[32:47], a[108:111], a[4:7], v[32:47]
    ds_read_b128 a[80:83], v5 offset:2048
    s_waitcnt lgkmcnt(6)
    v_mfma_f32_32x32x16_bf16 v[48:63], a[112:115], a[4:7], v[48:63]
    ds_read_b128 a[84:87], v5 offset:6144
    buffer_load_dwordx4 v2, s[8:11], s47 offen offset:3072 sc1 lds
    s_add_u32 s47, s47, 4096
    s_waitcnt lgkmcnt(6)
    v_mfma_f32_32x32x16_bf16 v[64:79], a[116:119], a[4:7], v[64:79]
    ds_read_b128 a[88:91], v5 offset:10240
    s_waitcnt lgkmcnt(6)
    v_mfma_f32_32x32x16_bf16 v[80:95], a[120:123], a[4:7], v[80:95]
    ds_read_b128 a[92:95], v5 offset:14336
    s_add_u32 s50, s46, 114688
    s_mov_b32 m0, s50
    s_nop 0
    buffer_load_dwordx4 v2, s[8:11], s48 offen sc1 lds
    s_waitcnt lgkmcnt(6)
    v_mfma_f32_32x32x16_bf16 v[96:111], a[124:127], a[4:7], v[96:111]
    ds_read_b128 a[96:99], v5 offset:18432
    s_waitcnt lgkmcnt(6)
    v_mfma_f32_32x32x16_bf16 v[112:127], a[128:131], a[4:7], v[112:127]
    ds_read_b128 a[100:103], v5 offset:22528
    buffer_load_dwordx4 v2, s[8:11], s48 offen offset:1024 sc1 lds
    s_waitcnt lgkmcnt(6)
    v_mfma_f32_32x32x16_bf16 v[128:143], a[132:135], a[4:7], v[128:143]
    ds_read_b128 a[104:107], v5 offset:26624
    s_waitcnt lgkmcnt(6)
    v_mfma_f32_32x32x16_bf16 v[32:47], a[80:83], a[8:11], v[32:47]
    ds_read_b128 a[108:111], v5 offset:3072
    s_waitcnt lgkmcnt(6)
    v_mfma_f32_32x32x16_bf16 v[48:63], a[84:87], a[8:11], v[48:63]
    ds_read_b128 a[112:115], v5 offset:7168
    buffer_load_dwordx4 v2, s[8:11], s48 offen offset:2048 sc1 lds
    s_waitcnt lgkmcnt(6)
    v_mfma_f32_32x32x16_bf16 v[64:79], a[88:91], a[8:11], v[64:79]
    ds_read_b128 a[116:119], v5 offset:11264
    s_waitcnt lgkmcnt(6)
    v_mfma_f32_32x32x16_bf16 v[80:95], a[92:95], a[8:11], v[80:95]
    ds_read_b128 a[120:123], v5 offset:15360
    buffer_load_dwordx4 v2, s[8:11], s48 offen offset:3072 sc1 lds
    s_add_u32 s48, s48, 4096
    s_waitcnt lgkmcnt(6)
    v_mfma_f32_32x32x16_bf16 v[96:111], a[96:99], a[8:11], v[96:111]
    ds_read_b128 a[124:127], v5 offset:19456
    s_waitcnt lgkmcnt(6)
    v_mfma_f32_32x32x16_bf16 v[112:127], a[100:103], a[8:11], v[112:127]
    ds_read_b128 a[128:131], v5 offset:23552
    buffer_load_dwordx4 a[64:67], v2, s[8:11], s49 offen offset:0 sc1
    s_waitcnt lgkmcnt(6)
    v_mfma_f32_32x32x16_bf16 v[128:143], a[104:107], a[8:11], v[128:143]
    ds_read_b128 a[132:135], v5 offset:27648
    s_waitcnt lgkmcnt(6)
    v_mfma_f32_32x32x16_bf16 v[32:47], a[108:111], a[12:15], v[32:47]
    buffer_load_dwordx4 a[68:71], v2, s[8:11], s49 offen offset:1024 sc1
    s_waitcnt lgkmcnt(5)
    v_mfma_f32_32x32x16_bf16 v[48:63], a[112:115], a[12:15], v[48:63]
    buffer_load_dwordx4 a[72:75], v2, s[8:11], s49 offen offset:2048 sc1
    buffer_load_dwordx4 a[76:79], v2, s[8:11], s49 offen offset:3072 sc1
    s_add_u32 s49, s49, 4096
    s_waitcnt lgkmcnt(4)
    v_mfma_f32_32x32x16_bf16 v[64:79], a[116:119], a[12:15], v[64:79]
    s_waitcnt lgkmcnt(3)
    v_mfma_f32_32x32x16_bf16 v[80:95], a[120:123], a[12:15], v[80:95]
    s_waitcnt lgkmcnt(2)
    v_mfma_f32_32x32x16_bf16 v[96:111], a[124:127], a[12:15], v[96:111]
    s_waitcnt lgkmcnt(1)
    v_mfma_f32_32x32x16_bf16 v[112:127], a[128:131], a[12:15], v[112:127]
    s_waitcnt lgkmcnt(0)
    v_mfma_f32_32x32x16_bf16 v[128:143], a[132:135], a[12:15], v[128:143]
    s_waitcnt vmcnt(36)
    s_barrier
    ds_read_b128 a[80:83], v6 offset:0
    ds_read_b128 a[84:87], v6 offset:4096
    ds_read_b128 a[88:91], v6 offset:8192
    ds_read_b128 a[92:95], v6 offset:12288
    ds_read_b128 a[96:99], v6 offset:16384
    ds_read_b128 a[100:103], v6 offset:20480
    ds_read_b128 a[104:107], v6 offset:24576
    s_waitcnt lgkmcnt(6)
    v_mfma_f32_32x32x16_bf16 v[32:47], a[80:83], a[16:19], v[32:47]
    ds_read_b128 a[108:111], v6 offset:1024
    s_waitcnt lgkmcnt(6)
    v_mfma_f32_32x32x16_bf16 v[48:63], a[84:87], a[16:19], v[48:63]
    ds_read_b128 a[112:115], v6 offset:5120
    s_add_u32 s50, s45, 0
    s_mov_b32 m0, s50
    s_nop 0
    buffer_load_dwordx4 v2, s[8:11], s47 offen sc1 lds
    s_waitcnt lgkmcnt(6)
    v_mfma_f32_32x32x16_bf16 v[64:79], a[88:91], a[16:19], v[64:79]
    ds_read_b128 a[116:119], v6 offset:9216
    s_waitcnt lgkmcnt(6)
    v_mfma_f32_32x32x16_bf16 v[80:95], a[92:95], a[16:19], v[80:95]
    ds_read_b128 a[120:123], v6 offset:13312
    buffer_load_dwordx4 v2, s[8:11], s47 offen offset:1024 sc1 lds
    s_waitcnt lgkmcnt(6)
    v_mfma_f32_32x32x16_bf16 v[96:111], a[96:99], a[16:19], v[96:111]
    ds_read_b128 a[124:127], v6 offset:17408
    s_waitcnt lgkmcnt(6)
    v_mfma_f32_32x32x16_bf16 v[112:127], a[100:103], a[16:19], v[112:127]
    ds_read_b128 a[128:131], v6 offset:21504
    buffer_load_dwordx4 v2, s[8:11], s47 offen offset:2048 sc1 lds
    s_waitcnt lgkmcnt(6)
    v_mfma_f32_32x32x16_bf16 v[128:143], a[104:107], a[16:19], v[128:143]
    ds_read_b128 a[132:135], v6 offset:25600
    s_waitcnt lgkmcnt(6)
    v_mfma_f32_32x32x16_bf16 v[32:47], a[108:111], a[20:23], v[32:47]
    ds_read_b128 a[80:83], v6 offset:2048
    s_waitcnt lgkmcnt(6)
    v_mfma_f32_32x32x16_bf16 v[48:63], a[112:115], a[20:23], v[48:63]
    ds_read_b128 a[84:87], v6 offset:6144
    buffer_load_dwordx4 v2, s[8:11], s47 offen offset:3072 sc1 lds
    s_add_u32 s47, s47, 4096
    s_waitcnt lgkmcnt(6)
    v_mfma_f32_32x32x16_bf16 v[64:79], a[116:119], a[20:23], v[64:79]
    ds_read_b128 a[88:91], v6 offset:10240
    s_waitcnt lgkmcnt(6)
    v_mfma_f32_32x32x16_bf16 v[80:95], a[120:123], a[20:23], v[80:95]
    ds_read_b128 a[92:95], v6 offset:14336
    s_add_u32 s50, s46, 0
    s_mov_b32 m0, s50
    s_nop 0
    buffer_load_dwordx4 v2, s[8:11], s48 offen sc1 lds
    s_waitcnt lgkmcnt(6)
    v_mfma_f32_32x32x16_bf16 v[96:111], a[124:127], a[20:23], v[96:111]
    ds_read_b128 a[96:99], v6 offset:18432
    s_waitcnt lgkmcnt(6)
    v_mfma_f32_32x32x16_bf16 v[112:127], a[128:131], a[20:23], v[112:127]
    ds_read_b128 a[100:103], v6 offset:22528
    buffer_load_dwordx4 v2, s[8:11], s48 offen offset:1024 sc1 lds
    s_waitcnt lgkmcnt(6)
    v_mfma_f32_32x32x16_bf16 v[128:143], a[132:135], a[20:23], v[128:143]
    ds_read_b128 a[104:107], v6 offset:26624
    s_waitcnt lgkmcnt(6)
    v_mfma_f32_32x32x16_bf16 v[32:47], a[80:83], a[24:27], v[32:47]
    ds_read_b128 a[108:111], v6 offset:3072
    s_waitcnt lgkmcnt(6)
    v_mfma_f32_32x32x16_bf16 v[48:63], a[84:87], a[24:27], v[48:63]
    ds_read_b128 a[112:115], v6 offset:7168
    buffer_load_dwordx4 v2, s[8:11], s48 offen offset:2048 sc1 lds
    s_waitcnt lgkmcnt(6)
    v_mfma_f32_32x32x16_bf16 v[64:79], a[88:91], a[24:27], v[64:79]
    ds_read_b128 a[116:119], v6 offset:11264
    s_waitcnt lgkmcnt(6)
    v_mfma_f32_32x32x16_bf16 v[80:95], a[92:95], a[24:27], v[80:95]
    ds_read_b128 a[120:123], v6 offset:15360
    buffer_load_dwordx4 v2, s[8:11], s48 offen offset:3072 sc1 lds
    s_add_u32 s48, s48, 4096
    s_waitcnt lgkmcnt(6)
    v_mfma_f32_32x32x16_bf16 v[96:111], a[96:99], a[24:27], v[96:111]
    ds_read_b128 a[124:127], v6 offset:19456
    s_waitcnt lgkmcnt(6)
    v_mfma_f32_32x32x16_bf16 v[112:127], a[100:103], a[24:27], v[112:127]
    ds_read_b128 a[128:131], v6 offset:23552
    buffer_load_dwordx4 a[0:3], v2, s[8:11], s49 offen offset:0 sc1
    s_waitcnt lgkmcnt(6)
    v_mfma_f32_32x32x16_bf16 v[128:143], a[104:107], a[24:27], v[128:143]
    ds_read_b128 a[132:135], v6 offset:27648
    s_waitcnt lgkmcnt(6)
    v_mfma_f32_32x32x16_bf16 v[32:47], a[108:111], a[28:31], v[32:47]
    buffer_load_dwordx4 a[4:7], v2, s[8:11], s49 offen offset:1024 sc1
    s_waitcnt lgkmcnt(5)
    v_mfma_f32_32x32x16_bf16 v[48:63], a[112:115], a[28:31], v[48:63]
    buffer_load_dwordx4 a[8:11], v2, s[8:11], s49 offen offset:2048 sc1
    buffer_load_dwordx4 a[12:15], v2, s[8:11], s49 offen offset:3072 sc1
    s_add_u32 s49, s49, 4096
    s_waitcnt lgkmcnt(4)
    v_mfma_f32_32x32x16_bf16 v[64:79], a[116:119], a[28:31], v[64:79]
    s_waitcnt lgkmcnt(3)
    v_mfma_f32_32x32x16_bf16 v[80:95], a[120:123], a[28:31], v[80:95]
    s_waitcnt lgkmcnt(2)
    v_mfma_f32_32x32x16_bf16 v[96:111], a[124:127], a[28:31], v[96:111]
    s_waitcnt lgkmcnt(1)
    v_mfma_f32_32x32x16_bf16 v[112:127], a[128:131], a[28:31], v[112:127]
    s_waitcnt lgkmcnt(0)
    v_mfma_f32_32x32x16_bf16 v[128:143], a[132:135], a[28:31], v[128:143]
    s_waitcnt vmcnt(36)
    s_barrier
    ds_read_b128 a[80:83], v7 offset:0
    ds_read_b128 a[84:87], v7 offset:4096
    ds_read_b128 a[88:91], v7 offset:8192
    ds_read_b128 a[92:95], v7 offset:12288
    ds_read_b128 a[96:99], v7 offset:16384
    ds_read_b128 a[100:103], v7 offset:20480
    ds_read_b128 a[104:107], v7 offset:24576
    s_waitcnt lgkmcnt(6)
    v_mfma_f32_32x32x16_bf16 v[32:47], a[80:83], a[32:35], v[32:47]
    ds_read_b128 a[108:111], v7 offset:1024
    s_waitcnt lgkmcnt(6)
    v_mfma_f32_32x32x16_bf16 v[48:63], a[84:87], a[32:35], v[48:63]
    ds_read_b128 a[112:115], v7 offset:5120
    s_add_u32 s50, s45, 28672
    s_mov_b32 m0, s50
    s_nop 0
    buffer_load_dwordx4 v2, s[8:11], s47 offen sc1 lds
    s_waitcnt lgkmcnt(6)
    v_mfma_f32_32x32x16_bf16 v[64:79], a[88:91], a[32:35], v[64:79]
    ds_read_b128 a[116:119], v7 offset:9216
    s_waitcnt lgkmcnt(6)
    v_mfma_f32_32x32x16_bf16 v[80:95], a[92:95], a[32:35], v[80:95]
    ds_read_b128 a[120:123], v7 offset:13312
    buffer_load_dwordx4 v2, s[8:11], s47 offen offset:1024 sc1 lds
    s_waitcnt lgkmcnt(6)
    v_mfma_f32_32x32x16_bf16 v[96:111], a[96:99], a[32:35], v[96:111]
    ds_read_b128 a[124:127], v7 offset:17408
    s_waitcnt lgkmcnt(6)
    v_mfma_f32_32x32x16_bf16 v[112:127], a[100:103], a[32:35], v[112:127]
    ds_read_b128 a[128:131], v7 offset:21504
    buffer_load_dwordx4 v2, s[8:11], s47 offen offset:2048 sc1 lds
    s_waitcnt lgkmcnt(6)
    v_mfma_f32_32x32x16_bf16 v[128:143], a[104:107], a[32:35], v[128:143]
    ds_read_b128 a[132:135], v7 offset:25600
    s_waitcnt lgkmcnt(6)
    v_mfma_f32_32x32x16_bf16 v[32:47], a[108:111], a[36:39], v[32:47]
    ds_read_b128 a[80:83], v7 offset:2048
    s_waitcnt lgkmcnt(6)
    v_mfma_f32_32x32x16_bf16 v[48:63], a[112:115], a[36:39], v[48:63]
    ds_read_b128 a[84:87], v7 offset:6144
    buffer_load_dwordx4 v2, s[8:11], s47 offen offset:3072 sc1 lds
    s_add_u32 s47, s47, 4096
    s_waitcnt lgkmcnt(6)
    v_mfma_f32_32x32x16_bf16 v[64:79], a[116:119], a[36:39], v[64:79]
    ds_read_b128 a[88:91], v7 offset:10240
    s_waitcnt lgkmcnt(6)
    v_mfma_f32_32x32x16_bf16 v[80:95], a[120:123], a[36:39], v[80:95]
    ds_read_b128 a[92:95], v7 offset:14336
    s_add_u32 s50, s46, 28672
    s_mov_b32 m0, s50
    s_nop 0
    buffer_load_dwordx4 v2, s[8:11], s48 offen sc1 lds
    s_waitcnt lgkmcnt(6)
    v_mfma_f32_32x32x16_bf16 v[96:111], a[124:127], a[36:39], v[96:111]
    ds_read_b128 a[96:99], v7 offset:18432
    s_waitcnt lgkmcnt(6)
    v_mfma_f32_32x32x16_bf16 v[112:127], a[128:131], a[36:39], v[112:127]
    ds_read_b128 a[100:103], v7 offset:22528
    buffer_load_dwordx4 v2, s[8:11], s48 offen offset:1024 sc1 lds
    s_waitcnt lgkmcnt(6)
    v_mfma_f32_32x32x16_bf16 v[128:143], a[132:135], a[36:39], v[128:143]
    ds_read_b128 a[104:107], v7 offset:26624
    s_waitcnt lgkmcnt(6)
    v_mfma_f32_32x32x16_bf16 v[32:47], a[80:83], a[40:43], v[32:47]
    ds_read_b128 a[108:111], v7 offset:3072
    s_waitcnt lgkmcnt(6)
    v_mfma_f32_32x32x16_bf16 v[48:63], a[84:87], a[40:43], v[48:63]
    ds_read_b128 a[112:115], v7 offset:7168
    buffer_load_dwordx4 v2, s[8:11], s48 offen offset:2048 sc1 lds
    s_waitcnt lgkmcnt(6)
    v_mfma_f32_32x32x16_bf16 v[64:79], a[88:91], a[40:43], v[64:79]
    ds_read_b128 a[116:119], v7 offset:11264
    s_waitcnt lgkmcnt(6)
    v_mfma_f32_32x32x16_bf16 v[80:95], a[92:95], a[40:43], v[80:95]
    ds_read_b128 a[120:123], v7 offset:15360
    buffer_load_dwordx4 v2, s[8:11], s48 offen offset:3072 sc1 lds
    s_add_u32 s48, s48, 4096
    s_waitcnt lgkmcnt(6)
    v_mfma_f32_32x32x16_bf16 v[96:111], a[96:99], a[40:43], v[96:111]
    ds_read_b128 a[124:127], v7 offset:19456
    s_waitcnt lgkmcnt(6)
    v_mfma_f32_32x32x16_bf16 v[112:127], a[100:103], a[40:43], v[112:127]
    ds_read_b128 a[128:131], v7 offset:23552
    buffer_load_dwordx4 a[16:19], v2, s[8:11], s49 offen offset:0 sc1
    s_waitcnt lgkmcnt(6)
    v_mfma_f32_32x32x16_bf16 v[128:143], a[104:107], a[40:43], v[128:143]
    ds_read_b128 a[132:135], v7 offset:27648
    s_waitcnt lgkmcnt(6)
    v_mfma_f32_32x32x16_bf16 v[32:47], a[108:111], a[44:47], v[32:47]
    buffer_load_dwordx4 a[20:23], v2, s[8:11], s49 offen offset:1024 sc1
    s_waitcnt lgkmcnt(5)
    v_mfma_f32_32x32x16_bf16 v[48:63], a[112:115], a[44:47], v[48:63]
    buffer_load_dwordx4 a[24:27], v2, s[8:11], s49 offen offset:2048 sc1
    buffer_load_dwordx4 a[28:31], v2, s[8:11], s49 offen offset:3072 sc1
    s_add_u32 s49, s49, 4096
    s_waitcnt lgkmcnt(4)
    v_mfma_f32_32x32x16_bf16 v[64:79], a[116:119], a[44:47], v[64:79]
    s_waitcnt lgkmcnt(3)
    v_mfma_f32_32x32x16_bf16 v[80:95], a[120:123], a[44:47], v[80:95]
    s_waitcnt lgkmcnt(2)
    v_mfma_f32_32x32x16_bf16 v[96:111], a[124:127], a[44:47], v[96:111]
    s_waitcnt lgkmcnt(1)
    v_mfma_f32_32x32x16_bf16 v[112:127], a[128:131], a[44:47], v[112:127]
    s_waitcnt lgkmcnt(0)
    v_mfma_f32_32x32x16_bf16 v[128:143], a[132:135], a[44:47], v[128:143]
    s_waitcnt vmcnt(36)
    s_barrier
    ds_read_b128 a[80:83], v8 offset:0
    ds_read_b128 a[84:87], v8 offset:4096
    ds_read_b128 a[88:91], v8 offset:8192
    ds_read_b128 a[92:95], v8 offset:12288
    ds_read_b128 a[96:99], v8 offset:16384
    ds_read_b128 a[100:103], v8 offset:20480
    ds_read_b128 a[104:107], v8 offset:24576
    s_waitcnt lgkmcnt(6)
    v_mfma_f32_32x32x16_bf16 v[32:47], a[80:83], a[48:51], v[32:47]
    ds_read_b128 a[108:111], v8 offset:1024
    s_waitcnt lgkmcnt(6)
    v_mfma_f32_32x32x16_bf16 v[48:63], a[84:87], a[48:51], v[48:63]
    ds_read_b128 a[112:115], v8 offset:5120
    s_add_u32 s50, s45, 57344
    s_mov_b32 m0, s50
    s_nop 0
    buffer_load_dwordx4 v2, s[8:11], s47 offen sc1 lds
    s_waitcnt lgkmcnt(6)
    v_mfma_f32_32x32x16_bf16 v[64:79], a[88:91], a[48:51], v[64:79]
    ds_read_b128 a[116:119], v8 offset:9216
    s_waitcnt lgkmcnt(6)
    v_mfma_f32_32x32x16_bf16 v[80:95], a[92:95], a[48:51], v[80:95]
    ds_read_b128 a[120:123], v8 offset:13312
    buffer_load_dwordx4 v2, s[8:11], s47 offen offset:1024 sc1 lds
    s_waitcnt lgkmcnt(6)
    v_mfma_f32_32x32x16_bf16 v[96:111], a[96:99], a[48:51], v[96:111]
    ds_read_b128 a[124:127], v8 offset:17408
    s_waitcnt lgkmcnt(6)
    v_mfma_f32_32x32x16_bf16 v[112:127], a[100:103], a[48:51], v[112:127]
    ds_read_b128 a[128:131], v8 offset:21504
    buffer_load_dwordx4 v2, s[8:11], s47 offen offset:2048 sc1 lds
    s_waitcnt lgkmcnt(6)
    v_mfma_f32_32x32x16_bf16 v[128:143], a[104:107], a[48:51], v[128:143]
    ds_read_b128 a[132:135], v8 offset:25600
    s_waitcnt lgkmcnt(6)
    v_mfma_f32_32x32x16_bf16 v[32:47], a[108:111], a[52:55], v[32:47]
    ds_read_b128 a[80:83], v8 offset:2048
    s_waitcnt lgkmcnt(6)
    v_mfma_f32_32x32x16_bf16 v[48:63], a[112:115], a[52:55], v[48:63]
    ds_read_b128 a[84:87], v8 offset:6144
    buffer_load_dwordx4 v2, s[8:11], s47 offen offset:3072 sc1 lds
    s_add_u32 s47, s47, 4096
    s_waitcnt lgkmcnt(6)
    v_mfma_f32_32x32x16_bf16 v[64:79], a[116:119], a[52:55], v[64:79]
    ds_read_b128 a[88:91], v8 offset:10240
    s_waitcnt lgkmcnt(6)
    v_mfma_f32_32x32x16_bf16 v[80:95], a[120:123], a[52:55], v[80:95]
    ds_read_b128 a[92:95], v8 offset:14336
    s_add_u32 s50, s46, 57344
    s_mov_b32 m0, s50
    s_nop 0
    buffer_load_dwordx4 v2, s[8:11], s48 offen sc1 lds
    s_waitcnt lgkmcnt(6)
    v_mfma_f32_32x32x16_bf16 v[96:111], a[124:127], a[52:55], v[96:111]
    ds_read_b128 a[96:99], v8 offset:18432
    s_waitcnt lgkmcnt(6)
    v_mfma_f32_32x32x16_bf16 v[112:127], a[128:131], a[52:55], v[112:127]
    ds_read_b128 a[100:103], v8 offset:22528
    buffer_load_dwordx4 v2, s[8:11], s48 offen offset:1024 sc1 lds
    s_waitcnt lgkmcnt(6)
    v_mfma_f32_32x32x16_bf16 v[128:143], a[132:135], a[52:55], v[128:143]
    ds_read_b128 a[104:107], v8 offset:26624
    s_waitcnt lgkmcnt(6)
    v_mfma_f32_32x32x16_bf16 v[32:47], a[80:83], a[56:59], v[32:47]
    ds_read_b128 a[108:111], v8 offset:3072
    s_waitcnt lgkmcnt(6)
    v_mfma_f32_32x32x16_bf16 v[48:63], a[84:87], a[56:59], v[48:63]
    ds_read_b128 a[112:115], v8 offset:7168
    buffer_load_dwordx4 v2, s[8:11], s48 offen offset:2048 sc1 lds
    s_waitcnt lgkmcnt(6)
    v_mfma_f32_32x32x16_bf16 v[64:79], a[88:91], a[56:59], v[64:79]
    ds_read_b128 a[116:119], v8 offset:11264
    s_waitcnt lgkmcnt(6)
    v_mfma_f32_32x32x16_bf16 v[80:95], a[92:95], a[56:59], v[80:95]
    ds_read_b128 a[120:123], v8 offset:15360
    buffer_load_dwordx4 v2, s[8:11], s48 offen offset:3072 sc1 lds
    s_add_u32 s48, s48, 4096
    s_waitcnt lgkmcnt(6)
    v_mfma_f32_32x32x16_bf16 v[96:111], a[96:99], a[56:59], v[96:111]
    ds_read_b128 a[124:127], v8 offset:19456
    s_waitcnt lgkmcnt(6)
    v_mfma_f32_32x32x16_bf16 v[112:127], a[100:103], a[56:59], v[112:127]
    ds_read_b128 a[128:131], v8 offset:23552
    buffer_load_dwordx4 a[32:35], v2, s[8:11], s49 offen offset:0 sc1
    s_waitcnt lgkmcnt(6)
    v_mfma_f32_32x32x16_bf16 v[128:143], a[104:107], a[56:59], v[128:143]
    ds_read_b128 a[132:135], v8 offset:27648
    s_waitcnt lgkmcnt(6)
    v_mfma_f32_32x32x16_bf16 v[32:47], a[108:111], a[60:63], v[32:47]
    buffer_load_dwordx4 a[36:39], v2, s[8:11], s49 offen offset:1024 sc1
    s_waitcnt lgkmcnt(5)
    v_mfma_f32_32x32x16_bf16 v[48:63], a[112:115], a[60:63], v[48:63]
    buffer_load_dwordx4 a[40:43], v2, s[8:11], s49 offen offset:2048 sc1
    buffer_load_dwordx4 a[44:47], v2, s[8:11], s49 offen offset:3072 sc1
    s_add_u32 s49, s49, 4096
    s_waitcnt lgkmcnt(4)
    v_mfma_f32_32x32x16_bf16 v[64:79], a[116:119], a[60:63], v[64:79]
    s_waitcnt lgkmcnt(3)
    v_mfma_f32_32x32x16_bf16 v[80:95], a[120:123], a[60:63], v[80:95]
    s_waitcnt lgkmcnt(2)
    v_mfma_f32_32x32x16_bf16 v[96:111], a[124:127], a[60:63], v[96:111]
    s_waitcnt lgkmcnt(1)
    v_mfma_f32_32x32x16_bf16 v[112:127], a[128:131], a[60:63], v[112:127]
    s_waitcnt lgkmcnt(0)
    v_mfma_f32_32x32x16_bf16 v[128:143], a[132:135], a[60:63], v[128:143]
    s_waitcnt vmcnt(36)
    s_barrier
    ds_read_b128 a[80:83], v9 offset:0
    ds_read_b128 a[84:87], v9 offset:4096
    ds_read_b128 a[88:91], v9 offset:8192
    ds_read_b128 a[92:95], v9 offset:12288
    ds_read_b128 a[96:99], v9 offset:16384
    ds_read_b128 a[100:103], v9 offset:20480
    ds_read_b128 a[104:107], v9 offset:24576
    s_waitcnt lgkmcnt(6)
    v_mfma_f32_32x32x16_bf16 v[32:47], a[80:83], a[64:67], v[32:47]
    ds_read_b128 a[108:111], v9 offset:1024
    s_waitcnt lgkmcnt(6)
    v_mfma_f32_32x32x16_bf16 v[48:63], a[84:87], a[64:67], v[48:63]
    ds_read_b128 a[112:115], v9 offset:5120
    s_add_u32 s50, s45, 86016
    s_mov_b32 m0, s50
    s_nop 0
    buffer_load_dwordx4 v2, s[8:11], s47 offen sc1 lds
    s_waitcnt lgkmcnt(6)
    v_mfma_f32_32x32x16_bf16 v[64:79], a[88:91], a[64:67], v[64:79]
    ds_read_b128 a[116:119], v9 offset:9216
    s_waitcnt lgkmcnt(6)
    v_mfma_f32_32x32x16_bf16 v[80:95], a[92:95], a[64:67], v[80:95]
    ds_read_b128 a[120:123], v9 offset:13312
    buffer_load_dwordx4 v2, s[8:11], s47 offen offset:1024 sc1 lds
    s_waitcnt lgkmcnt(6)
    v_mfma_f32_32x32x16_bf16 v[96:111], a[96:99], a[64:67], v[96:111]
    ds_read_b128 a[124:127], v9 offset:17408
    s_waitcnt lgkmcnt(6)
    v_mfma_f32_32x32x16_bf16 v[112:127], a[100:103], a[64:67], v[112:127]
    ds_read_b128 a[128:131], v9 offset:21504
    buffer_load_dwordx4 v2, s[8:11], s47 offen offset:2048 sc1 lds
    s_waitcnt lgkmcnt(6)
    v_mfma_f32_32x32x16_bf16 v[128:143], a[104:107], a[64:67], v[128:143]
    ds_read_b128 a[132:135], v9 offset:25600
    s_waitcnt lgkmcnt(6)
    v_mfma_f32_32x32x16_bf16 v[32:47], a[108:111], a[68:71], v[32:47]
    ds_read_b128 a[80:83], v9 offset:2048
    s_waitcnt lgkmcnt(6)
    v_mfma_f32_32x32x16_bf16 v[48:63], a[112:115], a[68:71], v[48:63]
    ds_read_b128 a[84:87], v9 offset:6144
    buffer_load_dwordx4 v2, s[8:11], s47 offen offset:3072 sc1 lds
    s_add_u32 s47, s47, 4096
    s_waitcnt lgkmcnt(6)
    v_mfma_f32_32x32x16_bf16 v[64:79], a[116:119], a[68:71], v[64:79]
    ds_read_b128 a[88:91], v9 offset:10240
    s_waitcnt lgkmcnt(6)
    v_mfma_f32_32x32x16_bf16 v[80:95], a[120:123], a[68:71], v[80:95]
    ds_read_b128 a[92:95], v9 offset:14336
    s_add_u32 s50, s46, 86016
    s_mov_b32 m0, s50
    s_nop 0
    buffer_load_dwordx4 v2, s[8:11], s48 offen sc1 lds
    s_waitcnt lgkmcnt(6)
    v_mfma_f32_32x32x16_bf16 v[96:111], a[124:127], a[68:71], v[96:111]
    ds_read_b128 a[96:99], v9 offset:18432
    s_waitcnt lgkmcnt(6)
    v_mfma_f32_32x32x16_bf16 v[112:127], a[128:131], a[68:71], v[112:127]
    ds_read_b128 a[100:103], v9 offset:22528
    buffer_load_dwordx4 v2, s[8:11], s48 offen offset:1024 sc1 lds
    s_waitcnt lgkmcnt(6)
    v_mfma_f32_32x32x16_bf16 v[128:143], a[132:135], a[68:71], v[128:143]
    ds_read_b128 a[104:107], v9 offset:26624
    s_waitcnt lgkmcnt(6)
    v_mfma_f32_32x32x16_bf16 v[32:47], a[80:83], a[72:75], v[32:47]
    ds_read_b128 a[108:111], v9 offset:3072
    s_waitcnt lgkmcnt(6)
    v_mfma_f32_32x32x16_bf16 v[48:63], a[84:87], a[72:75], v[48:63]
    ds_read_b128 a[112:115], v9 offset:7168
    buffer_load_dwordx4 v2, s[8:11], s48 offen offset:2048 sc1 lds
    s_waitcnt lgkmcnt(6)
    v_mfma_f32_32x32x16_bf16 v[64:79], a[88:91], a[72:75], v[64:79]
    ds_read_b128 a[116:119], v9 offset:11264
    s_waitcnt lgkmcnt(6)
    v_mfma_f32_32x32x16_bf16 v[80:95], a[92:95], a[72:75], v[80:95]
    ds_read_b128 a[120:123], v9 offset:15360
    buffer_load_dwordx4 v2, s[8:11], s48 offen offset:3072 sc1 lds
    s_add_u32 s48, s48, 4096
    s_waitcnt lgkmcnt(6)
    v_mfma_f32_32x32x16_bf16 v[96:111], a[96:99], a[72:75], v[96:111]
    ds_read_b128 a[124:127], v9 offset:19456
    s_waitcnt lgkmcnt(6)
    v_mfma_f32_32x32x16_bf16 v[112:127], a[100:103], a[72:75], v[112:127]
    ds_read_b128 a[128:131], v9 offset:23552
    buffer_load_dwordx4 a[48:51], v2, s[8:11], s49 offen offset:0 sc1
    s_waitcnt lgkmcnt(6)
    v_mfma_f32_32x32x16_bf16 v[128:143], a[104:107], a[72:75], v[128:143]
    ds_read_b128 a[132:135], v9 offset:27648
    s_waitcnt lgkmcnt(6)
    v_mfma_f32_32x32x16_bf16 v[32:47], a[108:111], a[76:79], v[32:47]
    buffer_load_dwordx4 a[52:55], v2, s[8:11], s49 offen offset:1024 sc1
    s_waitcnt lgkmcnt(5)
    v_mfma_f32_32x32x16_bf16 v[48:63], a[112:115], a[76:79], v[48:63]
    buffer_load_dwordx4 a[56:59], v2, s[8:11], s49 offen offset:2048 sc1
    buffer_load_dwordx4 a[60:63], v2, s[8:11], s49 offen offset:3072 sc1
    s_add_u32 s49, s49, 4096
    s_waitcnt lgkmcnt(4)
    v_mfma_f32_32x32x16_bf16 v[64:79], a[116:119], a[76:79], v[64:79]
    s_waitcnt lgkmcnt(3)
    v_mfma_f32_32x32x16_bf16 v[80:95], a[120:123], a[76:79], v[80:95]
    s_waitcnt lgkmcnt(2)
    v_mfma_f32_32x32x16_bf16 v[96:111], a[124:127], a[76:79], v[96:111]
    s_waitcnt lgkmcnt(1)
    v_mfma_f32_32x32x16_bf16 v[112:127], a[128:131], a[76:79], v[112:127]
    s_waitcnt lgkmcnt(0)
    v_mfma_f32_32x32x16_bf16 v[128:143], a[132:135], a[76:79], v[128:143]
    s_sub_u32 s52, s52, 1
    s_cmp_lg_u32 s52, 0
    s_cbranch_scc1 g2_loop_74
    s_waitcnt vmcnt(36)
    s_barrier
    ds_read_b128 a[80:83], v5 offset:0
    ds_read_b128 a[84:87], v5 offset:4096
    ds_read_b128 a[88:91], v5 offset:8192
    ds_read_b128 a[92:95], v5 offset:12288
    ds_read_b128 a[96:99], v5 offset:16384
    ds_read_b128 a[100:103], v5 offset:20480
    ds_read_b128 a[104:107], v5 offset:24576
    s_waitcnt lgkmcnt(6)
    v_mfma_f32_32x32x16_bf16 v[32:47], a[80:83], a[0:3], v[32:47]
    ds_read_b128 a[108:111], v5 offset:1024
    s_waitcnt lgkmcnt(6)
    v_mfma_f32_32x32x16_bf16 v[48:63], a[84:87], a[0:3], v[48:63]
    ds_read_b128 a[112:115], v5 offset:5120
    s_waitcnt lgkmcnt(6)
    v_mfma_f32_32x32x16_bf16 v[64:79], a[88:91], a[0:3], v[64:79]
    ds_read_b128 a[116:119], v5 offset:9216
    s_waitcnt lgkmcnt(6)
    v_mfma_f32_32x32x16_bf16 v[80:95], a[92:95], a[0:3], v[80:95]
    ds_read_b128 a[120:123], v5 offset:13312
    s_waitcnt lgkmcnt(6)
    v_mfma_f32_32x32x16_bf16 v[96:111], a[96:99], a[0:3], v[96:111]
    ds_read_b128 a[124:127], v5 offset:17408
    s_waitcnt lgkmcnt(6)
    v_mfma_f32_32x32x16_bf16 v[112:127], a[100:103], a[0:3], v[112:127]
    ds_read_b128 a[128:131], v5 offset:21504
    s_waitcnt lgkmcnt(6)
    v_mfma_f32_32x32x16_bf16 v[128:143], a[104:107], a[0:3], v[128:143]
    ds_read_b128 a[132:135], v5 offset:25600
    s_waitcnt lgkmcnt(6)
    v_mfma_f32_32x32x16_bf16 v[32:47], a[108:111], a[4:7], v[32:47]
    ds_read_b128 a[80:83], v5 offset:2048
    s_waitcnt lgkmcnt(6)
    v_mfma_f32_32x32x16_bf16 v[48:63], a[112:115], a[4:7], v[48:63]
    ds_read_b128 a[84:87], v5 offset:6144
    s_waitcnt lgkmcnt(6)
    v_mfma_f32_32x32x16_bf16 v[64:79], a[116:119], a[4:7], v[64:79]
    ds_read_b128 a[88:91], v5 offset:10240
    s_waitcnt lgkmcnt(6)
    v_mfma_f32_32x32x16_bf16 v[80:95], a[120:123], a[4:7], v[80:95]
    ds_read_b128 a[92:95], v5 offset:14336
    s_waitcnt lgkmcnt(6)
    v_mfma_f32_32x32x16_bf16 v[96:111], a[124:127], a[4:7], v[96:111]
    ds_read_b128 a[96:99], v5 offset:18432
    s_waitcnt lgkmcnt(6)
    v_mfma_f32_32x32x16_bf16 v[112:127], a[128:131], a[4:7], v[112:127]
    ds_read_b128 a[100:103], v5 offset:22528
    s_waitcnt lgkmcnt(6)
    v_mfma_f32_32x32x16_bf16 v[128:143], a[132:135], a[4:7], v[128:143]
    ds_read_b128 a[104:107], v5 offset:26624
    s_waitcnt lgkmcnt(6)
    v_mfma_f32_32x32x16_bf16 v[32:47], a[80:83], a[8:11], v[32:47]
    ds_read_b128 a[108:111], v5 offset:3072
    s_waitcnt lgkmcnt(6)
    v_mfma_f32_32x32x16_bf16 v[48:63], a[84:87], a[8:11], v[48:63]
    ds_read_b128 a[112:115], v5 offset:7168
    s_waitcnt lgkmcnt(6)
    v_mfma_f32_32x32x16_bf16 v[64:79], a[88:91], a[8:11], v[64:79]
    ds_read_b128 a[116:119], v5 offset:11264
    s_waitcnt lgkmcnt(6)
    v_mfma_f32_32x32x16_bf16 v[80:95], a[92:95], a[8:11], v[80:95]
    ds_read_b128 a[120:123], v5 offset:15360
    s_waitcnt lgkmcnt(6)
    v_mfma_f32_32x32x16_bf16 v[96:111], a[96:99], a[8:11], v[96:111]
    ds_read_b128 a[124:127], v5 offset:19456
    s_waitcnt lgkmcnt(6)
    v_mfma_f32_32x32x16_bf16 v[112:127], a[100:103], a[8:11], v[112:127]
    ds_read_b128 a[128:131], v5 offset:23552
    s_waitcnt lgkmcnt(6)
    v_mfma_f32_32x32x16_bf16 v[128:143], a[104:107], a[8:11], v[128:143]
    ds_read_b128 a[132:135], v5 offset:27648
    s_waitcnt lgkmcnt(6)
    v_mfma_f32_32x32x16_bf16 v[32:47], a[108:111], a[12:15], v[32:47]
    s_waitcnt lgkmcnt(5)
    v_mfma_f32_32x32x16_bf16 v[48:63], a[112:115], a[12:15], v[48:63]
    s_waitcnt lgkmcnt(4)
    v_mfma_f32_32x32x16_bf16 v[64:79], a[116:119], a[12:15], v[64:79]
    s_waitcnt lgkmcnt(3)
    v_mfma_f32_32x32x16_bf16 v[80:95], a[120:123], a[12:15], v[80:95]
    s_waitcnt lgkmcnt(2)
    v_mfma_f32_32x32x16_bf16 v[96:111], a[124:127], a[12:15], v[96:111]
    s_waitcnt lgkmcnt(1)
    v_mfma_f32_32x32x16_bf16 v[112:127], a[128:131], a[12:15], v[112:127]
    s_waitcnt lgkmcnt(0)
    v_mfma_f32_32x32x16_bf16 v[128:143], a[132:135], a[12:15], v[128:143]
    s_waitcnt vmcnt(24)
    s_barrier
    ds_read_b128 a[80:83], v6 offset:0
    ds_read_b128 a[84:87], v6 offset:4096
    ds_read_b128 a[88:91], v6 offset:8192
    ds_read_b128 a[92:95], v6 offset:12288
    ds_read_b128 a[96:99], v6 offset:16384
    ds_read_b128 a[100:103], v6 offset:20480
    ds_read_b128 a[104:107], v6 offset:24576
    s_waitcnt lgkmcnt(6)
    v_mfma_f32_32x32x16_bf16 v[32:47], a[80:83], a[16:19], v[32:47]
    ds_read_b128 a[108:111], v6 offset:1024
    s_waitcnt lgkmcnt(6)
    v_mfma_f32_32x32x16_bf16 v[48:63], a[84:87], a[16:19], v[48:63]
    ds_read_b128 a[112:115], v6 offset:5120
    s_waitcnt lgkmcnt(6)
    v_mfma_f32_32x32x16_bf16 v[64:79], a[88:91], a[16:19], v[64:79]
    ds_read_b128 a[116:119], v6 offset:9216
    s_waitcnt lgkmcnt(6)
    v_mfma_f32_32x32x16_bf16 v[80:95], a[92:95], a[16:19], v[80:95]
    ds_read_b128 a[120:123], v6 offset:13312
    s_waitcnt lgkmcnt(6)
    v_mfma_f32_32x32x16_bf16 v[96:111], a[96:99], a[16:19], v[96:111]
    ds_read_b128 a[124:127], v6 offset:17408
    s_waitcnt lgkmcnt(6)
    v_mfma_f32_32x32x16_bf16 v[112:127], a[100:103], a[16:19], v[112:127]
    ds_read_b128 a[128:131], v6 offset:21504
    s_waitcnt lgkmcnt(6)
    v_mfma_f32_32x32x16_bf16 v[128:143], a[104:107], a[16:19], v[128:143]
    ds_read_b128 a[132:135], v6 offset:25600
    s_waitcnt lgkmcnt(6)
    v_mfma_f32_32x32x16_bf16 v[32:47], a[108:111], a[20:23], v[32:47]
    ds_read_b128 a[80:83], v6 offset:2048
    s_waitcnt lgkmcnt(6)
    v_mfma_f32_32x32x16_bf16 v[48:63], a[112:115], a[20:23], v[48:63]
    ds_read_b128 a[84:87], v6 offset:6144
    s_waitcnt lgkmcnt(6)
    v_mfma_f32_32x32x16_bf16 v[64:79], a[116:119], a[20:23], v[64:79]
    ds_read_b128 a[88:91], v6 offset:10240
    s_waitcnt lgkmcnt(6)
    v_mfma_f32_32x32x16_bf16 v[80:95], a[120:123], a[20:23], v[80:95]
    ds_read_b128 a[92:95], v6 offset:14336
    s_waitcnt lgkmcnt(6)
    v_mfma_f32_32x32x16_bf16 v[96:111], a[124:127], a[20:23], v[96:111]
    ds_read_b128 a[96:99], v6 offset:18432
    s_waitcnt lgkmcnt(6)
    v_mfma_f32_32x32x16_bf16 v[112:127], a[128:131], a[20:23], v[112:127]
    ds_read_b128 a[100:103], v6 offset:22528
    s_waitcnt lgkmcnt(6)
    v_mfma_f32_32x32x16_bf16 v[128:143], a[132:135], a[20:23], v[128:143]
    ds_read_b128 a[104:107], v6 offset:26624
    s_waitcnt lgkmcnt(6)
    v_mfma_f32_32x32x16_bf16 v[32:47], a[80:83], a[24:27], v[32:47]
    ds_read_b128 a[108:111], v6 offset:3072
    s_waitcnt lgkmcnt(6)
    v_mfma_f32_32x32x16_bf16 v[48:63], a[84:87], a[24:27], v[48:63]
    ds_read_b128 a[112:115], v6 offset:7168
    s_waitcnt lgkmcnt(6)
    v_mfma_f32_32x32x16_bf16 v[64:79], a[88:91], a[24:27], v[64:79]
    ds_read_b128 a[116:119], v6 offset:11264
    s_waitcnt lgkmcnt(6)
    v_mfma_f32_32x32x16_bf16 v[80:95], a[92:95], a[24:27], v[80:95]
    ds_read_b128 a[120:123], v6 offset:15360
    s_waitcnt lgkmcnt(6)
    v_mfma_f32_32x32x16_bf16 v[96:111], a[96:99], a[24:27], v[96:111]
    ds_read_b128 a[124:127], v6 offset:19456
    s_waitcnt lgkmcnt(6)
    v_mfma_f32_32x32x16_bf16 v[112:127], a[100:103], a[24:27], v[112:127]
    ds_read_b128 a[128:131], v6 offset:23552
    s_waitcnt lgkmcnt(6)
    v_mfma_f32_32x32x16_bf16 v[128:143], a[104:107], a[24:27], v[128:143]
    ds_read_b128 a[132:135], v6 offset:27648
    s_waitcnt lgkmcnt(6)
    v_mfma_f32_32x32x16_bf16 v[32:47], a[108:111], a[28:31], v[32:47]
    s_waitcnt lgkmcnt(5)
    v_mfma_f32_32x32x16_bf16 v[48:63], a[112:115], a[28:31], v[48:63]
    s_waitcnt lgkmcnt(4)
    v_mfma_f32_32x32x16_bf16 v[64:79], a[116:119], a[28:31], v[64:79]
    s_waitcnt lgkmcnt(3)
    v_mfma_f32_32x32x16_bf16 v[80:95], a[120:123], a[28:31], v[80:95]
    s_waitcnt lgkmcnt(2)
    v_mfma_f32_32x32x16_bf16 v[96:111], a[124:127], a[28:31], v[96:111]
    s_waitcnt lgkmcnt(1)
    v_mfma_f32_32x32x16_bf16 v[112:127], a[128:131], a[28:31], v[112:127]
    s_waitcnt lgkmcnt(0)
    v_mfma_f32_32x32x16_bf16 v[128:143], a[132:135], a[28:31], v[128:143]
    s_waitcnt vmcnt(12)
    s_barrier
    ds_read_b128 a[80:83], v7 offset:0
    ds_read_b128 a[84:87], v7 offset:4096
    ds_read_b128 a[88:91], v7 offset:8192
    ds_read_b128 a[92:95], v7 offset:12288
    ds_read_b128 a[96:99], v7 offset:16384
    ds_read_b128 a[100:103], v7 offset:20480
    ds_read_b128 a[104:107], v7 offset:24576
    s_waitcnt lgkmcnt(6)
    v_mfma_f32_32x32x16_bf16 v[32:47], a[80:83], a[32:35], v[32:47]
    ds_read_b128 a[108:111], v7 offset:1024
    s_waitcnt lgkmcnt(6)
    v_mfma_f32_32x32x16_bf16 v[48:63], a[84:87], a[32:35], v[48:63]
    ds_read_b128 a[112:115], v7 offset:5120
    s_waitcnt lgkmcnt(6)
    v_mfma_f32_32x32x16_bf16 v[64:79], a[88:91], a[32:35], v[64:79]
    ds_read_b128 a[116:119], v7 offset:9216
    s_waitcnt lgkmcnt(6)
    v_mfma_f32_32x32x16_bf16 v[80:95], a[92:95], a[32:35], v[80:95]
    ds_read_b128 a[120:123], v7 offset:13312
    s_waitcnt lgkmcnt(6)
    v_mfma_f32_32x32x16_bf16 v[96:111], a[96:99], a[32:35], v[96:111]
    ds_read_b128 a[124:127], v7 offset:17408
    s_waitcnt lgkmcnt(6)
    v_mfma_f32_32x32x16_bf16 v[112:127], a[100:103], a[32:35], v[112:127]
    ds_read_b128 a[128:131], v7 offset:21504
    s_waitcnt lgkmcnt(6)
    v_mfma_f32_32x32x16_bf16 v[128:143], a[104:107], a[32:35], v[128:143]
    ds_read_b128 a[132:135], v7 offset:25600
    s_waitcnt lgkmcnt(6)
    v_mfma_f32_32x32x16_bf16 v[32:47], a[108:111], a[36:39], v[32:47]
    ds_read_b128 a[80:83], v7 offset:2048
    s_waitcnt lgkmcnt(6)
    v_mfma_f32_32x32x16_bf16 v[48:63], a[112:115], a[36:39], v[48:63]
    ds_read_b128 a[84:87], v7 offset:6144
    s_waitcnt lgkmcnt(6)
    v_mfma_f32_32x32x16_bf16 v[64:79], a[116:119], a[36:39], v[64:79]
    ds_read_b128 a[88:91], v7 offset:10240
    s_waitcnt lgkmcnt(6)
    v_mfma_f32_32x32x16_bf16 v[80:95], a[120:123], a[36:39], v[80:95]
    ds_read_b128 a[92:95], v7 offset:14336
    s_waitcnt lgkmcnt(6)
    v_mfma_f32_32x32x16_bf16 v[96:111], a[124:127], a[36:39], v[96:111]
    ds_read_b128 a[96:99], v7 offset:18432
    s_waitcnt lgkmcnt(6)
    v_mfma_f32_32x32x16_bf16 v[112:127], a[128:131], a[36:39], v[112:127]
    ds_read_b128 a[100:103], v7 offset:22528
    s_waitcnt lgkmcnt(6)
    v_mfma_f32_32x32x16_bf16 v[128:143], a[132:135], a[36:39], v[128:143]
    ds_read_b128 a[104:107], v7 offset:26624
    s_waitcnt lgkmcnt(6)
    v_mfma_f32_32x32x16_bf16 v[32:47], a[80:83], a[40:43], v[32:47]
    ds_read_b128 a[108:111], v7 offset:3072
    s_waitcnt lgkmcnt(6)
    v_mfma_f32_32x32x16_bf16 v[48:63], a[84:87], a[40:43], v[48:63]
    ds_read_b128 a[112:115], v7 offset:7168
    s_waitcnt lgkmcnt(6)
    v_mfma_f32_32x32x16_bf16 v[64:79], a[88:91], a[40:43], v[64:79]
    ds_read_b128 a[116:119], v7 offset:11264
    s_waitcnt lgkmcnt(6)
    v_mfma_f32_32x32x16_bf16 v[80:95], a[92:95], a[40:43], v[80:95]
    ds_read_b128 a[120:123], v7 offset:15360
    s_waitcnt lgkmcnt(6)
    v_mfma_f32_32x32x16_bf16 v[96:111], a[96:99], a[40:43], v[96:111]
    ds_read_b128 a[124:127], v7 offset:19456
    s_waitcnt lgkmcnt(6)
    v_mfma_f32_32x32x16_bf16 v[112:127], a[100:103], a[40:43], v[112:127]
    ds_read_b128 a[128:131], v7 offset:23552
    s_waitcnt lgkmcnt(6)
    v_mfma_f32_32x32x16_bf16 v[128:143], a[104:107], a[40:43], v[128:143]
    ds_read_b128 a[132:135], v7 offset:27648
    s_waitcnt lgkmcnt(6)
    v_mfma_f32_32x32x16_bf16 v[32:47], a[108:111], a[44:47], v[32:47]
    s_waitcnt lgkmcnt(5)
    v_mfma_f32_32x32x16_bf16 v[48:63], a[112:115], a[44:47], v[48:63]
    s_waitcnt lgkmcnt(4)
    v_mfma_f32_32x32x16_bf16 v[64:79], a[116:119], a[44:47], v[64:79]
    s_waitcnt lgkmcnt(3)
    v_mfma_f32_32x32x16_bf16 v[80:95], a[120:123], a[44:47], v[80:95]
    s_waitcnt lgkmcnt(2)
    v_mfma_f32_32x32x16_bf16 v[96:111], a[124:127], a[44:47], v[96:111]
    s_waitcnt lgkmcnt(1)
    v_mfma_f32_32x32x16_bf16 v[112:127], a[128:131], a[44:47], v[112:127]
    s_waitcnt lgkmcnt(0)
    v_mfma_f32_32x32x16_bf16 v[128:143], a[132:135], a[44:47], v[128:143]
    s_waitcnt vmcnt(0)
    s_barrier
    ds_read_b128 a[80:83], v8 offset:0
    ds_read_b128 a[84:87], v8 offset:4096
    ds_read_b128 a[88:91], v8 offset:8192
    ds_read_b128 a[92:95], v8 offset:12288
    ds_read_b128 a[96:99], v8 offset:16384
    ds_read_b128 a[100:103], v8 offset:20480
    ds_read_b128 a[104:107], v8 offset:24576
    s_waitcnt lgkmcnt(6)
    v_mfma_f32_32x32x16_bf16 v[32:47], a[80:83], a[48:51], v[32:47]
    ds_read_b128 a[108:111], v8 offset:1024
    s_waitcnt lgkmcnt(6)
    v_mfma_f32_32x32x16_bf16 v[48:63], a[84:87], a[48:51], v[48:63]
    ds_read_b128 a[112:115], v8 offset:5120
    s_waitcnt lgkmcnt(6)
    v_mfma_f32_32x32x16_bf16 v[64:79], a[88:91], a[48:51], v[64:79]
    ds_read_b128 a[116:119], v8 offset:9216
    s_waitcnt lgkmcnt(6)
    v_mfma_f32_32x32x16_bf16 v[80:95], a[92:95], a[48:51], v[80:95]
    ds_read_b128 a[120:123], v8 offset:13312
    s_waitcnt lgkmcnt(6)
    v_mfma_f32_32x32x16_bf16 v[96:111], a[96:99], a[48:51], v[96:111]
    ds_read_b128 a[124:127], v8 offset:17408
    s_waitcnt lgkmcnt(6)
    v_mfma_f32_32x32x16_bf16 v[112:127], a[100:103], a[48:51], v[112:127]
    ds_read_b128 a[128:131], v8 offset:21504
    s_waitcnt lgkmcnt(6)
    v_mfma_f32_32x32x16_bf16 v[128:143], a[104:107], a[48:51], v[128:143]
    ds_read_b128 a[132:135], v8 offset:25600
    s_waitcnt lgkmcnt(6)
    v_mfma_f32_32x32x16_bf16 v[32:47], a[108:111], a[52:55], v[32:47]
    ds_read_b128 a[80:83], v8 offset:2048
    s_waitcnt lgkmcnt(6)
    v_mfma_f32_32x32x16_bf16 v[48:63], a[112:115], a[52:55], v[48:63]
    ds_read_b128 a[84:87], v8 offset:6144
    s_waitcnt lgkmcnt(6)
    v_mfma_f32_32x32x16_bf16 v[64:79], a[116:119], a[52:55], v[64:79]
    ds_read_b128 a[88:91], v8 offset:10240
    s_waitcnt lgkmcnt(6)
    v_mfma_f32_32x32x16_bf16 v[80:95], a[120:123], a[52:55], v[80:95]
    ds_read_b128 a[92:95], v8 offset:14336
    s_waitcnt lgkmcnt(6)
    v_mfma_f32_32x32x16_bf16 v[96:111], a[124:127], a[52:55], v[96:111]
    ds_read_b128 a[96:99], v8 offset:18432
    s_waitcnt lgkmcnt(6)
    v_mfma_f32_32x32x16_bf16 v[112:127], a[128:131], a[52:55], v[112:127]
    ds_read_b128 a[100:103], v8 offset:22528
    s_waitcnt lgkmcnt(6)
    v_mfma_f32_32x32x16_bf16 v[128:143], a[132:135], a[52:55], v[128:143]
    ds_read_b128 a[104:107], v8 offset:26624
    s_waitcnt lgkmcnt(6)
    v_mfma_f32_32x32x16_bf16 v[32:47], a[80:83], a[56:59], v[32:47]
    ds_read_b128 a[108:111], v8 offset:3072
    s_waitcnt lgkmcnt(6)
    v_mfma_f32_32x32x16_bf16 v[48:63], a[84:87], a[56:59], v[48:63]
    ds_read_b128 a[112:115], v8 offset:7168
    s_waitcnt lgkmcnt(6)
    v_mfma_f32_32x32x16_bf16 v[64:79], a[88:91], a[56:59], v[64:79]
    ds_read_b128 a[116:119], v8 offset:11264
    s_waitcnt lgkmcnt(6)
    v_mfma_f32_32x32x16_bf16 v[80:95], a[92:95], a[56:59], v[80:95]
    ds_read_b128 a[120:123], v8 offset:15360
    s_waitcnt lgkmcnt(6)
    v_mfma_f32_32x32x16_bf16 v[96:111], a[96:99], a[56:59], v[96:111]
    ds_read_b128 a[124:127], v8 offset:19456
    s_waitcnt lgkmcnt(6)
    v_mfma_f32_32x32x16_bf16 v[112:127], a[100:103], a[56:59], v[112:127]
    ds_read_b128 a[128:131], v8 offset:23552
    s_waitcnt lgkmcnt(6)
    v_mfma_f32_32x32x16_bf16 v[128:143], a[104:107], a[56:59], v[128:143]
    ds_read_b128 a[132:135], v8 offset:27648
    s_waitcnt lgkmcnt(6)
    v_mfma_f32_32x32x16_bf16 v[32:47], a[108:111], a[60:63], v[32:47]
    s_waitcnt lgkmcnt(5)
    v_mfma_f32_32x32x16_bf16 v[48:63], a[112:115], a[60:63], v[48:63]
    s_waitcnt lgkmcnt(4)
    v_mfma_f32_32x32x16_bf16 v[64:79], a[116:119], a[60:63], v[64:79]
    s_waitcnt lgkmcnt(3)
    v_mfma_f32_32x32x16_bf16 v[80:95], a[120:123], a[60:63], v[80:95]
    s_waitcnt lgkmcnt(2)
    v_mfma_f32_32x32x16_bf16 v[96:111], a[124:127], a[60:63], v[96:111]
    s_waitcnt lgkmcnt(1)
    v_mfma_f32_32x32x16_bf16 v[112:127], a[128:131], a[60:63], v[112:127]
    s_waitcnt lgkmcnt(0)
    v_mfma_f32_32x32x16_bf16 v[128:143], a[132:135], a[60:63], v[128:143]
    s_add_u32 s50, s42, 0
    v_cvt_pk_bf16_f32 v8, v32, v33
    v_cvt_pk_bf16_f32 v9, v34, v35
    v_cvt_pk_bf16_f32 v10, v36, v37
    v_cvt_pk_bf16_f32 v11, v38, v39
    buffer_store_dwordx4 v[8:11], v2, s[8:11], s50 offen offset:0 sc1
    v_cvt_pk_bf16_f32 v12, v40, v41
    v_cvt_pk_bf16_f32 v13, v42, v43
    v_cvt_pk_bf16_f32 v14, v44, v45
    v_cvt_pk_bf16_f32 v15, v46, v47
    buffer_store_dwordx4 v[12:15], v2, s[8:11], s50 offen offset:1024 sc1
    v_cvt_pk_bf16_f32 v16, v48, v49
    v_cvt_pk_bf16_f32 v17, v50, v51
    v_cvt_pk_bf16_f32 v18, v52, v53
    v_cvt_pk_bf16_f32 v19, v54, v55
    buffer_store_dwordx4 v[16:19], v2, s[8:11], s50 offen offset:2048 sc1
    v_cvt_pk_bf16_f32 v20, v56, v57
    v_cvt_pk_bf16_f32 v21, v58, v59
    v_cvt_pk_bf16_f32 v22, v60, v61
    v_cvt_pk_bf16_f32 v23, v62, v63
    buffer_store_dwordx4 v[20:23], v2, s[8:11], s50 offen offset:3072 sc1
    s_add_u32 s50, s50, 4096
    v_cvt_pk_bf16_f32 v8, v64, v65
    v_cvt_pk_bf16_f32 v9, v66, v67
    v_cvt_pk_bf16_f32 v10, v68, v69
    v_cvt_pk_bf16_f32 v11, v70, v71
    buffer_store_dwordx4 v[8:11], v2, s[8:11], s50 offen offset:0 sc1
    v_cvt_pk_bf16_f32 v12, v72, v73
    v_cvt_pk_bf16_f32 v13, v74, v75
    v_cvt_pk_bf16_f32 v14, v76, v77
    v_cvt_pk_bf16_f32 v15, v78, v79
    buffer_store_dwordx4 v[12:15], v2, s[8:11], s50 offen offset:1024 sc1
    v_cvt_pk_bf16_f32 v16, v80, v81
    v_cvt_pk_bf16_f32 v17, v82, v83
    v_cvt_pk_bf16_f32 v18, v84, v85
    v_cvt_pk_bf16_f32 v19, v86, v87
    buffer_store_dwordx4 v[16:19], v2, s[8:11], s50 offen offset:2048 sc1
    v_cvt_pk_bf16_f32 v20, v88, v89
    v_cvt_pk_bf16_f32 v21, v90, v91
    v_cvt_pk_bf16_f32 v22, v92, v93
    v_cvt_pk_bf16_f32 v23, v94, v95
    buffer_store_dwordx4 v[20:23], v2, s[8:11], s50 offen offset:3072 sc1
    s_add_u32 s50, s50, 4096
    v_cvt_pk_bf16_f32 v8, v96, v97
    v_cvt_pk_bf16_f32 v9, v98, v99
    v_cvt_pk_bf16_f32 v10, v100, v101
    v_cvt_pk_bf16_f32 v11, v102, v103
    buffer_store_dwordx4 v[8:11], v2, s[8:11], s50 offen offset:0 sc1
    v_cvt_pk_bf16_f32 v12, v104, v105
    v_cvt_pk_bf16_f32 v13, v106, v107
    v_cvt_pk_bf16_f32 v14, v108, v109
    v_cvt_pk_bf16_f32 v15, v110, v111
    buffer_store_dwordx4 v[12:15], v2, s[8:11], s50 offen offset:1024 sc1
    v_cvt_pk_bf16_f32 v16, v112, v113
    v_cvt_pk_bf16_f32 v17, v114, v115
    v_cvt_pk_bf16_f32 v18, v116, v117
    v_cvt_pk_bf16_f32 v19, v118, v119
    buffer_store_dwordx4 v[16:19], v2, s[8:11], s50 offen offset:2048 sc1
    v_cvt_pk_bf16_f32 v20, v120, v121
    v_cvt_pk_bf16_f32 v21, v122, v123
    v_cvt_pk_bf16_f32 v22, v124, v125
    v_cvt_pk_bf16_f32 v23, v126, v127
    buffer_store_dwordx4 v[20:23], v2, s[8:11], s50 offen offset:3072 sc1
    s_add_u32 s50, s50, 4096
    v_cvt_pk_bf16_f32 v8, v128, v129
    v_cvt_pk_bf16_f32 v9, v130, v131
    v_cvt_pk_bf16_f32 v10, v132, v133
    v_cvt_pk_bf16_f32 v11, v134, v135
    buffer_store_dwordx4 v[8:11], v2, s[8:11], s50 offen offset:0 sc1
    v_cvt_pk_bf16_f32 v12, v136, v137
    v_cvt_pk_bf16_f32 v13, v138, v139
    v_cvt_pk_bf16_f32 v14, v140, v141
    v_cvt_pk_bf16_f32 v15, v142, v143
    buffer_store_dwordx4 v[12:15], v2, s[8:11], s50 offen offset:1024 sc1
    s_branch W_end
W_late:
    s_cmp_eq_u32 s78, 0
    s_cbranch_scc1 W_l2
    v_and_b32 v8, 63, v0
    v_lshlrev_b32 v8, 3, v8
FM_75:
    s_add_u32 s33, s33, 1
    s_cmp_gt_u32 s33, 0x200000
    s_cbranch_scc1 L_bail
    s_mov_b32 s38, 117454848
    buffer_load_dwordx2 v[10:11], v8, s[8:11], s38 offen sc1
    s_mov_b32 s38, 117455360
    buffer_load_dwordx2 v[12:13], v8, s[8:11], s38 offen sc1
    s_mov_b32 s38, 117455872
    buffer_load_dwordx2 v[14:15], v8, s[8:11], s38 offen sc1
    s_mov_b32 s38, 117456384
    buffer_load_dwordx2 v[16:17], v8, s[8:11], s38 offen sc1
    s_waitcnt vmcnt(0)
    s_mov_b64 s[40:41], 0
    v_cmp_ne_u64 vcc, s[96:97], v[10:11]
    s_nop 0
    s_or_b64 s[40:41], s[40:41], vcc
    v_cmp_ne_u64 vcc, s[96:97], v[12:13]
    s_nop 0
    s_or_b64 s[40:41], s[40:41], vcc
    v_cmp_ne_u64 vcc, s[96:97], v[14:15]
    s_nop 0
    s_or_b64 s[40:41], s[40:41], vcc
    v_cmp_ne_u64 vcc, s[96:97], v[16:17]
    s_nop 0
    s_or_b64 s[40:41], s[40:41], vcc
    s_cbranch_scc0 FMok_76
    s_sleep 4
    s_branch FM_75
FMok_76:
    s_mov_b32 s78, 0
W_l2:
    s_cmp_ge_u32 s68, 759
    s_cbranch_scc1 L_bail
    s_mul_hi_u32 s71, s68, 0x1745d175
    s_mul_i32 s38, s71, 11
    s_sub_u32 s72, s68, s38
    s_cmp_ge_u32 s72, 4
    s_cbranch_scc1 W_pv
    s_cmp_ge_u32 s71, 64
    s_cbranch_scc1 W_skip
    s_lshl_b32 s39, s71, 2
    s_add_u32 s39, s39, s72
    s_add_u32 s69, s39, 704
    s_lshr_b32 s70, s71, 3
    s_lshl_b32 s70, s70, 5
    s_lshl_b32 s38, s72, 3
    s_add_u32 s70, s70, s38
    s_add_u32 s70, s70, 384
    v_and_b32 v8, 63, v0
    v_min_u32 v8, 7, v8
    v_lshlrev_b32 v8, 3, v8
    s_lshl_b32 s38, s70, 3
    s_add_u32 s38, s38, 117440512
FW_77:
    s_add_u32 s33, s33, 1
    s_cmp_gt_u32 s33, 0x200000
    s_cbranch_scc1 L_bail
    buffer_load_dwordx2 v[10:11], v8, s[8:11], s38 offen sc1
    s_waitcnt vmcnt(0)
    v_cmp_ne_u64 vcc, s[96:97], v[10:11]
    s_cbranch_vccz FWok_78
    s_sleep 16
    s_branch FW_77
FWok_78:
    s_lshr_b32 s53, s39, 2
    s_and_b32 s54, s39, 3
    s_lshl_b32 s55, s54, 2
    s_add_u32 s55, s55, s13
    s_lshl_b32 s50, s53, 4
    s_add_u32 s50, s50, s55
    s_mul_i32 s40, s50, 28672
    s_add_u32 s40, s40, 50331648
    s_mul_i32 s41, s53, 28672
    s_mul_i32 s50, s13, 7168
    s_add_u32 s41, s41, s50
    s_add_u32 s41, s41, 0
    s_add_u32 s50, s50, 0
    s_mov_b32 m0, s50
    s_nop 0
    buffer_load_dwordx4 v2, s[8:11], s41 offen offset:0 sc1 lds
    buffer_load_dwordx4 v2, s[8:11], s41 offen offset:1024 sc1 lds
    buffer_load_dwordx4 v2, s[8:11], s41 offen offset:2048 sc1 lds
    buffer_load_dwordx4 v2, s[8:11], s41 offen offset:3072 sc1 lds
    s_add_u32 s50, s50, 4096
    s_mov_b32 m0, s50
    s_add_u32 s41, s41, 4096
    buffer_load_dwordx4 v2, s[8:11], s41 offen offset:0 sc1 lds
    buffer_load_dwordx4 v2, s[8:11], s41 offen offset:1024 sc1 lds
    buffer_load_dwordx4 v2, s[8:11], s41 offen offset:2048 sc1 lds
    buffer_load_dwordx4 a[0:3], v2, s[8:11], s40 offen offset:0 sc1
    buffer_load_dwordx4 a[4:7], v2, s[8:11], s40 offen offset:1024 sc1
    buffer_load_dwordx4 a[8:11], v2, s[8:11], s40 offen offset:2048 sc1
    buffer_load_dwordx4 a[12:15], v2, s[8:11], s40 offen offset:3072 sc1
    s_add_u32 s40, s40, 4096
    buffer_load_dwordx4 a[16:19], v2, s[8:11], s40 offen offset:0 sc1
    buffer_load_dwordx4 a[20:23], v2, s[8:11], s40 offen offset:1024 sc1
    buffer_load_dwordx4 a[24:27], v2, s[8:11], s40 offen offset:2048 sc1
    buffer_load_dwordx4 a[28:31], v2, s[8:11], s40 offen offset:3072 sc1
    s_add_u32 s40, s40, 4096
    buffer_load_dwordx4 a[32:35], v2, s[8:11], s40 offen offset:0 sc1
    buffer_load_dwordx4 a[36:39], v2, s[8:11], s40 offen offset:1024 sc1
    buffer_load_dwordx4 a[40:43], v2, s[8:11], s40 offen offset:2048 sc1
    buffer_load_dwordx4 a[44:47], v2, s[8:11], s40 offen offset:3072 sc1
    s_add_u32 s40, s40, 4096
    buffer_load_dwordx4 a[48:51], v2, s[8:11], s40 offen offset:0 sc1
    buffer_load_dwordx4 a[52:55], v2, s[8:11], s40 offen offset:1024 sc1
    buffer_load_dwordx4 a[56:59], v2, s[8:11], s40 offen offset:2048 sc1
    buffer_load_dwordx4 a[60:63], v2, s[8:11], s40 offen offset:3072 sc1
    s_add_u32 s40, s40, 4096
    buffer_load_dwordx4 a[64:67], v2, s[8:11], s40 offen offset:0 sc1
    buffer_load_dwordx4 a[68:71], v2, s[8:11], s40 offen offset:1024 sc1
    buffer_load_dwordx4 a[72:75], v2, s[8:11], s40 offen offset:2048 sc1
    buffer_load_dwordx4 a[76:79], v2, s[8:11], s40 offen offset:3072 sc1
    s_add_u32 s40, s40, 4096
    buffer_load_dwordx4 a[80:83], v2, s[8:11], s40 offen offset:0 sc1
    buffer_load_dwordx4 a[84:87], v2, s[8:11], s40 offen offset:1024 sc1
    buffer_load_dwordx4 a[88:91], v2, s[8:11], s40 offen offset:2048 sc1
    buffer_load_dwordx4 a[92:95], v2, s[8:11], s40 offen offset:3072 sc1
    s_add_u32 s40, s40, 4096
    buffer_load_dwordx4 a[96:99], v2, s[8:11], s40 offen offset:0 sc1
    buffer_load_dwordx4 a[100:103], v2, s[8:11], s40 offen offset:1024 sc1
    buffer_load_dwordx4 a[104:107], v2, s[8:11], s40 offen offset:2048 sc1
    buffer_load_dwordx4 a[108:111], v2, s[8:11], s40 offen offset:3072 sc1
    s_lshl_b32 s44, s53, 13
    s_lshl_b32 s46, s13, 11
    s_add_u32 s44, s44, s46
    s_add_u32 s44, s44, 92274688
    s_cmp_eq_u32 s13, 3
    s_cselect_b32 s45, 0, 1024
    s_add_u32 s45, s45, s44
    buffer_load_dwordx4 v[96:99], v2, s[8:11], s44 offen sc1
    buffer_load_dwordx4 v[100:103], v2, s[8:11], s45 offen sc1
    v_mov_b32 v32, 0
    v_mov_b32 v33, 0
    v_mov_b32 v34, 0
    v_mov_b32 v35, 0
    v_mov_b32 v36, 0
    v_mov_b32 v37, 0
    v_mov_b32 v38, 0
    v_mov_b32 v39, 0
    v_mov_b32 v40, 0
    v_mov_b32 v41, 0
    v_mov_b32 v42, 0
    v_mov_b32 v43, 0
    v_mov_b32 v44, 0
    v_mov_b32 v45, 0
    v_mov_b32 v46, 0
    v_mov_b32 v47, 0
    v_mov_b32 v48, 0
    v_mov_b32 v49, 0
    v_mov_b32 v50, 0
    v_mov_b32 v51, 0
    v_mov_b32 v52, 0
    v_mov_b32 v53, 0
    v_mov_b32 v54, 0
    v_mov_b32 v55, 0
    v_mov_b32 v56, 0
    v_mov_b32 v57, 0
    v_mov_b32 v58, 0
    v_mov_b32 v59, 0
    v_mov_b32 v60, 0
    v_mov_b32 v61, 0
    v_mov_b32 v62, 0
    v_mov_b32 v63, 0
    v_lshrrev_b32 v8, 5, v1
    v_and_b32 v9, 7, v1
    v_lshlrev_b32 v5, 4, v9
    v_lshl_add_u32 v5, v8, 7, v5
    v_add_u32 v5, 28672, v5
    v_and_b32 v9, 31, v1
    v_lshlrev_b32 v8, 3, v8
    v_sub_u32 v6, v9, v8
    s_waitcnt vmcnt(30)
    s_barrier
    ds_read_b128 v[64:67], v3 offset:0
    ds_read_b128 v[68:71], v3 offset:1024
    ds_read_b128 v[72:75], v3 offset:2048
    ds_read_b128 v[76:79], v3 offset:3072
    ds_read_b128 v[80:83], v3 offset:4096
    ds_read_b128 v[84:87], v3 offset:5120
    s_waitcnt vmcnt(29) lgkmcnt(5)
    v_mfma_f32_32x32x16_bf16 v[32:47], v[64:67], a[0:3], v[32:47]
    ds_read_b128 v[88:91], v3 offset:6144
    s_waitcnt vmcnt(28) lgkmcnt(5)
    v_mfma_f32_32x32x16_bf16 v[32:47], v[68:71], a[4:7], v[32:47]
    ds_read_b128 v[92:95], v3 offset:7168
    s_waitcnt vmcnt(27) lgkmcnt(5)
    v_mfma_f32_32x32x16_bf16 v[32:47], v[72:75], a[8:11], v[32:47]
    ds_read_b128 v[64:67], v3 offset:8192
    s_waitcnt vmcnt(26) lgkmcnt(5)
    v_mfma_f32_32x32x16_bf16 v[32:47], v[76:79], a[12:15], v[32:47]
    ds_read_b128 v[68:71], v3 offset:9216
    s_waitcnt vmcnt(25) lgkmcnt(5)
    v_mfma_f32_32x32x16_bf16 v[32:47], v[80:83], a[16:19], v[32:47]
    ds_read_b128 v[72:75], v3 offset:10240
    s_waitcnt vmcnt(24) lgkmcnt(5)
    v_mfma_f32_32x32x16_bf16 v[32:47], v[84:87], a[20:23], v[32:47]
    ds_read_b128 v[76:79], v3 offset:11264
    s_waitcnt vmcnt(23) lgkmcnt(5)
    v_mfma_f32_32x32x16_bf16 v[32:47], v[88:91], a[24:27], v[32:47]
    ds_read_b128 v[80:83], v3 offset:12288
    s_waitcnt vmcnt(22) lgkmcnt(5)
    v_mfma_f32_32x32x16_bf16 v[32:47], v[92:95], a[28:31], v[32:47]
    ds_read_b128 v[84:87], v3 offset:13312
    s_waitcnt vmcnt(21) lgkmcnt(5)
    v_mfma_f32_32x32x16_bf16 v[32:47], v[64:67], a[32:35], v[32:47]
    ds_read_b128 v[88:91], v3 offset:14336
    s_waitcnt vmcnt(20) lgkmcnt(5)
    v_mfma_f32_32x32x16_bf16 v[32:47], v[68:71], a[36:39], v[32:47]
    ds_read_b128 v[92:95], v3 offset:15360
    s_waitcnt vmcnt(19) lgkmcnt(5)
    v_mfma_f32_32x32x16_bf16 v[32:47], v[72:75], a[40:43], v[32:47]
    ds_read_b128 v[64:67], v3 offset:16384
    s_waitcnt vmcnt(18) lgkmcnt(5)
    v_mfma_f32_32x32x16_bf16 v[32:47], v[76:79], a[44:47], v[32:47]
    ds_read_b128 v[68:71], v3 offset:17408
    s_waitcnt vmcnt(17) lgkmcnt(5)
    v_mfma_f32_32x32x16_bf16 v[32:47], v[80:83], a[48:51], v[32:47]
    ds_read_b128 v[72:75], v3 offset:18432
    s_waitcnt vmcnt(16) lgkmcnt(5)
    v_mfma_f32_32x32x16_bf16 v[32:47], v[84:87], a[52:55], v[32:47]
    ds_read_b128 v[76:79], v3 offset:19456
    s_waitcnt vmcnt(15) lgkmcnt(5)
    v_mfma_f32_32x32x16_bf16 v[32:47], v[88:91], a[56:59], v[32:47]
    ds_read_b128 v[80:83], v3 offset:20480
    s_waitcnt vmcnt(14) lgkmcnt(5)
    v_mfma_f32_32x32x16_bf16 v[32:47], v[92:95], a[60:63], v[32:47]
    ds_read_b128 v[84:87], v3 offset:21504
    s_waitcnt vmcnt(13) lgkmcnt(5)
    v_mfma_f32_32x32x16_bf16 v[32:47], v[64:67], a[64:67], v[32:47]
    ds_read_b128 v[88:91], v3 offset:22528
    s_waitcnt vmcnt(12) lgkmcnt(5)
    v_mfma_f32_32x32x16_bf16 v[32:47], v[68:71], a[68:71], v[32:47]
    ds_read_b128 v[92:95], v3 offset:23552
    s_waitcnt vmcnt(11) lgkmcnt(5)
    v_mfma_f32_32x32x16_bf16 v[32:47], v[72:75], a[72:75], v[32:47]
    ds_read_b128 v[64:67], v3 offset:24576
    s_waitcnt vmcnt(10) lgkmcnt(5)
    v_mfma_f32_32x32x16_bf16 v[32:47], v[76:79], a[76:79], v[32:47]
    ds_read_b128 v[68:71], v3 offset:25600
    s_waitcnt vmcnt(9) lgkmcnt(5)
    v_mfma_f32_32x32x16_bf16 v[32:47], v[80:83], a[80:83], v[32:47]
    ds_read_b128 v[72:75], v3 offset:26624
    s_waitcnt vmcnt(8) lgkmcnt(5)
    v_mfma_f32_32x32x16_bf16 v[32:47], v[84:87], a[84:87], v[32:47]
    ds_read_b128 v[76:79], v3 offset:27648
    s_waitcnt vmcnt(7) lgkmcnt(5)
    v_mfma_f32_32x32x16_bf16 v[32:47], v[88:91], a[88:91], v[32:47]
    s_waitcnt vmcnt(6) lgkmcnt(4)
    v_mfma_f32_32x32x16_bf16 v[32:47], v[92:95], a[92:95], v[32:47]
    s_waitcnt vmcnt(5) lgkmcnt(3)
    v_mfma_f32_32x32x16_bf16 v[32:47], v[64:67], a[96:99], v[32:47]
    s_waitcnt vmcnt(4) lgkmcnt(2)
    v_mfma_f32_32x32x16_bf16 v[32:47], v[68:71], a[100:103], v[32:47]
    s_waitcnt vmcnt(3) lgkmcnt(1)
    v_mfma_f32_32x32x16_bf16 v[32:47], v[72:75], a[104:107], v[32:47]
    s_waitcnt vmcnt(2) lgkmcnt(0)
    v_mfma_f32_32x32x16_bf16 v[32:47], v[76:79], a[108:111], v[32:47]
    v_mov_b32 v10, 0xf149f2ca
    v_cmp_le_i32 vcc, 0, v6
    s_nop 9
    v_cndmask_b32 v32, v10, v32, vcc
    v_cmp_le_i32 vcc, 1, v6
    s_nop 1
    v_cndmask_b32 v33, v10, v33, vcc
    v_cmp_le_i32 vcc, 2, v6
    s_nop 1
    v_cndmask_b32 v34, v10, v34, vcc
    v_cmp_le_i32 vcc, 3, v6
    s_nop 1
    v_cndmask_b32 v35, v10, v35, vcc
    v_cmp_le_i32 vcc, 4, v6
    s_nop 1
    v_cndmask_b32 v36, v10, v36, vcc
    v_cmp_le_i32 vcc, 5, v6
    s_nop 1
    v_cndmask_b32 v37, v10, v37, vcc
    v_cmp_le_i32 vcc, 6, v6
    s_nop 1
    v_cndmask_b32 v38, v10, v38, vcc
    v_cmp_le_i32 vcc, 7, v6
    s_nop 1
    v_cndmask_b32 v39, v10, v39, vcc
    v_cmp_le_i32 vcc, 16, v6
    s_nop 1
    v_cndmask_b32 v40, v10, v40, vcc
    v_cmp_le_i32 vcc, 17, v6
    s_nop 1
    v_cndmask_b32 v41, v10, v41, vcc
    v_cmp_le_i32 vcc, 18, v6
    s_nop 1
    v_cndmask_b32 v42, v10, v42, vcc
    v_cmp_le_i32 vcc, 19, v6
    s_nop 1
    v_cndmask_b32 v43, v10, v43, vcc
    v_cmp_le_i32 vcc, 20, v6
    s_nop 1
    v_cndmask_b32 v44, v10, v44, vcc
    v_cmp_le_i32 vcc, 21, v6
    s_nop 1
    v_cndmask_b32 v45, v10, v45, vcc
    v_cmp_le_i32 vcc, 22, v6
    s_nop 1
    v_cndmask_b32 v46, v10, v46, vcc
    v_cmp_le_i32 vcc, 23, v6
    s_nop 1
    v_cndmask_b32 v47, v10, v47, vcc
    s_waitcnt vmcnt(0)
    v_max3_u32 v9, v96, v97, v98
    v_max3_u32 v9, v9, v99, v100
    v_max3_u32 v9, v9, v101, v102
    v_max_u32 v9, v9, v103
    v_cmp_eq_u32 vcc, -1, v9
    s_nop 0
    s_mov_b64 s[48:49], vcc
    s_cmp_lg_u32 s13, 0
    s_cbranch_scc1 P_near_80
    s_cbranch_vccz P_near_80
    s_max_u32 s38, s53, 7
    s_sub_u32 s38, s38, 7
    s_lshl_b32 s38, s38, 13
    s_add_u32 s38, s38, 92274688
    v_mov_b32 v8, 0
PG_81:
    s_add_u32 s33, s33, 1
    s_cmp_gt_u32 s33, 0x200000
    s_cbranch_scc1 L_bail
    buffer_load_dword v9, v8, s[8:11], s38 offen sc1
    s_waitcnt vmcnt(0)
    v_cmp_eq_u32 vcc, -1, v9
    s_cbranch_vccz PGok_82
    s_sleep 127
    s_sleep 127
    s_branch PG_81
PGok_82:
    s_max_u32 s38, s53, 3
    s_sub_u32 s38, s38, 3
    s_lshl_b32 s38, s38, 13
    s_add_u32 s38, s38, 92274688
    v_mov_b32 v8, 0
PG_83:
    s_add_u32 s33, s33, 1
    s_cmp_gt_u32 s33, 0x200000
    s_cbranch_scc1 L_bail
    buffer_load_dword v9, v8, s[8:11], s38 offen sc1
    s_waitcnt vmcnt(0)
    v_cmp_eq_u32 vcc, -1, v9
    s_cbranch_vccz PGok_84
    s_sleep 48
    s_branch PG_83
PGok_84:
    s_max_u32 s38, s53, 1
    s_sub_u32 s38, s38, 1
    s_lshl_b32 s38, s38, 13
    s_add_u32 s38, s38, 92274688
    v_mov_b32 v8, 0
PG_85:
    s_add_u32 s33, s33, 1
    s_cmp_gt_u32 s33, 0x200000
    s_cbranch_scc1 L_bail
    buffer_load_dword v9, v8, s[8:11], s38 offen sc1
    s_waitcnt vmcnt(0)
    v_cmp_eq_u32 vcc, -1, v9
    s_cbranch_vccz PGok_86
    s_sleep 10
    s_branch PG_85
PGok_86:
P_near_80:
    s_barrier
    s_cmp_eq_u64 s[48:49], 0
    s_cbranch_scc1 P_ok_79
P_poll_87:
    s_add_u32 s33, s33, 1
    s_cmp_gt_u32 s33, 0x200000
    s_cbranch_scc1 L_bail
    buffer_load_dwordx4 v[96:99], v2, s[8:11], s44 offen sc1
    buffer_load_dwordx4 v[100:103], v2, s[8:11], s45 offen sc1
    s_waitcnt vmcnt(0)
    v_max3_u32 v9, v96, v97, v98
    v_max3_u32 v9, v9, v99, v100
    v_max3_u32 v9, v9, v101, v102
    v_max_u32 v9, v9, v103
    v_cmp_eq_u32 vcc, -1, v9
    s_cbranch_vccz P_ok_79
    s_sleep 2
    s_branch P_poll_87
P_ok_79:
    s_cmp_lg_u32 s13, 0
    s_cbranch_scc1 W_ed2
    s_mov_b64 exec, 1
    s_lshl_b32 s38, s75, 2
    v_mov_b32 v26, s38
    v_mov_b32 v30, 1
    global_atomic_add v30, v26, v30, s[4:5] offset:128 sc0
    s_mov_b64 exec, -1
W_ed2:
    v_add_u32 v8, s46, v2
    v_add_u32 v8, 28672, v8
    ds_write_b128 v8, v[96:99]
    ds_write_b128 v8, v[100:103] offset:1024
    s_waitcnt lgkmcnt(0)
    s_barrier
    ds_read_b128 v[64:67], v5 offset:0
    ds_read_b128 v[68:71], v5 offset:256
    ds_read_b128 v[72:75], v5 offset:512
    ds_read_b128 v[76:79], v5 offset:768
    ds_read_b128 v[80:83], v5 offset:1024
    ds_read_b128 v[84:87], v5 offset:1280
    s_waitcnt lgkmcnt(5)
    v_mfma_f32_32x32x16_bf16 v[48:63], v[64:67], a[0:3], v[48:63]
    ds_read_b128 v[88:91], v5 offset:1536
    s_waitcnt lgkmcnt(5)
    v_mfma_f32_32x32x16_bf16 v[48:63], v[68:71], a[4:7], v[48:63]
    ds_read_b128 v[92:95], v5 offset:1792
    s_waitcnt lgkmcnt(5)
    v_mfma_f32_32x32x16_bf16 v[48:63], v[72:75], a[8:11], v[48:63]
    ds_read_b128 v[64:67], v5 offset:2048
    s_waitcnt lgkmcnt(5)
    v_mfma_f32_32x32x16_bf16 v[48:63], v[76:79], a[12:15], v[48:63]
    ds_read_b128 v[68:71], v5 offset:2304
    s_waitcnt lgkmcnt(5)
    v_mfma_f32_32x32x16_bf16 v[48:63], v[80:83], a[16:19], v[48:63]
    ds_read_b128 v[72:75], v5 offset:2560
    s_waitcnt lgkmcnt(5)
    v_mfma_f32_32x32x16_bf16 v[48:63], v[84:87], a[20:23], v[48:63]
    ds_read_b128 v[76:79], v5 offset:2816
    s_waitcnt lgkmcnt(5)
    v_mfma_f32_32x32x16_bf16 v[48:63], v[88:91], a[24:27], v[48:63]
    ds_read_b128 v[80:83], v5 offset:3072
    s_waitcnt lgkmcnt(5)
    v_mfma_f32_32x32x16_bf16 v[48:63], v[92:95], a[28:31], v[48:63]
    ds_read_b128 v[84:87], v5 offset:3328
    s_waitcnt lgkmcnt(5)
    v_mfma_f32_32x32x16_bf16 v[48:63], v[64:67], a[32:35], v[48:63]
    ds_read_b128 v[88:91], v5 offset:3584
    s_waitcnt lgkmcnt(5)
    v_mfma_f32_32x32x16_bf16 v[48:63], v[68:71], a[36:39], v[48:63]
    ds_read_b128 v[92:95], v5 offset:3840
    s_waitcnt lgkmcnt(5)
    v_mfma_f32_32x32x16_bf16 v[48:63], v[72:75], a[40:43], v[48:63]
    ds_read_b128 v[64:67], v5 offset:4096
    s_waitcnt lgkmcnt(5)
    v_mfma_f32_32x32x16_bf16 v[48:63], v[76:79], a[44:47], v[48:63]
    ds_read_b128 v[68:71], v5 offset:4352
    s_waitcnt lgkmcnt(5)
    v_mfma_f32_32x32x16_bf16 v[48:63], v[80:83], a[48:51], v[48:63]
    ds_read_b128 v[72:75], v5 offset:4608
    s_waitcnt lgkmcnt(5)
    v_mfma_f32_32x32x16_bf16 v[48:63], v[84:87], a[52:55], v[48:63]
    ds_read_b128 v[76:79], v5 offset:4864
    s_waitcnt lgkmcnt(5)
    v_mfma_f32_32x32x16_bf16 v[48:63], v[88:91], a[56:59], v[48:63]
    ds_read_b128 v[80:83], v5 offset:5120
    s_waitcnt lgkmcnt(5)
    v_mfma_f32_32x32x16_bf16 v[48:63], v[92:95], a[60:63], v[48:63]
    ds_read_b128 v[84:87], v5 offset:5376
    s_waitcnt lgkmcnt(5)
    v_mfma_f32_32x32x16_bf16 v[48:63], v[64:67], a[64:67], v[48:63]
    ds_read_b128 v[88:91], v5 offset:5632
    s_waitcnt lgkmcnt(5)
    v_mfma_f32_32x32x16_bf16 v[48:63], v[68:71], a[68:71], v[48:63]
    ds_read_b128 v[92:95], v5 offset:5888
    s_waitcnt lgkmcnt(5)
    v_mfma_f32_32x32x16_bf16 v[48:63], v[72:75], a[72:75], v[48:63]
    ds_read_b128 v[64:67], v5 offset:6144
    s_waitcnt lgkmcnt(5)
    v_mfma_f32_32x32x16_bf16 v[48:63], v[76:79], a[76:79], v[48:63]
    ds_read_b128 v[68:71], v5 offset:6400
    s_waitcnt lgkmcnt(5)
    v_mfma_f32_32x32x16_bf16 v[48:63], v[80:83], a[80:83], v[48:63]
    ds_read_b128 v[72:75], v5 offset:6656
    s_waitcnt lgkmcnt(5)
    v_mfma_f32_32x32x16_bf16 v[48:63], v[84:87], a[84:87], v[48:63]
    ds_read_b128 v[76:79], v5 offset:6912
    s_waitcnt lgkmcnt(5)
    v_mfma_f32_32x32x16_bf16 v[48:63], v[88:91], a[88:91], v[48:63]
    s_waitcnt lgkmcnt(4)
    v_mfma_f32_32x32x16_bf16 v[48:63], v[92:95], a[92:95], v[48:63]
    s_waitcnt lgkmcnt(3)
    v_mfma_f32_32x32x16_bf16 v[48:63], v[64:67], a[96:99], v[48:63]
    s_waitcnt lgkmcnt(2)
    v_mfma_f32_32x32x16_bf16 v[48:63], v[68:71], a[100:103], v[48:63]
    s_waitcnt lgkmcnt(1)
    v_mfma_f32_32x32x16_bf16 v[48:63], v[72:75], a[104:107], v[48:63]
    s_waitcnt lgkmcnt(0)
    v_mfma_f32_32x32x16_bf16 v[48:63], v[76:79], a[108:111], v[48:63]
    v_max3_f32 v11, v32, v33, v34
    v_max3_f32 v11, v11, v35, v36
    v_max3_f32 v11, v11, v37, v38
    v_max3_f32 v11, v11, v39, v40
    v_max3_f32 v11, v11, v41, v42
    v_max3_f32 v11, v11, v43, v44
    v_max3_f32 v11, v11, v45, v46
    s_nop 4
    v_max3_f32 v11, v11, v47, v48
    v_max3_f32 v11, v11, v49, v50
    v_max_f32 v11, v11, v51
    v_mov_b32 v12, v11
    s_nop 1
    v_permlane32_swap_b32 v11, v12
    v_max_f32 v11, v11, v12
    v_sub_f32 v32, v32, v11
    v_sub_f32 v33, v33, v11
    v_sub_f32 v34, v34, v11
    v_sub_f32 v35, v35, v11
    v_sub_f32 v36, v36, v11
    v_sub_f32 v37, v37, v11
    v_sub_f32 v38, v38, v11
    v_sub_f32 v39, v39, v11
    v_sub_f32 v40, v40, v11
    v_sub_f32 v41, v41, v11
    v_sub_f32 v42, v42, v11
    v_sub_f32 v43, v43, v11
    v_sub_f32 v44, v44, v11
    v_sub_f32 v45, v45, v11
    v_sub_f32 v46, v46, v11
    v_sub_f32 v47, v47, v11
    v_sub_f32 v48, v48, v11
    v_sub_f32 v49, v49, v11
    v_sub_f32 v50, v50, v11
    v_sub_f32 v51, v51, v11
    v_exp_f32 v32, v32
    v_exp_f32 v33, v33
    v_exp_f32 v34, v34
    v_exp_f32 v35, v35
    v_exp_f32 v36, v36
    v_exp_f32 v37, v37
    v_exp_f32 v38, v38
    v_exp_f32 v39, v39
    v_exp_f32 v40, v40
    v_exp_f32 v41, v41
    v_exp_f32 v42, v42
    v_exp_f32 v43, v43
    v_exp_f32 v44, v44
    v_exp_f32 v45, v45
    v_exp_f32 v46, v46
    v_exp_f32 v47, v47
    v_exp_f32 v48, v48
    v_exp_f32 v49, v49
    v_exp_f32 v50, v50
    v_exp_f32 v51, v51
    v_add_f32 v13, v32, v33
    v_add_f32 v14, v34, v35
    v_add_f32 v13, v13, v36
    v_add_f32 v14, v14, v37
    v_add_f32 v13, v13, v38
    v_add_f32 v14, v14, v39
    v_add_f32 v13, v13, v40
    v_add_f32 v14, v14, v41
    v_add_f32 v13, v13, v42
    v_add_f32 v14, v14, v43
    v_add_f32 v13, v13, v44
    v_add_f32 v14, v14, v45
    v_add_f32 v13, v13, v46
    v_add_f32 v14, v14, v47
    v_add_f32 v13, v13, v48
    v_add_f32 v14, v14, v49
    v_add_f32 v13, v13, v50
    v_add_f32 v14, v14, v51
    v_add_f32 v13, v13, v14
    v_mov_b32 v14, v13
    s_nop 1
    v_permlane32_swap_b32 v13, v14
    v_add_f32 v13, v13, v14
    v_rcp_f32 v13, v13
    s_nop 0
    v_mul_f32 v32, v32, v13
    v_mul_f32 v33, v33, v13
    v_mul_f32 v34, v34, v13
    v_mul_f32 v35, v35, v13
    v_mul_f32 v36, v36, v13
    v_mul_f32 v37, v37, v13
    v_mul_f32 v38, v38, v13
    v_mul_f32 v39, v39, v13
    v_mul_f32 v40, v40, v13
    v_mul_f32 v41, v41, v13
    v_mul_f32 v42, v42, v13
    v_mul_f32 v43, v43, v13
    v_mul_f32 v44, v44, v13
    v_mul_f32 v45, v45, v13
    v_mul_f32 v46, v46, v13
    v_mul_f32 v47, v47, v13
    v_mul_f32 v48, v48, v13
    v_mul_f32 v49, v49, v13
    v_mul_f32 v50, v50, v13
    v_mul_f32 v51, v51, v13
    v_cvt_pk_bf16_f32 v96, v32, v33
    v_cvt_pk_bf16_f32 v97, v34, v35
    v_cvt_pk_bf16_f32 v98, v36, v37
    v_cvt_pk_bf16_f32 v99, v38, v39
    v_cvt_pk_bf16_f32 v100, v40, v41
    v_cvt_pk_bf16_f32 v101, v42, v43
    v_cvt_pk_bf16_f32 v102, v44, v45
    v_cvt_pk_bf16_f32 v103, v46, v47
    v_cvt_pk_bf16_f32 v104, v48, v49
    v_cvt_pk_bf16_f32 v105, v50, v51
    v_min_u32 v96, -2, v96
    v_min_u32 v97, -2, v97
    v_min_u32 v98, -2, v98
    v_min_u32 v99, -2, v99
    v_min_u32 v100, -2, v100
    v_min_u32 v101, -2, v101
    v_min_u32 v102, -2, v102
    v_min_u32 v103, -2, v103
    v_min_u32 v104, -2, v104
    v_min_u32 v105, -2, v105
    s_mul_i32 s42, s53, 40960
    s_add_u32 s42, s42, 93847552
    s_lshl_b32 s50, s55, 11
    s_add_u32 s50, s50, s42
    buffer_store_dwordx4 v[96:99], v2, s[8:11], s50 offen offset:0 sc1
    buffer_store_dwordx4 v[100:103], v2, s[8:11], s50 offen offset:1024 sc1
    s_and_b32 s50, s13, 1
    s_lshl_b32 s50, s50, 10
    s_lshr_b32 s51, s13, 1
    s_lshl_b32 s51, s51, 2
    s_add_u32 s51, s51, s50
    s_add_u32 s51, s51, 36864
    v_add_u32 v7, s51, v2
    ds_write2_b32 v7, v104, v105 offset0:0 offset1:2
    s_waitcnt lgkmcnt(0)
    s_barrier
    s_cmp_ge_u32 s13, 2
    s_cbranch_scc1 P_done_88
    ds_read_b128 v[108:111], v7
    s_lshl_b32 s51, s54, 11
    s_add_u32 s50, s50, s51
    s_add_u32 s50, s50, s42
    s_add_u32 s50, s50, 32768
    s_waitcnt lgkmcnt(0)
    buffer_store_dwordx4 v[108:111], v2, s[8:11], s50 offen sc1
P_done_88:
    s_waitcnt vmcnt(3)
    s_branch W_nf
W_skip:
    s_barrier
    s_branch W_deq
W_pv:
    s_cmp_lt_u32 s71, 5
    s_cbranch_scc1 W_skip
    s_sub_u32 s71, s71, 5
    s_mul_i32 s39, s71, 7
    s_add_u32 s39, s39, s72
    s_sub_u32 s39, s39, 4
    s_add_u32 s69, s39, 960
    s_lshr_b32 s70, s71, 3
    s_lshl_b32 s70, s70, 5
    s_lshr_b32 s38, s71, 2
    s_lshl_b32 s38, s38, 5
    s_add_u32 s38, s38, 1408
    s_cmp_lt_u32 s71, 8
    s_cselect_b32 s70, s38, s70
    v_and_b32 v8, 63, v0
    v_min_u32 v8, 31, v8
    v_lshlrev_b32 v8, 3, v8
    s_lshl_b32 s38, s70, 3
    s_add_u32 s38, s38, 117440512
FW_89:
    s_add_u32 s33, s33, 1
    s_cmp_gt_u32 s33, 0x200000
    s_cbranch_scc1 L_bail
    buffer_load_dwordx2 v[10:11], v8, s[8:11], s38 offen sc1
    s_waitcnt vmcnt(0)
    v_cmp_ne_u64 vcc, s[96:97], v[10:11]
    s_cbranch_vccz FWok_90
    s_sleep 16
    s_branch FW_89
FWok_90:
    s_lshr_b32 s70, s71, 2
    s_lshl_b32 s70, s70, 2
    s_add_u32 s70, s70, 640
    v_and_b32 v8, 63, v0
    v_min_u32 v8, 3, v8
    v_lshlrev_b32 v8, 3, v8
    s_lshl_b32 s38, s70, 3
    s_add_u32 s38, s38, 117440512
FW_91:
    s_add_u32 s33, s33, 1
    s_cmp_gt_u32 s33, 0x200000
    s_cbranch_scc1 L_bail
    buffer_load_dwordx2 v[10:11], v8, s[8:11], s38 offen sc1
    s_waitcnt vmcnt(0)
    v_cmp_ne_u64 vcc, s[96:97], v[10:11]
    s_cbranch_vccz FWok_92
    s_sleep 16
    s_branch FW_91
FWok_92:
    s_mul_hi_u32 s53, s39, 0x24924925
    s_mul_i32 s50, s53, 7
    s_sub_u32 s54, s39, s50
    s_lshl_b32 s54, s54, 1
    s_and_b32 s50, s13, 1
    s_add_u32 s54, s54, s50
    s_lshr_b32 s55, s13, 1
    v_lshrrev_b32 v8, 4, v3
    v_and_b32 v8, 31, v8
    v_and_b32 v9, 1, v8
    v_lshrrev_b32 v8, 1, v8
    v_lshrrev_b32 v10, 5, v1
    v_lshlrev_b32 v5, 4, v8
    v_lshl_add_u32 v6, v9, 10, v5
    v_lshl_add_u32 v6, v10, 8, v6
    v_lshl_add_u32 v5, v9, 8, v5
    v_lshl_add_u32 v5, v10, 9, v5
    v_and_b32 v8, 31, v1
    v_mul_u32_u24 v7, 896, v8
    v_lshl_add_u32 v7, v10, 4, v7
    s_lshl_b32 s50, s53, 4
    s_lshl_b32 s51, s55, 3
    s_add_u32 s50, s50, s51
    s_mul_i32 s50, s50, 14
    s_add_u32 s50, s50, s54
    s_lshl_b32 s40, s50, 11
    s_add_u32 s40, s40, 20971520
    buffer_load_dwordx4 a[0:3], v5, s[8:11], s40 offen offset:0 sc1
    buffer_load_dwordx4 a[4:7], v5, s[8:11], s40 offen offset:1024 sc1
    s_add_u32 s40, s40, 28672
    buffer_load_dwordx4 a[8:11], v5, s[8:11], s40 offen offset:0 sc1
    buffer_load_dwordx4 a[12:15], v5, s[8:11], s40 offen offset:1024 sc1
    s_add_u32 s40, s40, 28672
    buffer_load_dwordx4 a[16:19], v5, s[8:11], s40 offen offset:0 sc1
    buffer_load_dwordx4 a[20:23], v5, s[8:11], s40 offen offset:1024 sc1
    s_add_u32 s40, s40, 28672
    buffer_load_dwordx4 a[24:27], v5, s[8:11], s40 offen offset:0 sc1
    buffer_load_dwordx4 a[28:31], v5, s[8:11], s40 offen offset:1024 sc1
    s_add_u32 s40, s40, 28672
    buffer_load_dwordx4 a[32:35], v5, s[8:11], s40 offen offset:0 sc1
    buffer_load_dwordx4 a[36:39], v5, s[8:11], s40 offen offset:1024 sc1
    s_add_u32 s40, s40, 28672
    buffer_load_dwordx4 a[40:43], v5, s[8:11], s40 offen offset:0 sc1
    buffer_load_dwordx4 a[44:47], v5, s[8:11], s40 offen offset:1024 sc1
    s_add_u32 s40, s40, 28672
    buffer_load_dwordx4 a[48:51], v5, s[8:11], s40 offen offset:0 sc1
    buffer_load_dwordx4 a[52:55], v5, s[8:11], s40 offen offset:1024 sc1
    s_add_u32 s40, s40, 28672
    buffer_load_dwordx4 a[56:59], v5, s[8:11], s40 offen offset:0 sc1
    buffer_load_dwordx4 a[60:63], v5, s[8:11], s40 offen offset:1024 sc1
    s_add_u32 s40, s40, 28672
    s_mul_i32 s41, s53, 14
    s_add_u32 s41, s41, s54
    s_lshl_b32 s42, s41, 11
    s_mul_i32 s50, s55, 26214400
    s_add_u32 s42, s42, s50
    s_add_u32 s42, s42, 87031808
    buffer_load_dwordx4 v[80:83], v2, s[8:11], s42 offen offset:0 sc1
    buffer_load_dwordx4 v[84:87], v2, s[8:11], s42 offen offset:1024 sc1
    s_mul_i32 s44, s53, 28672
    s_lshl_b32 s51, s54, 6
    s_add_u32 s44, s44, s51
    s_cmp_eq_u32 s55, 0
    s_cselect_b32 s50, s44, 0x40000000
    buffer_load_dwordx4 v[88:91], v7, s[56:59], s50 offen offset:0
    buffer_load_dwordx4 v[92:95], v7, s[56:59], s50 offen offset:32
    s_lshl_b32 s41, s41, 2
    s_lshl_b32 s50, s55, 1
    s_add_u32 s41, s41, s50
    s_add_u32 s43, s41, 2304
    s_lshl_b32 s41, s41, 11
    s_add_u32 s41, s41, 98566144
    s_add_u32 s50, s41, 0xff738000
    s_cmp_ge_u32 s53, 62
    s_cselect_b32 s41, s50, s41
    s_cmp_lg_u32 s13, 0
    s_cbranch_scc1 AP_93
    s_max_u32 s38, s71, 6
    s_sub_u32 s38, s38, 6
    s_lshl_b32 s38, s38, 13
    s_add_u32 s38, s38, 92274688
    v_mov_b32 v12, 0
PG_94:
    s_add_u32 s33, s33, 1
    s_cmp_gt_u32 s33, 0x200000
    s_cbranch_scc1 L_bail
    buffer_load_dword v13, v12, s[8:11], s38 offen sc1
    s_waitcnt vmcnt(0)
    v_cmp_eq_u32 vcc, -1, v13
    s_cbranch_vccz PGok_95
    s_sleep 127
    s_sleep 127
    s_branch PG_94
PGok_95:
    s_max_u32 s38, s71, 2
    s_sub_u32 s38, s38, 2
    s_lshl_b32 s38, s38, 13
    s_add_u32 s38, s38, 92274688
    v_mov_b32 v12, 0
PG_96:
    s_add_u32 s33, s33, 1
    s_cmp_gt_u32 s33, 0x200000
    s_cbranch_scc1 L_bail
    buffer_load_dword v13, v12, s[8:11], s38 offen sc1
    s_waitcnt vmcnt(0)
    v_cmp_eq_u32 vcc, -1, v13
    s_cbranch_vccz PGok_97
    s_sleep 48
    s_branch PG_96
PGok_97:
    s_max_u32 s38, s71, 0
    s_sub_u32 s38, s38, 0
    s_lshl_b32 s38, s38, 13
    s_add_u32 s38, s38, 92274688
    v_mov_b32 v12, 0
PG_98:
    s_add_u32 s33, s33, 1
    s_cmp_gt_u32 s33, 0x200000
    s_cbranch_scc1 L_bail
    buffer_load_dword v13, v12, s[8:11], s38 offen sc1
    s_waitcnt vmcnt(0)
    v_cmp_eq_u32 vcc, -1, v13
    s_cbranch_vccz PGok_99
    s_sleep 10
    s_branch PG_98
PGok_99:
AP_93:
    s_barrier
    s_cmp_ge_u32 s71, 62
    s_cbranch_scc1 W_ymok
    s_add_u32 s38, s71, 2
    s_lshl_b32 s38, s38, 13
    s_lshl_b32 s70, s54, 9
    s_add_u32 s38, s38, s70
    s_add_u32 s38, s38, 92274688
    v_mov_b32 v12, 0
W_ymp:
    s_add_u32 s33, s33, 1
    s_cmp_gt_u32 s33, 0x200000
    s_cbranch_scc1 L_bail
    buffer_load_dword v13, v12, s[8:11], s38 offen sc1
    s_waitcnt vmcnt(0)
    v_cmp_eq_u32 vcc, -1, v13
    s_cbranch_vccz W_ymok
    s_sleep 16
    s_branch W_ymp
W_ymok:
    s_cmp_lg_u32 s13, 0
    s_cbranch_scc1 W_ed
    s_mov_b64 exec, 1
    s_lshl_b32 s38, s75, 2
    v_mov_b32 v26, s38
    v_mov_b32 v30, 1
    global_atomic_add v30, v26, v30, s[4:5] offset:128 sc0
    s_mov_b64 exec, -1
W_ed:
    v_lshlrev_b32 v32, 16, v80
    v_and_b32 v33, 0xffff0000, v80
    v_lshlrev_b32 v8, 16, v88
    v_and_b32 v9, 0xffff0000, v88
    v_add_f32 v32, v32, v8
    v_add_f32 v33, v33, v9
    v_lshlrev_b32 v34, 16, v81
    v_and_b32 v35, 0xffff0000, v81
    v_lshlrev_b32 v8, 16, v89
    v_and_b32 v9, 0xffff0000, v89
    v_add_f32 v34, v34, v8
    v_add_f32 v35, v35, v9
    v_lshlrev_b32 v36, 16, v82
    v_and_b32 v37, 0xffff0000, v82
    v_lshlrev_b32 v8, 16, v90
    v_and_b32 v9, 0xffff0000, v90
    v_add_f32 v36, v36, v8
    v_add_f32 v37, v37, v9
    v_lshlrev_b32 v38, 16, v83
    v_and_b32 v39, 0xffff0000, v83
    v_lshlrev_b32 v8, 16, v91
    v_and_b32 v9, 0xffff0000, v91
    v_add_f32 v38, v38, v8
    v_add_f32 v39, v39, v9
    v_lshlrev_b32 v40, 16, v84
    v_and_b32 v41, 0xffff0000, v84
    v_lshlrev_b32 v8, 16, v92
    v_and_b32 v9, 0xffff0000, v92
    v_add_f32 v40, v40, v8
    v_add_f32 v41, v41, v9
    v_lshlrev_b32 v42, 16, v85
    v_and_b32 v43, 0xffff0000, v85
    v_lshlrev_b32 v8, 16, v93
    v_and_b32 v9, 0xffff0000, v93
    v_add_f32 v42, v42, v8
    v_add_f32 v43, v43, v9
    v_lshlrev_b32 v44, 16, v86
    v_and_b32 v45, 0xffff0000, v86
    v_lshlrev_b32 v8, 16, v94
    v_and_b32 v9, 0xffff0000, v94
    v_add_f32 v44, v44, v8
    v_add_f32 v45, v45, v9
    v_lshlrev_b32 v46, 16, v87
    v_and_b32 v47, 0xffff0000, v87
    v_lshlrev_b32 v8, 16, v95
    v_and_b32 v9, 0xffff0000, v95
    v_add_f32 v46, v46, v8
    v_add_f32 v47, v47, v9
    s_mul_i32 s42, s53, 40960
    s_add_u32 s42, s42, 93847552
PV_poll_100:
    s_add_u32 s33, s33, 1
    s_cmp_gt_u32 s33, 0x200000
    s_cbranch_scc1 L_bail
    s_lshl_b32 s50, s55, 14
    s_add_u32 s40, s42, s50
    buffer_load_dwordx4 v[96:99], v2, s[8:11], s40 offen offset:0 sc1
    buffer_load_dwordx4 v[100:103], v2, s[8:11], s40 offen offset:1024 sc1
    buffer_load_dwordx4 v[104:107], v2, s[8:11], s40 offen offset:2048 sc1
    buffer_load_dwordx4 v[108:111], v2, s[8:11], s40 offen offset:3072 sc1
    s_add_u32 s40, s40, 4096
    buffer_load_dwordx4 v[112:115], v2, s[8:11], s40 offen offset:0 sc1
    buffer_load_dwordx4 v[116:119], v2, s[8:11], s40 offen offset:1024 sc1
    buffer_load_dwordx4 v[120:123], v2, s[8:11], s40 offen offset:2048 sc1
    buffer_load_dwordx4 v[124:127], v2, s[8:11], s40 offen offset:3072 sc1
    s_add_u32 s40, s40, 4096
    buffer_load_dwordx4 v[128:131], v2, s[8:11], s40 offen offset:0 sc1
    buffer_load_dwordx4 v[132:135], v2, s[8:11], s40 offen offset:1024 sc1
    buffer_load_dwordx4 v[136:139], v2, s[8:11], s40 offen offset:2048 sc1
    buffer_load_dwordx4 v[140:143], v2, s[8:11], s40 offen offset:3072 sc1
    s_add_u32 s40, s40, 4096
    buffer_load_dwordx4 v[144:147], v2, s[8:11], s40 offen offset:0 sc1
    buffer_load_dwordx4 v[148:151], v2, s[8:11], s40 offen offset:1024 sc1
    buffer_load_dwordx4 v[152:155], v2, s[8:11], s40 offen offset:2048 sc1
    buffer_load_dwordx4 v[156:159], v2, s[8:11], s40 offen offset:3072 sc1
    s_lshl_b32 s50, s55, 12
    s_add_u32 s40, s42, s50
    s_add_u32 s40, s40, 32768
    buffer_load_dwordx4 v[160:163], v2, s[8:11], s40 offen offset:0 sc1
    buffer_load_dwordx4 v[164:167], v2, s[8:11], s40 offen offset:1024 sc1
    buffer_load_dwordx4 v[168:171], v2, s[8:11], s40 offen offset:2048 sc1
    buffer_load_dwordx4 v[172:175], v2, s[8:11], s40 offen offset:3072 sc1
    buffer_load_dwordx4 v[48:51], v6, s[8:11], s41 offen offset:0 sc1
    buffer_load_dwordx4 v[52:55], v6, s[8:11], s41 offen offset:512 sc1
    buffer_load_dwordx4 v[56:59], v6, s[8:11], s41 offen offset:2048 sc1
    buffer_load_dwordx4 v[60:63], v6, s[8:11], s41 offen offset:2560 sc1
    v_mov_b32 v8, 0
    s_waitcnt vmcnt(23)
    v_max3_u32 v8, v8, v96, v97
    v_max3_u32 v8, v8, v98, v99
    s_waitcnt vmcnt(22)
    v_max3_u32 v8, v8, v100, v101
    v_max3_u32 v8, v8, v102, v103
    s_waitcnt vmcnt(21)
    v_max3_u32 v8, v8, v104, v105
    v_max3_u32 v8, v8, v106, v107
    s_waitcnt vmcnt(20)
    v_max3_u32 v8, v8, v108, v109
    v_max3_u32 v8, v8, v110, v111
    s_waitcnt vmcnt(19)
    v_max3_u32 v8, v8, v112, v113
    v_max3_u32 v8, v8, v114, v115
    s_waitcnt vmcnt(18)
    v_max3_u32 v8, v8, v116, v117
    v_max3_u32 v8, v8, v118, v119
    s_waitcnt vmcnt(17)
    v_max3_u32 v8, v8, v120, v121
    v_max3_u32 v8, v8, v122, v123
    s_waitcnt vmcnt(16)
    v_max3_u32 v8, v8, v124, v125
    v_max3_u32 v8, v8, v126, v127
    s_waitcnt vmcnt(15)
    v_max3_u32 v8, v8, v128, v129
    v_max3_u32 v8, v8, v130, v131
    s_waitcnt vmcnt(14)
    v_max3_u32 v8, v8, v132, v133
    v_max3_u32 v8, v8, v134, v135
    s_waitcnt vmcnt(13)
    v_max3_u32 v8, v8, v136, v137
    v_max3_u32 v8, v8, v138, v139
    s_waitcnt vmcnt(12)
    v_max3_u32 v8, v8, v140, v141
    v_max3_u32 v8, v8, v142, v143
    s_waitcnt vmcnt(11)
    v_max3_u32 v8, v8, v144, v145
    v_max3_u32 v8, v8, v146, v147
    s_waitcnt vmcnt(10)
    v_max3_u32 v8, v8, v148, v149
    v_max3_u32 v8, v8, v150, v151
    s_waitcnt vmcnt(9)
    v_max3_u32 v8, v8, v152, v153
    v_max3_u32 v8, v8, v154, v155
    s_waitcnt vmcnt(8)
    v_max3_u32 v8, v8, v156, v157
    v_max3_u32 v8, v8, v158, v159
    s_waitcnt vmcnt(7)
    v_max3_u32 v8, v8, v160, v161
    v_max3_u32 v8, v8, v162, v163
    s_waitcnt vmcnt(6)
    v_max3_u32 v8, v8, v164, v165
    v_max3_u32 v8, v8, v166, v167
    s_waitcnt vmcnt(5)
    v_max3_u32 v8, v8, v168, v169
    v_max3_u32 v8, v8, v170, v171
    s_waitcnt vmcnt(4)
    v_max3_u32 v8, v8, v172, v173
    v_max3_u32 v8, v8, v174, v175
    s_waitcnt vmcnt(0)
    s_cmp_lt_u32 s53, 62
    s_cbranch_scc1 PV_ny_102
    v_max3_u32 v8, v8, v48, v49
    v_max3_u32 v8, v8, v50, v51
    v_max3_u32 v8, v8, v52, v53
    v_max3_u32 v8, v8, v54, v55
    v_max3_u32 v8, v8, v56, v57
    v_max3_u32 v8, v8, v58, v59
    v_max3_u32 v8, v8, v60, v61
    v_max3_u32 v8, v8, v62, v63
PV_ny_102:
    v_cmp_eq_u32 vcc, -1, v8
    s_cbranch_vccz PV_ok_101
    s_sleep 2
    s_branch PV_poll_100
PV_ok_101:
    v_mfma_f32_32x32x16_bf16 v[32:47], a[0:3], v[96:99], v[32:47]
    v_mfma_f32_32x32x16_bf16 v[32:47], a[4:7], v[100:103], v[32:47]
    v_mfma_f32_32x32x16_bf16 v[32:47], a[8:11], v[104:107], v[32:47]
    v_mfma_f32_32x32x16_bf16 v[32:47], a[12:15], v[108:111], v[32:47]
    v_mfma_f32_32x32x16_bf16 v[32:47], a[16:19], v[112:115], v[32:47]
    v_mfma_f32_32x32x16_bf16 v[32:47], a[20:23], v[116:119], v[32:47]
    v_mfma_f32_32x32x16_bf16 v[32:47], a[24:27], v[120:123], v[32:47]
    v_mfma_f32_32x32x16_bf16 v[32:47], a[28:31], v[124:127], v[32:47]
    v_mfma_f32_32x32x16_bf16 v[32:47], a[32:35], v[128:131], v[32:47]
    v_mfma_f32_32x32x16_bf16 v[32:47], a[36:39], v[132:135], v[32:47]
    v_mfma_f32_32x32x16_bf16 v[32:47], a[40:43], v[136:139], v[32:47]
    v_mfma_f32_32x32x16_bf16 v[32:47], a[44:47], v[140:143], v[32:47]
    v_mfma_f32_32x32x16_bf16 v[32:47], a[48:51], v[144:147], v[32:47]
    v_mfma_f32_32x32x16_bf16 v[32:47], a[52:55], v[148:151], v[32:47]
    v_mfma_f32_32x32x16_bf16 v[32:47], a[56:59], v[152:155], v[32:47]
    v_mfma_f32_32x32x16_bf16 v[32:47], a[60:63], v[156:159], v[32:47]
    v_mfma_f32_32x32x16_bf16 v[32:47], v[48:51], v[160:163], v[32:47]
    v_mfma_f32_32x32x16_bf16 v[32:47], v[52:55], v[164:167], v[32:47]
    v_mfma_f32_32x32x16_bf16 v[32:47], v[56:59], v[168:171], v[32:47]
    v_mfma_f32_32x32x16_bf16 v[32:47], v[60:63], v[172:175], v[32:47]
    s_and_b32 s50, s13, 1
    s_lshl_b32 s50, s50, 12
    v_add_u32 v8, s50, v2
    s_cmp_eq_u32 s55, 0
    s_cbranch_scc1 PV_lo_103
    s_nop 6
    ds_write_b128 v8, v[32:35] offset:0
    ds_write_b128 v8, v[36:39] offset:1024
    ds_write_b128 v8, v[40:43] offset:2048
    ds_write_b128 v8, v[44:47] offset:3072
    s_waitcnt lgkmcnt(0)
    s_barrier
    s_branch PV_done_104
PV_lo_103:
    s_barrier
    ds_read_b128 v[64:67], v8 offset:0
    ds_read_b128 v[68:71], v8 offset:1024
    ds_read_b128 v[72:75], v8 offset:2048
    ds_read_b128 v[76:79], v8 offset:3072
    s_nop 7
    s_waitcnt lgkmcnt(3)
    v_pk_add_f32 v[32:33], v[32:33], v[64:65]
    v_pk_add_f32 v[34:35], v[34:35], v[66:67]
    s_waitcnt lgkmcnt(2)
    v_pk_add_f32 v[36:37], v[36:37], v[68:69]
    v_pk_add_f32 v[38:39], v[38:39], v[70:71]
    s_waitcnt lgkmcnt(1)
    v_pk_add_f32 v[40:41], v[40:41], v[72:73]
    v_pk_add_f32 v[42:43], v[42:43], v[74:75]
    s_waitcnt lgkmcnt(0)
    v_pk_add_f32 v[44:45], v[44:45], v[76:77]
    v_pk_add_f32 v[46:47], v[46:47], v[78:79]
    v_cvt_pk_bf16_f32 v64, v32, v33
    v_cvt_pk_bf16_f32 v65, v34, v35
    v_cvt_pk_bf16_f32 v66, v36, v37
    v_cvt_pk_bf16_f32 v67, v38, v39
    v_cvt_pk_bf16_f32 v68, v40, v41
    v_cvt_pk_bf16_f32 v69, v42, v43
    v_cvt_pk_bf16_f32 v70, v44, v45
    v_cvt_pk_bf16_f32 v71, v46, v47
    buffer_store_dwordx4 v[64:67], v7, s[60:63], s44 offen offset:0
    buffer_store_dwordx4 v[68:71], v7, s[60:63], s44 offen offset:32
PV_done_104:
W_nf:
    s_cmp_lg_u32 s13, 0
    s_cbranch_scc1 W_e2
    s_mov_b64 exec, 1
    ds_write_b32 v28, v30
    s_mov_b64 exec, -1
    s_waitcnt lgkmcnt(0)
    s_barrier
    s_branch W_next
W_end:
    s_cmp_lg_u32 s13, 0
    s_cbranch_scc1 W_e1
    v_readfirstlane_b32 s38, v29
    v_mov_b32 v30, -1
    s_cmp_lt_u32 s38, 32
    s_cbranch_scc1 W_e1
    s_mov_b64 exec, 1
    s_lshl_b32 s38, s75, 2
    v_mov_b32 v26, s38
    v_mov_b32 v30, 1
    global_atomic_add v30, v26, v30, s[4:5] offset:128 sc0
    s_mov_b64 exec, -1
    global_load_dword v29, v31, s[4:5] sc1
W_e1:
    s_waitcnt vmcnt(0)
    s_cmp_lg_u32 s13, 0
    s_cbranch_scc1 W_e2
    s_mov_b64 exec, 1
    ds_write_b32 v28, v30
    s_waitcnt lgkmcnt(0)
    s_barrier
    s_lshl_b32 s38, s69, 3
    s_add_u32 s38, s38, 117440512
    v_mov_b32 v24, s96
    v_mov_b32 v25, s97
    buffer_store_dwordx2 v[24:25], v31, s[8:11], s38 offen sc1
    s_mov_b64 exec, -1
    s_branch W_next
W_e2:
    s_barrier
    s_branch W_next
W_claim:
    s_barrier
    s_branch CLAIM
CODE_END:
.section .rodata,"a"
.p2align 6
.amdhsa_kernel parallel_sum__memory_aug_recurrent_mem_tr__glu_gated_bilinear__prompt_kernel
  .amdhsa_next_free_vgpr 512
  .amdhsa_next_free_sgpr 102
  .amdhsa_accum_offset 256
  .amdhsa_group_segment_fixed_size 0
  .amdhsa_kernarg_size 112
  .amdhsa_user_sgpr_count 2
  .amdhsa_user_sgpr_kernarg_segment_ptr 1
  .amdhsa_system_sgpr_workgroup_id_x 1
.end_amdhsa_kernel
```
